```python
import torch

def _softmax(x, axis=-1):
    return torch.softmax(x, dim=axis)
def _gelu(x):
    return torch.nn.functional.gelu(x, approximate="tanh")
def _silu(x):
    return torch.nn.functional.silu(x)
def _sigmoid(x):
    return torch.sigmoid(x)
def _layernorm(x, axis=-1, eps=1e-5):
    m = x.mean(dim=axis, keepdim=True)
    v = x.var(dim=axis, keepdim=True, unbiased=False)
    return (x - m) / torch.sqrt(v + eps)
def _scatter_add(tgt, idx, src, axis=0):
    return tgt.clone().index_add_(axis, idx, src)
def _segment_sum(src, seg, n):
    out = torch.zeros((n,) + src.shape[1:], dtype=src.dtype)
    return out.index_add_(0, seg, src)
def _pad(x, pw):
    flat = tuple(v for pair in reversed(pw) for v in pair)
    return torch.nn.functional.pad(x, flat)

kernel_name = 'gated_mix__mha_block__glu_gated_bilinear__prompt'

def setup_inputs():

    _w = (lambda a: (lambda t: t.to(torch.bfloat16) if t.is_floating_point() else t)(torch.as_tensor(a)))
    def _A_setup():
        B, S, D, H = 1, 2048, 640, 32
        return {
            "x": _w((lambda *s: torch.randn(*s, dtype=torch.bfloat16) * 0.05)(B, S, D)),
            "wqkv": _w((lambda *s: torch.randn(*s, dtype=torch.bfloat16) * 0.8)(D, 3 * D)),
            "wo": _w((lambda *s: torch.randn(*s, dtype=torch.bfloat16) * 0.05)(D, D)),
        }
    _A_in = _A_setup()

    def _B_setup():
        B, S, D, F = 1, 2048, 640, 1728
        return {
            "x": _w((lambda *s: torch.randn(*s, dtype=torch.bfloat16) * 0.05)(B, S, D)),
            "w_gate": _w((lambda *s: torch.randn(*s, dtype=torch.bfloat16) * 1.6)(D, F) * (D ** -0.5)),
            "w_up": _w((lambda *s: torch.randn(*s, dtype=torch.bfloat16) * 1.6)(D, F) * (D ** -0.5)),
            "w_down": _w((lambda *s: torch.randn(*s, dtype=torch.bfloat16) * 1.6)(F, D) * (F ** -0.5)),
        }
    _B_in = _B_setup()

    return {
        "A_x": _A_in["x"],
        "A_wqkv": _A_in["wqkv"],
        "A_wo": _A_in["wo"],
        "B_x": _B_in["x"],
        "B_w_gate": _B_in["w_gate"],
        "B_w_up": _B_in["w_up"],
        "B_w_down": _B_in["w_down"],
        "gate_w": _w((lambda *s: torch.randn(*s, dtype=torch.bfloat16) * 0.05)(640) * 16.0),
    }

def reference(A_x, A_wqkv, A_wo, B_x, B_w_gate, B_w_up, B_w_down, gate_w):
    def _A_ref(x, wqkv, wo):
        B, S, D = x.shape
        H = 32
        Dh = D // H
        qkv = (lambda x, *d: x.permute(*d))((x @ wqkv).reshape(B, S, 3, H, Dh), 2, 0, 3, 1, 4)
        q, k, v = qkv[0], qkv[1], qkv[2]
        scores = torch.einsum("bhqd,bhkd->bhqk", q, k) * (Dh ** -0.5)
        p = _softmax(scores, axis=-1)
        o = torch.einsum("bhqk,bhkd->bhqd", p, v)
        return (lambda x, *d: x.permute(*d))(o, 0, 2, 1, 3).reshape(B, S, D) @ wo

    def _B_ref(x, w_gate, w_up, w_down):
        g = torch.einsum("bsd,df->bsf", x, w_gate)
        u = torch.einsum("bsd,df->bsf", x, w_up)
        h = g * u
        return torch.einsum("bsf,fd->bsd", h, w_down)

    x = A_x
    g = _sigmoid((x * gate_w).sum(-1, keepdims=True))
    a = _A_ref(x, A_wqkv, A_wo)
    b = _B_ref(x, B_w_gate, B_w_up, B_w_down)
    return g * a + (1 - g) * b
```

```asm
; @launch grid=(256,1,1) block=(512,1,1) lds=163840
.amdgcn_target "amdgcn-amd-amdhsa--gfx950"
.text
.globl gated_mix__mha_block__glu_gated_bilinear__prompt_kernel
.p2align 8
.type gated_mix__mha_block__glu_gated_bilinear__prompt_kernel,@function
gated_mix__mha_block__glu_gated_bilinear__prompt_kernel:
    s_cmp_ge_u32 s2, 256
    s_cbranch_scc1 L_end
    s_load_dwordx16 s[40:55], s[0:1], 0
    s_load_dwordx4 s[56:59], s[0:1], 64
    s_load_dwordx2 s[60:61], s[0:1], 80
    v_lshrrev_b32 v1, 6, v0
    v_and_b32 v0, 63, v0
    v_readfirstlane_b32 s36, v1
    s_and_b32 s65, s2, 7
    s_lshr_b32 s66, s2, 3
    s_and_b32 s37, s36, 3
    s_lshr_b32 s38, s36, 2
    s_and_b32 s68, s65, 1
    s_lshl_b32 s68, s68, 3
    s_and_b32 s81, s66, 7
    s_add_u32 s39, s68, s81
    s_lshr_b32 s63, s66, 3
    s_lshr_b32 s67, s65, 1
    s_lshl_b32 s62, s67, 2
    s_add_u32 s62, s62, s63
    s_mul_i32 s64, s67, 3
    s_add_u32 s64, s64, s63
    s_lshl_b32 s80, s65, 2
    s_add_u32 s80, s80, s63
    s_lshl_b32 s3, s66, 3
    s_add_u32 s3, s3, s36
    s_lshl_b32 s68, s39, 7
    s_lshl_b32 s69, s36, 4
    s_add_u32 s68, s68, s69
    v_lshrrev_b32 v1, 3, v0
    v_add_u32 v1, s68, v1
    v_mul_u32_u24 v1, 1280, v1
    v_lshrrev_b32 v2, 4, v0
    v_and_b32 v3, 7, v0
    v_xor_b32 v2, v2, v3
    v_lshl_add_u32 v8, v2, 4, v1
    v_xor_b32 v9, 64, v8
    v_add_u32 v9, 9216, v9
    s_lshl_b32 s76, s36, 11
    s_add_u32 s76, s76, 98304
    s_mul_i32 s68, s81, 5
    s_lshr_b32 s68, s68, 2
    s_mul_i32 s69, s63, 4
    s_lshr_b32 s69, s69, 2
    s_add_u32 s88, s68, s69
    s_cmp_ge_u32 s88, 10
    s_cselect_b32 s68, 10, 0
    s_sub_u32 s88, s88, s68
    s_lshl_b32 s73, s88, 7
    s_cmp_eq_u32 s38, 0
    s_waitcnt lgkmcnt(0)
    s_cselect_b32 s12, s48, s50
    s_cselect_b32 s13, s49, s51
    s_mov_b32 s14, 2211840
    s_mov_b32 s15, 0x20000
    s_mov_b32 s4, s40
    s_mov_b32 s5, s41
    s_mov_b32 s6, 2621440
    s_mov_b32 s7, 0x20000
    s_cmp_eq_u32 s63, 3
    s_cselect_b32 s8, s12, s42
    s_cselect_b32 s9, s13, s43
    s_mov_b32 s72, 2457600
    s_cselect_b32 s10, 2211840, s72
    s_mov_b32 s11, 0x20000
    s_mov_b32 s96, s44
    s_mov_b32 s97, s45
    s_add_u32 m0, s76, 0
    s_nop 0
    buffer_load_dwordx4 v8, s[4:7], s73 offen  lds
    buffer_load_dwordx4 v9, s[4:7], s73 offen offset:1024  lds
    s_add_u32 s73, s73, 128
    s_cmp_eq_u32 s88, 9
    s_cmov_b32 s73, 0
    s_lshl_b32 s68, s37, 1
    s_mul_i32 s69, s37, 3
    s_add_u32 s69, s69, 8
    s_cmp_eq_u32 s63, 3
    s_cselect_b32 s99, 0, s38
    s_cmp_eq_u32 s99, 0
    s_cselect_b32 s68, s68, s69
    s_lshl_b32 s77, s68, 10
    s_lshl_b32 s68, s68, 6
    s_lshl_b32 s69, s36, 11
    s_mul_i32 s90, s64, 320
    s_lshl_b32 s70, s67, 7
    s_add_u32 s70, s70, 3072
    s_cmp_eq_u32 s67, 3
    s_cselect_b32 s70, 1073741824, s70
    s_cmp_eq_u32 s63, 3
    s_cselect_b32 s77, s69, s77
    s_cselect_b32 s90, s70, s90
    s_movk_i32 s69, 3277
    s_cselect_b32 s69, 8192, s69
    s_cselect_b32 s70, 8, 20
    s_movk_i32 s71, 3840
    s_cselect_b32 s71, 3456, s71
    s_cselect_b32 s72, 4, 0
    s_cselect_b32 s89, 2, 1
    s_lshl_b32 s79, s71, 6
    s_mul_i32 s74, s88, s79
    s_add_u32 s74, s74, s90
    v_add_u32 v1, s68, v0
    v_mul_u32_u24 v2, s69, v1
    v_lshrrev_b32 v2, 16, v2
    v_mul_u32_u24 v3, s70, v2
    v_sub_u32 v1, v1, v3
    v_bfe_u32 v3, v2, 1, 1
    v_mul_u32_u24 v3, s72, v3
    v_xor_b32 v1, v1, v3
    v_bfe_u32 v3, v2, 3, 1
    v_mul_u32_u24 v3, s89, v3
    v_xor_b32 v1, v1, v3
    v_mul_u32_u24 v2, s71, v2
    v_lshl_add_u32 v10, v1, 4, v2
    s_add_u32 s68, s68, 64
    v_add_u32 v1, s68, v0
    v_mul_u32_u24 v2, s69, v1
    v_lshrrev_b32 v2, 16, v2
    v_mul_u32_u24 v3, s70, v2
    v_sub_u32 v1, v1, v3
    v_bfe_u32 v3, v2, 1, 1
    v_mul_u32_u24 v3, s72, v3
    v_xor_b32 v1, v1, v3
    v_bfe_u32 v3, v2, 3, 1
    v_mul_u32_u24 v3, s89, v3
    v_xor_b32 v1, v1, v3
    v_mul_u32_u24 v2, s71, v2
    v_lshl_add_u32 v11, v1, 4, v2
    v_subrev_u32 v11, 1024, v11
    s_add_u32 s68, s68, 64
    v_add_u32 v1, s68, v0
    v_mul_u32_u24 v2, s69, v1
    v_lshrrev_b32 v2, 16, v2
    v_mul_u32_u24 v3, s70, v2
    v_sub_u32 v1, v1, v3
    v_bfe_u32 v3, v2, 1, 1
    v_mul_u32_u24 v3, s72, v3
    v_xor_b32 v1, v1, v3
    v_bfe_u32 v3, v2, 3, 1
    v_mul_u32_u24 v3, s89, v3
    v_xor_b32 v1, v1, v3
    v_mul_u32_u24 v2, s71, v2
    v_lshl_add_u32 v12, v1, 4, v2
    v_subrev_u32 v12, 2048, v12
    s_add_u32 m0, s77, 0
    s_nop 0
    buffer_load_dwordx4 v10, s[8:11], s74 offen  lds
    buffer_load_dwordx4 v11, s[8:11], s74 offen offset:1024  lds
    s_cmp_eq_u32 s99, 0
    s_cbranch_scc1 L_no3_0
    buffer_load_dwordx4 v12, s[8:11], s74 offen offset:2048  lds
L_no3_0:
    s_add_u32 s74, s74, s79
    s_cmp_eq_u32 s88, 9
    s_cmov_b32 s74, s90
    s_mul_i32 s68, s63, 4
    s_lshr_b32 s68, s68, 2
    s_sub_u32 s69, s88, s68
    s_add_u32 s68, s68, 4
    s_mul_i32 s70, s68, 52
    s_lshr_b32 s70, s70, 8
    s_mul_i32 s70, s70, 5
    s_sub_u32 s98, s68, s70
    s_lshr_b32 s71, s79, 6
    s_lshl_b32 s68, s37, 1
    s_cmp_eq_u32 s63, 3
    s_cselect_b32 s68, s68, s36
    s_cselect_b32 s72, s71, 0
    s_lshl_b32 s69, s81, 3
    s_add_u32 s68, s68, s69
    s_lshl_b32 s69, s98, 6
    s_add_u32 s68, s68, s69
    s_mul_i32 s68, s68, s71
    s_and_b32 s69, s90, 0xffffff80
    s_add_u32 s68, s68, s69
    s_mul_i32 s69, s79, 5
    v_and_b32 v1, 3, v0
    v_lshlrev_b32 v1, 7, v1
    v_bfe_u32 v2, v0, 2, 1
    v_mul_lo_u32 v2, v2, s69
    v_bfe_u32 v3, v0, 3, 1
    v_mul_u32_u24 v3, s72, v3
    v_add3_u32 v28, v1, v2, v3
    s_mov_b32 s89, s68
    s_lshl_b32 s68, s37, 1
    s_lshl_b32 s69, s81, 3
    s_add_u32 s68, s68, s69
    s_lshl_b32 s69, s98, 6
    s_add_u32 s68, s68, s69
    s_mul_i32 s68, s68, 3456
    s_mul_i32 s69, s62, 192
    s_and_b32 s69, s69, 0xffffff80
    s_add_u32 s85, s68, s69
    v_and_b32 v1, 1, v0
    v_lshlrev_b32 v1, 7, v1
    v_bfe_u32 v2, v0, 1, 1
    v_mul_u32_u24 v2, 1105920, v2
    v_bfe_u32 v3, v0, 2, 1
    v_mul_u32_u24 v3, 3456, v3
    v_add3_u32 v7, v1, v2, v3
    s_getpc_b64 s[28:29]
L_pc:
    s_sub_u32 s28, s28, L_pc-gated_mix__mha_block__glu_gated_bilinear__prompt_kernel
    s_subb_u32 s29, s29, 0
    s_mul_i32 s30, s3, 384
    s_min_u32 s30, s30, 74880
    s_add_u32 s28, s28, s30
    s_addc_u32 s29, s29, 0
    v_lshrrev_b32 v1, 4, v0
    v_min_u32 v1, 2, v1
    v_lshlrev_b32 v1, 7, v1
    v_mov_b32 v31, s29
    v_add_co_u32 v30, vcc, s28, v1
    s_nop 1
    v_addc_co_u32 v31, vcc, 0, v31, vcc
    s_add_u32 m0, s76, 16384
    s_nop 0
    buffer_load_dwordx4 v8, s[4:7], s73 offen  lds
    buffer_load_dwordx4 v9, s[4:7], s73 offen offset:1024  lds
    s_add_u32 s73, s73, 128
    s_cmp_eq_u32 s88, 8
    s_cmov_b32 s73, 0
    s_add_u32 m0, s77, 24576
    s_nop 0
    buffer_load_dwordx4 v10, s[8:11], s74 offen  lds
    buffer_load_dwordx4 v11, s[8:11], s74 offen offset:1024  lds
    s_cmp_eq_u32 s99, 0
    s_cbranch_scc1 L_no3_1
    buffer_load_dwordx4 v12, s[8:11], s74 offen offset:2048  lds
L_no3_1:
    s_add_u32 s74, s74, s79
    s_cmp_eq_u32 s88, 8
    s_cmov_b32 s74, s90
    s_mov_b32 s32, s54
    s_mov_b32 s33, s55
    s_mov_b32 s34, 1280
    s_mov_b32 s35, 0x20000
    s_mov_b32 s16, s60
    s_mov_b32 s17, s61
    s_mov_b32 s18, 22020096
    s_mov_b32 s19, 0x20000
    s_mov_b32 s28, s58
    s_mov_b32 s29, s59
    s_mov_b32 s30, 256
    s_mov_b32 s31, 0x20000
    s_mov_b32 s24, s56
    s_mov_b32 s25, s57
    s_mov_b32 s26, 2621440
    s_mov_b32 s27, 0x20000
    s_lshl_b32 s69, s2, 7
    s_cmp_eq_u32 s36, 0
    s_cselect_b32 s69, s69, 1073741824
    v_mov_b32 v32, 1073741824
    v_writelane_b32 v32, s69, 0
    v_mov_b32 v33, 0
    s_mul_i32 s68, s2, 4
    s_add_u32 s68, s68, s36
    s_mul_i32 s68, s68, 52429
    s_lshr_b32 s68, s68, 19
    s_cmp_ge_u32 s68, 37
    s_cselect_b32 s94, 2, 0
    s_cselect_b32 s69, 37, 0
    s_sub_u32 s95, s68, s69
    s_cmp_ge_u32 s95, 19
    s_cselect_b32 s69, 19, 0
    s_addc_u32 s94, s94, 0
    s_sub_u32 s95, s95, s69
    s_cmp_eq_u32 s69, 0
    s_cselect_b32 s69, 64, 13
    s_cmp_ge_u32 s95, s69
    s_addc_u32 s95, s95, 0
    s_cmp_lt_u32 s68, 74
    s_cselect_b32 s94, s94, 64
    s_cmp_lt_u32 s36, 4
    s_cselect_b32 s94, s94, 64
    s_cmp_lt_u32 s95, 14
    s_cselect_b32 s20, s52, s96
    s_cselect_b32 s21, s53, s97
    s_mov_b32 s72, 819200
    s_cselect_b32 s22, 2211840, s72
    s_mov_b32 s23, 0x20000
    v_and_b32 v1, 15, v0
    v_lshrrev_b32 v2, 4, v0
    v_bfe_u32 v3, v0, 1, 3
    v_xor_b32 v3, v3, v2
    s_lshl_b32 s68, s37, 12
    s_add_u32 s68, s68, 98304
    v_lshl_add_u32 v1, v1, 7, s68
    v_xor_b32 v2, 0, v3
    v_lshl_add_u32 v4, v2, 4, v1
    v_xor_b32 v2, 4, v3
    v_lshl_add_u32 v5, v2, 4, v1
    s_mul_i32 s68, s37, 192
    v_add_u32 v1, s68, v0
    v_mul_u32_u24 v2, 5462, v1
    v_lshrrev_b32 v2, 16, v2
    v_mul_u32_u24 v3, 12, v2
    v_sub_u32 v1, v1, v3
    v_bfe_u32 v3, v2, 3, 1
    v_lshlrev_b32 v3, 1, v3
    v_xor_b32 v1, v1, v3
    v_mul_u32_u24 v2, 3456, v2
    v_lshl_add_u32 v13, v1, 4, v2
    s_add_u32 s68, s68, 64
    v_add_u32 v1, s68, v0
    v_mul_u32_u24 v2, 5462, v1
    v_lshrrev_b32 v2, 16, v2
    v_mul_u32_u24 v3, 12, v2
    v_sub_u32 v1, v1, v3
    v_bfe_u32 v3, v2, 3, 1
    v_lshlrev_b32 v3, 1, v3
    v_xor_b32 v1, v1, v3
    v_mul_u32_u24 v2, 3456, v2
    v_lshl_add_u32 v14, v1, 4, v2
    v_subrev_u32 v14, 1024, v14
    s_add_u32 s68, s68, 64
    v_add_u32 v1, s68, v0
    v_mul_u32_u24 v2, 5462, v1
    v_lshrrev_b32 v2, 16, v2
    v_mul_u32_u24 v3, 12, v2
    v_sub_u32 v1, v1, v3
    v_bfe_u32 v3, v2, 3, 1
    v_lshlrev_b32 v3, 1, v3
    v_xor_b32 v1, v1, v3
    v_mul_u32_u24 v2, 3456, v2
    v_lshl_add_u32 v15, v1, 4, v2
    v_subrev_u32 v15, 2048, v15
    s_mul_i32 s78, s38, 12288
    s_mul_i32 s68, s37, 3072
    s_add_u32 s78, s78, s68
    s_mul_i32 s93, s62, 192
    s_mul_i32 s75, s88, 221184
    s_add_u32 s75, s75, s93
    v_lshrrev_b32 v1, 4, v0
    v_bfe_u32 v2, v0, 2, 2
    v_lshl_add_u32 v1, v1, 3, v2
    v_mul_u32_u24 v1, 192, v1
    v_and_b32 v2, 3, v0
    v_lshl_add_u32 v1, v2, 3, v1
    v_add_u32 v1, 49152, v1
    v_bfe_u32 v3, v0, 4, 1
    s_mul_i32 s68, s38, 3
    v_xor_b32 v2, s68, v3
    v_lshl_add_u32 v18, v2, 5, v1
    s_add_u32 s68, s68, 1
    v_xor_b32 v2, s68, v3
    v_lshl_add_u32 v19, v2, 5, v1
    s_add_u32 s68, s68, 1
    v_xor_b32 v2, s68, v3
    v_lshl_add_u32 v20, v2, 5, v1
    v_lshrrev_b32 v1, 4, v0
    v_bfe_u32 v2, v0, 2, 2
    v_lshl_add_u32 v21, v1, 3, v2
    v_bfe_u32 v22, v0, 4, 1
    v_and_b32 v23, 3, v0
    s_cmp_eq_u32 s63, 3
    s_cbranch_scc1 L_selE
    s_cmp_ge_u32 s64, 8
    s_cbranch_scc1 L_selS
    s_cmp_eq_u32 s38, 0
    s_cbranch_scc1 L_N0
    s_branch L_N1
L_selS:
    s_cmp_eq_u32 s38, 0
    s_cbranch_scc1 L_S0
    s_branch L_S1
L_selE:
    s_cmp_lg_u32 s67, 3
    s_cbranch_scc1 L_E0
    s_branch L_E1
L_N0:
    v_mul_u32_u24 v1, 320, v21
    v_and_b32 v2, 1, v23
    v_lshrrev_b32 v3, 1, v23
    v_lshlrev_b32 v25, 5, v3
    v_lshl_add_u32 v25, v2, 3, v25
    v_add_u32 v25, 8, v25
    v_lshlrev_b32 v22, 4, v22
    v_xor_b32 v26, v25, v22
    v_add_u32 v16, v1, v26
    v_add_u32 v25, 16, v25
    v_xor_b32 v26, v25, v22
    v_subrev_u32 v26, 16, v26
    v_add_u32 v17, v1, v26
    v_mul_u32_u24 v2, 72, v2
    v_mul_u32_u24 v3, 160, v3
    v_add3_u32 v2, v2, v3, 0
    v_xor_b32 v2, v2, v22
    v_add_u32 v6, v1, v2
    s_and_b32 s68, s2, 1
    s_lshl_b32 s68, s68, 7
    s_cmp_eq_u32 s36, 0
    s_cselect_b32 s68, s68, 1073741824
    v_mov_b32 v22, 1073741824
    v_writelane_b32 v22, s68, 0
    v_mov_b32 v21, 1
    s_bfe_u32 s91, s2, 0x30003
    s_add_u32 s91, s91, 1
    s_cmp_eq_u32 s36, 0
    s_cselect_b32 s91, s91, 0
    s_lshl_b32 s68, s80, 6
    s_add_u32 s69, s68, s37
    s_mul_i32 s69, s69, 1280
    s_cmp_eq_u32 s38, 0
    s_mov_b32 s82, 5570560
    s_cselect_b32 s82, 2949120, s82
    s_add_u32 s82, s82, s69
    s_mul_i32 s83, s36, 1280
    s_add_u32 s83, s83, 122880
    s_and_b32 s96, s36, 1
    s_lshl_b32 s96, s96, 1
    s_add_u32 s96, s96, s38
    s_lshr_b32 s97, s37, 1
    s_lshl_b32 s68, s81, 2
    s_lshr_b32 s69, s36, 1
    s_add_u32 s68, s68, s69
    s_mul_i32 s68, s68, 19
    s_and_b32 s69, s36, 1
    s_add_u32 s68, s68, s69
    s_mul_i32 s68, s68, 5120
    s_add_u32 s84, s68, 17891328
    s_lshl_b32 s68, s80, 1
    s_add_u32 s68, s68, s97
    s_mul_i32 s68, s68, 108
    s_mul_i32 s69, s96, 14
    s_add_u32 s68, s68, s69
    s_lshr_b32 s69, s96, 1
    s_sub_u32 s68, s68, s69
    s_lshl_b32 s68, s68, 10
    s_add_u32 s68, s68, 10813440
    s_mul_i32 s69, s38, 55296
    s_add_u32 s86, s68, s69
    s_sub_u32 s68, s68, s69
    s_add_u32 s98, s68, 55296
    s_mul_i32 s69, s38, 14336
    s_sub_u32 s69, 13312, s69
    s_add_u32 s92, s86, s69
    s_mov_b64 exec, 0x7777
    buffer_load_dwordx2 v[254:255], v28, s[8:11], s89 offen offset:60
    s_mov_b64 exec, -1
    global_load_dwordx2 v[254:255], v[30:31], off offset:60
    buffer_store_dword v33, v32, s[16:19], 0 offen sc1
    s_waitcnt vmcnt(7)
    s_barrier
    ds_read_b128 v[96:99], v4 offset:0
    ds_read_b128 v[100:103], v4 offset:2048
    ds_read_b128 v[104:107], v5 offset:0
    ds_read_b128 v[108:111], v5 offset:2048
    ds_read_b64_tr_b16 v[24:25], v16 offset:0
    ds_read_b64_tr_b16 v[26:27], v16 offset:1280
    ds_read_b64_tr_b16 v[28:29], v16 offset:10240
    ds_read_b64_tr_b16 v[30:31], v16 offset:11520
    ds_read_b64_tr_b16 v[32:33], v17 offset:16
    ds_read_b64_tr_b16 v[34:35], v17 offset:1296
    ds_read_b64_tr_b16 v[36:37], v17 offset:10256
    ds_read_b64_tr_b16 v[38:39], v17 offset:11536
    ds_read_b64_tr_b16 v[40:41], v17 offset:80
    ds_read_b64_tr_b16 v[42:43], v17 offset:1360
    ds_read_b64_tr_b16 v[44:45], v17 offset:10320
    ds_read_b64_tr_b16 v[46:47], v17 offset:11600
    s_waitcnt lgkmcnt(8)
    v_mfma_f32_16x16x32_bf16 v[48:51], v[24:27], v[96:99], 0
    s_add_u32 m0, s77, 49152
    v_mfma_f32_16x16x32_bf16 v[48:51], v[28:31], v[104:107], v[48:51]
    buffer_load_dwordx4 v10, s[8:11], s74 offen  lds
    v_mfma_f32_16x16x32_bf16 v[52:55], v[24:27], v[100:103], 0
    s_add_u32 m0, s77, 49152
    v_mfma_f32_16x16x32_bf16 v[52:55], v[28:31], v[108:111], v[52:55]
    buffer_load_dwordx4 v11, s[8:11], s74 offen offset:1024  lds
    s_add_u32 s74, s74, s79
    s_cmp_eq_u32 s88, 7
    s_cmov_b32 s74, s90
    s_waitcnt lgkmcnt(4)
    v_mfma_f32_16x16x32_bf16 v[56:59], v[32:35], v[96:99], 0
    ds_read_b64_tr_b16 v[24:25], v16 offset:96
    s_add_u32 m0, s76, 32768
    v_mfma_f32_16x16x32_bf16 v[56:59], v[36:39], v[104:107], v[56:59]
    ds_read_b64_tr_b16 v[26:27], v16 offset:1376
    buffer_load_dwordx4 v8, s[4:7], s73 offen  lds
    s_add_u32 m0, s76, 32768
    s_nop 0
    buffer_load_dwordx4 v9, s[4:7], s73 offen offset:1024  lds
    s_add_u32 s73, s73, 128
    s_cmp_eq_u32 s88, 7
    s_cmov_b32 s73, 0
    v_mfma_f32_16x16x32_bf16 v[60:63], v[32:35], v[100:103], 0
    ds_read_b64_tr_b16 v[28:29], v16 offset:10336
    v_mfma_f32_16x16x32_bf16 v[60:63], v[36:39], v[108:111], v[60:63]
    s_waitcnt vmcnt(7)
    s_barrier
    ds_read_b64_tr_b16 v[30:31], v16 offset:11616
    ds_read_b128 v[112:115], v4 offset:16384
    s_waitcnt lgkmcnt(5)
    v_mfma_f32_16x16x32_bf16 v[64:67], v[40:43], v[96:99], 0
    ds_read_b64_tr_b16 v[32:33], v6 offset:0
    s_add_u32 m0, s77, 73728
    v_mfma_f32_16x16x32_bf16 v[64:67], v[44:47], v[104:107], v[64:67]
    ds_read_b64_tr_b16 v[34:35], v6 offset:1280
    ds_read_b128 v[116:119], v4 offset:18432
    buffer_load_dwordx4 v10, s[8:11], s74 offen  lds
    v_mfma_f32_16x16x32_bf16 v[68:71], v[40:43], v[100:103], 0
    ds_read_b64_tr_b16 v[36:37], v6 offset:10240
    v_mfma_f32_16x16x32_bf16 v[68:71], v[44:47], v[108:111], v[68:71]
    ds_read_b64_tr_b16 v[38:39], v6 offset:11520
    ds_read_b128 v[120:123], v5 offset:16384
    s_waitcnt lgkmcnt(7)
    v_mfma_f32_16x16x32_bf16 v[72:75], v[24:27], v[96:99], 0
    v_add_u32 v16, 24576, v16
    ds_read_b64_tr_b16 v[40:41], v16 offset:0
    s_add_u32 m0, s77, 73728
    v_mfma_f32_16x16x32_bf16 v[72:75], v[28:31], v[104:107], v[72:75]
    ds_read_b64_tr_b16 v[42:43], v16 offset:1280
    ds_read_b128 v[124:127], v5 offset:18432
    buffer_load_dwordx4 v11, s[8:11], s74 offen offset:1024  lds
    s_add_u32 s74, s74, s79
    s_cmp_eq_u32 s88, 6
    s_cmov_b32 s74, s90
    v_mfma_f32_16x16x32_bf16 v[76:79], v[24:27], v[100:103], 0
    ds_read_b64_tr_b16 v[44:45], v16 offset:10240
    v_mfma_f32_16x16x32_bf16 v[76:79], v[28:31], v[108:111], v[76:79]
    ds_read_b64_tr_b16 v[46:47], v16 offset:11520
    s_waitcnt lgkmcnt(6)
    v_mfma_f32_16x16x32_bf16 v[80:83], v[32:35], v[96:99], 0
    v_add_u32 v17, 24576, v17
    ds_read_b64_tr_b16 v[24:25], v17 offset:16
    s_add_u32 m0, s76, 49152
    v_mfma_f32_16x16x32_bf16 v[80:83], v[36:39], v[104:107], v[80:83]
    ds_read_b64_tr_b16 v[26:27], v17 offset:1296
    buffer_load_dwordx4 v8, s[4:7], s73 offen  lds
    v_mfma_f32_16x16x32_bf16 v[84:87], v[32:35], v[100:103], 0
    ds_read_b64_tr_b16 v[28:29], v17 offset:10256
    v_mfma_f32_16x16x32_bf16 v[84:87], v[36:39], v[108:111], v[84:87]
    ds_read_b64_tr_b16 v[30:31], v17 offset:11536
    s_waitcnt lgkmcnt(4)
    v_mfma_f32_16x16x32_bf16 v[48:51], v[40:43], v[112:115], v[48:51]
    ds_read_b64_tr_b16 v[32:33], v17 offset:80
    s_add_u32 m0, s76, 49152
    v_mfma_f32_16x16x32_bf16 v[48:51], v[44:47], v[120:123], v[48:51]
    ds_read_b64_tr_b16 v[34:35], v17 offset:1360
    buffer_load_dwordx4 v9, s[4:7], s73 offen offset:1024  lds
    s_add_u32 s73, s73, 128
    s_cmp_eq_u32 s88, 6
    s_cmov_b32 s73, 0
    v_mfma_f32_16x16x32_bf16 v[52:55], v[40:43], v[116:119], v[52:55]
    ds_read_b64_tr_b16 v[36:37], v17 offset:10320
    v_mfma_f32_16x16x32_bf16 v[52:55], v[44:47], v[124:127], v[52:55]
    ds_read_b64_tr_b16 v[38:39], v17 offset:11600
    s_waitcnt lgkmcnt(4)
    v_mfma_f32_16x16x32_bf16 v[56:59], v[24:27], v[112:115], v[56:59]
    ds_read_b64_tr_b16 v[40:41], v16 offset:96
    v_mfma_f32_16x16x32_bf16 v[56:59], v[28:31], v[120:123], v[56:59]
    ds_read_b64_tr_b16 v[42:43], v16 offset:1376
    v_mfma_f32_16x16x32_bf16 v[60:63], v[24:27], v[116:119], v[60:63]
    ds_read_b64_tr_b16 v[44:45], v16 offset:10336
    v_mfma_f32_16x16x32_bf16 v[60:63], v[28:31], v[124:127], v[60:63]
    s_waitcnt vmcnt(4)
    s_barrier
    s_cmp_eq_u32 s91, 1
    s_cbranch_scc1 L_at_N0_1
L_at_N0_1b:
    ds_read_b64_tr_b16 v[46:47], v16 offset:11616
    ds_read_b128 v[128:131], v4 offset:32768
    s_waitcnt lgkmcnt(5)
    v_mfma_f32_16x16x32_bf16 v[64:67], v[32:35], v[112:115], v[64:67]
    v_add_u32 v6, 24576, v6
    ds_read_b64_tr_b16 v[24:25], v6 offset:0
    s_add_u32 m0, s77, 0
    v_mfma_f32_16x16x32_bf16 v[64:67], v[36:39], v[120:123], v[64:67]
    ds_read_b64_tr_b16 v[26:27], v6 offset:1280
    ds_read_b128 v[132:135], v4 offset:34816
    buffer_load_dwordx4 v10, s[8:11], s74 offen  lds
    v_mfma_f32_16x16x32_bf16 v[68:71], v[32:35], v[116:119], v[68:71]
    ds_read_b64_tr_b16 v[28:29], v6 offset:10240
    v_mfma_f32_16x16x32_bf16 v[68:71], v[36:39], v[124:127], v[68:71]
    ds_read_b64_tr_b16 v[30:31], v6 offset:11520
    ds_read_b128 v[136:139], v5 offset:32768
    s_waitcnt lgkmcnt(7)
    v_mfma_f32_16x16x32_bf16 v[72:75], v[40:43], v[112:115], v[72:75]
    v_add_u32 v16, 24576, v16
    ds_read_b64_tr_b16 v[32:33], v16 offset:0
    s_add_u32 m0, s77, 0
    v_mfma_f32_16x16x32_bf16 v[72:75], v[44:47], v[120:123], v[72:75]
    ds_read_b64_tr_b16 v[34:35], v16 offset:1280
    ds_read_b128 v[140:143], v5 offset:34816
    buffer_load_dwordx4 v11, s[8:11], s74 offen offset:1024  lds
    s_add_u32 s74, s74, s79
    s_cmp_eq_u32 s88, 5
    s_cmov_b32 s74, s90
    v_mfma_f32_16x16x32_bf16 v[76:79], v[40:43], v[116:119], v[76:79]
    ds_read_b64_tr_b16 v[36:37], v16 offset:10240
    v_mfma_f32_16x16x32_bf16 v[76:79], v[44:47], v[124:127], v[76:79]
    ds_read_b64_tr_b16 v[38:39], v16 offset:11520
    s_waitcnt lgkmcnt(6)
    v_mfma_f32_16x16x32_bf16 v[80:83], v[24:27], v[112:115], v[80:83]
    v_add_u32 v17, 24576, v17
    ds_read_b64_tr_b16 v[40:41], v17 offset:16
    s_add_u32 m0, s76, 0
    v_mfma_f32_16x16x32_bf16 v[80:83], v[28:31], v[120:123], v[80:83]
    ds_read_b64_tr_b16 v[42:43], v17 offset:1296
    buffer_load_dwordx4 v8, s[4:7], s73 offen  lds
    v_mfma_f32_16x16x32_bf16 v[84:87], v[24:27], v[116:119], v[84:87]
    ds_read_b64_tr_b16 v[44:45], v17 offset:10256
    v_mfma_f32_16x16x32_bf16 v[84:87], v[28:31], v[124:127], v[84:87]
    ds_read_b64_tr_b16 v[46:47], v17 offset:11536
    s_mov_b64 exec, 0xff
    buffer_load_dword v7, v7, s[12:15], s85 offen
    s_mov_b64 exec, -1
    s_waitcnt lgkmcnt(4)
    v_mfma_f32_16x16x32_bf16 v[48:51], v[32:35], v[128:131], v[48:51]
    ds_read_b64_tr_b16 v[24:25], v17 offset:80
    s_add_u32 m0, s76, 0
    v_mfma_f32_16x16x32_bf16 v[48:51], v[36:39], v[136:139], v[48:51]
    ds_read_b64_tr_b16 v[26:27], v17 offset:1360
    buffer_load_dwordx4 v9, s[4:7], s73 offen offset:1024  lds
    s_add_u32 s73, s73, 128
    s_cmp_eq_u32 s88, 5
    s_cmov_b32 s73, 0
    v_mfma_f32_16x16x32_bf16 v[52:55], v[32:35], v[132:135], v[52:55]
    ds_read_b64_tr_b16 v[28:29], v17 offset:10320
    v_mfma_f32_16x16x32_bf16 v[52:55], v[36:39], v[140:143], v[52:55]
    ds_read_b64_tr_b16 v[30:31], v17 offset:11600
    s_waitcnt lgkmcnt(4)
    v_mfma_f32_16x16x32_bf16 v[56:59], v[40:43], v[128:131], v[56:59]
    ds_read_b64_tr_b16 v[32:33], v16 offset:96
    v_mfma_f32_16x16x32_bf16 v[56:59], v[44:47], v[136:139], v[56:59]
    ds_read_b64_tr_b16 v[34:35], v16 offset:1376
    v_mfma_f32_16x16x32_bf16 v[60:63], v[40:43], v[132:135], v[60:63]
    ds_read_b64_tr_b16 v[36:37], v16 offset:10336
    v_mfma_f32_16x16x32_bf16 v[60:63], v[44:47], v[140:143], v[60:63]
    s_waitcnt vmcnt(5)
    s_barrier
    s_cmp_eq_u32 s91, 2
    s_cbranch_scc1 L_at_N0_2
L_at_N0_2b:
    ds_read_b64_tr_b16 v[38:39], v16 offset:11616
    ds_read_b128 v[144:147], v4 offset:49152
    s_waitcnt lgkmcnt(5)
    v_mfma_f32_16x16x32_bf16 v[64:67], v[24:27], v[128:131], v[64:67]
    v_add_u32 v6, 24576, v6
    ds_read_b64_tr_b16 v[40:41], v6 offset:0
    s_add_u32 m0, s77, 24576
    v_mfma_f32_16x16x32_bf16 v[64:67], v[28:31], v[136:139], v[64:67]
    ds_read_b64_tr_b16 v[42:43], v6 offset:1280
    ds_read_b128 v[148:151], v4 offset:51200
    buffer_load_dwordx4 v10, s[8:11], s74 offen  lds
    v_mfma_f32_16x16x32_bf16 v[68:71], v[24:27], v[132:135], v[68:71]
    ds_read_b64_tr_b16 v[44:45], v6 offset:10240
    v_mfma_f32_16x16x32_bf16 v[68:71], v[28:31], v[140:143], v[68:71]
    ds_read_b64_tr_b16 v[46:47], v6 offset:11520
    ds_read_b128 v[152:155], v5 offset:49152
    s_waitcnt lgkmcnt(7)
    v_mfma_f32_16x16x32_bf16 v[72:75], v[32:35], v[128:131], v[72:75]
    v_add_u32 v16, 24576, v16
    ds_read_b64_tr_b16 v[24:25], v16 offset:0
    s_add_u32 m0, s77, 24576
    v_mfma_f32_16x16x32_bf16 v[72:75], v[36:39], v[136:139], v[72:75]
    ds_read_b64_tr_b16 v[26:27], v16 offset:1280
    ds_read_b128 v[156:159], v5 offset:51200
    buffer_load_dwordx4 v11, s[8:11], s74 offen offset:1024  lds
    s_add_u32 s74, s74, s79
    s_cmp_eq_u32 s88, 4
    s_cmov_b32 s74, s90
    v_mfma_f32_16x16x32_bf16 v[76:79], v[32:35], v[132:135], v[76:79]
    ds_read_b64_tr_b16 v[28:29], v16 offset:10240
    v_mfma_f32_16x16x32_bf16 v[76:79], v[36:39], v[140:143], v[76:79]
    ds_read_b64_tr_b16 v[30:31], v16 offset:11520
    s_waitcnt lgkmcnt(6)
    v_mfma_f32_16x16x32_bf16 v[80:83], v[40:43], v[128:131], v[80:83]
    v_add_u32 v17, 24576, v17
    ds_read_b64_tr_b16 v[32:33], v17 offset:16
    s_add_u32 m0, s76, 16384
    v_mfma_f32_16x16x32_bf16 v[80:83], v[44:47], v[136:139], v[80:83]
    ds_read_b64_tr_b16 v[34:35], v17 offset:1296
    buffer_load_dwordx4 v8, s[4:7], s73 offen  lds
    v_mfma_f32_16x16x32_bf16 v[84:87], v[40:43], v[132:135], v[84:87]
    ds_read_b64_tr_b16 v[36:37], v17 offset:10256
    v_mfma_f32_16x16x32_bf16 v[84:87], v[44:47], v[140:143], v[84:87]
    ds_read_b64_tr_b16 v[38:39], v17 offset:11536
    s_waitcnt lgkmcnt(4)
    v_mfma_f32_16x16x32_bf16 v[48:51], v[24:27], v[144:147], v[48:51]
    ds_read_b64_tr_b16 v[40:41], v17 offset:80
    s_add_u32 m0, s76, 16384
    v_mfma_f32_16x16x32_bf16 v[48:51], v[28:31], v[152:155], v[48:51]
    ds_read_b64_tr_b16 v[42:43], v17 offset:1360
    buffer_load_dwordx4 v9, s[4:7], s73 offen offset:1024  lds
    s_add_u32 s73, s73, 128
    s_cmp_eq_u32 s88, 4
    s_cmov_b32 s73, 0
    v_mfma_f32_16x16x32_bf16 v[52:55], v[24:27], v[148:151], v[52:55]
    ds_read_b64_tr_b16 v[44:45], v17 offset:10320
    v_mfma_f32_16x16x32_bf16 v[52:55], v[28:31], v[156:159], v[52:55]
    ds_read_b64_tr_b16 v[46:47], v17 offset:11600
    s_waitcnt lgkmcnt(4)
    v_mfma_f32_16x16x32_bf16 v[56:59], v[32:35], v[144:147], v[56:59]
    ds_read_b64_tr_b16 v[24:25], v16 offset:96
    v_mfma_f32_16x16x32_bf16 v[56:59], v[36:39], v[152:155], v[56:59]
    ds_read_b64_tr_b16 v[26:27], v16 offset:1376
    v_mfma_f32_16x16x32_bf16 v[60:63], v[32:35], v[148:151], v[60:63]
    ds_read_b64_tr_b16 v[28:29], v16 offset:10336
    v_mfma_f32_16x16x32_bf16 v[60:63], v[36:39], v[156:159], v[60:63]
    s_waitcnt vmcnt(4)
    s_barrier
    s_cmp_eq_u32 s91, 3
    s_cbranch_scc1 L_at_N0_3
L_at_N0_3b:
    ds_read_b64_tr_b16 v[30:31], v16 offset:11616
    ds_read_b128 v[160:163], v4 offset:0
    s_waitcnt lgkmcnt(5)
    v_mfma_f32_16x16x32_bf16 v[64:67], v[40:43], v[144:147], v[64:67]
    v_add_u32 v6, 24576, v6
    ds_read_b64_tr_b16 v[32:33], v6 offset:0
    s_add_u32 m0, s77, 49152
    v_mfma_f32_16x16x32_bf16 v[64:67], v[44:47], v[152:155], v[64:67]
    ds_read_b64_tr_b16 v[34:35], v6 offset:1280
    ds_read_b128 v[164:167], v4 offset:2048
    buffer_load_dwordx4 v10, s[8:11], s74 offen  lds
    v_mfma_f32_16x16x32_bf16 v[68:71], v[40:43], v[148:151], v[68:71]
    ds_read_b64_tr_b16 v[36:37], v6 offset:10240
    v_mfma_f32_16x16x32_bf16 v[68:71], v[44:47], v[156:159], v[68:71]
    ds_read_b64_tr_b16 v[38:39], v6 offset:11520
    ds_read_b128 v[168:171], v5 offset:0
    s_waitcnt lgkmcnt(7)
    v_mfma_f32_16x16x32_bf16 v[72:75], v[24:27], v[144:147], v[72:75]
    v_subrev_u32 v16, 73728, v16
    ds_read_b64_tr_b16 v[40:41], v16 offset:0
    s_add_u32 m0, s77, 49152
    v_mfma_f32_16x16x32_bf16 v[72:75], v[28:31], v[152:155], v[72:75]
    ds_read_b64_tr_b16 v[42:43], v16 offset:1280
    ds_read_b128 v[172:175], v5 offset:2048
    buffer_load_dwordx4 v11, s[8:11], s74 offen offset:1024  lds
    s_add_u32 s74, s74, s79
    s_cmp_eq_u32 s88, 3
    s_cmov_b32 s74, s90
    v_mfma_f32_16x16x32_bf16 v[76:79], v[24:27], v[148:151], v[76:79]
    ds_read_b64_tr_b16 v[44:45], v16 offset:10240
    v_mfma_f32_16x16x32_bf16 v[76:79], v[28:31], v[156:159], v[76:79]
    ds_read_b64_tr_b16 v[46:47], v16 offset:11520
    s_waitcnt lgkmcnt(6)
    v_mfma_f32_16x16x32_bf16 v[80:83], v[32:35], v[144:147], v[80:83]
    v_subrev_u32 v17, 73728, v17
    ds_read_b64_tr_b16 v[24:25], v17 offset:16
    s_add_u32 m0, s76, 32768
    v_mfma_f32_16x16x32_bf16 v[80:83], v[36:39], v[152:155], v[80:83]
    ds_read_b64_tr_b16 v[26:27], v17 offset:1296
    buffer_load_dwordx4 v8, s[4:7], s73 offen  lds
    v_mfma_f32_16x16x32_bf16 v[84:87], v[32:35], v[148:151], v[84:87]
    ds_read_b64_tr_b16 v[28:29], v17 offset:10256
    v_mfma_f32_16x16x32_bf16 v[84:87], v[36:39], v[156:159], v[84:87]
    ds_read_b64_tr_b16 v[30:31], v17 offset:11536
    s_waitcnt lgkmcnt(4)
    v_mfma_f32_16x16x32_bf16 v[48:51], v[40:43], v[160:163], v[48:51]
    ds_read_b64_tr_b16 v[32:33], v17 offset:80
    s_add_u32 m0, s76, 32768
    v_mfma_f32_16x16x32_bf16 v[48:51], v[44:47], v[168:171], v[48:51]
    ds_read_b64_tr_b16 v[34:35], v17 offset:1360
    buffer_load_dwordx4 v9, s[4:7], s73 offen offset:1024  lds
    s_add_u32 s73, s73, 128
    s_cmp_eq_u32 s88, 3
    s_cmov_b32 s73, 0
    v_mfma_f32_16x16x32_bf16 v[52:55], v[40:43], v[164:167], v[52:55]
    ds_read_b64_tr_b16 v[36:37], v17 offset:10320
    v_mfma_f32_16x16x32_bf16 v[52:55], v[44:47], v[172:175], v[52:55]
    ds_read_b64_tr_b16 v[38:39], v17 offset:11600
    s_waitcnt lgkmcnt(4)
    v_mfma_f32_16x16x32_bf16 v[56:59], v[24:27], v[160:163], v[56:59]
    ds_read_b64_tr_b16 v[40:41], v16 offset:96
    v_mfma_f32_16x16x32_bf16 v[56:59], v[28:31], v[168:171], v[56:59]
    ds_read_b64_tr_b16 v[42:43], v16 offset:1376
    v_mfma_f32_16x16x32_bf16 v[60:63], v[24:27], v[164:167], v[60:63]
    ds_read_b64_tr_b16 v[44:45], v16 offset:10336
    v_mfma_f32_16x16x32_bf16 v[60:63], v[28:31], v[172:175], v[60:63]
    s_waitcnt vmcnt(4)
    s_barrier
    s_cmp_eq_u32 s91, 4
    s_cbranch_scc1 L_at_N0_4
L_at_N0_4b:
    ds_read_b64_tr_b16 v[46:47], v16 offset:11616
    ds_read_b128 v[176:179], v4 offset:16384
    s_waitcnt lgkmcnt(5)
    v_mfma_f32_16x16x32_bf16 v[64:67], v[32:35], v[160:163], v[64:67]
    v_subrev_u32 v6, 73728, v6
    ds_read_b64_tr_b16 v[24:25], v6 offset:0
    s_add_u32 m0, s77, 73728
    v_mfma_f32_16x16x32_bf16 v[64:67], v[36:39], v[168:171], v[64:67]
    ds_read_b64_tr_b16 v[26:27], v6 offset:1280
    ds_read_b128 v[180:183], v4 offset:18432
    buffer_load_dwordx4 v10, s[8:11], s74 offen  lds
    v_mfma_f32_16x16x32_bf16 v[68:71], v[32:35], v[164:167], v[68:71]
    ds_read_b64_tr_b16 v[28:29], v6 offset:10240
    v_mfma_f32_16x16x32_bf16 v[68:71], v[36:39], v[172:175], v[68:71]
    ds_read_b64_tr_b16 v[30:31], v6 offset:11520
    ds_read_b128 v[184:187], v5 offset:16384
    s_waitcnt lgkmcnt(7)
    v_mfma_f32_16x16x32_bf16 v[72:75], v[40:43], v[160:163], v[72:75]
    v_add_u32 v16, 24576, v16
    ds_read_b64_tr_b16 v[32:33], v16 offset:0
    s_add_u32 m0, s77, 73728
    v_mfma_f32_16x16x32_bf16 v[72:75], v[44:47], v[168:171], v[72:75]
    ds_read_b64_tr_b16 v[34:35], v16 offset:1280
    ds_read_b128 v[188:191], v5 offset:18432
    buffer_load_dwordx4 v11, s[8:11], s74 offen offset:1024  lds
    s_add_u32 s74, s74, s79
    s_cmp_eq_u32 s88, 2
    s_cmov_b32 s74, s90
    v_mfma_f32_16x16x32_bf16 v[76:79], v[40:43], v[164:167], v[76:79]
    ds_read_b64_tr_b16 v[36:37], v16 offset:10240
    v_mfma_f32_16x16x32_bf16 v[76:79], v[44:47], v[172:175], v[76:79]
    ds_read_b64_tr_b16 v[38:39], v16 offset:11520
    s_waitcnt lgkmcnt(6)
    v_mfma_f32_16x16x32_bf16 v[80:83], v[24:27], v[160:163], v[80:83]
    v_add_u32 v17, 24576, v17
    ds_read_b64_tr_b16 v[40:41], v17 offset:16
    s_add_u32 m0, s76, 49152
    v_mfma_f32_16x16x32_bf16 v[80:83], v[28:31], v[168:171], v[80:83]
    ds_read_b64_tr_b16 v[42:43], v17 offset:1296
    buffer_load_dwordx4 v8, s[4:7], s73 offen  lds
    v_mfma_f32_16x16x32_bf16 v[84:87], v[24:27], v[164:167], v[84:87]
    ds_read_b64_tr_b16 v[44:45], v17 offset:10256
    v_mfma_f32_16x16x32_bf16 v[84:87], v[28:31], v[172:175], v[84:87]
    ds_read_b64_tr_b16 v[46:47], v17 offset:11536
    s_waitcnt lgkmcnt(4)
    v_mfma_f32_16x16x32_bf16 v[48:51], v[32:35], v[176:179], v[48:51]
    ds_read_b64_tr_b16 v[24:25], v17 offset:80
    s_add_u32 m0, s76, 49152
    v_mfma_f32_16x16x32_bf16 v[48:51], v[36:39], v[184:187], v[48:51]
    ds_read_b64_tr_b16 v[26:27], v17 offset:1360
    buffer_load_dwordx4 v9, s[4:7], s73 offen offset:1024  lds
    s_add_u32 s73, s73, 128
    s_cmp_eq_u32 s88, 2
    s_cmov_b32 s73, 0
    v_mfma_f32_16x16x32_bf16 v[52:55], v[32:35], v[180:183], v[52:55]
    ds_read_b64_tr_b16 v[28:29], v17 offset:10320
    v_mfma_f32_16x16x32_bf16 v[52:55], v[36:39], v[188:191], v[52:55]
    ds_read_b64_tr_b16 v[30:31], v17 offset:11600
    s_waitcnt lgkmcnt(4)
    v_mfma_f32_16x16x32_bf16 v[56:59], v[40:43], v[176:179], v[56:59]
    ds_read_b64_tr_b16 v[32:33], v16 offset:96
    v_mfma_f32_16x16x32_bf16 v[56:59], v[44:47], v[184:187], v[56:59]
    ds_read_b64_tr_b16 v[34:35], v16 offset:1376
    v_mfma_f32_16x16x32_bf16 v[60:63], v[40:43], v[180:183], v[60:63]
    ds_read_b64_tr_b16 v[36:37], v16 offset:10336
    v_mfma_f32_16x16x32_bf16 v[60:63], v[44:47], v[188:191], v[60:63]
    s_waitcnt vmcnt(4)
    s_barrier
    s_cmp_eq_u32 s91, 5
    s_cbranch_scc1 L_at_N0_5
L_at_N0_5b:
    ds_read_b64_tr_b16 v[38:39], v16 offset:11616
    ds_read_b128 v[192:195], v4 offset:32768
    s_waitcnt lgkmcnt(5)
    v_mfma_f32_16x16x32_bf16 v[64:67], v[24:27], v[176:179], v[64:67]
    v_add_u32 v6, 24576, v6
    ds_read_b64_tr_b16 v[40:41], v6 offset:0
    s_add_u32 m0, s77, 0
    v_mfma_f32_16x16x32_bf16 v[64:67], v[28:31], v[184:187], v[64:67]
    ds_read_b64_tr_b16 v[42:43], v6 offset:1280
    ds_read_b128 v[196:199], v4 offset:34816
    buffer_load_dwordx4 v10, s[8:11], s74 offen  lds
    v_mfma_f32_16x16x32_bf16 v[68:71], v[24:27], v[180:183], v[68:71]
    ds_read_b64_tr_b16 v[44:45], v6 offset:10240
    v_mfma_f32_16x16x32_bf16 v[68:71], v[28:31], v[188:191], v[68:71]
    ds_read_b64_tr_b16 v[46:47], v6 offset:11520
    ds_read_b128 v[200:203], v5 offset:32768
    s_waitcnt lgkmcnt(7)
    v_mfma_f32_16x16x32_bf16 v[72:75], v[32:35], v[176:179], v[72:75]
    v_add_u32 v16, 24576, v16
    ds_read_b64_tr_b16 v[24:25], v16 offset:0
    s_add_u32 m0, s77, 0
    v_mfma_f32_16x16x32_bf16 v[72:75], v[36:39], v[184:187], v[72:75]
    ds_read_b64_tr_b16 v[26:27], v16 offset:1280
    ds_read_b128 v[204:207], v5 offset:34816
    buffer_load_dwordx4 v11, s[8:11], s74 offen offset:1024  lds
    s_add_u32 s74, s74, s79
    s_cmp_eq_u32 s88, 1
    s_cmov_b32 s74, s90
    v_mfma_f32_16x16x32_bf16 v[76:79], v[32:35], v[180:183], v[76:79]
    ds_read_b64_tr_b16 v[28:29], v16 offset:10240
    v_mfma_f32_16x16x32_bf16 v[76:79], v[36:39], v[188:191], v[76:79]
    ds_read_b64_tr_b16 v[30:31], v16 offset:11520
    s_waitcnt lgkmcnt(6)
    v_mfma_f32_16x16x32_bf16 v[80:83], v[40:43], v[176:179], v[80:83]
    v_add_u32 v17, 24576, v17
    ds_read_b64_tr_b16 v[32:33], v17 offset:16
    s_add_u32 m0, s76, 0
    v_mfma_f32_16x16x32_bf16 v[80:83], v[44:47], v[184:187], v[80:83]
    ds_read_b64_tr_b16 v[34:35], v17 offset:1296
    buffer_load_dwordx4 v8, s[4:7], s73 offen  lds
    v_mfma_f32_16x16x32_bf16 v[84:87], v[40:43], v[180:183], v[84:87]
    ds_read_b64_tr_b16 v[36:37], v17 offset:10256
    v_mfma_f32_16x16x32_bf16 v[84:87], v[44:47], v[188:191], v[84:87]
    ds_read_b64_tr_b16 v[38:39], v17 offset:11536
    s_waitcnt lgkmcnt(4)
    v_mfma_f32_16x16x32_bf16 v[48:51], v[24:27], v[192:195], v[48:51]
    ds_read_b64_tr_b16 v[40:41], v17 offset:80
    s_add_u32 m0, s76, 0
    v_mfma_f32_16x16x32_bf16 v[48:51], v[28:31], v[200:203], v[48:51]
    ds_read_b64_tr_b16 v[42:43], v17 offset:1360
    buffer_load_dwordx4 v9, s[4:7], s73 offen offset:1024  lds
    s_add_u32 s73, s73, 128
    s_cmp_eq_u32 s88, 1
    s_cmov_b32 s73, 0
    v_mfma_f32_16x16x32_bf16 v[52:55], v[24:27], v[196:199], v[52:55]
    ds_read_b64_tr_b16 v[44:45], v17 offset:10320
    v_mfma_f32_16x16x32_bf16 v[52:55], v[28:31], v[204:207], v[52:55]
    ds_read_b64_tr_b16 v[46:47], v17 offset:11600
    s_waitcnt lgkmcnt(4)
    v_mfma_f32_16x16x32_bf16 v[56:59], v[32:35], v[192:195], v[56:59]
    ds_read_b64_tr_b16 v[24:25], v16 offset:96
    v_mfma_f32_16x16x32_bf16 v[56:59], v[36:39], v[200:203], v[56:59]
    ds_read_b64_tr_b16 v[26:27], v16 offset:1376
    v_mfma_f32_16x16x32_bf16 v[60:63], v[32:35], v[196:199], v[60:63]
    ds_read_b64_tr_b16 v[28:29], v16 offset:10336
    v_mfma_f32_16x16x32_bf16 v[60:63], v[36:39], v[204:207], v[60:63]
    s_waitcnt vmcnt(4)
    s_barrier
    s_cmp_eq_u32 s91, 6
    s_cbranch_scc1 L_at_N0_6
L_at_N0_6b:
    ds_read_b64_tr_b16 v[30:31], v16 offset:11616
    ds_read_b128 v[208:211], v4 offset:49152
    s_waitcnt lgkmcnt(5)
    v_mfma_f32_16x16x32_bf16 v[64:67], v[40:43], v[192:195], v[64:67]
    v_add_u32 v6, 24576, v6
    ds_read_b64_tr_b16 v[32:33], v6 offset:0
    s_add_u32 m0, s77, 24576
    v_mfma_f32_16x16x32_bf16 v[64:67], v[44:47], v[200:203], v[64:67]
    ds_read_b64_tr_b16 v[34:35], v6 offset:1280
    ds_read_b128 v[212:215], v4 offset:51200
    buffer_load_dwordx4 v10, s[8:11], s74 offen  lds
    v_mfma_f32_16x16x32_bf16 v[68:71], v[40:43], v[196:199], v[68:71]
    ds_read_b64_tr_b16 v[36:37], v6 offset:10240
    v_mfma_f32_16x16x32_bf16 v[68:71], v[44:47], v[204:207], v[68:71]
    ds_read_b64_tr_b16 v[38:39], v6 offset:11520
    ds_read_b128 v[216:219], v5 offset:49152
    s_waitcnt lgkmcnt(7)
    v_mfma_f32_16x16x32_bf16 v[72:75], v[24:27], v[192:195], v[72:75]
    v_add_u32 v16, 24576, v16
    ds_read_b64_tr_b16 v[40:41], v16 offset:0
    s_add_u32 m0, s77, 24576
    v_mfma_f32_16x16x32_bf16 v[72:75], v[28:31], v[200:203], v[72:75]
    ds_read_b64_tr_b16 v[42:43], v16 offset:1280
    ds_read_b128 v[220:223], v5 offset:51200
    buffer_load_dwordx4 v11, s[8:11], s74 offen offset:1024  lds
    v_mfma_f32_16x16x32_bf16 v[76:79], v[24:27], v[196:199], v[76:79]
    ds_read_b64_tr_b16 v[44:45], v16 offset:10240
    v_mfma_f32_16x16x32_bf16 v[76:79], v[28:31], v[204:207], v[76:79]
    ds_read_b64_tr_b16 v[46:47], v16 offset:11520
    s_waitcnt lgkmcnt(6)
    v_mfma_f32_16x16x32_bf16 v[80:83], v[32:35], v[192:195], v[80:83]
    v_add_u32 v17, 24576, v17
    ds_read_b64_tr_b16 v[24:25], v17 offset:16
    s_add_u32 m0, s76, 16384
    v_mfma_f32_16x16x32_bf16 v[80:83], v[36:39], v[200:203], v[80:83]
    ds_read_b64_tr_b16 v[26:27], v17 offset:1296
    buffer_load_dwordx4 v8, s[4:7], s73 offen  lds
    v_mfma_f32_16x16x32_bf16 v[84:87], v[32:35], v[196:199], v[84:87]
    ds_read_b64_tr_b16 v[28:29], v17 offset:10256
    v_mfma_f32_16x16x32_bf16 v[84:87], v[36:39], v[204:207], v[84:87]
    ds_read_b64_tr_b16 v[30:31], v17 offset:11536
    s_waitcnt lgkmcnt(4)
    v_mfma_f32_16x16x32_bf16 v[48:51], v[40:43], v[208:211], v[48:51]
    ds_read_b64_tr_b16 v[32:33], v17 offset:80
    s_add_u32 m0, s76, 16384
    v_mfma_f32_16x16x32_bf16 v[48:51], v[44:47], v[216:219], v[48:51]
    ds_read_b64_tr_b16 v[34:35], v17 offset:1360
    buffer_load_dwordx4 v9, s[4:7], s73 offen offset:1024  lds
    v_mfma_f32_16x16x32_bf16 v[52:55], v[40:43], v[212:215], v[52:55]
    ds_read_b64_tr_b16 v[36:37], v17 offset:10320
    v_mfma_f32_16x16x32_bf16 v[52:55], v[44:47], v[220:223], v[52:55]
    ds_read_b64_tr_b16 v[38:39], v17 offset:11600
    s_waitcnt lgkmcnt(4)
    v_mfma_f32_16x16x32_bf16 v[56:59], v[24:27], v[208:211], v[56:59]
    ds_read_b64_tr_b16 v[40:41], v16 offset:96
    v_mfma_f32_16x16x32_bf16 v[56:59], v[28:31], v[216:219], v[56:59]
    ds_read_b64_tr_b16 v[42:43], v16 offset:1376
    v_mfma_f32_16x16x32_bf16 v[60:63], v[24:27], v[212:215], v[60:63]
    ds_read_b64_tr_b16 v[44:45], v16 offset:10336
    v_mfma_f32_16x16x32_bf16 v[60:63], v[28:31], v[220:223], v[60:63]
    s_waitcnt vmcnt(4)
    s_barrier
    s_cmp_eq_u32 s91, 7
    s_cbranch_scc1 L_at_N0_7
L_at_N0_7b:
    ds_read_b64_tr_b16 v[46:47], v16 offset:11616
    ds_read_b128 v[224:227], v4 offset:0
    s_add_u32 m0, s78, 49152
    s_nop 0
    buffer_load_dwordx4 v13, s[12:15], s75 offen  lds
    s_waitcnt lgkmcnt(5)
    v_mfma_f32_16x16x32_bf16 v[64:67], v[32:35], v[208:211], v[64:67]
    v_add_u32 v6, 24576, v6
    ds_read_b64_tr_b16 v[24:25], v6 offset:0
    s_add_u32 m0, s78, 49152
    v_mfma_f32_16x16x32_bf16 v[64:67], v[36:39], v[216:219], v[64:67]
    ds_read_b64_tr_b16 v[26:27], v6 offset:1280
    ds_read_b128 v[228:231], v4 offset:2048
    buffer_load_dwordx4 v14, s[12:15], s75 offen offset:1024  lds
    v_mfma_f32_16x16x32_bf16 v[68:71], v[32:35], v[212:215], v[68:71]
    ds_read_b64_tr_b16 v[28:29], v6 offset:10240
    v_mfma_f32_16x16x32_bf16 v[68:71], v[36:39], v[220:223], v[68:71]
    ds_read_b64_tr_b16 v[30:31], v6 offset:11520
    ds_read_b128 v[232:235], v5 offset:0
    s_cmp_lt_u32 s64, 4
    s_mov_b32 s89, 2949120
    s_cselect_b32 s89, 327680, s89
    s_cselect_b32 s71, 0, 8
    s_movk_i32 s72, 0x80
    s_cselect_b32 s72, 0x100, s72
    s_cselect_b32 s70, 0x3ea52b5c, 1.0
    s_waitcnt lgkmcnt(7)
    v_mfma_f32_16x16x32_bf16 v[72:75], v[40:43], v[208:211], v[72:75]
    v_subrev_u32 v16, 73728, v16
    ds_read_b64_tr_b16 v[32:33], v16 offset:0
    v_mfma_f32_16x16x32_bf16 v[72:75], v[44:47], v[216:219], v[72:75]
    ds_read_b64_tr_b16 v[34:35], v16 offset:1280
    ds_read_b128 v[236:239], v5 offset:2048
    v_mov_b32 v8, s70
    v_mov_b32 v9, s70
    s_and_b32 s68, s64, 3
    s_lshl_b32 s68, s68, 9
    s_lshl_b32 s69, s39, 2
    v_mfma_f32_16x16x32_bf16 v[76:79], v[40:43], v[212:215], v[76:79]
    ds_read_b64_tr_b16 v[36:37], v16 offset:10240
    v_mfma_f32_16x16x32_bf16 v[76:79], v[44:47], v[220:223], v[76:79]
    ds_read_b64_tr_b16 v[38:39], v16 offset:11520
    s_add_u32 s68, s68, s69
    s_add_u32 s68, s68, s37
    s_mul_i32 s68, s68, 1280
    s_add_u32 s89, s89, s68
    v_and_b32 v1, 15, v0
    s_waitcnt lgkmcnt(6)
    v_mfma_f32_16x16x32_bf16 v[80:83], v[24:27], v[208:211], v[80:83]
    v_subrev_u32 v17, 73728, v17
    ds_read_b64_tr_b16 v[40:41], v17 offset:16
    s_add_u32 m0, s78, 49152
    v_mfma_f32_16x16x32_bf16 v[80:83], v[28:31], v[216:219], v[80:83]
    ds_read_b64_tr_b16 v[42:43], v17 offset:1296
    buffer_load_dwordx4 v15, s[12:15], s75 offen offset:2048  lds
    s_add_u32 s75, s75, 221184
    s_cmp_eq_u32 s88, 9
    s_cmov_b32 s75, s93
    v_mfma_f32_16x16x32_bf16 v[84:87], v[24:27], v[212:215], v[84:87]
    ds_read_b64_tr_b16 v[44:45], v17 offset:10256
    v_mfma_f32_16x16x32_bf16 v[84:87], v[28:31], v[220:223], v[84:87]
    ds_read_b64_tr_b16 v[46:47], v17 offset:11536
    v_bfe_u32 v2, v0, 3, 1
    v_mul_u32_u24 v2, s71, v2
    v_add_u32 v3, v1, v2
    v_lshrrev_b32 v2, 5, v0
    v_bfe_u32 v12, v0, 4, 1
    s_waitcnt lgkmcnt(4)
    v_mfma_f32_16x16x32_bf16 v[48:51], v[32:35], v[224:227], v[48:51]
    ds_read_b64_tr_b16 v[24:25], v17 offset:80
    v_mfma_f32_16x16x32_bf16 v[48:51], v[36:39], v[232:235], v[48:51]
    ds_read_b64_tr_b16 v[26:27], v17 offset:1360
    v_mul_u32_u24 v10, 81920, v2
    v_lshl_add_u32 v10, v12, 9, v10
    v_lshl_add_u32 v10, v3, 4, v10
    v_lshl_add_u32 v11, v2, 2, v12
    v_mul_u32_u24 v11, 81920, v11
    v_mfma_f32_16x16x32_bf16 v[52:55], v[32:35], v[228:231], v[52:55]
    ds_read_b64_tr_b16 v[28:29], v17 offset:10320
    v_mfma_f32_16x16x32_bf16 v[52:55], v[36:39], v[236:239], v[52:55]
    ds_read_b64_tr_b16 v[30:31], v17 offset:11600
    v_lshl_add_u32 v11, v1, 3, v11
    s_waitcnt lgkmcnt(4)
    v_mfma_f32_16x16x32_bf16 v[56:59], v[40:43], v[224:227], v[56:59]
    ds_read_b64_tr_b16 v[32:33], v16 offset:96
    v_mfma_f32_16x16x32_bf16 v[56:59], v[44:47], v[232:235], v[56:59]
    ds_read_b64_tr_b16 v[34:35], v16 offset:1376
    v_mfma_f32_16x16x32_bf16 v[60:63], v[40:43], v[228:231], v[60:63]
    ds_read_b64_tr_b16 v[36:37], v16 offset:10336
    v_mfma_f32_16x16x32_bf16 v[60:63], v[44:47], v[236:239], v[60:63]
    s_waitcnt vmcnt(3)
    s_barrier
    s_cmp_eq_u32 s91, 8
    s_cbranch_scc1 L_at_N0_8
L_at_N0_8b:
    ds_read_b64_tr_b16 v[38:39], v16 offset:11616
    ds_read_b128 v[240:243], v4 offset:16384
    s_waitcnt lgkmcnt(5)
    v_mfma_f32_16x16x32_bf16 v[64:67], v[24:27], v[224:227], v[64:67]
    v_subrev_u32 v6, 73728, v6
    ds_read_b64_tr_b16 v[40:41], v6 offset:0
    v_mfma_f32_16x16x32_bf16 v[64:67], v[28:31], v[232:235], v[64:67]
    ds_read_b64_tr_b16 v[42:43], v6 offset:1280
    ds_read_b128 v[244:247], v4 offset:18432
    v_mfma_f32_16x16x32_bf16 v[68:71], v[24:27], v[228:231], v[68:71]
    ds_read_b64_tr_b16 v[44:45], v6 offset:10240
    s_add_u32 m0, s78, 73728
    v_mfma_f32_16x16x32_bf16 v[68:71], v[28:31], v[236:239], v[68:71]
    ds_read_b64_tr_b16 v[46:47], v6 offset:11520
    ds_read_b128 v[248:251], v5 offset:16384
    buffer_load_dwordx4 v13, s[12:15], s75 offen  lds
    s_waitcnt lgkmcnt(7)
    v_mfma_f32_16x16x32_bf16 v[72:75], v[32:35], v[224:227], v[72:75]
    v_add_u32 v16, 24576, v16
    ds_read_b64_tr_b16 v[24:25], v16 offset:0
    v_mfma_f32_16x16x32_bf16 v[72:75], v[36:39], v[232:235], v[72:75]
    ds_read_b64_tr_b16 v[26:27], v16 offset:1280
    ds_read_b128 v[252:255], v5 offset:18432
    v_mfma_f32_16x16x32_bf16 v[76:79], v[32:35], v[228:231], v[76:79]
    ds_read_b64_tr_b16 v[28:29], v16 offset:10240
    s_add_u32 m0, s78, 73728
    v_mfma_f32_16x16x32_bf16 v[76:79], v[36:39], v[236:239], v[76:79]
    ds_read_b64_tr_b16 v[30:31], v16 offset:11520
    buffer_load_dwordx4 v14, s[12:15], s75 offen offset:1024  lds
    s_waitcnt lgkmcnt(6)
    v_mfma_f32_16x16x32_bf16 v[80:83], v[40:43], v[224:227], v[80:83]
    v_add_u32 v17, 24576, v17
    ds_read_b64_tr_b16 v[32:33], v17 offset:16
    v_mfma_f32_16x16x32_bf16 v[80:83], v[44:47], v[232:235], v[80:83]
    ds_read_b64_tr_b16 v[34:35], v17 offset:1296
    v_mfma_f32_16x16x32_bf16 v[84:87], v[40:43], v[228:231], v[84:87]
    ds_read_b64_tr_b16 v[36:37], v17 offset:10256
    s_add_u32 m0, s78, 73728
    v_mfma_f32_16x16x32_bf16 v[84:87], v[44:47], v[236:239], v[84:87]
    ds_read_b64_tr_b16 v[38:39], v17 offset:11536
    buffer_load_dwordx4 v15, s[12:15], s75 offen offset:2048  lds
    s_add_u32 s75, s75, 221184
    s_cmp_eq_u32 s88, 8
    s_cmov_b32 s75, s93
    s_waitcnt lgkmcnt(4)
    v_mfma_f32_16x16x32_bf16 v[48:51], v[24:27], v[240:243], v[48:51]
    ds_read_b64_tr_b16 v[40:41], v17 offset:80
    v_mfma_f32_16x16x32_bf16 v[48:51], v[28:31], v[248:251], v[48:51]
    ds_read_b64_tr_b16 v[42:43], v17 offset:1360
    v_mfma_f32_16x16x32_bf16 v[52:55], v[24:27], v[244:247], v[52:55]
    ds_read_b64_tr_b16 v[44:45], v17 offset:10320
    v_mfma_f32_16x16x32_bf16 v[52:55], v[28:31], v[252:255], v[52:55]
    ds_read_b64_tr_b16 v[46:47], v17 offset:11600
    s_waitcnt lgkmcnt(4)
    v_mfma_f32_16x16x32_bf16 v[56:59], v[32:35], v[240:243], v[56:59]
    ds_read_b64_tr_b16 v[24:25], v16 offset:96
    v_mfma_f32_16x16x32_bf16 v[56:59], v[36:39], v[248:251], v[56:59]
    ds_read_b64_tr_b16 v[26:27], v16 offset:1376
    v_mfma_f32_16x16x32_bf16 v[60:63], v[32:35], v[244:247], v[60:63]
    ds_read_b64_tr_b16 v[28:29], v16 offset:10336
    v_mfma_f32_16x16x32_bf16 v[60:63], v[36:39], v[252:255], v[60:63]
    s_waitcnt vmcnt(3)
    s_barrier
    ds_read_b64_tr_b16 v[30:31], v16 offset:11616
    s_waitcnt lgkmcnt(4)
    v_mfma_f32_16x16x32_bf16 v[64:67], v[40:43], v[240:243], v[64:67]
    v_add_u32 v6, 24576, v6
    ds_read_b64_tr_b16 v[32:33], v6 offset:0
    v_mfma_f32_16x16x32_bf16 v[64:67], v[44:47], v[248:251], v[64:67]
    ds_read_b64_tr_b16 v[34:35], v6 offset:1280
    v_mfma_f32_16x16x32_bf16 v[68:71], v[40:43], v[244:247], v[68:71]
    ds_read_b64_tr_b16 v[36:37], v6 offset:10240
    s_add_u32 m0, s78, 0
    v_mfma_f32_16x16x32_bf16 v[68:71], v[44:47], v[252:255], v[68:71]
    ds_read_b64_tr_b16 v[38:39], v6 offset:11520
    buffer_load_dwordx4 v13, s[12:15], s75 offen  lds
    s_waitcnt lgkmcnt(4)
    v_mfma_f32_16x16x32_bf16 v[72:75], v[24:27], v[240:243], v[72:75]
    v_mfma_f32_16x16x32_bf16 v[72:75], v[28:31], v[248:251], v[72:75]
    v_mfma_f32_16x16x32_bf16 v[76:79], v[24:27], v[244:247], v[76:79]
    s_add_u32 m0, s78, 0
    v_mfma_f32_16x16x32_bf16 v[76:79], v[28:31], v[252:255], v[76:79]
    buffer_load_dwordx4 v14, s[12:15], s75 offen offset:1024  lds
    s_waitcnt lgkmcnt(0)
    v_mfma_f32_16x16x32_bf16 v[80:83], v[32:35], v[240:243], v[80:83]
    ds_read_b64_tr_b16 v[24:25], v18 offset:0
    v_mfma_f32_16x16x32_bf16 v[80:83], v[36:39], v[248:251], v[80:83]
    ds_read_b64_tr_b16 v[26:27], v18 offset:768
    v_mfma_f32_16x16x32_bf16 v[84:87], v[32:35], v[244:247], v[84:87]
    ds_read_b64_tr_b16 v[28:29], v18 offset:6144
    s_add_u32 m0, s78, 0
    v_mfma_f32_16x16x32_bf16 v[84:87], v[36:39], v[252:255], v[84:87]
    ds_read_b64_tr_b16 v[30:31], v18 offset:6912
    buffer_load_dwordx4 v15, s[12:15], s75 offen offset:2048  lds
    s_add_u32 s75, s75, 221184
    s_cmp_eq_u32 s88, 7
    s_cmov_b32 s75, s93
    ds_read_b64_tr_b16 v[32:33], v18 offset:12288
    ds_read_b64_tr_b16 v[34:35], v18 offset:13056
    ds_read_b64_tr_b16 v[36:37], v18 offset:18432
    ds_read_b64_tr_b16 v[38:39], v18 offset:19200
    ds_read_b64_tr_b16 v[40:41], v19 offset:0
    ds_read_b64_tr_b16 v[42:43], v19 offset:768
    ds_read_b64_tr_b16 v[44:45], v19 offset:6144
    ds_read_b64_tr_b16 v[46:47], v19 offset:6912
    v_pk_mul_f32 v[48:49], v[48:49], v[8:9]
    v_pk_mul_f32 v[50:51], v[50:51], v[8:9]
    v_pk_mul_f32 v[56:57], v[56:57], v[8:9]
    v_pk_mul_f32 v[58:59], v[58:59], v[8:9]
    s_add_u32 s68, s89, 0
    v_cvt_pk_bf16_f32 v48, v48, v49
    v_cvt_pk_bf16_f32 v49, v50, v51
    v_cvt_pk_bf16_f32 v50, v56, v57
    v_cvt_pk_bf16_f32 v51, v58, v59
    buffer_store_dwordx4 v[48:51], v10, s[16:19], s68 offen sc1
    v_pk_mul_f32 v[52:53], v[52:53], v[8:9]
    v_pk_mul_f32 v[54:55], v[54:55], v[8:9]
    v_pk_mul_f32 v[60:61], v[60:61], v[8:9]
    v_pk_mul_f32 v[62:63], v[62:63], v[8:9]
    s_add_u32 s68, s68, s72
    v_cvt_pk_bf16_f32 v52, v52, v53
    v_cvt_pk_bf16_f32 v53, v54, v55
    v_cvt_pk_bf16_f32 v54, v60, v61
    v_cvt_pk_bf16_f32 v55, v62, v63
    buffer_store_dwordx4 v[52:55], v10, s[16:19], s68 offen sc1
    v_pk_mul_f32 v[64:65], v[64:65], v[8:9]
    v_pk_mul_f32 v[66:67], v[66:67], v[8:9]
    v_pk_mul_f32 v[72:73], v[72:73], v[8:9]
    v_pk_mul_f32 v[74:75], v[74:75], v[8:9]
    s_add_u32 s68, s89, 163840
    v_cvt_pk_bf16_f32 v64, v64, v65
    v_cvt_pk_bf16_f32 v65, v66, v67
    v_cvt_pk_bf16_f32 v66, v72, v73
    v_cvt_pk_bf16_f32 v67, v74, v75
    buffer_store_dwordx4 v[64:67], v10, s[16:19], s68 offen sc1
    v_pk_mul_f32 v[68:69], v[68:69], v[8:9]
    v_pk_mul_f32 v[70:71], v[70:71], v[8:9]
    v_pk_mul_f32 v[76:77], v[76:77], v[8:9]
    v_pk_mul_f32 v[78:79], v[78:79], v[8:9]
    s_add_u32 s68, s68, s72
    v_cvt_pk_bf16_f32 v68, v68, v69
    v_cvt_pk_bf16_f32 v69, v70, v71
    v_cvt_pk_bf16_f32 v70, v76, v77
    v_cvt_pk_bf16_f32 v71, v78, v79
    buffer_store_dwordx4 v[68:71], v10, s[16:19], s68 offen sc1
    v_pk_mul_f32 v[80:81], v[80:81], v[8:9]
    v_pk_mul_f32 v[82:83], v[82:83], v[8:9]
    s_add_u32 s68, s89, 0
    v_cvt_pk_bf16_f32 v80, v80, v81
    v_cvt_pk_bf16_f32 v81, v82, v83
    buffer_store_dwordx2 v[80:81], v11, s[16:19], s68 offen offset:1024 sc1
    v_pk_mul_f32 v[84:85], v[84:85], v[8:9]
    v_pk_mul_f32 v[86:87], v[86:87], v[8:9]
    v_cvt_pk_bf16_f32 v84, v84, v85
    v_cvt_pk_bf16_f32 v85, v86, v87
    buffer_store_dwordx2 v[84:85], v11, s[16:19], s68 offen offset:1152 sc1
    s_branch L_pass2
L_N1:
    v_mul_u32_u24 v1, 320, v21
    v_and_b32 v2, 1, v23
    v_lshrrev_b32 v3, 1, v23
    v_lshlrev_b32 v25, 5, v3
    v_lshl_add_u32 v25, v2, 3, v25
    v_add_u32 v25, 168, v25
    v_lshlrev_b32 v22, 4, v22
    v_xor_b32 v26, v25, v22
    v_add_u32 v16, v1, v26
    v_add_u32 v25, 16, v25
    v_xor_b32 v26, v25, v22
    v_subrev_u32 v26, 16, v26
    v_add_u32 v17, v1, v26
    v_mul_u32_u24 v2, 72, v2
    v_mul_u32_u24 v3, 160, v3
    v_add3_u32 v2, v2, v3, 0
    v_add_u32 v2, 80, v2
    v_xor_b32 v2, v2, v22
    v_add_u32 v6, v1, v2
    s_and_b32 s68, s2, 1
    s_lshl_b32 s68, s68, 7
    s_cmp_eq_u32 s36, 0
    s_cselect_b32 s68, s68, 1073741824
    v_mov_b32 v22, 1073741824
    v_writelane_b32 v22, s68, 0
    v_mov_b32 v21, 1
    s_bfe_u32 s91, s2, 0x30003
    s_add_u32 s91, s91, 1
    s_cmp_eq_u32 s36, 0
    s_cselect_b32 s91, s91, 0
    s_lshl_b32 s68, s80, 6
    s_add_u32 s69, s68, s37
    s_mul_i32 s69, s69, 1280
    s_cmp_eq_u32 s38, 0
    s_mov_b32 s82, 5570560
    s_cselect_b32 s82, 2949120, s82
    s_add_u32 s82, s82, s69
    s_mul_i32 s83, s36, 1280
    s_add_u32 s83, s83, 122880
    s_and_b32 s96, s36, 1
    s_lshl_b32 s96, s96, 1
    s_add_u32 s96, s96, s38
    s_lshr_b32 s97, s37, 1
    s_lshl_b32 s68, s81, 2
    s_lshr_b32 s69, s36, 1
    s_add_u32 s68, s68, s69
    s_mul_i32 s68, s68, 19
    s_and_b32 s69, s36, 1
    s_add_u32 s68, s68, s69
    s_mul_i32 s68, s68, 5120
    s_add_u32 s84, s68, 17891328
    s_lshl_b32 s68, s80, 1
    s_add_u32 s68, s68, s97
    s_mul_i32 s68, s68, 108
    s_mul_i32 s69, s96, 14
    s_add_u32 s68, s68, s69
    s_lshr_b32 s69, s96, 1
    s_sub_u32 s68, s68, s69
    s_lshl_b32 s68, s68, 10
    s_add_u32 s68, s68, 10813440
    s_mul_i32 s69, s38, 55296
    s_add_u32 s86, s68, s69
    s_sub_u32 s68, s68, s69
    s_add_u32 s98, s68, 55296
    s_mul_i32 s69, s38, 14336
    s_sub_u32 s69, 13312, s69
    s_add_u32 s92, s86, s69
    s_mov_b64 exec, 0x7777
    buffer_load_dwordx2 v[254:255], v28, s[8:11], s89 offen offset:60
    s_mov_b64 exec, -1
    global_load_dwordx2 v[254:255], v[30:31], off offset:60
    buffer_store_dword v33, v32, s[16:19], 0 offen sc1
    s_waitcnt vmcnt(8)
    s_barrier
    ds_read_b128 v[96:99], v4 offset:0
    ds_read_b128 v[100:103], v4 offset:2048
    ds_read_b128 v[104:107], v5 offset:0
    ds_read_b128 v[108:111], v5 offset:2048
    ds_read_b64_tr_b16 v[24:25], v16 offset:0
    ds_read_b64_tr_b16 v[26:27], v16 offset:1280
    ds_read_b64_tr_b16 v[28:29], v16 offset:10240
    ds_read_b64_tr_b16 v[30:31], v16 offset:11520
    ds_read_b64_tr_b16 v[32:33], v17 offset:16
    ds_read_b64_tr_b16 v[34:35], v17 offset:1296
    ds_read_b64_tr_b16 v[36:37], v17 offset:10256
    ds_read_b64_tr_b16 v[38:39], v17 offset:11536
    ds_read_b64_tr_b16 v[40:41], v17 offset:80
    ds_read_b64_tr_b16 v[42:43], v17 offset:1360
    ds_read_b64_tr_b16 v[44:45], v17 offset:10320
    ds_read_b64_tr_b16 v[46:47], v17 offset:11600
    s_waitcnt lgkmcnt(8)
    v_mfma_f32_16x16x32_bf16 v[48:51], v[24:27], v[96:99], 0
    s_add_u32 m0, s77, 49152
    v_mfma_f32_16x16x32_bf16 v[48:51], v[28:31], v[104:107], v[48:51]
    buffer_load_dwordx4 v10, s[8:11], s74 offen  lds
    v_mfma_f32_16x16x32_bf16 v[52:55], v[24:27], v[100:103], 0
    s_add_u32 m0, s77, 49152
    v_mfma_f32_16x16x32_bf16 v[52:55], v[28:31], v[108:111], v[52:55]
    buffer_load_dwordx4 v11, s[8:11], s74 offen offset:1024  lds
    s_waitcnt lgkmcnt(4)
    v_mfma_f32_16x16x32_bf16 v[56:59], v[32:35], v[96:99], 0
    ds_read_b64_tr_b16 v[24:25], v16 offset:96
    s_add_u32 m0, s77, 49152
    v_mfma_f32_16x16x32_bf16 v[56:59], v[36:39], v[104:107], v[56:59]
    ds_read_b64_tr_b16 v[26:27], v16 offset:1376
    buffer_load_dwordx4 v12, s[8:11], s74 offen offset:2048  lds
    s_add_u32 s74, s74, s79
    s_cmp_eq_u32 s88, 7
    s_cmov_b32 s74, s90
    s_add_u32 m0, s76, 32768
    s_nop 0
    buffer_load_dwordx4 v8, s[4:7], s73 offen  lds
    s_add_u32 m0, s76, 32768
    s_nop 0
    buffer_load_dwordx4 v9, s[4:7], s73 offen offset:1024  lds
    s_add_u32 s73, s73, 128
    s_cmp_eq_u32 s88, 7
    s_cmov_b32 s73, 0
    v_mfma_f32_16x16x32_bf16 v[60:63], v[32:35], v[100:103], 0
    ds_read_b64_tr_b16 v[28:29], v16 offset:10336
    v_mfma_f32_16x16x32_bf16 v[60:63], v[36:39], v[108:111], v[60:63]
    s_waitcnt vmcnt(8)
    s_barrier
    ds_read_b64_tr_b16 v[30:31], v16 offset:11616
    ds_read_b128 v[112:115], v4 offset:16384
    s_waitcnt lgkmcnt(5)
    v_mfma_f32_16x16x32_bf16 v[64:67], v[40:43], v[96:99], 0
    ds_read_b64_tr_b16 v[32:33], v6 offset:0
    s_add_u32 m0, s77, 73728
    v_mfma_f32_16x16x32_bf16 v[64:67], v[44:47], v[104:107], v[64:67]
    ds_read_b64_tr_b16 v[34:35], v6 offset:1280
    ds_read_b128 v[116:119], v4 offset:18432
    buffer_load_dwordx4 v10, s[8:11], s74 offen  lds
    v_mfma_f32_16x16x32_bf16 v[68:71], v[40:43], v[100:103], 0
    ds_read_b64_tr_b16 v[36:37], v6 offset:10240
    s_add_u32 m0, s77, 73728
    v_mfma_f32_16x16x32_bf16 v[68:71], v[44:47], v[108:111], v[68:71]
    ds_read_b64_tr_b16 v[38:39], v6 offset:11520
    ds_read_b128 v[120:123], v5 offset:16384
    buffer_load_dwordx4 v11, s[8:11], s74 offen offset:1024  lds
    s_waitcnt lgkmcnt(7)
    v_mfma_f32_16x16x32_bf16 v[72:75], v[24:27], v[96:99], 0
    v_add_u32 v16, 24576, v16
    ds_read_b64_tr_b16 v[40:41], v16 offset:0
    v_mfma_f32_16x16x32_bf16 v[72:75], v[28:31], v[104:107], v[72:75]
    ds_read_b64_tr_b16 v[42:43], v16 offset:1280
    ds_read_b128 v[124:127], v5 offset:18432
    v_mfma_f32_16x16x32_bf16 v[76:79], v[24:27], v[100:103], 0
    ds_read_b64_tr_b16 v[44:45], v16 offset:10240
    s_add_u32 m0, s77, 73728
    v_mfma_f32_16x16x32_bf16 v[76:79], v[28:31], v[108:111], v[76:79]
    ds_read_b64_tr_b16 v[46:47], v16 offset:11520
    buffer_load_dwordx4 v12, s[8:11], s74 offen offset:2048  lds
    s_add_u32 s74, s74, s79
    s_cmp_eq_u32 s88, 6
    s_cmov_b32 s74, s90
    s_waitcnt lgkmcnt(6)
    v_mfma_f32_16x16x32_bf16 v[80:83], v[32:35], v[96:99], 0
    v_add_u32 v17, 24576, v17
    ds_read_b64_tr_b16 v[24:25], v17 offset:16
    s_add_u32 m0, s76, 49152
    v_mfma_f32_16x16x32_bf16 v[80:83], v[36:39], v[104:107], v[80:83]
    ds_read_b64_tr_b16 v[26:27], v17 offset:1296
    buffer_load_dwordx4 v8, s[4:7], s73 offen  lds
    v_mfma_f32_16x16x32_bf16 v[84:87], v[32:35], v[100:103], 0
    ds_read_b64_tr_b16 v[28:29], v17 offset:10256
    v_mfma_f32_16x16x32_bf16 v[84:87], v[36:39], v[108:111], v[84:87]
    ds_read_b64_tr_b16 v[30:31], v17 offset:11536
    s_waitcnt lgkmcnt(4)
    v_mfma_f32_16x16x32_bf16 v[48:51], v[40:43], v[112:115], v[48:51]
    ds_read_b64_tr_b16 v[32:33], v17 offset:80
    s_add_u32 m0, s76, 49152
    v_mfma_f32_16x16x32_bf16 v[48:51], v[44:47], v[120:123], v[48:51]
    ds_read_b64_tr_b16 v[34:35], v17 offset:1360
    buffer_load_dwordx4 v9, s[4:7], s73 offen offset:1024  lds
    s_add_u32 s73, s73, 128
    s_cmp_eq_u32 s88, 6
    s_cmov_b32 s73, 0
    v_mfma_f32_16x16x32_bf16 v[52:55], v[40:43], v[116:119], v[52:55]
    ds_read_b64_tr_b16 v[36:37], v17 offset:10320
    v_mfma_f32_16x16x32_bf16 v[52:55], v[44:47], v[124:127], v[52:55]
    ds_read_b64_tr_b16 v[38:39], v17 offset:11600
    s_waitcnt lgkmcnt(4)
    v_mfma_f32_16x16x32_bf16 v[56:59], v[24:27], v[112:115], v[56:59]
    ds_read_b64_tr_b16 v[40:41], v16 offset:96
    v_mfma_f32_16x16x32_bf16 v[56:59], v[28:31], v[120:123], v[56:59]
    ds_read_b64_tr_b16 v[42:43], v16 offset:1376
    v_mfma_f32_16x16x32_bf16 v[60:63], v[24:27], v[116:119], v[60:63]
    ds_read_b64_tr_b16 v[44:45], v16 offset:10336
    v_mfma_f32_16x16x32_bf16 v[60:63], v[28:31], v[124:127], v[60:63]
    s_waitcnt vmcnt(5)
    s_barrier
    s_cmp_eq_u32 s91, 1
    s_cbranch_scc1 L_at_N1_1
L_at_N1_1b:
    ds_read_b64_tr_b16 v[46:47], v16 offset:11616
    ds_read_b128 v[128:131], v4 offset:32768
    s_waitcnt lgkmcnt(5)
    v_mfma_f32_16x16x32_bf16 v[64:67], v[32:35], v[112:115], v[64:67]
    v_add_u32 v6, 24576, v6
    ds_read_b64_tr_b16 v[24:25], v6 offset:0
    s_add_u32 m0, s77, 0
    v_mfma_f32_16x16x32_bf16 v[64:67], v[36:39], v[120:123], v[64:67]
    ds_read_b64_tr_b16 v[26:27], v6 offset:1280
    ds_read_b128 v[132:135], v4 offset:34816
    buffer_load_dwordx4 v10, s[8:11], s74 offen  lds
    v_mfma_f32_16x16x32_bf16 v[68:71], v[32:35], v[116:119], v[68:71]
    ds_read_b64_tr_b16 v[28:29], v6 offset:10240
    s_add_u32 m0, s77, 0
    v_mfma_f32_16x16x32_bf16 v[68:71], v[36:39], v[124:127], v[68:71]
    ds_read_b64_tr_b16 v[30:31], v6 offset:11520
    ds_read_b128 v[136:139], v5 offset:32768
    buffer_load_dwordx4 v11, s[8:11], s74 offen offset:1024  lds
    s_waitcnt lgkmcnt(7)
    v_mfma_f32_16x16x32_bf16 v[72:75], v[40:43], v[112:115], v[72:75]
    v_add_u32 v16, 24576, v16
    ds_read_b64_tr_b16 v[32:33], v16 offset:0
    v_mfma_f32_16x16x32_bf16 v[72:75], v[44:47], v[120:123], v[72:75]
    ds_read_b64_tr_b16 v[34:35], v16 offset:1280
    ds_read_b128 v[140:143], v5 offset:34816
    v_mfma_f32_16x16x32_bf16 v[76:79], v[40:43], v[116:119], v[76:79]
    ds_read_b64_tr_b16 v[36:37], v16 offset:10240
    s_add_u32 m0, s77, 0
    v_mfma_f32_16x16x32_bf16 v[76:79], v[44:47], v[124:127], v[76:79]
    ds_read_b64_tr_b16 v[38:39], v16 offset:11520
    buffer_load_dwordx4 v12, s[8:11], s74 offen offset:2048  lds
    s_add_u32 s74, s74, s79
    s_cmp_eq_u32 s88, 5
    s_cmov_b32 s74, s90
    s_waitcnt lgkmcnt(6)
    v_mfma_f32_16x16x32_bf16 v[80:83], v[24:27], v[112:115], v[80:83]
    v_add_u32 v17, 24576, v17
    ds_read_b64_tr_b16 v[40:41], v17 offset:16
    s_add_u32 m0, s76, 0
    v_mfma_f32_16x16x32_bf16 v[80:83], v[28:31], v[120:123], v[80:83]
    ds_read_b64_tr_b16 v[42:43], v17 offset:1296
    buffer_load_dwordx4 v8, s[4:7], s73 offen  lds
    v_mfma_f32_16x16x32_bf16 v[84:87], v[24:27], v[116:119], v[84:87]
    ds_read_b64_tr_b16 v[44:45], v17 offset:10256
    v_mfma_f32_16x16x32_bf16 v[84:87], v[28:31], v[124:127], v[84:87]
    ds_read_b64_tr_b16 v[46:47], v17 offset:11536
    s_mov_b64 exec, 0xff
    buffer_load_dword v7, v7, s[12:15], s85 offen
    s_mov_b64 exec, -1
    s_waitcnt lgkmcnt(4)
    v_mfma_f32_16x16x32_bf16 v[48:51], v[32:35], v[128:131], v[48:51]
    ds_read_b64_tr_b16 v[24:25], v17 offset:80
    s_add_u32 m0, s76, 0
    v_mfma_f32_16x16x32_bf16 v[48:51], v[36:39], v[136:139], v[48:51]
    ds_read_b64_tr_b16 v[26:27], v17 offset:1360
    buffer_load_dwordx4 v9, s[4:7], s73 offen offset:1024  lds
    s_add_u32 s73, s73, 128
    s_cmp_eq_u32 s88, 5
    s_cmov_b32 s73, 0
    v_mfma_f32_16x16x32_bf16 v[52:55], v[32:35], v[132:135], v[52:55]
    ds_read_b64_tr_b16 v[28:29], v17 offset:10320
    v_mfma_f32_16x16x32_bf16 v[52:55], v[36:39], v[140:143], v[52:55]
    ds_read_b64_tr_b16 v[30:31], v17 offset:11600
    s_waitcnt lgkmcnt(4)
    v_mfma_f32_16x16x32_bf16 v[56:59], v[40:43], v[128:131], v[56:59]
    ds_read_b64_tr_b16 v[32:33], v16 offset:96
    v_mfma_f32_16x16x32_bf16 v[56:59], v[44:47], v[136:139], v[56:59]
    ds_read_b64_tr_b16 v[34:35], v16 offset:1376
    v_mfma_f32_16x16x32_bf16 v[60:63], v[40:43], v[132:135], v[60:63]
    ds_read_b64_tr_b16 v[36:37], v16 offset:10336
    v_mfma_f32_16x16x32_bf16 v[60:63], v[44:47], v[140:143], v[60:63]
    s_waitcnt vmcnt(6)
    s_barrier
    s_cmp_eq_u32 s91, 2
    s_cbranch_scc1 L_at_N1_2
L_at_N1_2b:
    ds_read_b64_tr_b16 v[38:39], v16 offset:11616
    ds_read_b128 v[144:147], v4 offset:49152
    s_waitcnt lgkmcnt(5)
    v_mfma_f32_16x16x32_bf16 v[64:67], v[24:27], v[128:131], v[64:67]
    v_add_u32 v6, 24576, v6
    ds_read_b64_tr_b16 v[40:41], v6 offset:0
    s_add_u32 m0, s77, 24576
    v_mfma_f32_16x16x32_bf16 v[64:67], v[28:31], v[136:139], v[64:67]
    ds_read_b64_tr_b16 v[42:43], v6 offset:1280
    ds_read_b128 v[148:151], v4 offset:51200
    buffer_load_dwordx4 v10, s[8:11], s74 offen  lds
    v_mfma_f32_16x16x32_bf16 v[68:71], v[24:27], v[132:135], v[68:71]
    ds_read_b64_tr_b16 v[44:45], v6 offset:10240
    s_add_u32 m0, s77, 24576
    v_mfma_f32_16x16x32_bf16 v[68:71], v[28:31], v[140:143], v[68:71]
    ds_read_b64_tr_b16 v[46:47], v6 offset:11520
    ds_read_b128 v[152:155], v5 offset:49152
    buffer_load_dwordx4 v11, s[8:11], s74 offen offset:1024  lds
    s_waitcnt lgkmcnt(7)
    v_mfma_f32_16x16x32_bf16 v[72:75], v[32:35], v[128:131], v[72:75]
    v_add_u32 v16, 24576, v16
    ds_read_b64_tr_b16 v[24:25], v16 offset:0
    v_mfma_f32_16x16x32_bf16 v[72:75], v[36:39], v[136:139], v[72:75]
    ds_read_b64_tr_b16 v[26:27], v16 offset:1280
    ds_read_b128 v[156:159], v5 offset:51200
    v_mfma_f32_16x16x32_bf16 v[76:79], v[32:35], v[132:135], v[76:79]
    ds_read_b64_tr_b16 v[28:29], v16 offset:10240
    s_add_u32 m0, s77, 24576
    v_mfma_f32_16x16x32_bf16 v[76:79], v[36:39], v[140:143], v[76:79]
    ds_read_b64_tr_b16 v[30:31], v16 offset:11520
    buffer_load_dwordx4 v12, s[8:11], s74 offen offset:2048  lds
    s_add_u32 s74, s74, s79
    s_cmp_eq_u32 s88, 4
    s_cmov_b32 s74, s90
    s_waitcnt lgkmcnt(6)
    v_mfma_f32_16x16x32_bf16 v[80:83], v[40:43], v[128:131], v[80:83]
    v_add_u32 v17, 24576, v17
    ds_read_b64_tr_b16 v[32:33], v17 offset:16
    s_add_u32 m0, s76, 16384
    v_mfma_f32_16x16x32_bf16 v[80:83], v[44:47], v[136:139], v[80:83]
    ds_read_b64_tr_b16 v[34:35], v17 offset:1296
    buffer_load_dwordx4 v8, s[4:7], s73 offen  lds
    v_mfma_f32_16x16x32_bf16 v[84:87], v[40:43], v[132:135], v[84:87]
    ds_read_b64_tr_b16 v[36:37], v17 offset:10256
    v_mfma_f32_16x16x32_bf16 v[84:87], v[44:47], v[140:143], v[84:87]
    ds_read_b64_tr_b16 v[38:39], v17 offset:11536
    s_waitcnt lgkmcnt(4)
    v_mfma_f32_16x16x32_bf16 v[48:51], v[24:27], v[144:147], v[48:51]
    ds_read_b64_tr_b16 v[40:41], v17 offset:80
    s_add_u32 m0, s76, 16384
    v_mfma_f32_16x16x32_bf16 v[48:51], v[28:31], v[152:155], v[48:51]
    ds_read_b64_tr_b16 v[42:43], v17 offset:1360
    buffer_load_dwordx4 v9, s[4:7], s73 offen offset:1024  lds
    s_add_u32 s73, s73, 128
    s_cmp_eq_u32 s88, 4
    s_cmov_b32 s73, 0
    v_mfma_f32_16x16x32_bf16 v[52:55], v[24:27], v[148:151], v[52:55]
    ds_read_b64_tr_b16 v[44:45], v17 offset:10320
    v_mfma_f32_16x16x32_bf16 v[52:55], v[28:31], v[156:159], v[52:55]
    ds_read_b64_tr_b16 v[46:47], v17 offset:11600
    s_waitcnt lgkmcnt(4)
    v_mfma_f32_16x16x32_bf16 v[56:59], v[32:35], v[144:147], v[56:59]
    ds_read_b64_tr_b16 v[24:25], v16 offset:96
    v_mfma_f32_16x16x32_bf16 v[56:59], v[36:39], v[152:155], v[56:59]
    ds_read_b64_tr_b16 v[26:27], v16 offset:1376
    v_mfma_f32_16x16x32_bf16 v[60:63], v[32:35], v[148:151], v[60:63]
    ds_read_b64_tr_b16 v[28:29], v16 offset:10336
    v_mfma_f32_16x16x32_bf16 v[60:63], v[36:39], v[156:159], v[60:63]
    s_waitcnt vmcnt(5)
    s_barrier
    s_cmp_eq_u32 s91, 3
    s_cbranch_scc1 L_at_N1_3
L_at_N1_3b:
    ds_read_b64_tr_b16 v[30:31], v16 offset:11616
    ds_read_b128 v[160:163], v4 offset:0
    s_waitcnt lgkmcnt(5)
    v_mfma_f32_16x16x32_bf16 v[64:67], v[40:43], v[144:147], v[64:67]
    v_add_u32 v6, 24576, v6
    ds_read_b64_tr_b16 v[32:33], v6 offset:0
    s_add_u32 m0, s77, 49152
    v_mfma_f32_16x16x32_bf16 v[64:67], v[44:47], v[152:155], v[64:67]
    ds_read_b64_tr_b16 v[34:35], v6 offset:1280
    ds_read_b128 v[164:167], v4 offset:2048
    buffer_load_dwordx4 v10, s[8:11], s74 offen  lds
    v_mfma_f32_16x16x32_bf16 v[68:71], v[40:43], v[148:151], v[68:71]
    ds_read_b64_tr_b16 v[36:37], v6 offset:10240
    s_add_u32 m0, s77, 49152
    v_mfma_f32_16x16x32_bf16 v[68:71], v[44:47], v[156:159], v[68:71]
    ds_read_b64_tr_b16 v[38:39], v6 offset:11520
    ds_read_b128 v[168:171], v5 offset:0
    buffer_load_dwordx4 v11, s[8:11], s74 offen offset:1024  lds
    s_waitcnt lgkmcnt(7)
    v_mfma_f32_16x16x32_bf16 v[72:75], v[24:27], v[144:147], v[72:75]
    v_subrev_u32 v16, 73728, v16
    ds_read_b64_tr_b16 v[40:41], v16 offset:0
    v_mfma_f32_16x16x32_bf16 v[72:75], v[28:31], v[152:155], v[72:75]
    ds_read_b64_tr_b16 v[42:43], v16 offset:1280
    ds_read_b128 v[172:175], v5 offset:2048
    v_mfma_f32_16x16x32_bf16 v[76:79], v[24:27], v[148:151], v[76:79]
    ds_read_b64_tr_b16 v[44:45], v16 offset:10240
    s_add_u32 m0, s77, 49152
    v_mfma_f32_16x16x32_bf16 v[76:79], v[28:31], v[156:159], v[76:79]
    ds_read_b64_tr_b16 v[46:47], v16 offset:11520
    buffer_load_dwordx4 v12, s[8:11], s74 offen offset:2048  lds
    s_add_u32 s74, s74, s79
    s_cmp_eq_u32 s88, 3
    s_cmov_b32 s74, s90
    s_waitcnt lgkmcnt(6)
    v_mfma_f32_16x16x32_bf16 v[80:83], v[32:35], v[144:147], v[80:83]
    v_subrev_u32 v17, 73728, v17
    ds_read_b64_tr_b16 v[24:25], v17 offset:16
    s_add_u32 m0, s76, 32768
    v_mfma_f32_16x16x32_bf16 v[80:83], v[36:39], v[152:155], v[80:83]
    ds_read_b64_tr_b16 v[26:27], v17 offset:1296
    buffer_load_dwordx4 v8, s[4:7], s73 offen  lds
    v_mfma_f32_16x16x32_bf16 v[84:87], v[32:35], v[148:151], v[84:87]
    ds_read_b64_tr_b16 v[28:29], v17 offset:10256
    v_mfma_f32_16x16x32_bf16 v[84:87], v[36:39], v[156:159], v[84:87]
    ds_read_b64_tr_b16 v[30:31], v17 offset:11536
    s_waitcnt lgkmcnt(4)
    v_mfma_f32_16x16x32_bf16 v[48:51], v[40:43], v[160:163], v[48:51]
    ds_read_b64_tr_b16 v[32:33], v17 offset:80
    s_add_u32 m0, s76, 32768
    v_mfma_f32_16x16x32_bf16 v[48:51], v[44:47], v[168:171], v[48:51]
    ds_read_b64_tr_b16 v[34:35], v17 offset:1360
    buffer_load_dwordx4 v9, s[4:7], s73 offen offset:1024  lds
    s_add_u32 s73, s73, 128
    s_cmp_eq_u32 s88, 3
    s_cmov_b32 s73, 0
    v_mfma_f32_16x16x32_bf16 v[52:55], v[40:43], v[164:167], v[52:55]
    ds_read_b64_tr_b16 v[36:37], v17 offset:10320
    v_mfma_f32_16x16x32_bf16 v[52:55], v[44:47], v[172:175], v[52:55]
    ds_read_b64_tr_b16 v[38:39], v17 offset:11600
    s_waitcnt lgkmcnt(4)
    v_mfma_f32_16x16x32_bf16 v[56:59], v[24:27], v[160:163], v[56:59]
    ds_read_b64_tr_b16 v[40:41], v16 offset:96
    v_mfma_f32_16x16x32_bf16 v[56:59], v[28:31], v[168:171], v[56:59]
    ds_read_b64_tr_b16 v[42:43], v16 offset:1376
    v_mfma_f32_16x16x32_bf16 v[60:63], v[24:27], v[164:167], v[60:63]
    ds_read_b64_tr_b16 v[44:45], v16 offset:10336
    v_mfma_f32_16x16x32_bf16 v[60:63], v[28:31], v[172:175], v[60:63]
    s_waitcnt vmcnt(5)
    s_barrier
    s_cmp_eq_u32 s91, 4
    s_cbranch_scc1 L_at_N1_4
L_at_N1_4b:
    ds_read_b64_tr_b16 v[46:47], v16 offset:11616
    ds_read_b128 v[176:179], v4 offset:16384
    s_waitcnt lgkmcnt(5)
    v_mfma_f32_16x16x32_bf16 v[64:67], v[32:35], v[160:163], v[64:67]
    v_subrev_u32 v6, 73728, v6
    ds_read_b64_tr_b16 v[24:25], v6 offset:0
    s_add_u32 m0, s77, 73728
    v_mfma_f32_16x16x32_bf16 v[64:67], v[36:39], v[168:171], v[64:67]
    ds_read_b64_tr_b16 v[26:27], v6 offset:1280
    ds_read_b128 v[180:183], v4 offset:18432
    buffer_load_dwordx4 v10, s[8:11], s74 offen  lds
    v_mfma_f32_16x16x32_bf16 v[68:71], v[32:35], v[164:167], v[68:71]
    ds_read_b64_tr_b16 v[28:29], v6 offset:10240
    s_add_u32 m0, s77, 73728
    v_mfma_f32_16x16x32_bf16 v[68:71], v[36:39], v[172:175], v[68:71]
    ds_read_b64_tr_b16 v[30:31], v6 offset:11520
    ds_read_b128 v[184:187], v5 offset:16384
    buffer_load_dwordx4 v11, s[8:11], s74 offen offset:1024  lds
    s_waitcnt lgkmcnt(7)
    v_mfma_f32_16x16x32_bf16 v[72:75], v[40:43], v[160:163], v[72:75]
    v_add_u32 v16, 24576, v16
    ds_read_b64_tr_b16 v[32:33], v16 offset:0
    v_mfma_f32_16x16x32_bf16 v[72:75], v[44:47], v[168:171], v[72:75]
    ds_read_b64_tr_b16 v[34:35], v16 offset:1280
    ds_read_b128 v[188:191], v5 offset:18432
    v_mfma_f32_16x16x32_bf16 v[76:79], v[40:43], v[164:167], v[76:79]
    ds_read_b64_tr_b16 v[36:37], v16 offset:10240
    s_add_u32 m0, s77, 73728
    v_mfma_f32_16x16x32_bf16 v[76:79], v[44:47], v[172:175], v[76:79]
    ds_read_b64_tr_b16 v[38:39], v16 offset:11520
    buffer_load_dwordx4 v12, s[8:11], s74 offen offset:2048  lds
    s_add_u32 s74, s74, s79
    s_cmp_eq_u32 s88, 2
    s_cmov_b32 s74, s90
    s_waitcnt lgkmcnt(6)
    v_mfma_f32_16x16x32_bf16 v[80:83], v[24:27], v[160:163], v[80:83]
    v_add_u32 v17, 24576, v17
    ds_read_b64_tr_b16 v[40:41], v17 offset:16
    s_add_u32 m0, s76, 49152
    v_mfma_f32_16x16x32_bf16 v[80:83], v[28:31], v[168:171], v[80:83]
    ds_read_b64_tr_b16 v[42:43], v17 offset:1296
    buffer_load_dwordx4 v8, s[4:7], s73 offen  lds
    v_mfma_f32_16x16x32_bf16 v[84:87], v[24:27], v[164:167], v[84:87]
    ds_read_b64_tr_b16 v[44:45], v17 offset:10256
    v_mfma_f32_16x16x32_bf16 v[84:87], v[28:31], v[172:175], v[84:87]
    ds_read_b64_tr_b16 v[46:47], v17 offset:11536
    s_waitcnt lgkmcnt(4)
    v_mfma_f32_16x16x32_bf16 v[48:51], v[32:35], v[176:179], v[48:51]
    ds_read_b64_tr_b16 v[24:25], v17 offset:80
    s_add_u32 m0, s76, 49152
    v_mfma_f32_16x16x32_bf16 v[48:51], v[36:39], v[184:187], v[48:51]
    ds_read_b64_tr_b16 v[26:27], v17 offset:1360
    buffer_load_dwordx4 v9, s[4:7], s73 offen offset:1024  lds
    s_add_u32 s73, s73, 128
    s_cmp_eq_u32 s88, 2
    s_cmov_b32 s73, 0
    v_mfma_f32_16x16x32_bf16 v[52:55], v[32:35], v[180:183], v[52:55]
    ds_read_b64_tr_b16 v[28:29], v17 offset:10320
    v_mfma_f32_16x16x32_bf16 v[52:55], v[36:39], v[188:191], v[52:55]
    ds_read_b64_tr_b16 v[30:31], v17 offset:11600
    s_waitcnt lgkmcnt(4)
    v_mfma_f32_16x16x32_bf16 v[56:59], v[40:43], v[176:179], v[56:59]
    ds_read_b64_tr_b16 v[32:33], v16 offset:96
    v_mfma_f32_16x16x32_bf16 v[56:59], v[44:47], v[184:187], v[56:59]
    ds_read_b64_tr_b16 v[34:35], v16 offset:1376
    v_mfma_f32_16x16x32_bf16 v[60:63], v[40:43], v[180:183], v[60:63]
    ds_read_b64_tr_b16 v[36:37], v16 offset:10336
    v_mfma_f32_16x16x32_bf16 v[60:63], v[44:47], v[188:191], v[60:63]
    s_waitcnt vmcnt(5)
    s_barrier
    s_cmp_eq_u32 s91, 5
    s_cbranch_scc1 L_at_N1_5
L_at_N1_5b:
    ds_read_b64_tr_b16 v[38:39], v16 offset:11616
    ds_read_b128 v[192:195], v4 offset:32768
    s_waitcnt lgkmcnt(5)
    v_mfma_f32_16x16x32_bf16 v[64:67], v[24:27], v[176:179], v[64:67]
    v_add_u32 v6, 24576, v6
    ds_read_b64_tr_b16 v[40:41], v6 offset:0
    s_add_u32 m0, s77, 0
    v_mfma_f32_16x16x32_bf16 v[64:67], v[28:31], v[184:187], v[64:67]
    ds_read_b64_tr_b16 v[42:43], v6 offset:1280
    ds_read_b128 v[196:199], v4 offset:34816
    buffer_load_dwordx4 v10, s[8:11], s74 offen  lds
    v_mfma_f32_16x16x32_bf16 v[68:71], v[24:27], v[180:183], v[68:71]
    ds_read_b64_tr_b16 v[44:45], v6 offset:10240
    s_add_u32 m0, s77, 0
    v_mfma_f32_16x16x32_bf16 v[68:71], v[28:31], v[188:191], v[68:71]
    ds_read_b64_tr_b16 v[46:47], v6 offset:11520
    ds_read_b128 v[200:203], v5 offset:32768
    buffer_load_dwordx4 v11, s[8:11], s74 offen offset:1024  lds
    s_waitcnt lgkmcnt(7)
    v_mfma_f32_16x16x32_bf16 v[72:75], v[32:35], v[176:179], v[72:75]
    v_add_u32 v16, 24576, v16
    ds_read_b64_tr_b16 v[24:25], v16 offset:0
    v_mfma_f32_16x16x32_bf16 v[72:75], v[36:39], v[184:187], v[72:75]
    ds_read_b64_tr_b16 v[26:27], v16 offset:1280
    ds_read_b128 v[204:207], v5 offset:34816
    v_mfma_f32_16x16x32_bf16 v[76:79], v[32:35], v[180:183], v[76:79]
    ds_read_b64_tr_b16 v[28:29], v16 offset:10240
    s_add_u32 m0, s77, 0
    v_mfma_f32_16x16x32_bf16 v[76:79], v[36:39], v[188:191], v[76:79]
    ds_read_b64_tr_b16 v[30:31], v16 offset:11520
    buffer_load_dwordx4 v12, s[8:11], s74 offen offset:2048  lds
    s_add_u32 s74, s74, s79
    s_cmp_eq_u32 s88, 1
    s_cmov_b32 s74, s90
    s_waitcnt lgkmcnt(6)
    v_mfma_f32_16x16x32_bf16 v[80:83], v[40:43], v[176:179], v[80:83]
    v_add_u32 v17, 24576, v17
    ds_read_b64_tr_b16 v[32:33], v17 offset:16
    s_add_u32 m0, s76, 0
    v_mfma_f32_16x16x32_bf16 v[80:83], v[44:47], v[184:187], v[80:83]
    ds_read_b64_tr_b16 v[34:35], v17 offset:1296
    buffer_load_dwordx4 v8, s[4:7], s73 offen  lds
    v_mfma_f32_16x16x32_bf16 v[84:87], v[40:43], v[180:183], v[84:87]
    ds_read_b64_tr_b16 v[36:37], v17 offset:10256
    v_mfma_f32_16x16x32_bf16 v[84:87], v[44:47], v[188:191], v[84:87]
    ds_read_b64_tr_b16 v[38:39], v17 offset:11536
    s_waitcnt lgkmcnt(4)
    v_mfma_f32_16x16x32_bf16 v[48:51], v[24:27], v[192:195], v[48:51]
    ds_read_b64_tr_b16 v[40:41], v17 offset:80
    s_add_u32 m0, s76, 0
    v_mfma_f32_16x16x32_bf16 v[48:51], v[28:31], v[200:203], v[48:51]
    ds_read_b64_tr_b16 v[42:43], v17 offset:1360
    buffer_load_dwordx4 v9, s[4:7], s73 offen offset:1024  lds
    s_add_u32 s73, s73, 128
    s_cmp_eq_u32 s88, 1
    s_cmov_b32 s73, 0
    v_mfma_f32_16x16x32_bf16 v[52:55], v[24:27], v[196:199], v[52:55]
    ds_read_b64_tr_b16 v[44:45], v17 offset:10320
    v_mfma_f32_16x16x32_bf16 v[52:55], v[28:31], v[204:207], v[52:55]
    ds_read_b64_tr_b16 v[46:47], v17 offset:11600
    s_waitcnt lgkmcnt(4)
    v_mfma_f32_16x16x32_bf16 v[56:59], v[32:35], v[192:195], v[56:59]
    ds_read_b64_tr_b16 v[24:25], v16 offset:96
    v_mfma_f32_16x16x32_bf16 v[56:59], v[36:39], v[200:203], v[56:59]
    ds_read_b64_tr_b16 v[26:27], v16 offset:1376
    v_mfma_f32_16x16x32_bf16 v[60:63], v[32:35], v[196:199], v[60:63]
    ds_read_b64_tr_b16 v[28:29], v16 offset:10336
    v_mfma_f32_16x16x32_bf16 v[60:63], v[36:39], v[204:207], v[60:63]
    s_waitcnt vmcnt(5)
    s_barrier
    s_cmp_eq_u32 s91, 6
    s_cbranch_scc1 L_at_N1_6
L_at_N1_6b:
    ds_read_b64_tr_b16 v[30:31], v16 offset:11616
    ds_read_b128 v[208:211], v4 offset:49152
    s_waitcnt lgkmcnt(5)
    v_mfma_f32_16x16x32_bf16 v[64:67], v[40:43], v[192:195], v[64:67]
    v_add_u32 v6, 24576, v6
    ds_read_b64_tr_b16 v[32:33], v6 offset:0
    s_add_u32 m0, s77, 24576
    v_mfma_f32_16x16x32_bf16 v[64:67], v[44:47], v[200:203], v[64:67]
    ds_read_b64_tr_b16 v[34:35], v6 offset:1280
    ds_read_b128 v[212:215], v4 offset:51200
    buffer_load_dwordx4 v10, s[8:11], s74 offen  lds
    v_mfma_f32_16x16x32_bf16 v[68:71], v[40:43], v[196:199], v[68:71]
    ds_read_b64_tr_b16 v[36:37], v6 offset:10240
    s_add_u32 m0, s77, 24576
    v_mfma_f32_16x16x32_bf16 v[68:71], v[44:47], v[204:207], v[68:71]
    ds_read_b64_tr_b16 v[38:39], v6 offset:11520
    ds_read_b128 v[216:219], v5 offset:49152
    buffer_load_dwordx4 v11, s[8:11], s74 offen offset:1024  lds
    s_waitcnt lgkmcnt(7)
    v_mfma_f32_16x16x32_bf16 v[72:75], v[24:27], v[192:195], v[72:75]
    v_add_u32 v16, 24576, v16
    ds_read_b64_tr_b16 v[40:41], v16 offset:0
    v_mfma_f32_16x16x32_bf16 v[72:75], v[28:31], v[200:203], v[72:75]
    ds_read_b64_tr_b16 v[42:43], v16 offset:1280
    ds_read_b128 v[220:223], v5 offset:51200
    v_mfma_f32_16x16x32_bf16 v[76:79], v[24:27], v[196:199], v[76:79]
    ds_read_b64_tr_b16 v[44:45], v16 offset:10240
    s_add_u32 m0, s77, 24576
    v_mfma_f32_16x16x32_bf16 v[76:79], v[28:31], v[204:207], v[76:79]
    ds_read_b64_tr_b16 v[46:47], v16 offset:11520
    buffer_load_dwordx4 v12, s[8:11], s74 offen offset:2048  lds
    s_waitcnt lgkmcnt(6)
    v_mfma_f32_16x16x32_bf16 v[80:83], v[32:35], v[192:195], v[80:83]
    v_add_u32 v17, 24576, v17
    ds_read_b64_tr_b16 v[24:25], v17 offset:16
    s_add_u32 m0, s76, 16384
    v_mfma_f32_16x16x32_bf16 v[80:83], v[36:39], v[200:203], v[80:83]
    ds_read_b64_tr_b16 v[26:27], v17 offset:1296
    buffer_load_dwordx4 v8, s[4:7], s73 offen  lds
    v_mfma_f32_16x16x32_bf16 v[84:87], v[32:35], v[196:199], v[84:87]
    ds_read_b64_tr_b16 v[28:29], v17 offset:10256
    v_mfma_f32_16x16x32_bf16 v[84:87], v[36:39], v[204:207], v[84:87]
    ds_read_b64_tr_b16 v[30:31], v17 offset:11536
    s_waitcnt lgkmcnt(4)
    v_mfma_f32_16x16x32_bf16 v[48:51], v[40:43], v[208:211], v[48:51]
    ds_read_b64_tr_b16 v[32:33], v17 offset:80
    s_add_u32 m0, s76, 16384
    v_mfma_f32_16x16x32_bf16 v[48:51], v[44:47], v[216:219], v[48:51]
    ds_read_b64_tr_b16 v[34:35], v17 offset:1360
    buffer_load_dwordx4 v9, s[4:7], s73 offen offset:1024  lds
    v_mfma_f32_16x16x32_bf16 v[52:55], v[40:43], v[212:215], v[52:55]
    ds_read_b64_tr_b16 v[36:37], v17 offset:10320
    v_mfma_f32_16x16x32_bf16 v[52:55], v[44:47], v[220:223], v[52:55]
    ds_read_b64_tr_b16 v[38:39], v17 offset:11600
    s_waitcnt lgkmcnt(4)
    v_mfma_f32_16x16x32_bf16 v[56:59], v[24:27], v[208:211], v[56:59]
    ds_read_b64_tr_b16 v[40:41], v16 offset:96
    v_mfma_f32_16x16x32_bf16 v[56:59], v[28:31], v[216:219], v[56:59]
    ds_read_b64_tr_b16 v[42:43], v16 offset:1376
    v_mfma_f32_16x16x32_bf16 v[60:63], v[24:27], v[212:215], v[60:63]
    ds_read_b64_tr_b16 v[44:45], v16 offset:10336
    v_mfma_f32_16x16x32_bf16 v[60:63], v[28:31], v[220:223], v[60:63]
    s_waitcnt vmcnt(5)
    s_barrier
    s_cmp_eq_u32 s91, 7
    s_cbranch_scc1 L_at_N1_7
L_at_N1_7b:
    ds_read_b64_tr_b16 v[46:47], v16 offset:11616
    ds_read_b128 v[224:227], v4 offset:0
    s_add_u32 m0, s78, 49152
    s_nop 0
    buffer_load_dwordx4 v13, s[12:15], s75 offen  lds
    s_waitcnt lgkmcnt(5)
    v_mfma_f32_16x16x32_bf16 v[64:67], v[32:35], v[208:211], v[64:67]
    v_add_u32 v6, 24576, v6
    ds_read_b64_tr_b16 v[24:25], v6 offset:0
    s_add_u32 m0, s78, 49152
    v_mfma_f32_16x16x32_bf16 v[64:67], v[36:39], v[216:219], v[64:67]
    ds_read_b64_tr_b16 v[26:27], v6 offset:1280
    ds_read_b128 v[228:231], v4 offset:2048
    buffer_load_dwordx4 v14, s[12:15], s75 offen offset:1024  lds
    v_mfma_f32_16x16x32_bf16 v[68:71], v[32:35], v[212:215], v[68:71]
    ds_read_b64_tr_b16 v[28:29], v6 offset:10240
    v_mfma_f32_16x16x32_bf16 v[68:71], v[36:39], v[220:223], v[68:71]
    ds_read_b64_tr_b16 v[30:31], v6 offset:11520
    ds_read_b128 v[232:235], v5 offset:0
    s_cmp_lt_u32 s64, 4
    s_mov_b32 s89, 2949120
    s_cselect_b32 s89, 327680, s89
    s_cselect_b32 s71, 0, 8
    s_movk_i32 s72, 0x80
    s_cselect_b32 s72, 0x100, s72
    s_cselect_b32 s70, 0x3ea52b5c, 1.0
    s_waitcnt lgkmcnt(7)
    v_mfma_f32_16x16x32_bf16 v[72:75], v[40:43], v[208:211], v[72:75]
    v_subrev_u32 v16, 73728, v16
    ds_read_b64_tr_b16 v[32:33], v16 offset:0
    v_mfma_f32_16x16x32_bf16 v[72:75], v[44:47], v[216:219], v[72:75]
    ds_read_b64_tr_b16 v[34:35], v16 offset:1280
    ds_read_b128 v[236:239], v5 offset:2048
    v_mov_b32 v8, s70
    v_mov_b32 v9, s70
    s_and_b32 s68, s64, 3
    s_lshl_b32 s68, s68, 9
    s_lshl_b32 s69, s39, 2
    v_mfma_f32_16x16x32_bf16 v[76:79], v[40:43], v[212:215], v[76:79]
    ds_read_b64_tr_b16 v[36:37], v16 offset:10240
    v_mfma_f32_16x16x32_bf16 v[76:79], v[44:47], v[220:223], v[76:79]
    ds_read_b64_tr_b16 v[38:39], v16 offset:11520
    s_add_u32 s68, s68, s69
    s_add_u32 s68, s68, s37
    s_mul_i32 s68, s68, 1280
    s_add_u32 s89, s89, s68
    v_and_b32 v1, 15, v0
    s_waitcnt lgkmcnt(6)
    v_mfma_f32_16x16x32_bf16 v[80:83], v[24:27], v[208:211], v[80:83]
    v_subrev_u32 v17, 73728, v17
    ds_read_b64_tr_b16 v[40:41], v17 offset:16
    s_add_u32 m0, s78, 49152
    v_mfma_f32_16x16x32_bf16 v[80:83], v[28:31], v[216:219], v[80:83]
    ds_read_b64_tr_b16 v[42:43], v17 offset:1296
    buffer_load_dwordx4 v15, s[12:15], s75 offen offset:2048  lds
    s_add_u32 s75, s75, 221184
    s_cmp_eq_u32 s88, 9
    s_cmov_b32 s75, s93
    v_mfma_f32_16x16x32_bf16 v[84:87], v[24:27], v[212:215], v[84:87]
    ds_read_b64_tr_b16 v[44:45], v17 offset:10256
    v_mfma_f32_16x16x32_bf16 v[84:87], v[28:31], v[220:223], v[84:87]
    ds_read_b64_tr_b16 v[46:47], v17 offset:11536
    v_bfe_u32 v2, v0, 3, 1
    v_mul_u32_u24 v2, s71, v2
    v_add_u32 v3, v1, v2
    v_lshrrev_b32 v2, 5, v0
    v_bfe_u32 v12, v0, 4, 1
    s_waitcnt lgkmcnt(4)
    v_mfma_f32_16x16x32_bf16 v[48:51], v[32:35], v[224:227], v[48:51]
    ds_read_b64_tr_b16 v[24:25], v17 offset:80
    v_mfma_f32_16x16x32_bf16 v[48:51], v[36:39], v[232:235], v[48:51]
    ds_read_b64_tr_b16 v[26:27], v17 offset:1360
    v_mul_u32_u24 v10, 81920, v2
    v_lshl_add_u32 v10, v12, 9, v10
    v_lshl_add_u32 v10, v3, 4, v10
    v_lshl_add_u32 v11, v2, 2, v12
    v_mul_u32_u24 v11, 81920, v11
    v_mfma_f32_16x16x32_bf16 v[52:55], v[32:35], v[228:231], v[52:55]
    ds_read_b64_tr_b16 v[28:29], v17 offset:10320
    v_mfma_f32_16x16x32_bf16 v[52:55], v[36:39], v[236:239], v[52:55]
    ds_read_b64_tr_b16 v[30:31], v17 offset:11600
    v_lshl_add_u32 v11, v1, 3, v11
    s_waitcnt lgkmcnt(4)
    v_mfma_f32_16x16x32_bf16 v[56:59], v[40:43], v[224:227], v[56:59]
    ds_read_b64_tr_b16 v[32:33], v16 offset:96
    v_mfma_f32_16x16x32_bf16 v[56:59], v[44:47], v[232:235], v[56:59]
    ds_read_b64_tr_b16 v[34:35], v16 offset:1376
    v_mfma_f32_16x16x32_bf16 v[60:63], v[40:43], v[228:231], v[60:63]
    ds_read_b64_tr_b16 v[36:37], v16 offset:10336
    v_mfma_f32_16x16x32_bf16 v[60:63], v[44:47], v[236:239], v[60:63]
    s_waitcnt vmcnt(3)
    s_barrier
    s_cmp_eq_u32 s91, 8
    s_cbranch_scc1 L_at_N1_8
L_at_N1_8b:
    ds_read_b64_tr_b16 v[38:39], v16 offset:11616
    ds_read_b128 v[240:243], v4 offset:16384
    s_waitcnt lgkmcnt(5)
    v_mfma_f32_16x16x32_bf16 v[64:67], v[24:27], v[224:227], v[64:67]
    v_subrev_u32 v6, 73728, v6
    ds_read_b64_tr_b16 v[40:41], v6 offset:0
    v_mfma_f32_16x16x32_bf16 v[64:67], v[28:31], v[232:235], v[64:67]
    ds_read_b64_tr_b16 v[42:43], v6 offset:1280
    ds_read_b128 v[244:247], v4 offset:18432
    v_mfma_f32_16x16x32_bf16 v[68:71], v[24:27], v[228:231], v[68:71]
    ds_read_b64_tr_b16 v[44:45], v6 offset:10240
    s_add_u32 m0, s78, 73728
    v_mfma_f32_16x16x32_bf16 v[68:71], v[28:31], v[236:239], v[68:71]
    ds_read_b64_tr_b16 v[46:47], v6 offset:11520
    ds_read_b128 v[248:251], v5 offset:16384
    buffer_load_dwordx4 v13, s[12:15], s75 offen  lds
    s_waitcnt lgkmcnt(7)
    v_mfma_f32_16x16x32_bf16 v[72:75], v[32:35], v[224:227], v[72:75]
    v_add_u32 v16, 24576, v16
    ds_read_b64_tr_b16 v[24:25], v16 offset:0
    v_mfma_f32_16x16x32_bf16 v[72:75], v[36:39], v[232:235], v[72:75]
    ds_read_b64_tr_b16 v[26:27], v16 offset:1280
    ds_read_b128 v[252:255], v5 offset:18432
    v_mfma_f32_16x16x32_bf16 v[76:79], v[32:35], v[228:231], v[76:79]
    ds_read_b64_tr_b16 v[28:29], v16 offset:10240
    s_add_u32 m0, s78, 73728
    v_mfma_f32_16x16x32_bf16 v[76:79], v[36:39], v[236:239], v[76:79]
    ds_read_b64_tr_b16 v[30:31], v16 offset:11520
    buffer_load_dwordx4 v14, s[12:15], s75 offen offset:1024  lds
    s_waitcnt lgkmcnt(6)
    v_mfma_f32_16x16x32_bf16 v[80:83], v[40:43], v[224:227], v[80:83]
    v_add_u32 v17, 24576, v17
    ds_read_b64_tr_b16 v[32:33], v17 offset:16
    v_mfma_f32_16x16x32_bf16 v[80:83], v[44:47], v[232:235], v[80:83]
    ds_read_b64_tr_b16 v[34:35], v17 offset:1296
    v_mfma_f32_16x16x32_bf16 v[84:87], v[40:43], v[228:231], v[84:87]
    ds_read_b64_tr_b16 v[36:37], v17 offset:10256
    s_add_u32 m0, s78, 73728
    v_mfma_f32_16x16x32_bf16 v[84:87], v[44:47], v[236:239], v[84:87]
    ds_read_b64_tr_b16 v[38:39], v17 offset:11536
    buffer_load_dwordx4 v15, s[12:15], s75 offen offset:2048  lds
    s_add_u32 s75, s75, 221184
    s_cmp_eq_u32 s88, 8
    s_cmov_b32 s75, s93
    s_waitcnt lgkmcnt(4)
    v_mfma_f32_16x16x32_bf16 v[48:51], v[24:27], v[240:243], v[48:51]
    ds_read_b64_tr_b16 v[40:41], v17 offset:80
    v_mfma_f32_16x16x32_bf16 v[48:51], v[28:31], v[248:251], v[48:51]
    ds_read_b64_tr_b16 v[42:43], v17 offset:1360
    v_mfma_f32_16x16x32_bf16 v[52:55], v[24:27], v[244:247], v[52:55]
    ds_read_b64_tr_b16 v[44:45], v17 offset:10320
    v_mfma_f32_16x16x32_bf16 v[52:55], v[28:31], v[252:255], v[52:55]
    ds_read_b64_tr_b16 v[46:47], v17 offset:11600
    s_waitcnt lgkmcnt(4)
    v_mfma_f32_16x16x32_bf16 v[56:59], v[32:35], v[240:243], v[56:59]
    ds_read_b64_tr_b16 v[24:25], v16 offset:96
    v_mfma_f32_16x16x32_bf16 v[56:59], v[36:39], v[248:251], v[56:59]
    ds_read_b64_tr_b16 v[26:27], v16 offset:1376
    v_mfma_f32_16x16x32_bf16 v[60:63], v[32:35], v[244:247], v[60:63]
    ds_read_b64_tr_b16 v[28:29], v16 offset:10336
    v_mfma_f32_16x16x32_bf16 v[60:63], v[36:39], v[252:255], v[60:63]
    s_waitcnt vmcnt(3)
    s_barrier
    ds_read_b64_tr_b16 v[30:31], v16 offset:11616
    s_waitcnt lgkmcnt(4)
    v_mfma_f32_16x16x32_bf16 v[64:67], v[40:43], v[240:243], v[64:67]
    v_add_u32 v6, 24576, v6
    ds_read_b64_tr_b16 v[32:33], v6 offset:0
    v_mfma_f32_16x16x32_bf16 v[64:67], v[44:47], v[248:251], v[64:67]
    ds_read_b64_tr_b16 v[34:35], v6 offset:1280
    v_mfma_f32_16x16x32_bf16 v[68:71], v[40:43], v[244:247], v[68:71]
    ds_read_b64_tr_b16 v[36:37], v6 offset:10240
    s_add_u32 m0, s78, 0
    v_mfma_f32_16x16x32_bf16 v[68:71], v[44:47], v[252:255], v[68:71]
    ds_read_b64_tr_b16 v[38:39], v6 offset:11520
    buffer_load_dwordx4 v13, s[12:15], s75 offen  lds
    s_waitcnt lgkmcnt(4)
    v_mfma_f32_16x16x32_bf16 v[72:75], v[24:27], v[240:243], v[72:75]
    v_mfma_f32_16x16x32_bf16 v[72:75], v[28:31], v[248:251], v[72:75]
    v_mfma_f32_16x16x32_bf16 v[76:79], v[24:27], v[244:247], v[76:79]
    s_add_u32 m0, s78, 0
    v_mfma_f32_16x16x32_bf16 v[76:79], v[28:31], v[252:255], v[76:79]
    buffer_load_dwordx4 v14, s[12:15], s75 offen offset:1024  lds
    s_waitcnt lgkmcnt(0)
    v_mfma_f32_16x16x32_bf16 v[80:83], v[32:35], v[240:243], v[80:83]
    ds_read_b64_tr_b16 v[24:25], v18 offset:0
    v_mfma_f32_16x16x32_bf16 v[80:83], v[36:39], v[248:251], v[80:83]
    ds_read_b64_tr_b16 v[26:27], v18 offset:768
    v_mfma_f32_16x16x32_bf16 v[84:87], v[32:35], v[244:247], v[84:87]
    ds_read_b64_tr_b16 v[28:29], v18 offset:6144
    s_add_u32 m0, s78, 0
    v_mfma_f32_16x16x32_bf16 v[84:87], v[36:39], v[252:255], v[84:87]
    ds_read_b64_tr_b16 v[30:31], v18 offset:6912
    buffer_load_dwordx4 v15, s[12:15], s75 offen offset:2048  lds
    s_add_u32 s75, s75, 221184
    s_cmp_eq_u32 s88, 7
    s_cmov_b32 s75, s93
    ds_read_b64_tr_b16 v[32:33], v18 offset:12288
    ds_read_b64_tr_b16 v[34:35], v18 offset:13056
    ds_read_b64_tr_b16 v[36:37], v18 offset:18432
    ds_read_b64_tr_b16 v[38:39], v18 offset:19200
    ds_read_b64_tr_b16 v[40:41], v19 offset:0
    ds_read_b64_tr_b16 v[42:43], v19 offset:768
    ds_read_b64_tr_b16 v[44:45], v19 offset:6144
    ds_read_b64_tr_b16 v[46:47], v19 offset:6912
    v_pk_mul_f32 v[48:49], v[48:49], v[8:9]
    v_pk_mul_f32 v[50:51], v[50:51], v[8:9]
    v_pk_mul_f32 v[56:57], v[56:57], v[8:9]
    v_pk_mul_f32 v[58:59], v[58:59], v[8:9]
    s_add_u32 s68, s89, 327680
    v_cvt_pk_bf16_f32 v48, v48, v49
    v_cvt_pk_bf16_f32 v49, v50, v51
    v_cvt_pk_bf16_f32 v50, v56, v57
    v_cvt_pk_bf16_f32 v51, v58, v59
    buffer_store_dwordx4 v[48:51], v10, s[16:19], s68 offen sc1
    v_pk_mul_f32 v[52:53], v[52:53], v[8:9]
    v_pk_mul_f32 v[54:55], v[54:55], v[8:9]
    v_pk_mul_f32 v[60:61], v[60:61], v[8:9]
    v_pk_mul_f32 v[62:63], v[62:63], v[8:9]
    s_add_u32 s68, s68, s72
    v_cvt_pk_bf16_f32 v52, v52, v53
    v_cvt_pk_bf16_f32 v53, v54, v55
    v_cvt_pk_bf16_f32 v54, v60, v61
    v_cvt_pk_bf16_f32 v55, v62, v63
    buffer_store_dwordx4 v[52:55], v10, s[16:19], s68 offen sc1
    v_pk_mul_f32 v[64:65], v[64:65], v[8:9]
    v_pk_mul_f32 v[66:67], v[66:67], v[8:9]
    v_pk_mul_f32 v[72:73], v[72:73], v[8:9]
    v_pk_mul_f32 v[74:75], v[74:75], v[8:9]
    s_add_u32 s68, s89, 491520
    v_cvt_pk_bf16_f32 v64, v64, v65
    v_cvt_pk_bf16_f32 v65, v66, v67
    v_cvt_pk_bf16_f32 v66, v72, v73
    v_cvt_pk_bf16_f32 v67, v74, v75
    buffer_store_dwordx4 v[64:67], v10, s[16:19], s68 offen sc1
    v_pk_mul_f32 v[68:69], v[68:69], v[8:9]
    v_pk_mul_f32 v[70:71], v[70:71], v[8:9]
    v_pk_mul_f32 v[76:77], v[76:77], v[8:9]
    v_pk_mul_f32 v[78:79], v[78:79], v[8:9]
    s_add_u32 s68, s68, s72
    v_cvt_pk_bf16_f32 v68, v68, v69
    v_cvt_pk_bf16_f32 v69, v70, v71
    v_cvt_pk_bf16_f32 v70, v76, v77
    v_cvt_pk_bf16_f32 v71, v78, v79
    buffer_store_dwordx4 v[68:71], v10, s[16:19], s68 offen sc1
    v_pk_mul_f32 v[80:81], v[80:81], v[8:9]
    v_pk_mul_f32 v[82:83], v[82:83], v[8:9]
    s_add_u32 s68, s89, 163840
    v_cvt_pk_bf16_f32 v80, v80, v81
    v_cvt_pk_bf16_f32 v81, v82, v83
    buffer_store_dwordx2 v[80:81], v11, s[16:19], s68 offen offset:1024 sc1
    v_pk_mul_f32 v[84:85], v[84:85], v[8:9]
    v_pk_mul_f32 v[86:87], v[86:87], v[8:9]
    v_cvt_pk_bf16_f32 v84, v84, v85
    v_cvt_pk_bf16_f32 v85, v86, v87
    buffer_store_dwordx2 v[84:85], v11, s[16:19], s68 offen offset:1152 sc1
    s_branch L_pass2
L_S0:
    v_mul_u32_u24 v1, 320, v21
    v_and_b32 v2, 1, v23
    v_lshrrev_b32 v3, 1, v23
    v_lshlrev_b32 v25, 5, v3
    v_lshl_add_u32 v25, v2, 3, v25
    v_add_u32 v25, 8, v25
    v_lshlrev_b32 v22, 4, v22
    v_xor_b32 v26, v25, v22
    v_add_u32 v16, v1, v26
    v_add_u32 v25, 16, v25
    v_xor_b32 v26, v25, v22
    v_subrev_u32 v26, 16, v26
    v_add_u32 v17, v1, v26
    v_mul_u32_u24 v2, 72, v2
    v_mul_u32_u24 v3, 160, v3
    v_add3_u32 v2, v2, v3, 0
    v_xor_b32 v2, v2, v22
    v_add_u32 v6, v1, v2
    s_and_b32 s68, s2, 1
    s_lshl_b32 s68, s68, 7
    s_cmp_eq_u32 s36, 0
    s_cselect_b32 s68, s68, 1073741824
    v_mov_b32 v22, 1073741824
    v_writelane_b32 v22, s68, 0
    v_mov_b32 v21, 1
    s_bfe_u32 s91, s2, 0x30003
    s_add_u32 s91, s91, 1
    s_cmp_eq_u32 s36, 0
    s_cselect_b32 s91, s91, 0
    s_lshl_b32 s68, s80, 6
    s_add_u32 s69, s68, s37
    s_mul_i32 s69, s69, 1280
    s_cmp_eq_u32 s38, 0
    s_mov_b32 s82, 5570560
    s_cselect_b32 s82, 2949120, s82
    s_add_u32 s82, s82, s69
    s_mul_i32 s83, s36, 1280
    s_add_u32 s83, s83, 122880
    s_and_b32 s96, s36, 1
    s_lshl_b32 s96, s96, 1
    s_add_u32 s96, s96, s38
    s_lshr_b32 s97, s37, 1
    s_lshl_b32 s68, s81, 2
    s_lshr_b32 s69, s36, 1
    s_add_u32 s68, s68, s69
    s_mul_i32 s68, s68, 19
    s_and_b32 s69, s36, 1
    s_add_u32 s68, s68, s69
    s_mul_i32 s68, s68, 5120
    s_add_u32 s84, s68, 17891328
    s_lshl_b32 s68, s80, 1
    s_add_u32 s68, s68, s97
    s_mul_i32 s68, s68, 108
    s_mul_i32 s69, s96, 14
    s_add_u32 s68, s68, s69
    s_lshr_b32 s69, s96, 1
    s_sub_u32 s68, s68, s69
    s_lshl_b32 s68, s68, 10
    s_add_u32 s68, s68, 10813440
    s_mul_i32 s69, s38, 55296
    s_add_u32 s86, s68, s69
    s_sub_u32 s68, s68, s69
    s_add_u32 s98, s68, 55296
    s_mul_i32 s69, s38, 14336
    s_sub_u32 s69, 13312, s69
    s_add_u32 s92, s86, s69
    s_mov_b64 exec, 0x7777
    buffer_load_dwordx2 v[254:255], v28, s[8:11], s89 offen offset:60
    s_mov_b64 exec, -1
    global_load_dwordx2 v[254:255], v[30:31], off offset:60
    buffer_store_dword v33, v32, s[16:19], 0 offen sc1
    s_waitcnt vmcnt(7)
    s_barrier
    ds_read_b128 v[96:99], v4 offset:0
    ds_read_b128 v[100:103], v4 offset:2048
    ds_read_b128 v[104:107], v5 offset:0
    ds_read_b128 v[108:111], v5 offset:2048
    ds_read_b64_tr_b16 v[24:25], v16 offset:0
    ds_read_b64_tr_b16 v[26:27], v16 offset:1280
    ds_read_b64_tr_b16 v[28:29], v16 offset:10240
    ds_read_b64_tr_b16 v[30:31], v16 offset:11520
    ds_read_b64_tr_b16 v[32:33], v17 offset:16
    ds_read_b64_tr_b16 v[34:35], v17 offset:1296
    ds_read_b64_tr_b16 v[36:37], v17 offset:10256
    ds_read_b64_tr_b16 v[38:39], v17 offset:11536
    ds_read_b64_tr_b16 v[40:41], v17 offset:80
    ds_read_b64_tr_b16 v[42:43], v17 offset:1360
    ds_read_b64_tr_b16 v[44:45], v17 offset:10320
    ds_read_b64_tr_b16 v[46:47], v17 offset:11600
    s_waitcnt lgkmcnt(8)
    v_mfma_f32_16x16x32_bf16 v[48:51], v[96:99], v[24:27], 0
    s_add_u32 m0, s77, 49152
    v_mfma_f32_16x16x32_bf16 v[48:51], v[104:107], v[28:31], v[48:51]
    buffer_load_dwordx4 v10, s[8:11], s74 offen  lds
    v_mfma_f32_16x16x32_bf16 v[52:55], v[100:103], v[24:27], 0
    s_add_u32 m0, s77, 49152
    v_mfma_f32_16x16x32_bf16 v[52:55], v[108:111], v[28:31], v[52:55]
    buffer_load_dwordx4 v11, s[8:11], s74 offen offset:1024  lds
    s_add_u32 s74, s74, s79
    s_cmp_eq_u32 s88, 7
    s_cmov_b32 s74, s90
    s_waitcnt lgkmcnt(4)
    v_mfma_f32_16x16x32_bf16 v[56:59], v[96:99], v[32:35], 0
    ds_read_b64_tr_b16 v[24:25], v16 offset:96
    s_add_u32 m0, s76, 32768
    v_mfma_f32_16x16x32_bf16 v[56:59], v[104:107], v[36:39], v[56:59]
    ds_read_b64_tr_b16 v[26:27], v16 offset:1376
    buffer_load_dwordx4 v8, s[4:7], s73 offen  lds
    s_add_u32 m0, s76, 32768
    s_nop 0
    buffer_load_dwordx4 v9, s[4:7], s73 offen offset:1024  lds
    s_add_u32 s73, s73, 128
    s_cmp_eq_u32 s88, 7
    s_cmov_b32 s73, 0
    v_mfma_f32_16x16x32_bf16 v[60:63], v[100:103], v[32:35], 0
    ds_read_b64_tr_b16 v[28:29], v16 offset:10336
    v_mfma_f32_16x16x32_bf16 v[60:63], v[108:111], v[36:39], v[60:63]
    s_waitcnt vmcnt(7)
    s_barrier
    ds_read_b64_tr_b16 v[30:31], v16 offset:11616
    ds_read_b128 v[112:115], v4 offset:16384
    s_waitcnt lgkmcnt(5)
    v_mfma_f32_16x16x32_bf16 v[64:67], v[96:99], v[40:43], 0
    ds_read_b64_tr_b16 v[32:33], v6 offset:0
    s_add_u32 m0, s77, 73728
    v_mfma_f32_16x16x32_bf16 v[64:67], v[104:107], v[44:47], v[64:67]
    ds_read_b64_tr_b16 v[34:35], v6 offset:1280
    ds_read_b128 v[116:119], v4 offset:18432
    buffer_load_dwordx4 v10, s[8:11], s74 offen  lds
    v_mfma_f32_16x16x32_bf16 v[68:71], v[100:103], v[40:43], 0
    ds_read_b64_tr_b16 v[36:37], v6 offset:10240
    v_mfma_f32_16x16x32_bf16 v[68:71], v[108:111], v[44:47], v[68:71]
    ds_read_b64_tr_b16 v[38:39], v6 offset:11520
    ds_read_b128 v[120:123], v5 offset:16384
    s_waitcnt lgkmcnt(7)
    v_mfma_f32_16x16x32_bf16 v[72:75], v[96:99], v[24:27], 0
    v_add_u32 v16, 24576, v16
    ds_read_b64_tr_b16 v[40:41], v16 offset:0
    s_add_u32 m0, s77, 73728
    v_mfma_f32_16x16x32_bf16 v[72:75], v[104:107], v[28:31], v[72:75]
    ds_read_b64_tr_b16 v[42:43], v16 offset:1280
    ds_read_b128 v[124:127], v5 offset:18432
    buffer_load_dwordx4 v11, s[8:11], s74 offen offset:1024  lds
    s_add_u32 s74, s74, s79
    s_cmp_eq_u32 s88, 6
    s_cmov_b32 s74, s90
    v_mfma_f32_16x16x32_bf16 v[76:79], v[100:103], v[24:27], 0
    ds_read_b64_tr_b16 v[44:45], v16 offset:10240
    v_mfma_f32_16x16x32_bf16 v[76:79], v[108:111], v[28:31], v[76:79]
    ds_read_b64_tr_b16 v[46:47], v16 offset:11520
    s_waitcnt lgkmcnt(6)
    v_mfma_f32_16x16x32_bf16 v[80:83], v[96:99], v[32:35], 0
    v_add_u32 v17, 24576, v17
    ds_read_b64_tr_b16 v[24:25], v17 offset:16
    s_add_u32 m0, s76, 49152
    v_mfma_f32_16x16x32_bf16 v[80:83], v[104:107], v[36:39], v[80:83]
    ds_read_b64_tr_b16 v[26:27], v17 offset:1296
    buffer_load_dwordx4 v8, s[4:7], s73 offen  lds
    v_mfma_f32_16x16x32_bf16 v[84:87], v[100:103], v[32:35], 0
    ds_read_b64_tr_b16 v[28:29], v17 offset:10256
    v_mfma_f32_16x16x32_bf16 v[84:87], v[108:111], v[36:39], v[84:87]
    ds_read_b64_tr_b16 v[30:31], v17 offset:11536
    s_waitcnt lgkmcnt(4)
    v_mfma_f32_16x16x32_bf16 v[48:51], v[112:115], v[40:43], v[48:51]
    ds_read_b64_tr_b16 v[32:33], v17 offset:80
    s_add_u32 m0, s76, 49152
    v_mfma_f32_16x16x32_bf16 v[48:51], v[120:123], v[44:47], v[48:51]
    ds_read_b64_tr_b16 v[34:35], v17 offset:1360
    buffer_load_dwordx4 v9, s[4:7], s73 offen offset:1024  lds
    s_add_u32 s73, s73, 128
    s_cmp_eq_u32 s88, 6
    s_cmov_b32 s73, 0
    v_mfma_f32_16x16x32_bf16 v[52:55], v[116:119], v[40:43], v[52:55]
    ds_read_b64_tr_b16 v[36:37], v17 offset:10320
    v_mfma_f32_16x16x32_bf16 v[52:55], v[124:127], v[44:47], v[52:55]
    ds_read_b64_tr_b16 v[38:39], v17 offset:11600
    s_waitcnt lgkmcnt(4)
    v_mfma_f32_16x16x32_bf16 v[56:59], v[112:115], v[24:27], v[56:59]
    ds_read_b64_tr_b16 v[40:41], v16 offset:96
    v_mfma_f32_16x16x32_bf16 v[56:59], v[120:123], v[28:31], v[56:59]
    ds_read_b64_tr_b16 v[42:43], v16 offset:1376
    v_mfma_f32_16x16x32_bf16 v[60:63], v[116:119], v[24:27], v[60:63]
    ds_read_b64_tr_b16 v[44:45], v16 offset:10336
    v_mfma_f32_16x16x32_bf16 v[60:63], v[124:127], v[28:31], v[60:63]
    s_waitcnt vmcnt(4)
    s_barrier
    s_cmp_eq_u32 s91, 1
    s_cbranch_scc1 L_at_S0_1
L_at_S0_1b:
    ds_read_b64_tr_b16 v[46:47], v16 offset:11616
    ds_read_b128 v[128:131], v4 offset:32768
    s_waitcnt lgkmcnt(5)
    v_mfma_f32_16x16x32_bf16 v[64:67], v[112:115], v[32:35], v[64:67]
    v_add_u32 v6, 24576, v6
    ds_read_b64_tr_b16 v[24:25], v6 offset:0
    s_add_u32 m0, s77, 0
    v_mfma_f32_16x16x32_bf16 v[64:67], v[120:123], v[36:39], v[64:67]
    ds_read_b64_tr_b16 v[26:27], v6 offset:1280
    ds_read_b128 v[132:135], v4 offset:34816
    buffer_load_dwordx4 v10, s[8:11], s74 offen  lds
    v_mfma_f32_16x16x32_bf16 v[68:71], v[116:119], v[32:35], v[68:71]
    ds_read_b64_tr_b16 v[28:29], v6 offset:10240
    v_mfma_f32_16x16x32_bf16 v[68:71], v[124:127], v[36:39], v[68:71]
    ds_read_b64_tr_b16 v[30:31], v6 offset:11520
    ds_read_b128 v[136:139], v5 offset:32768
    s_waitcnt lgkmcnt(7)
    v_mfma_f32_16x16x32_bf16 v[72:75], v[112:115], v[40:43], v[72:75]
    v_add_u32 v16, 24576, v16
    ds_read_b64_tr_b16 v[32:33], v16 offset:0
    s_add_u32 m0, s77, 0
    v_mfma_f32_16x16x32_bf16 v[72:75], v[120:123], v[44:47], v[72:75]
    ds_read_b64_tr_b16 v[34:35], v16 offset:1280
    ds_read_b128 v[140:143], v5 offset:34816
    buffer_load_dwordx4 v11, s[8:11], s74 offen offset:1024  lds
    s_add_u32 s74, s74, s79
    s_cmp_eq_u32 s88, 5
    s_cmov_b32 s74, s90
    v_mfma_f32_16x16x32_bf16 v[76:79], v[116:119], v[40:43], v[76:79]
    ds_read_b64_tr_b16 v[36:37], v16 offset:10240
    v_mfma_f32_16x16x32_bf16 v[76:79], v[124:127], v[44:47], v[76:79]
    ds_read_b64_tr_b16 v[38:39], v16 offset:11520
    s_waitcnt lgkmcnt(6)
    v_mfma_f32_16x16x32_bf16 v[80:83], v[112:115], v[24:27], v[80:83]
    v_add_u32 v17, 24576, v17
    ds_read_b64_tr_b16 v[40:41], v17 offset:16
    s_add_u32 m0, s76, 0
    v_mfma_f32_16x16x32_bf16 v[80:83], v[120:123], v[28:31], v[80:83]
    ds_read_b64_tr_b16 v[42:43], v17 offset:1296
    buffer_load_dwordx4 v8, s[4:7], s73 offen  lds
    v_mfma_f32_16x16x32_bf16 v[84:87], v[116:119], v[24:27], v[84:87]
    ds_read_b64_tr_b16 v[44:45], v17 offset:10256
    v_mfma_f32_16x16x32_bf16 v[84:87], v[124:127], v[28:31], v[84:87]
    ds_read_b64_tr_b16 v[46:47], v17 offset:11536
    s_mov_b64 exec, 0xff
    buffer_load_dword v7, v7, s[12:15], s85 offen
    s_mov_b64 exec, -1
    s_waitcnt lgkmcnt(4)
    v_mfma_f32_16x16x32_bf16 v[48:51], v[128:131], v[32:35], v[48:51]
    ds_read_b64_tr_b16 v[24:25], v17 offset:80
    s_add_u32 m0, s76, 0
    v_mfma_f32_16x16x32_bf16 v[48:51], v[136:139], v[36:39], v[48:51]
    ds_read_b64_tr_b16 v[26:27], v17 offset:1360
    buffer_load_dwordx4 v9, s[4:7], s73 offen offset:1024  lds
    s_add_u32 s73, s73, 128
    s_cmp_eq_u32 s88, 5
    s_cmov_b32 s73, 0
    v_mfma_f32_16x16x32_bf16 v[52:55], v[132:135], v[32:35], v[52:55]
    ds_read_b64_tr_b16 v[28:29], v17 offset:10320
    v_mfma_f32_16x16x32_bf16 v[52:55], v[140:143], v[36:39], v[52:55]
    ds_read_b64_tr_b16 v[30:31], v17 offset:11600
    s_waitcnt lgkmcnt(4)
    v_mfma_f32_16x16x32_bf16 v[56:59], v[128:131], v[40:43], v[56:59]
    ds_read_b64_tr_b16 v[32:33], v16 offset:96
    v_mfma_f32_16x16x32_bf16 v[56:59], v[136:139], v[44:47], v[56:59]
    ds_read_b64_tr_b16 v[34:35], v16 offset:1376
    v_mfma_f32_16x16x32_bf16 v[60:63], v[132:135], v[40:43], v[60:63]
    ds_read_b64_tr_b16 v[36:37], v16 offset:10336
    v_mfma_f32_16x16x32_bf16 v[60:63], v[140:143], v[44:47], v[60:63]
    s_waitcnt vmcnt(5)
    s_barrier
    s_cmp_eq_u32 s91, 2
    s_cbranch_scc1 L_at_S0_2
L_at_S0_2b:
    ds_read_b64_tr_b16 v[38:39], v16 offset:11616
    ds_read_b128 v[144:147], v4 offset:49152
    s_waitcnt lgkmcnt(5)
    v_mfma_f32_16x16x32_bf16 v[64:67], v[128:131], v[24:27], v[64:67]
    v_add_u32 v6, 24576, v6
    ds_read_b64_tr_b16 v[40:41], v6 offset:0
    s_add_u32 m0, s77, 24576
    v_mfma_f32_16x16x32_bf16 v[64:67], v[136:139], v[28:31], v[64:67]
    ds_read_b64_tr_b16 v[42:43], v6 offset:1280
    ds_read_b128 v[148:151], v4 offset:51200
    buffer_load_dwordx4 v10, s[8:11], s74 offen  lds
    v_mfma_f32_16x16x32_bf16 v[68:71], v[132:135], v[24:27], v[68:71]
    ds_read_b64_tr_b16 v[44:45], v6 offset:10240
    v_mfma_f32_16x16x32_bf16 v[68:71], v[140:143], v[28:31], v[68:71]
    ds_read_b64_tr_b16 v[46:47], v6 offset:11520
    ds_read_b128 v[152:155], v5 offset:49152
    s_waitcnt lgkmcnt(7)
    v_mfma_f32_16x16x32_bf16 v[72:75], v[128:131], v[32:35], v[72:75]
    v_add_u32 v16, 24576, v16
    ds_read_b64_tr_b16 v[24:25], v16 offset:0
    s_add_u32 m0, s77, 24576
    v_mfma_f32_16x16x32_bf16 v[72:75], v[136:139], v[36:39], v[72:75]
    ds_read_b64_tr_b16 v[26:27], v16 offset:1280
    ds_read_b128 v[156:159], v5 offset:51200
    buffer_load_dwordx4 v11, s[8:11], s74 offen offset:1024  lds
    s_add_u32 s74, s74, s79
    s_cmp_eq_u32 s88, 4
    s_cmov_b32 s74, s90
    v_mfma_f32_16x16x32_bf16 v[76:79], v[132:135], v[32:35], v[76:79]
    ds_read_b64_tr_b16 v[28:29], v16 offset:10240
    v_mfma_f32_16x16x32_bf16 v[76:79], v[140:143], v[36:39], v[76:79]
    ds_read_b64_tr_b16 v[30:31], v16 offset:11520
    s_waitcnt lgkmcnt(6)
    v_mfma_f32_16x16x32_bf16 v[80:83], v[128:131], v[40:43], v[80:83]
    v_add_u32 v17, 24576, v17
    ds_read_b64_tr_b16 v[32:33], v17 offset:16
    s_add_u32 m0, s76, 16384
    v_mfma_f32_16x16x32_bf16 v[80:83], v[136:139], v[44:47], v[80:83]
    ds_read_b64_tr_b16 v[34:35], v17 offset:1296
    buffer_load_dwordx4 v8, s[4:7], s73 offen  lds
    v_mfma_f32_16x16x32_bf16 v[84:87], v[132:135], v[40:43], v[84:87]
    ds_read_b64_tr_b16 v[36:37], v17 offset:10256
    v_mfma_f32_16x16x32_bf16 v[84:87], v[140:143], v[44:47], v[84:87]
    ds_read_b64_tr_b16 v[38:39], v17 offset:11536
    s_waitcnt lgkmcnt(4)
    v_mfma_f32_16x16x32_bf16 v[48:51], v[144:147], v[24:27], v[48:51]
    ds_read_b64_tr_b16 v[40:41], v17 offset:80
    s_add_u32 m0, s76, 16384
    v_mfma_f32_16x16x32_bf16 v[48:51], v[152:155], v[28:31], v[48:51]
    ds_read_b64_tr_b16 v[42:43], v17 offset:1360
    buffer_load_dwordx4 v9, s[4:7], s73 offen offset:1024  lds
    s_add_u32 s73, s73, 128
    s_cmp_eq_u32 s88, 4
    s_cmov_b32 s73, 0
    v_mfma_f32_16x16x32_bf16 v[52:55], v[148:151], v[24:27], v[52:55]
    ds_read_b64_tr_b16 v[44:45], v17 offset:10320
    v_mfma_f32_16x16x32_bf16 v[52:55], v[156:159], v[28:31], v[52:55]
    ds_read_b64_tr_b16 v[46:47], v17 offset:11600
    s_waitcnt lgkmcnt(4)
    v_mfma_f32_16x16x32_bf16 v[56:59], v[144:147], v[32:35], v[56:59]
    ds_read_b64_tr_b16 v[24:25], v16 offset:96
    v_mfma_f32_16x16x32_bf16 v[56:59], v[152:155], v[36:39], v[56:59]
    ds_read_b64_tr_b16 v[26:27], v16 offset:1376
    v_mfma_f32_16x16x32_bf16 v[60:63], v[148:151], v[32:35], v[60:63]
    ds_read_b64_tr_b16 v[28:29], v16 offset:10336
    v_mfma_f32_16x16x32_bf16 v[60:63], v[156:159], v[36:39], v[60:63]
    s_waitcnt vmcnt(4)
    s_barrier
    s_cmp_eq_u32 s91, 3
    s_cbranch_scc1 L_at_S0_3
L_at_S0_3b:
    ds_read_b64_tr_b16 v[30:31], v16 offset:11616
    ds_read_b128 v[160:163], v4 offset:0
    s_waitcnt lgkmcnt(5)
    v_mfma_f32_16x16x32_bf16 v[64:67], v[144:147], v[40:43], v[64:67]
    v_add_u32 v6, 24576, v6
    ds_read_b64_tr_b16 v[32:33], v6 offset:0
    s_add_u32 m0, s77, 49152
    v_mfma_f32_16x16x32_bf16 v[64:67], v[152:155], v[44:47], v[64:67]
    ds_read_b64_tr_b16 v[34:35], v6 offset:1280
    ds_read_b128 v[164:167], v4 offset:2048
    buffer_load_dwordx4 v10, s[8:11], s74 offen  lds
    v_mfma_f32_16x16x32_bf16 v[68:71], v[148:151], v[40:43], v[68:71]
    ds_read_b64_tr_b16 v[36:37], v6 offset:10240
    v_mfma_f32_16x16x32_bf16 v[68:71], v[156:159], v[44:47], v[68:71]
    ds_read_b64_tr_b16 v[38:39], v6 offset:11520
    ds_read_b128 v[168:171], v5 offset:0
    s_waitcnt lgkmcnt(7)
    v_mfma_f32_16x16x32_bf16 v[72:75], v[144:147], v[24:27], v[72:75]
    v_subrev_u32 v16, 73728, v16
    ds_read_b64_tr_b16 v[40:41], v16 offset:0
    s_add_u32 m0, s77, 49152
    v_mfma_f32_16x16x32_bf16 v[72:75], v[152:155], v[28:31], v[72:75]
    ds_read_b64_tr_b16 v[42:43], v16 offset:1280
    ds_read_b128 v[172:175], v5 offset:2048
    buffer_load_dwordx4 v11, s[8:11], s74 offen offset:1024  lds
    s_add_u32 s74, s74, s79
    s_cmp_eq_u32 s88, 3
    s_cmov_b32 s74, s90
    v_mfma_f32_16x16x32_bf16 v[76:79], v[148:151], v[24:27], v[76:79]
    ds_read_b64_tr_b16 v[44:45], v16 offset:10240
    v_mfma_f32_16x16x32_bf16 v[76:79], v[156:159], v[28:31], v[76:79]
    ds_read_b64_tr_b16 v[46:47], v16 offset:11520
    s_waitcnt lgkmcnt(6)
    v_mfma_f32_16x16x32_bf16 v[80:83], v[144:147], v[32:35], v[80:83]
    v_subrev_u32 v17, 73728, v17
    ds_read_b64_tr_b16 v[24:25], v17 offset:16
    s_add_u32 m0, s76, 32768
    v_mfma_f32_16x16x32_bf16 v[80:83], v[152:155], v[36:39], v[80:83]
    ds_read_b64_tr_b16 v[26:27], v17 offset:1296
    buffer_load_dwordx4 v8, s[4:7], s73 offen  lds
    v_mfma_f32_16x16x32_bf16 v[84:87], v[148:151], v[32:35], v[84:87]
    ds_read_b64_tr_b16 v[28:29], v17 offset:10256
    v_mfma_f32_16x16x32_bf16 v[84:87], v[156:159], v[36:39], v[84:87]
    ds_read_b64_tr_b16 v[30:31], v17 offset:11536
    s_waitcnt lgkmcnt(4)
    v_mfma_f32_16x16x32_bf16 v[48:51], v[160:163], v[40:43], v[48:51]
    ds_read_b64_tr_b16 v[32:33], v17 offset:80
    s_add_u32 m0, s76, 32768
    v_mfma_f32_16x16x32_bf16 v[48:51], v[168:171], v[44:47], v[48:51]
    ds_read_b64_tr_b16 v[34:35], v17 offset:1360
    buffer_load_dwordx4 v9, s[4:7], s73 offen offset:1024  lds
    s_add_u32 s73, s73, 128
    s_cmp_eq_u32 s88, 3
    s_cmov_b32 s73, 0
    v_mfma_f32_16x16x32_bf16 v[52:55], v[164:167], v[40:43], v[52:55]
    ds_read_b64_tr_b16 v[36:37], v17 offset:10320
    v_mfma_f32_16x16x32_bf16 v[52:55], v[172:175], v[44:47], v[52:55]
    ds_read_b64_tr_b16 v[38:39], v17 offset:11600
    s_waitcnt lgkmcnt(4)
    v_mfma_f32_16x16x32_bf16 v[56:59], v[160:163], v[24:27], v[56:59]
    ds_read_b64_tr_b16 v[40:41], v16 offset:96
    v_mfma_f32_16x16x32_bf16 v[56:59], v[168:171], v[28:31], v[56:59]
    ds_read_b64_tr_b16 v[42:43], v16 offset:1376
    v_mfma_f32_16x16x32_bf16 v[60:63], v[164:167], v[24:27], v[60:63]
    ds_read_b64_tr_b16 v[44:45], v16 offset:10336
    v_mfma_f32_16x16x32_bf16 v[60:63], v[172:175], v[28:31], v[60:63]
    s_waitcnt vmcnt(4)
    s_barrier
    s_cmp_eq_u32 s91, 4
    s_cbranch_scc1 L_at_S0_4
L_at_S0_4b:
    ds_read_b64_tr_b16 v[46:47], v16 offset:11616
    ds_read_b128 v[176:179], v4 offset:16384
    s_waitcnt lgkmcnt(5)
    v_mfma_f32_16x16x32_bf16 v[64:67], v[160:163], v[32:35], v[64:67]
    v_subrev_u32 v6, 73728, v6
    ds_read_b64_tr_b16 v[24:25], v6 offset:0
    s_add_u32 m0, s77, 73728
    v_mfma_f32_16x16x32_bf16 v[64:67], v[168:171], v[36:39], v[64:67]
    ds_read_b64_tr_b16 v[26:27], v6 offset:1280
    ds_read_b128 v[180:183], v4 offset:18432
    buffer_load_dwordx4 v10, s[8:11], s74 offen  lds
    v_mfma_f32_16x16x32_bf16 v[68:71], v[164:167], v[32:35], v[68:71]
    ds_read_b64_tr_b16 v[28:29], v6 offset:10240
    v_mfma_f32_16x16x32_bf16 v[68:71], v[172:175], v[36:39], v[68:71]
    ds_read_b64_tr_b16 v[30:31], v6 offset:11520
    ds_read_b128 v[184:187], v5 offset:16384
    s_waitcnt lgkmcnt(7)
    v_mfma_f32_16x16x32_bf16 v[72:75], v[160:163], v[40:43], v[72:75]
    v_add_u32 v16, 24576, v16
    ds_read_b64_tr_b16 v[32:33], v16 offset:0
    s_add_u32 m0, s77, 73728
    v_mfma_f32_16x16x32_bf16 v[72:75], v[168:171], v[44:47], v[72:75]
    ds_read_b64_tr_b16 v[34:35], v16 offset:1280
    ds_read_b128 v[188:191], v5 offset:18432
    buffer_load_dwordx4 v11, s[8:11], s74 offen offset:1024  lds
    s_add_u32 s74, s74, s79
    s_cmp_eq_u32 s88, 2
    s_cmov_b32 s74, s90
    v_mfma_f32_16x16x32_bf16 v[76:79], v[164:167], v[40:43], v[76:79]
    ds_read_b64_tr_b16 v[36:37], v16 offset:10240
    v_mfma_f32_16x16x32_bf16 v[76:79], v[172:175], v[44:47], v[76:79]
    ds_read_b64_tr_b16 v[38:39], v16 offset:11520
    s_waitcnt lgkmcnt(6)
    v_mfma_f32_16x16x32_bf16 v[80:83], v[160:163], v[24:27], v[80:83]
    v_add_u32 v17, 24576, v17
    ds_read_b64_tr_b16 v[40:41], v17 offset:16
    s_add_u32 m0, s76, 49152
    v_mfma_f32_16x16x32_bf16 v[80:83], v[168:171], v[28:31], v[80:83]
    ds_read_b64_tr_b16 v[42:43], v17 offset:1296
    buffer_load_dwordx4 v8, s[4:7], s73 offen  lds
    v_mfma_f32_16x16x32_bf16 v[84:87], v[164:167], v[24:27], v[84:87]
    ds_read_b64_tr_b16 v[44:45], v17 offset:10256
    v_mfma_f32_16x16x32_bf16 v[84:87], v[172:175], v[28:31], v[84:87]
    ds_read_b64_tr_b16 v[46:47], v17 offset:11536
    s_waitcnt lgkmcnt(4)
    v_mfma_f32_16x16x32_bf16 v[48:51], v[176:179], v[32:35], v[48:51]
    ds_read_b64_tr_b16 v[24:25], v17 offset:80
    s_add_u32 m0, s76, 49152
    v_mfma_f32_16x16x32_bf16 v[48:51], v[184:187], v[36:39], v[48:51]
    ds_read_b64_tr_b16 v[26:27], v17 offset:1360
    buffer_load_dwordx4 v9, s[4:7], s73 offen offset:1024  lds
    s_add_u32 s73, s73, 128
    s_cmp_eq_u32 s88, 2
    s_cmov_b32 s73, 0
    v_mfma_f32_16x16x32_bf16 v[52:55], v[180:183], v[32:35], v[52:55]
    ds_read_b64_tr_b16 v[28:29], v17 offset:10320
    v_mfma_f32_16x16x32_bf16 v[52:55], v[188:191], v[36:39], v[52:55]
    ds_read_b64_tr_b16 v[30:31], v17 offset:11600
    s_waitcnt lgkmcnt(4)
    v_mfma_f32_16x16x32_bf16 v[56:59], v[176:179], v[40:43], v[56:59]
    ds_read_b64_tr_b16 v[32:33], v16 offset:96
    v_mfma_f32_16x16x32_bf16 v[56:59], v[184:187], v[44:47], v[56:59]
    ds_read_b64_tr_b16 v[34:35], v16 offset:1376
    v_mfma_f32_16x16x32_bf16 v[60:63], v[180:183], v[40:43], v[60:63]
    ds_read_b64_tr_b16 v[36:37], v16 offset:10336
    v_mfma_f32_16x16x32_bf16 v[60:63], v[188:191], v[44:47], v[60:63]
    s_waitcnt vmcnt(4)
    s_barrier
    s_cmp_eq_u32 s91, 5
    s_cbranch_scc1 L_at_S0_5
L_at_S0_5b:
    ds_read_b64_tr_b16 v[38:39], v16 offset:11616
    ds_read_b128 v[192:195], v4 offset:32768
    s_waitcnt lgkmcnt(5)
    v_mfma_f32_16x16x32_bf16 v[64:67], v[176:179], v[24:27], v[64:67]
    v_add_u32 v6, 24576, v6
    ds_read_b64_tr_b16 v[40:41], v6 offset:0
    s_add_u32 m0, s77, 0
    v_mfma_f32_16x16x32_bf16 v[64:67], v[184:187], v[28:31], v[64:67]
    ds_read_b64_tr_b16 v[42:43], v6 offset:1280
    ds_read_b128 v[196:199], v4 offset:34816
    buffer_load_dwordx4 v10, s[8:11], s74 offen  lds
    v_mfma_f32_16x16x32_bf16 v[68:71], v[180:183], v[24:27], v[68:71]
    ds_read_b64_tr_b16 v[44:45], v6 offset:10240
    v_mfma_f32_16x16x32_bf16 v[68:71], v[188:191], v[28:31], v[68:71]
    ds_read_b64_tr_b16 v[46:47], v6 offset:11520
    ds_read_b128 v[200:203], v5 offset:32768
    s_waitcnt lgkmcnt(7)
    v_mfma_f32_16x16x32_bf16 v[72:75], v[176:179], v[32:35], v[72:75]
    v_add_u32 v16, 24576, v16
    ds_read_b64_tr_b16 v[24:25], v16 offset:0
    s_add_u32 m0, s77, 0
    v_mfma_f32_16x16x32_bf16 v[72:75], v[184:187], v[36:39], v[72:75]
    ds_read_b64_tr_b16 v[26:27], v16 offset:1280
    ds_read_b128 v[204:207], v5 offset:34816
    buffer_load_dwordx4 v11, s[8:11], s74 offen offset:1024  lds
    s_add_u32 s74, s74, s79
    s_cmp_eq_u32 s88, 1
    s_cmov_b32 s74, s90
    v_mfma_f32_16x16x32_bf16 v[76:79], v[180:183], v[32:35], v[76:79]
    ds_read_b64_tr_b16 v[28:29], v16 offset:10240
    v_mfma_f32_16x16x32_bf16 v[76:79], v[188:191], v[36:39], v[76:79]
    ds_read_b64_tr_b16 v[30:31], v16 offset:11520
    s_waitcnt lgkmcnt(6)
    v_mfma_f32_16x16x32_bf16 v[80:83], v[176:179], v[40:43], v[80:83]
    v_add_u32 v17, 24576, v17
    ds_read_b64_tr_b16 v[32:33], v17 offset:16
    s_add_u32 m0, s76, 0
    v_mfma_f32_16x16x32_bf16 v[80:83], v[184:187], v[44:47], v[80:83]
    ds_read_b64_tr_b16 v[34:35], v17 offset:1296
    buffer_load_dwordx4 v8, s[4:7], s73 offen  lds
    v_mfma_f32_16x16x32_bf16 v[84:87], v[180:183], v[40:43], v[84:87]
    ds_read_b64_tr_b16 v[36:37], v17 offset:10256
    v_mfma_f32_16x16x32_bf16 v[84:87], v[188:191], v[44:47], v[84:87]
    ds_read_b64_tr_b16 v[38:39], v17 offset:11536
    s_waitcnt lgkmcnt(4)
    v_mfma_f32_16x16x32_bf16 v[48:51], v[192:195], v[24:27], v[48:51]
    ds_read_b64_tr_b16 v[40:41], v17 offset:80
    s_add_u32 m0, s76, 0
    v_mfma_f32_16x16x32_bf16 v[48:51], v[200:203], v[28:31], v[48:51]
    ds_read_b64_tr_b16 v[42:43], v17 offset:1360
    buffer_load_dwordx4 v9, s[4:7], s73 offen offset:1024  lds
    s_add_u32 s73, s73, 128
    s_cmp_eq_u32 s88, 1
    s_cmov_b32 s73, 0
    v_mfma_f32_16x16x32_bf16 v[52:55], v[196:199], v[24:27], v[52:55]
    ds_read_b64_tr_b16 v[44:45], v17 offset:10320
    v_mfma_f32_16x16x32_bf16 v[52:55], v[204:207], v[28:31], v[52:55]
    ds_read_b64_tr_b16 v[46:47], v17 offset:11600
    s_waitcnt lgkmcnt(4)
    v_mfma_f32_16x16x32_bf16 v[56:59], v[192:195], v[32:35], v[56:59]
    ds_read_b64_tr_b16 v[24:25], v16 offset:96
    v_mfma_f32_16x16x32_bf16 v[56:59], v[200:203], v[36:39], v[56:59]
    ds_read_b64_tr_b16 v[26:27], v16 offset:1376
    v_mfma_f32_16x16x32_bf16 v[60:63], v[196:199], v[32:35], v[60:63]
    ds_read_b64_tr_b16 v[28:29], v16 offset:10336
    v_mfma_f32_16x16x32_bf16 v[60:63], v[204:207], v[36:39], v[60:63]
    s_waitcnt vmcnt(4)
    s_barrier
    s_cmp_eq_u32 s91, 6
    s_cbranch_scc1 L_at_S0_6
L_at_S0_6b:
    ds_read_b64_tr_b16 v[30:31], v16 offset:11616
    ds_read_b128 v[208:211], v4 offset:49152
    s_waitcnt lgkmcnt(5)
    v_mfma_f32_16x16x32_bf16 v[64:67], v[192:195], v[40:43], v[64:67]
    v_add_u32 v6, 24576, v6
    ds_read_b64_tr_b16 v[32:33], v6 offset:0
    s_add_u32 m0, s77, 24576
    v_mfma_f32_16x16x32_bf16 v[64:67], v[200:203], v[44:47], v[64:67]
    ds_read_b64_tr_b16 v[34:35], v6 offset:1280
    ds_read_b128 v[212:215], v4 offset:51200
    buffer_load_dwordx4 v10, s[8:11], s74 offen  lds
    v_mfma_f32_16x16x32_bf16 v[68:71], v[196:199], v[40:43], v[68:71]
    ds_read_b64_tr_b16 v[36:37], v6 offset:10240
    v_mfma_f32_16x16x32_bf16 v[68:71], v[204:207], v[44:47], v[68:71]
    ds_read_b64_tr_b16 v[38:39], v6 offset:11520
    ds_read_b128 v[216:219], v5 offset:49152
    s_waitcnt lgkmcnt(7)
    v_mfma_f32_16x16x32_bf16 v[72:75], v[192:195], v[24:27], v[72:75]
    v_add_u32 v16, 24576, v16
    ds_read_b64_tr_b16 v[40:41], v16 offset:0
    s_add_u32 m0, s77, 24576
    v_mfma_f32_16x16x32_bf16 v[72:75], v[200:203], v[28:31], v[72:75]
    ds_read_b64_tr_b16 v[42:43], v16 offset:1280
    ds_read_b128 v[220:223], v5 offset:51200
    buffer_load_dwordx4 v11, s[8:11], s74 offen offset:1024  lds
    v_mfma_f32_16x16x32_bf16 v[76:79], v[196:199], v[24:27], v[76:79]
    ds_read_b64_tr_b16 v[44:45], v16 offset:10240
    v_mfma_f32_16x16x32_bf16 v[76:79], v[204:207], v[28:31], v[76:79]
    ds_read_b64_tr_b16 v[46:47], v16 offset:11520
    s_waitcnt lgkmcnt(6)
    v_mfma_f32_16x16x32_bf16 v[80:83], v[192:195], v[32:35], v[80:83]
    v_add_u32 v17, 24576, v17
    ds_read_b64_tr_b16 v[24:25], v17 offset:16
    s_add_u32 m0, s76, 16384
    v_mfma_f32_16x16x32_bf16 v[80:83], v[200:203], v[36:39], v[80:83]
    ds_read_b64_tr_b16 v[26:27], v17 offset:1296
    buffer_load_dwordx4 v8, s[4:7], s73 offen  lds
    v_mfma_f32_16x16x32_bf16 v[84:87], v[196:199], v[32:35], v[84:87]
    ds_read_b64_tr_b16 v[28:29], v17 offset:10256
    v_mfma_f32_16x16x32_bf16 v[84:87], v[204:207], v[36:39], v[84:87]
    ds_read_b64_tr_b16 v[30:31], v17 offset:11536
    s_waitcnt lgkmcnt(4)
    v_mfma_f32_16x16x32_bf16 v[48:51], v[208:211], v[40:43], v[48:51]
    ds_read_b64_tr_b16 v[32:33], v17 offset:80
    s_add_u32 m0, s76, 16384
    v_mfma_f32_16x16x32_bf16 v[48:51], v[216:219], v[44:47], v[48:51]
    ds_read_b64_tr_b16 v[34:35], v17 offset:1360
    buffer_load_dwordx4 v9, s[4:7], s73 offen offset:1024  lds
    v_mfma_f32_16x16x32_bf16 v[52:55], v[212:215], v[40:43], v[52:55]
    ds_read_b64_tr_b16 v[36:37], v17 offset:10320
    v_mfma_f32_16x16x32_bf16 v[52:55], v[220:223], v[44:47], v[52:55]
    ds_read_b64_tr_b16 v[38:39], v17 offset:11600
    s_waitcnt lgkmcnt(4)
    v_mfma_f32_16x16x32_bf16 v[56:59], v[208:211], v[24:27], v[56:59]
    ds_read_b64_tr_b16 v[40:41], v16 offset:96
    v_mfma_f32_16x16x32_bf16 v[56:59], v[216:219], v[28:31], v[56:59]
    ds_read_b64_tr_b16 v[42:43], v16 offset:1376
    v_mfma_f32_16x16x32_bf16 v[60:63], v[212:215], v[24:27], v[60:63]
    ds_read_b64_tr_b16 v[44:45], v16 offset:10336
    v_mfma_f32_16x16x32_bf16 v[60:63], v[220:223], v[28:31], v[60:63]
    s_waitcnt vmcnt(4)
    s_barrier
    s_cmp_eq_u32 s91, 7
    s_cbranch_scc1 L_at_S0_7
L_at_S0_7b:
    ds_read_b64_tr_b16 v[46:47], v16 offset:11616
    ds_read_b128 v[224:227], v4 offset:0
    s_add_u32 m0, s78, 49152
    s_nop 0
    buffer_load_dwordx4 v13, s[12:15], s75 offen  lds
    s_waitcnt lgkmcnt(5)
    v_mfma_f32_16x16x32_bf16 v[64:67], v[208:211], v[32:35], v[64:67]
    v_add_u32 v6, 24576, v6
    ds_read_b64_tr_b16 v[24:25], v6 offset:0
    s_add_u32 m0, s78, 49152
    v_mfma_f32_16x16x32_bf16 v[64:67], v[216:219], v[36:39], v[64:67]
    ds_read_b64_tr_b16 v[26:27], v6 offset:1280
    ds_read_b128 v[228:231], v4 offset:2048
    buffer_load_dwordx4 v14, s[12:15], s75 offen offset:1024  lds
    v_mfma_f32_16x16x32_bf16 v[68:71], v[212:215], v[32:35], v[68:71]
    ds_read_b64_tr_b16 v[28:29], v6 offset:10240
    v_mfma_f32_16x16x32_bf16 v[68:71], v[220:223], v[36:39], v[68:71]
    ds_read_b64_tr_b16 v[30:31], v6 offset:11520
    ds_read_b128 v[232:235], v5 offset:0
    s_mov_b32 s89, 5570560
    s_and_b32 s68, s64, 3
    s_lshl_b32 s68, s68, 9
    s_lshl_b32 s69, s39, 2
    s_add_u32 s68, s68, s69
    s_waitcnt lgkmcnt(7)
    v_mfma_f32_16x16x32_bf16 v[72:75], v[208:211], v[40:43], v[72:75]
    v_subrev_u32 v16, 73728, v16
    ds_read_b64_tr_b16 v[32:33], v16 offset:0
    v_mfma_f32_16x16x32_bf16 v[72:75], v[216:219], v[44:47], v[72:75]
    ds_read_b64_tr_b16 v[34:35], v16 offset:1280
    ds_read_b128 v[236:239], v5 offset:2048
    s_add_u32 s68, s68, s37
    s_mul_i32 s68, s68, 1280
    s_add_u32 s89, s89, s68
    v_lshrrev_b32 v1, 5, v0
    v_mul_u32_u24 v1, 640, v1
    v_mfma_f32_16x16x32_bf16 v[76:79], v[212:215], v[40:43], v[76:79]
    ds_read_b64_tr_b16 v[36:37], v16 offset:10240
    v_mfma_f32_16x16x32_bf16 v[76:79], v[220:223], v[44:47], v[76:79]
    ds_read_b64_tr_b16 v[38:39], v16 offset:11520
    v_bfe_u32 v8, v0, 4, 1
    v_bfe_u32 v3, v0, 3, 1
    v_mul_u32_u24 v10, 81920, v3
    v_add_u32 v10, v10, v1
    v_and_b32 v2, 7, v0
    s_waitcnt lgkmcnt(6)
    v_mfma_f32_16x16x32_bf16 v[80:83], v[208:211], v[24:27], v[80:83]
    v_subrev_u32 v17, 73728, v17
    ds_read_b64_tr_b16 v[40:41], v17 offset:16
    s_add_u32 m0, s78, 49152
    v_mfma_f32_16x16x32_bf16 v[80:83], v[216:219], v[28:31], v[80:83]
    ds_read_b64_tr_b16 v[42:43], v17 offset:1296
    buffer_load_dwordx4 v15, s[12:15], s75 offen offset:2048  lds
    s_add_u32 s75, s75, 221184
    s_cmp_eq_u32 s88, 9
    s_cmov_b32 s75, s93
    v_mfma_f32_16x16x32_bf16 v[84:87], v[212:215], v[24:27], v[84:87]
    ds_read_b64_tr_b16 v[44:45], v17 offset:10256
    v_mfma_f32_16x16x32_bf16 v[84:87], v[220:223], v[28:31], v[84:87]
    ds_read_b64_tr_b16 v[46:47], v17 offset:11536
    v_lshl_add_u32 v10, v2, 4, v10
    v_lshl_add_u32 v9, v8, 7, v10
    v_add_u32 v9, 128, v9
    v_mul_u32_u24 v2, 384, v8
    v_add_u32 v10, v10, v2
    s_waitcnt lgkmcnt(4)
    v_mfma_f32_16x16x32_bf16 v[48:51], v[224:227], v[32:35], v[48:51]
    ds_read_b64_tr_b16 v[24:25], v17 offset:80
    v_mfma_f32_16x16x32_bf16 v[48:51], v[232:235], v[36:39], v[48:51]
    ds_read_b64_tr_b16 v[26:27], v17 offset:1360
    v_bfe_u32 v2, v0, 2, 1
    v_lshl_add_u32 v2, v3, 2, v2
    v_mul_u32_u24 v2, 81920, v2
    v_lshlrev_b32 v8, 6, v8
    v_add3_u32 v2, v2, v1, v8
    v_mfma_f32_16x16x32_bf16 v[52:55], v[228:231], v[32:35], v[52:55]
    ds_read_b64_tr_b16 v[28:29], v17 offset:10320
    v_mfma_f32_16x16x32_bf16 v[52:55], v[236:239], v[36:39], v[52:55]
    ds_read_b64_tr_b16 v[30:31], v17 offset:11600
    v_and_b32 v3, 3, v0
    v_lshl_add_u32 v11, v3, 4, v2
    s_waitcnt lgkmcnt(4)
    v_mfma_f32_16x16x32_bf16 v[56:59], v[224:227], v[40:43], v[56:59]
    ds_read_b64_tr_b16 v[32:33], v16 offset:96
    v_mfma_f32_16x16x32_bf16 v[56:59], v[232:235], v[44:47], v[56:59]
    ds_read_b64_tr_b16 v[34:35], v16 offset:1376
    v_mfma_f32_16x16x32_bf16 v[60:63], v[228:231], v[40:43], v[60:63]
    ds_read_b64_tr_b16 v[36:37], v16 offset:10336
    v_mfma_f32_16x16x32_bf16 v[60:63], v[236:239], v[44:47], v[60:63]
    s_waitcnt vmcnt(3)
    s_barrier
    s_cmp_eq_u32 s91, 8
    s_cbranch_scc1 L_at_S0_8
L_at_S0_8b:
    ds_read_b64_tr_b16 v[38:39], v16 offset:11616
    ds_read_b128 v[240:243], v4 offset:16384
    s_waitcnt lgkmcnt(5)
    v_mfma_f32_16x16x32_bf16 v[64:67], v[224:227], v[24:27], v[64:67]
    v_subrev_u32 v6, 73728, v6
    ds_read_b64_tr_b16 v[40:41], v6 offset:0
    v_mfma_f32_16x16x32_bf16 v[64:67], v[232:235], v[28:31], v[64:67]
    ds_read_b64_tr_b16 v[42:43], v6 offset:1280
    ds_read_b128 v[244:247], v4 offset:18432
    v_mfma_f32_16x16x32_bf16 v[68:71], v[228:231], v[24:27], v[68:71]
    ds_read_b64_tr_b16 v[44:45], v6 offset:10240
    s_add_u32 m0, s78, 73728
    v_mfma_f32_16x16x32_bf16 v[68:71], v[236:239], v[28:31], v[68:71]
    ds_read_b64_tr_b16 v[46:47], v6 offset:11520
    ds_read_b128 v[248:251], v5 offset:16384
    buffer_load_dwordx4 v13, s[12:15], s75 offen  lds
    s_waitcnt lgkmcnt(7)
    v_mfma_f32_16x16x32_bf16 v[72:75], v[224:227], v[32:35], v[72:75]
    v_add_u32 v16, 24576, v16
    ds_read_b64_tr_b16 v[24:25], v16 offset:0
    v_mfma_f32_16x16x32_bf16 v[72:75], v[232:235], v[36:39], v[72:75]
    ds_read_b64_tr_b16 v[26:27], v16 offset:1280
    ds_read_b128 v[252:255], v5 offset:18432
    v_mfma_f32_16x16x32_bf16 v[76:79], v[228:231], v[32:35], v[76:79]
    ds_read_b64_tr_b16 v[28:29], v16 offset:10240
    s_add_u32 m0, s78, 73728
    v_mfma_f32_16x16x32_bf16 v[76:79], v[236:239], v[36:39], v[76:79]
    ds_read_b64_tr_b16 v[30:31], v16 offset:11520
    buffer_load_dwordx4 v14, s[12:15], s75 offen offset:1024  lds
    s_waitcnt lgkmcnt(6)
    v_mfma_f32_16x16x32_bf16 v[80:83], v[224:227], v[40:43], v[80:83]
    v_add_u32 v17, 24576, v17
    ds_read_b64_tr_b16 v[32:33], v17 offset:16
    v_mfma_f32_16x16x32_bf16 v[80:83], v[232:235], v[44:47], v[80:83]
    ds_read_b64_tr_b16 v[34:35], v17 offset:1296
    v_mfma_f32_16x16x32_bf16 v[84:87], v[228:231], v[40:43], v[84:87]
    ds_read_b64_tr_b16 v[36:37], v17 offset:10256
    s_add_u32 m0, s78, 73728
    v_mfma_f32_16x16x32_bf16 v[84:87], v[236:239], v[44:47], v[84:87]
    ds_read_b64_tr_b16 v[38:39], v17 offset:11536
    buffer_load_dwordx4 v15, s[12:15], s75 offen offset:2048  lds
    s_add_u32 s75, s75, 221184
    s_cmp_eq_u32 s88, 8
    s_cmov_b32 s75, s93
    s_waitcnt lgkmcnt(4)
    v_mfma_f32_16x16x32_bf16 v[48:51], v[240:243], v[24:27], v[48:51]
    ds_read_b64_tr_b16 v[40:41], v17 offset:80
    v_mfma_f32_16x16x32_bf16 v[48:51], v[248:251], v[28:31], v[48:51]
    ds_read_b64_tr_b16 v[42:43], v17 offset:1360
    v_mfma_f32_16x16x32_bf16 v[52:55], v[244:247], v[24:27], v[52:55]
    ds_read_b64_tr_b16 v[44:45], v17 offset:10320
    v_mfma_f32_16x16x32_bf16 v[52:55], v[252:255], v[28:31], v[52:55]
    ds_read_b64_tr_b16 v[46:47], v17 offset:11600
    s_waitcnt lgkmcnt(4)
    v_mfma_f32_16x16x32_bf16 v[56:59], v[240:243], v[32:35], v[56:59]
    ds_read_b64_tr_b16 v[24:25], v16 offset:96
    v_mfma_f32_16x16x32_bf16 v[56:59], v[248:251], v[36:39], v[56:59]
    ds_read_b64_tr_b16 v[26:27], v16 offset:1376
    v_mfma_f32_16x16x32_bf16 v[60:63], v[244:247], v[32:35], v[60:63]
    ds_read_b64_tr_b16 v[28:29], v16 offset:10336
    v_mfma_f32_16x16x32_bf16 v[60:63], v[252:255], v[36:39], v[60:63]
    s_waitcnt vmcnt(3)
    s_barrier
    ds_read_b64_tr_b16 v[30:31], v16 offset:11616
    s_waitcnt lgkmcnt(4)
    v_mfma_f32_16x16x32_bf16 v[64:67], v[240:243], v[40:43], v[64:67]
    v_add_u32 v6, 24576, v6
    ds_read_b64_tr_b16 v[32:33], v6 offset:0
    v_mfma_f32_16x16x32_bf16 v[64:67], v[248:251], v[44:47], v[64:67]
    ds_read_b64_tr_b16 v[34:35], v6 offset:1280
    v_mfma_f32_16x16x32_bf16 v[68:71], v[244:247], v[40:43], v[68:71]
    ds_read_b64_tr_b16 v[36:37], v6 offset:10240
    s_add_u32 m0, s78, 0
    v_mfma_f32_16x16x32_bf16 v[68:71], v[252:255], v[44:47], v[68:71]
    ds_read_b64_tr_b16 v[38:39], v6 offset:11520
    buffer_load_dwordx4 v13, s[12:15], s75 offen  lds
    s_waitcnt lgkmcnt(4)
    v_mfma_f32_16x16x32_bf16 v[72:75], v[240:243], v[24:27], v[72:75]
    v_mfma_f32_16x16x32_bf16 v[72:75], v[248:251], v[28:31], v[72:75]
    v_mfma_f32_16x16x32_bf16 v[76:79], v[244:247], v[24:27], v[76:79]
    s_add_u32 m0, s78, 0
    v_mfma_f32_16x16x32_bf16 v[76:79], v[252:255], v[28:31], v[76:79]
    buffer_load_dwordx4 v14, s[12:15], s75 offen offset:1024  lds
    s_waitcnt lgkmcnt(0)
    v_mfma_f32_16x16x32_bf16 v[80:83], v[240:243], v[32:35], v[80:83]
    ds_read_b64_tr_b16 v[24:25], v18 offset:0
    v_mfma_f32_16x16x32_bf16 v[80:83], v[248:251], v[36:39], v[80:83]
    ds_read_b64_tr_b16 v[26:27], v18 offset:768
    v_mfma_f32_16x16x32_bf16 v[84:87], v[244:247], v[32:35], v[84:87]
    ds_read_b64_tr_b16 v[28:29], v18 offset:6144
    s_add_u32 m0, s78, 0
    v_mfma_f32_16x16x32_bf16 v[84:87], v[252:255], v[36:39], v[84:87]
    ds_read_b64_tr_b16 v[30:31], v18 offset:6912
    buffer_load_dwordx4 v15, s[12:15], s75 offen offset:2048  lds
    s_add_u32 s75, s75, 221184
    s_cmp_eq_u32 s88, 7
    s_cmov_b32 s75, s93
    ds_read_b64_tr_b16 v[32:33], v18 offset:12288
    ds_read_b64_tr_b16 v[34:35], v18 offset:13056
    ds_read_b64_tr_b16 v[36:37], v18 offset:18432
    ds_read_b64_tr_b16 v[38:39], v18 offset:19200
    ds_read_b64_tr_b16 v[40:41], v19 offset:0
    ds_read_b64_tr_b16 v[42:43], v19 offset:768
    ds_read_b64_tr_b16 v[44:45], v19 offset:6144
    ds_read_b64_tr_b16 v[46:47], v19 offset:6912
    s_add_u32 s68, s89, 0
    v_cvt_pk_bf16_f32 v48, v48, v49
    v_cvt_pk_bf16_f32 v49, v50, v51
    v_cvt_pk_bf16_f32 v50, v52, v53
    v_cvt_pk_bf16_f32 v51, v54, v55
    buffer_store_dwordx4 v[48:51], v10, s[16:19], s68 offen offset:0 sc1
    v_cvt_pk_bf16_f32 v56, v56, v57
    v_cvt_pk_bf16_f32 v57, v58, v59
    v_cvt_pk_bf16_f32 v58, v60, v61
    v_cvt_pk_bf16_f32 v59, v62, v63
    buffer_store_dwordx4 v[56:59], v9, s[16:19], s68 offen offset:0 sc1
    s_add_u32 s68, s89, 163840
    v_cvt_pk_bf16_f32 v64, v64, v65
    v_cvt_pk_bf16_f32 v65, v66, v67
    v_cvt_pk_bf16_f32 v66, v68, v69
    v_cvt_pk_bf16_f32 v67, v70, v71
    buffer_store_dwordx4 v[64:67], v10, s[16:19], s68 offen offset:0 sc1
    v_cvt_pk_bf16_f32 v72, v72, v73
    v_cvt_pk_bf16_f32 v73, v74, v75
    v_cvt_pk_bf16_f32 v74, v76, v77
    v_cvt_pk_bf16_f32 v75, v78, v79
    buffer_store_dwordx4 v[72:75], v9, s[16:19], s68 offen offset:0 sc1
    s_add_u32 s68, s89, 0
    v_cvt_pk_bf16_f32 v80, v80, v81
    v_cvt_pk_bf16_f32 v81, v82, v83
    v_cvt_pk_bf16_f32 v82, v84, v85
    v_cvt_pk_bf16_f32 v83, v86, v87
    buffer_store_dwordx4 v[80:83], v11, s[16:19], s68 offen offset:512 sc1
    v_mov_b32 v12, 1073741824
    buffer_load_dword v17, v12, s[32:35], 0 offen
    s_branch L_pass2
L_S1:
    v_mul_u32_u24 v1, 320, v21
    v_and_b32 v2, 1, v23
    v_lshrrev_b32 v3, 1, v23
    v_lshlrev_b32 v25, 5, v3
    v_lshl_add_u32 v25, v2, 3, v25
    v_add_u32 v25, 168, v25
    v_lshlrev_b32 v22, 4, v22
    v_xor_b32 v26, v25, v22
    v_add_u32 v16, v1, v26
    v_add_u32 v25, 16, v25
    v_xor_b32 v26, v25, v22
    v_subrev_u32 v26, 16, v26
    v_add_u32 v17, v1, v26
    v_mul_u32_u24 v2, 72, v2
    v_mul_u32_u24 v3, 160, v3
    v_add3_u32 v2, v2, v3, 0
    v_add_u32 v2, 80, v2
    v_xor_b32 v2, v2, v22
    v_add_u32 v6, v1, v2
    s_and_b32 s68, s2, 1
    s_lshl_b32 s68, s68, 7
    s_cmp_eq_u32 s36, 0
    s_cselect_b32 s68, s68, 1073741824
    v_mov_b32 v22, 1073741824
    v_writelane_b32 v22, s68, 0
    v_mov_b32 v21, 1
    s_bfe_u32 s91, s2, 0x30003
    s_add_u32 s91, s91, 1
    s_cmp_eq_u32 s36, 0
    s_cselect_b32 s91, s91, 0
    s_lshl_b32 s68, s80, 6
    s_add_u32 s69, s68, s37
    s_mul_i32 s69, s69, 1280
    s_cmp_eq_u32 s38, 0
    s_mov_b32 s82, 5570560
    s_cselect_b32 s82, 2949120, s82
    s_add_u32 s82, s82, s69
    s_mul_i32 s83, s36, 1280
    s_add_u32 s83, s83, 122880
    s_and_b32 s96, s36, 1
    s_lshl_b32 s96, s96, 1
    s_add_u32 s96, s96, s38
    s_lshr_b32 s97, s37, 1
    s_lshl_b32 s68, s81, 2
    s_lshr_b32 s69, s36, 1
    s_add_u32 s68, s68, s69
    s_mul_i32 s68, s68, 19
    s_and_b32 s69, s36, 1
    s_add_u32 s68, s68, s69
    s_mul_i32 s68, s68, 5120
    s_add_u32 s84, s68, 17891328
    s_lshl_b32 s68, s80, 1
    s_add_u32 s68, s68, s97
    s_mul_i32 s68, s68, 108
    s_mul_i32 s69, s96, 14
    s_add_u32 s68, s68, s69
    s_lshr_b32 s69, s96, 1
    s_sub_u32 s68, s68, s69
    s_lshl_b32 s68, s68, 10
    s_add_u32 s68, s68, 10813440
    s_mul_i32 s69, s38, 55296
    s_add_u32 s86, s68, s69
    s_sub_u32 s68, s68, s69
    s_add_u32 s98, s68, 55296
    s_mul_i32 s69, s38, 14336
    s_sub_u32 s69, 13312, s69
    s_add_u32 s92, s86, s69
    s_mov_b64 exec, 0x7777
    buffer_load_dwordx2 v[254:255], v28, s[8:11], s89 offen offset:60
    s_mov_b64 exec, -1
    global_load_dwordx2 v[254:255], v[30:31], off offset:60
    buffer_store_dword v33, v32, s[16:19], 0 offen sc1
    s_waitcnt vmcnt(8)
    s_barrier
    ds_read_b128 v[96:99], v4 offset:0
    ds_read_b128 v[100:103], v4 offset:2048
    ds_read_b128 v[104:107], v5 offset:0
    ds_read_b128 v[108:111], v5 offset:2048
    ds_read_b64_tr_b16 v[24:25], v16 offset:0
    ds_read_b64_tr_b16 v[26:27], v16 offset:1280
    ds_read_b64_tr_b16 v[28:29], v16 offset:10240
    ds_read_b64_tr_b16 v[30:31], v16 offset:11520
    ds_read_b64_tr_b16 v[32:33], v17 offset:16
    ds_read_b64_tr_b16 v[34:35], v17 offset:1296
    ds_read_b64_tr_b16 v[36:37], v17 offset:10256
    ds_read_b64_tr_b16 v[38:39], v17 offset:11536
    ds_read_b64_tr_b16 v[40:41], v17 offset:80
    ds_read_b64_tr_b16 v[42:43], v17 offset:1360
    ds_read_b64_tr_b16 v[44:45], v17 offset:10320
    ds_read_b64_tr_b16 v[46:47], v17 offset:11600
    s_waitcnt lgkmcnt(8)
    v_mfma_f32_16x16x32_bf16 v[48:51], v[96:99], v[24:27], 0
    s_add_u32 m0, s77, 49152
    v_mfma_f32_16x16x32_bf16 v[48:51], v[104:107], v[28:31], v[48:51]
    buffer_load_dwordx4 v10, s[8:11], s74 offen  lds
    v_mfma_f32_16x16x32_bf16 v[52:55], v[100:103], v[24:27], 0
    s_add_u32 m0, s77, 49152
    v_mfma_f32_16x16x32_bf16 v[52:55], v[108:111], v[28:31], v[52:55]
    buffer_load_dwordx4 v11, s[8:11], s74 offen offset:1024  lds
    s_waitcnt lgkmcnt(4)
    v_mfma_f32_16x16x32_bf16 v[56:59], v[96:99], v[32:35], 0
    ds_read_b64_tr_b16 v[24:25], v16 offset:96
    s_add_u32 m0, s77, 49152
    v_mfma_f32_16x16x32_bf16 v[56:59], v[104:107], v[36:39], v[56:59]
    ds_read_b64_tr_b16 v[26:27], v16 offset:1376
    buffer_load_dwordx4 v12, s[8:11], s74 offen offset:2048  lds
    s_add_u32 s74, s74, s79
    s_cmp_eq_u32 s88, 7
    s_cmov_b32 s74, s90
    s_add_u32 m0, s76, 32768
    s_nop 0
    buffer_load_dwordx4 v8, s[4:7], s73 offen  lds
    s_add_u32 m0, s76, 32768
    s_nop 0
    buffer_load_dwordx4 v9, s[4:7], s73 offen offset:1024  lds
    s_add_u32 s73, s73, 128
    s_cmp_eq_u32 s88, 7
    s_cmov_b32 s73, 0
    v_mfma_f32_16x16x32_bf16 v[60:63], v[100:103], v[32:35], 0
    ds_read_b64_tr_b16 v[28:29], v16 offset:10336
    v_mfma_f32_16x16x32_bf16 v[60:63], v[108:111], v[36:39], v[60:63]
    s_waitcnt vmcnt(8)
    s_barrier
    ds_read_b64_tr_b16 v[30:31], v16 offset:11616
    ds_read_b128 v[112:115], v4 offset:16384
    s_waitcnt lgkmcnt(5)
    v_mfma_f32_16x16x32_bf16 v[64:67], v[96:99], v[40:43], 0
    ds_read_b64_tr_b16 v[32:33], v6 offset:0
    s_add_u32 m0, s77, 73728
    v_mfma_f32_16x16x32_bf16 v[64:67], v[104:107], v[44:47], v[64:67]
    ds_read_b64_tr_b16 v[34:35], v6 offset:1280
    ds_read_b128 v[116:119], v4 offset:18432
    buffer_load_dwordx4 v10, s[8:11], s74 offen  lds
    v_mfma_f32_16x16x32_bf16 v[68:71], v[100:103], v[40:43], 0
    ds_read_b64_tr_b16 v[36:37], v6 offset:10240
    s_add_u32 m0, s77, 73728
    v_mfma_f32_16x16x32_bf16 v[68:71], v[108:111], v[44:47], v[68:71]
    ds_read_b64_tr_b16 v[38:39], v6 offset:11520
    ds_read_b128 v[120:123], v5 offset:16384
    buffer_load_dwordx4 v11, s[8:11], s74 offen offset:1024  lds
    s_waitcnt lgkmcnt(7)
    v_mfma_f32_16x16x32_bf16 v[72:75], v[96:99], v[24:27], 0
    v_add_u32 v16, 24576, v16
    ds_read_b64_tr_b16 v[40:41], v16 offset:0
    v_mfma_f32_16x16x32_bf16 v[72:75], v[104:107], v[28:31], v[72:75]
    ds_read_b64_tr_b16 v[42:43], v16 offset:1280
    ds_read_b128 v[124:127], v5 offset:18432
    v_mfma_f32_16x16x32_bf16 v[76:79], v[100:103], v[24:27], 0
    ds_read_b64_tr_b16 v[44:45], v16 offset:10240
    s_add_u32 m0, s77, 73728
    v_mfma_f32_16x16x32_bf16 v[76:79], v[108:111], v[28:31], v[76:79]
    ds_read_b64_tr_b16 v[46:47], v16 offset:11520
    buffer_load_dwordx4 v12, s[8:11], s74 offen offset:2048  lds
    s_add_u32 s74, s74, s79
    s_cmp_eq_u32 s88, 6
    s_cmov_b32 s74, s90
    s_waitcnt lgkmcnt(6)
    v_mfma_f32_16x16x32_bf16 v[80:83], v[96:99], v[32:35], 0
    v_add_u32 v17, 24576, v17
    ds_read_b64_tr_b16 v[24:25], v17 offset:16
    s_add_u32 m0, s76, 49152
    v_mfma_f32_16x16x32_bf16 v[80:83], v[104:107], v[36:39], v[80:83]
    ds_read_b64_tr_b16 v[26:27], v17 offset:1296
    buffer_load_dwordx4 v8, s[4:7], s73 offen  lds
    v_mfma_f32_16x16x32_bf16 v[84:87], v[100:103], v[32:35], 0
    ds_read_b64_tr_b16 v[28:29], v17 offset:10256
    v_mfma_f32_16x16x32_bf16 v[84:87], v[108:111], v[36:39], v[84:87]
    ds_read_b64_tr_b16 v[30:31], v17 offset:11536
    s_waitcnt lgkmcnt(4)
    v_mfma_f32_16x16x32_bf16 v[48:51], v[112:115], v[40:43], v[48:51]
    ds_read_b64_tr_b16 v[32:33], v17 offset:80
    s_add_u32 m0, s76, 49152
    v_mfma_f32_16x16x32_bf16 v[48:51], v[120:123], v[44:47], v[48:51]
    ds_read_b64_tr_b16 v[34:35], v17 offset:1360
    buffer_load_dwordx4 v9, s[4:7], s73 offen offset:1024  lds
    s_add_u32 s73, s73, 128
    s_cmp_eq_u32 s88, 6
    s_cmov_b32 s73, 0
    v_mfma_f32_16x16x32_bf16 v[52:55], v[116:119], v[40:43], v[52:55]
    ds_read_b64_tr_b16 v[36:37], v17 offset:10320
    v_mfma_f32_16x16x32_bf16 v[52:55], v[124:127], v[44:47], v[52:55]
    ds_read_b64_tr_b16 v[38:39], v17 offset:11600
    s_waitcnt lgkmcnt(4)
    v_mfma_f32_16x16x32_bf16 v[56:59], v[112:115], v[24:27], v[56:59]
    ds_read_b64_tr_b16 v[40:41], v16 offset:96
    v_mfma_f32_16x16x32_bf16 v[56:59], v[120:123], v[28:31], v[56:59]
    ds_read_b64_tr_b16 v[42:43], v16 offset:1376
    v_mfma_f32_16x16x32_bf16 v[60:63], v[116:119], v[24:27], v[60:63]
    ds_read_b64_tr_b16 v[44:45], v16 offset:10336
    v_mfma_f32_16x16x32_bf16 v[60:63], v[124:127], v[28:31], v[60:63]
    s_waitcnt vmcnt(5)
    s_barrier
    s_cmp_eq_u32 s91, 1
    s_cbranch_scc1 L_at_S1_1
L_at_S1_1b:
    ds_read_b64_tr_b16 v[46:47], v16 offset:11616
    ds_read_b128 v[128:131], v4 offset:32768
    s_waitcnt lgkmcnt(5)
    v_mfma_f32_16x16x32_bf16 v[64:67], v[112:115], v[32:35], v[64:67]
    v_add_u32 v6, 24576, v6
    ds_read_b64_tr_b16 v[24:25], v6 offset:0
    s_add_u32 m0, s77, 0
    v_mfma_f32_16x16x32_bf16 v[64:67], v[120:123], v[36:39], v[64:67]
    ds_read_b64_tr_b16 v[26:27], v6 offset:1280
    ds_read_b128 v[132:135], v4 offset:34816
    buffer_load_dwordx4 v10, s[8:11], s74 offen  lds
    v_mfma_f32_16x16x32_bf16 v[68:71], v[116:119], v[32:35], v[68:71]
    ds_read_b64_tr_b16 v[28:29], v6 offset:10240
    s_add_u32 m0, s77, 0
    v_mfma_f32_16x16x32_bf16 v[68:71], v[124:127], v[36:39], v[68:71]
    ds_read_b64_tr_b16 v[30:31], v6 offset:11520
    ds_read_b128 v[136:139], v5 offset:32768
    buffer_load_dwordx4 v11, s[8:11], s74 offen offset:1024  lds
    s_waitcnt lgkmcnt(7)
    v_mfma_f32_16x16x32_bf16 v[72:75], v[112:115], v[40:43], v[72:75]
    v_add_u32 v16, 24576, v16
    ds_read_b64_tr_b16 v[32:33], v16 offset:0
    v_mfma_f32_16x16x32_bf16 v[72:75], v[120:123], v[44:47], v[72:75]
    ds_read_b64_tr_b16 v[34:35], v16 offset:1280
    ds_read_b128 v[140:143], v5 offset:34816
    v_mfma_f32_16x16x32_bf16 v[76:79], v[116:119], v[40:43], v[76:79]
    ds_read_b64_tr_b16 v[36:37], v16 offset:10240
    s_add_u32 m0, s77, 0
    v_mfma_f32_16x16x32_bf16 v[76:79], v[124:127], v[44:47], v[76:79]
    ds_read_b64_tr_b16 v[38:39], v16 offset:11520
    buffer_load_dwordx4 v12, s[8:11], s74 offen offset:2048  lds
    s_add_u32 s74, s74, s79
    s_cmp_eq_u32 s88, 5
    s_cmov_b32 s74, s90
    s_waitcnt lgkmcnt(6)
    v_mfma_f32_16x16x32_bf16 v[80:83], v[112:115], v[24:27], v[80:83]
    v_add_u32 v17, 24576, v17
    ds_read_b64_tr_b16 v[40:41], v17 offset:16
    s_add_u32 m0, s76, 0
    v_mfma_f32_16x16x32_bf16 v[80:83], v[120:123], v[28:31], v[80:83]
    ds_read_b64_tr_b16 v[42:43], v17 offset:1296
    buffer_load_dwordx4 v8, s[4:7], s73 offen  lds
    v_mfma_f32_16x16x32_bf16 v[84:87], v[116:119], v[24:27], v[84:87]
    ds_read_b64_tr_b16 v[44:45], v17 offset:10256
    v_mfma_f32_16x16x32_bf16 v[84:87], v[124:127], v[28:31], v[84:87]
    ds_read_b64_tr_b16 v[46:47], v17 offset:11536
    s_mov_b64 exec, 0xff
    buffer_load_dword v7, v7, s[12:15], s85 offen
    s_mov_b64 exec, -1
    s_waitcnt lgkmcnt(4)
    v_mfma_f32_16x16x32_bf16 v[48:51], v[128:131], v[32:35], v[48:51]
    ds_read_b64_tr_b16 v[24:25], v17 offset:80
    s_add_u32 m0, s76, 0
    v_mfma_f32_16x16x32_bf16 v[48:51], v[136:139], v[36:39], v[48:51]
    ds_read_b64_tr_b16 v[26:27], v17 offset:1360
    buffer_load_dwordx4 v9, s[4:7], s73 offen offset:1024  lds
    s_add_u32 s73, s73, 128
    s_cmp_eq_u32 s88, 5
    s_cmov_b32 s73, 0
    v_mfma_f32_16x16x32_bf16 v[52:55], v[132:135], v[32:35], v[52:55]
    ds_read_b64_tr_b16 v[28:29], v17 offset:10320
    v_mfma_f32_16x16x32_bf16 v[52:55], v[140:143], v[36:39], v[52:55]
    ds_read_b64_tr_b16 v[30:31], v17 offset:11600
    s_waitcnt lgkmcnt(4)
    v_mfma_f32_16x16x32_bf16 v[56:59], v[128:131], v[40:43], v[56:59]
    ds_read_b64_tr_b16 v[32:33], v16 offset:96
    v_mfma_f32_16x16x32_bf16 v[56:59], v[136:139], v[44:47], v[56:59]
    ds_read_b64_tr_b16 v[34:35], v16 offset:1376
    v_mfma_f32_16x16x32_bf16 v[60:63], v[132:135], v[40:43], v[60:63]
    ds_read_b64_tr_b16 v[36:37], v16 offset:10336
    v_mfma_f32_16x16x32_bf16 v[60:63], v[140:143], v[44:47], v[60:63]
    s_waitcnt vmcnt(6)
    s_barrier
    s_cmp_eq_u32 s91, 2
    s_cbranch_scc1 L_at_S1_2
L_at_S1_2b:
    ds_read_b64_tr_b16 v[38:39], v16 offset:11616
    ds_read_b128 v[144:147], v4 offset:49152
    s_waitcnt lgkmcnt(5)
    v_mfma_f32_16x16x32_bf16 v[64:67], v[128:131], v[24:27], v[64:67]
    v_add_u32 v6, 24576, v6
    ds_read_b64_tr_b16 v[40:41], v6 offset:0
    s_add_u32 m0, s77, 24576
    v_mfma_f32_16x16x32_bf16 v[64:67], v[136:139], v[28:31], v[64:67]
    ds_read_b64_tr_b16 v[42:43], v6 offset:1280
    ds_read_b128 v[148:151], v4 offset:51200
    buffer_load_dwordx4 v10, s[8:11], s74 offen  lds
    v_mfma_f32_16x16x32_bf16 v[68:71], v[132:135], v[24:27], v[68:71]
    ds_read_b64_tr_b16 v[44:45], v6 offset:10240
    s_add_u32 m0, s77, 24576
    v_mfma_f32_16x16x32_bf16 v[68:71], v[140:143], v[28:31], v[68:71]
    ds_read_b64_tr_b16 v[46:47], v6 offset:11520
    ds_read_b128 v[152:155], v5 offset:49152
    buffer_load_dwordx4 v11, s[8:11], s74 offen offset:1024  lds
    s_waitcnt lgkmcnt(7)
    v_mfma_f32_16x16x32_bf16 v[72:75], v[128:131], v[32:35], v[72:75]
    v_add_u32 v16, 24576, v16
    ds_read_b64_tr_b16 v[24:25], v16 offset:0
    v_mfma_f32_16x16x32_bf16 v[72:75], v[136:139], v[36:39], v[72:75]
    ds_read_b64_tr_b16 v[26:27], v16 offset:1280
    ds_read_b128 v[156:159], v5 offset:51200
    v_mfma_f32_16x16x32_bf16 v[76:79], v[132:135], v[32:35], v[76:79]
    ds_read_b64_tr_b16 v[28:29], v16 offset:10240
    s_add_u32 m0, s77, 24576
    v_mfma_f32_16x16x32_bf16 v[76:79], v[140:143], v[36:39], v[76:79]
    ds_read_b64_tr_b16 v[30:31], v16 offset:11520
    buffer_load_dwordx4 v12, s[8:11], s74 offen offset:2048  lds
    s_add_u32 s74, s74, s79
    s_cmp_eq_u32 s88, 4
    s_cmov_b32 s74, s90
    s_waitcnt lgkmcnt(6)
    v_mfma_f32_16x16x32_bf16 v[80:83], v[128:131], v[40:43], v[80:83]
    v_add_u32 v17, 24576, v17
    ds_read_b64_tr_b16 v[32:33], v17 offset:16
    s_add_u32 m0, s76, 16384
    v_mfma_f32_16x16x32_bf16 v[80:83], v[136:139], v[44:47], v[80:83]
    ds_read_b64_tr_b16 v[34:35], v17 offset:1296
    buffer_load_dwordx4 v8, s[4:7], s73 offen  lds
    v_mfma_f32_16x16x32_bf16 v[84:87], v[132:135], v[40:43], v[84:87]
    ds_read_b64_tr_b16 v[36:37], v17 offset:10256
    v_mfma_f32_16x16x32_bf16 v[84:87], v[140:143], v[44:47], v[84:87]
    ds_read_b64_tr_b16 v[38:39], v17 offset:11536
    s_waitcnt lgkmcnt(4)
    v_mfma_f32_16x16x32_bf16 v[48:51], v[144:147], v[24:27], v[48:51]
    ds_read_b64_tr_b16 v[40:41], v17 offset:80
    s_add_u32 m0, s76, 16384
    v_mfma_f32_16x16x32_bf16 v[48:51], v[152:155], v[28:31], v[48:51]
    ds_read_b64_tr_b16 v[42:43], v17 offset:1360
    buffer_load_dwordx4 v9, s[4:7], s73 offen offset:1024  lds
    s_add_u32 s73, s73, 128
    s_cmp_eq_u32 s88, 4
    s_cmov_b32 s73, 0
    v_mfma_f32_16x16x32_bf16 v[52:55], v[148:151], v[24:27], v[52:55]
    ds_read_b64_tr_b16 v[44:45], v17 offset:10320
    v_mfma_f32_16x16x32_bf16 v[52:55], v[156:159], v[28:31], v[52:55]
    ds_read_b64_tr_b16 v[46:47], v17 offset:11600
    s_waitcnt lgkmcnt(4)
    v_mfma_f32_16x16x32_bf16 v[56:59], v[144:147], v[32:35], v[56:59]
    ds_read_b64_tr_b16 v[24:25], v16 offset:96
    v_mfma_f32_16x16x32_bf16 v[56:59], v[152:155], v[36:39], v[56:59]
    ds_read_b64_tr_b16 v[26:27], v16 offset:1376
    v_mfma_f32_16x16x32_bf16 v[60:63], v[148:151], v[32:35], v[60:63]
    ds_read_b64_tr_b16 v[28:29], v16 offset:10336
    v_mfma_f32_16x16x32_bf16 v[60:63], v[156:159], v[36:39], v[60:63]
    s_waitcnt vmcnt(5)
    s_barrier
    s_cmp_eq_u32 s91, 3
    s_cbranch_scc1 L_at_S1_3
L_at_S1_3b:
    ds_read_b64_tr_b16 v[30:31], v16 offset:11616
    ds_read_b128 v[160:163], v4 offset:0
    s_waitcnt lgkmcnt(5)
    v_mfma_f32_16x16x32_bf16 v[64:67], v[144:147], v[40:43], v[64:67]
    v_add_u32 v6, 24576, v6
    ds_read_b64_tr_b16 v[32:33], v6 offset:0
    s_add_u32 m0, s77, 49152
    v_mfma_f32_16x16x32_bf16 v[64:67], v[152:155], v[44:47], v[64:67]
    ds_read_b64_tr_b16 v[34:35], v6 offset:1280
    ds_read_b128 v[164:167], v4 offset:2048
    buffer_load_dwordx4 v10, s[8:11], s74 offen  lds
    v_mfma_f32_16x16x32_bf16 v[68:71], v[148:151], v[40:43], v[68:71]
    ds_read_b64_tr_b16 v[36:37], v6 offset:10240
    s_add_u32 m0, s77, 49152
    v_mfma_f32_16x16x32_bf16 v[68:71], v[156:159], v[44:47], v[68:71]
    ds_read_b64_tr_b16 v[38:39], v6 offset:11520
    ds_read_b128 v[168:171], v5 offset:0
    buffer_load_dwordx4 v11, s[8:11], s74 offen offset:1024  lds
    s_waitcnt lgkmcnt(7)
    v_mfma_f32_16x16x32_bf16 v[72:75], v[144:147], v[24:27], v[72:75]
    v_subrev_u32 v16, 73728, v16
    ds_read_b64_tr_b16 v[40:41], v16 offset:0
    v_mfma_f32_16x16x32_bf16 v[72:75], v[152:155], v[28:31], v[72:75]
    ds_read_b64_tr_b16 v[42:43], v16 offset:1280
    ds_read_b128 v[172:175], v5 offset:2048
    v_mfma_f32_16x16x32_bf16 v[76:79], v[148:151], v[24:27], v[76:79]
    ds_read_b64_tr_b16 v[44:45], v16 offset:10240
    s_add_u32 m0, s77, 49152
    v_mfma_f32_16x16x32_bf16 v[76:79], v[156:159], v[28:31], v[76:79]
    ds_read_b64_tr_b16 v[46:47], v16 offset:11520
    buffer_load_dwordx4 v12, s[8:11], s74 offen offset:2048  lds
    s_add_u32 s74, s74, s79
    s_cmp_eq_u32 s88, 3
    s_cmov_b32 s74, s90
    s_waitcnt lgkmcnt(6)
    v_mfma_f32_16x16x32_bf16 v[80:83], v[144:147], v[32:35], v[80:83]
    v_subrev_u32 v17, 73728, v17
    ds_read_b64_tr_b16 v[24:25], v17 offset:16
    s_add_u32 m0, s76, 32768
    v_mfma_f32_16x16x32_bf16 v[80:83], v[152:155], v[36:39], v[80:83]
    ds_read_b64_tr_b16 v[26:27], v17 offset:1296
    buffer_load_dwordx4 v8, s[4:7], s73 offen  lds
    v_mfma_f32_16x16x32_bf16 v[84:87], v[148:151], v[32:35], v[84:87]
    ds_read_b64_tr_b16 v[28:29], v17 offset:10256
    v_mfma_f32_16x16x32_bf16 v[84:87], v[156:159], v[36:39], v[84:87]
    ds_read_b64_tr_b16 v[30:31], v17 offset:11536
    s_waitcnt lgkmcnt(4)
    v_mfma_f32_16x16x32_bf16 v[48:51], v[160:163], v[40:43], v[48:51]
    ds_read_b64_tr_b16 v[32:33], v17 offset:80
    s_add_u32 m0, s76, 32768
    v_mfma_f32_16x16x32_bf16 v[48:51], v[168:171], v[44:47], v[48:51]
    ds_read_b64_tr_b16 v[34:35], v17 offset:1360
    buffer_load_dwordx4 v9, s[4:7], s73 offen offset:1024  lds
    s_add_u32 s73, s73, 128
    s_cmp_eq_u32 s88, 3
    s_cmov_b32 s73, 0
    v_mfma_f32_16x16x32_bf16 v[52:55], v[164:167], v[40:43], v[52:55]
    ds_read_b64_tr_b16 v[36:37], v17 offset:10320
    v_mfma_f32_16x16x32_bf16 v[52:55], v[172:175], v[44:47], v[52:55]
    ds_read_b64_tr_b16 v[38:39], v17 offset:11600
    s_waitcnt lgkmcnt(4)
    v_mfma_f32_16x16x32_bf16 v[56:59], v[160:163], v[24:27], v[56:59]
    ds_read_b64_tr_b16 v[40:41], v16 offset:96
    v_mfma_f32_16x16x32_bf16 v[56:59], v[168:171], v[28:31], v[56:59]
    ds_read_b64_tr_b16 v[42:43], v16 offset:1376
    v_mfma_f32_16x16x32_bf16 v[60:63], v[164:167], v[24:27], v[60:63]
    ds_read_b64_tr_b16 v[44:45], v16 offset:10336
    v_mfma_f32_16x16x32_bf16 v[60:63], v[172:175], v[28:31], v[60:63]
    s_waitcnt vmcnt(5)
    s_barrier
    s_cmp_eq_u32 s91, 4
    s_cbranch_scc1 L_at_S1_4
L_at_S1_4b:
    ds_read_b64_tr_b16 v[46:47], v16 offset:11616
    ds_read_b128 v[176:179], v4 offset:16384
    s_waitcnt lgkmcnt(5)
    v_mfma_f32_16x16x32_bf16 v[64:67], v[160:163], v[32:35], v[64:67]
    v_subrev_u32 v6, 73728, v6
    ds_read_b64_tr_b16 v[24:25], v6 offset:0
    s_add_u32 m0, s77, 73728
    v_mfma_f32_16x16x32_bf16 v[64:67], v[168:171], v[36:39], v[64:67]
    ds_read_b64_tr_b16 v[26:27], v6 offset:1280
    ds_read_b128 v[180:183], v4 offset:18432
    buffer_load_dwordx4 v10, s[8:11], s74 offen  lds
    v_mfma_f32_16x16x32_bf16 v[68:71], v[164:167], v[32:35], v[68:71]
    ds_read_b64_tr_b16 v[28:29], v6 offset:10240
    s_add_u32 m0, s77, 73728
    v_mfma_f32_16x16x32_bf16 v[68:71], v[172:175], v[36:39], v[68:71]
    ds_read_b64_tr_b16 v[30:31], v6 offset:11520
    ds_read_b128 v[184:187], v5 offset:16384
    buffer_load_dwordx4 v11, s[8:11], s74 offen offset:1024  lds
    s_waitcnt lgkmcnt(7)
    v_mfma_f32_16x16x32_bf16 v[72:75], v[160:163], v[40:43], v[72:75]
    v_add_u32 v16, 24576, v16
    ds_read_b64_tr_b16 v[32:33], v16 offset:0
    v_mfma_f32_16x16x32_bf16 v[72:75], v[168:171], v[44:47], v[72:75]
    ds_read_b64_tr_b16 v[34:35], v16 offset:1280
    ds_read_b128 v[188:191], v5 offset:18432
    v_mfma_f32_16x16x32_bf16 v[76:79], v[164:167], v[40:43], v[76:79]
    ds_read_b64_tr_b16 v[36:37], v16 offset:10240
    s_add_u32 m0, s77, 73728
    v_mfma_f32_16x16x32_bf16 v[76:79], v[172:175], v[44:47], v[76:79]
    ds_read_b64_tr_b16 v[38:39], v16 offset:11520
    buffer_load_dwordx4 v12, s[8:11], s74 offen offset:2048  lds
    s_add_u32 s74, s74, s79
    s_cmp_eq_u32 s88, 2
    s_cmov_b32 s74, s90
    s_waitcnt lgkmcnt(6)
    v_mfma_f32_16x16x32_bf16 v[80:83], v[160:163], v[24:27], v[80:83]
    v_add_u32 v17, 24576, v17
    ds_read_b64_tr_b16 v[40:41], v17 offset:16
    s_add_u32 m0, s76, 49152
    v_mfma_f32_16x16x32_bf16 v[80:83], v[168:171], v[28:31], v[80:83]
    ds_read_b64_tr_b16 v[42:43], v17 offset:1296
    buffer_load_dwordx4 v8, s[4:7], s73 offen  lds
    v_mfma_f32_16x16x32_bf16 v[84:87], v[164:167], v[24:27], v[84:87]
    ds_read_b64_tr_b16 v[44:45], v17 offset:10256
    v_mfma_f32_16x16x32_bf16 v[84:87], v[172:175], v[28:31], v[84:87]
    ds_read_b64_tr_b16 v[46:47], v17 offset:11536
    s_waitcnt lgkmcnt(4)
    v_mfma_f32_16x16x32_bf16 v[48:51], v[176:179], v[32:35], v[48:51]
    ds_read_b64_tr_b16 v[24:25], v17 offset:80
    s_add_u32 m0, s76, 49152
    v_mfma_f32_16x16x32_bf16 v[48:51], v[184:187], v[36:39], v[48:51]
    ds_read_b64_tr_b16 v[26:27], v17 offset:1360
    buffer_load_dwordx4 v9, s[4:7], s73 offen offset:1024  lds
    s_add_u32 s73, s73, 128
    s_cmp_eq_u32 s88, 2
    s_cmov_b32 s73, 0
    v_mfma_f32_16x16x32_bf16 v[52:55], v[180:183], v[32:35], v[52:55]
    ds_read_b64_tr_b16 v[28:29], v17 offset:10320
    v_mfma_f32_16x16x32_bf16 v[52:55], v[188:191], v[36:39], v[52:55]
    ds_read_b64_tr_b16 v[30:31], v17 offset:11600
    s_waitcnt lgkmcnt(4)
    v_mfma_f32_16x16x32_bf16 v[56:59], v[176:179], v[40:43], v[56:59]
    ds_read_b64_tr_b16 v[32:33], v16 offset:96
    v_mfma_f32_16x16x32_bf16 v[56:59], v[184:187], v[44:47], v[56:59]
    ds_read_b64_tr_b16 v[34:35], v16 offset:1376
    v_mfma_f32_16x16x32_bf16 v[60:63], v[180:183], v[40:43], v[60:63]
    ds_read_b64_tr_b16 v[36:37], v16 offset:10336
    v_mfma_f32_16x16x32_bf16 v[60:63], v[188:191], v[44:47], v[60:63]
    s_waitcnt vmcnt(5)
    s_barrier
    s_cmp_eq_u32 s91, 5
    s_cbranch_scc1 L_at_S1_5
L_at_S1_5b:
    ds_read_b64_tr_b16 v[38:39], v16 offset:11616
    ds_read_b128 v[192:195], v4 offset:32768
    s_waitcnt lgkmcnt(5)
    v_mfma_f32_16x16x32_bf16 v[64:67], v[176:179], v[24:27], v[64:67]
    v_add_u32 v6, 24576, v6
    ds_read_b64_tr_b16 v[40:41], v6 offset:0
    s_add_u32 m0, s77, 0
    v_mfma_f32_16x16x32_bf16 v[64:67], v[184:187], v[28:31], v[64:67]
    ds_read_b64_tr_b16 v[42:43], v6 offset:1280
    ds_read_b128 v[196:199], v4 offset:34816
    buffer_load_dwordx4 v10, s[8:11], s74 offen  lds
    v_mfma_f32_16x16x32_bf16 v[68:71], v[180:183], v[24:27], v[68:71]
    ds_read_b64_tr_b16 v[44:45], v6 offset:10240
    s_add_u32 m0, s77, 0
    v_mfma_f32_16x16x32_bf16 v[68:71], v[188:191], v[28:31], v[68:71]
    ds_read_b64_tr_b16 v[46:47], v6 offset:11520
    ds_read_b128 v[200:203], v5 offset:32768
    buffer_load_dwordx4 v11, s[8:11], s74 offen offset:1024  lds
    s_waitcnt lgkmcnt(7)
    v_mfma_f32_16x16x32_bf16 v[72:75], v[176:179], v[32:35], v[72:75]
    v_add_u32 v16, 24576, v16
    ds_read_b64_tr_b16 v[24:25], v16 offset:0
    v_mfma_f32_16x16x32_bf16 v[72:75], v[184:187], v[36:39], v[72:75]
    ds_read_b64_tr_b16 v[26:27], v16 offset:1280
    ds_read_b128 v[204:207], v5 offset:34816
    v_mfma_f32_16x16x32_bf16 v[76:79], v[180:183], v[32:35], v[76:79]
    ds_read_b64_tr_b16 v[28:29], v16 offset:10240
    s_add_u32 m0, s77, 0
    v_mfma_f32_16x16x32_bf16 v[76:79], v[188:191], v[36:39], v[76:79]
    ds_read_b64_tr_b16 v[30:31], v16 offset:11520
    buffer_load_dwordx4 v12, s[8:11], s74 offen offset:2048  lds
    s_add_u32 s74, s74, s79
    s_cmp_eq_u32 s88, 1
    s_cmov_b32 s74, s90
    s_waitcnt lgkmcnt(6)
    v_mfma_f32_16x16x32_bf16 v[80:83], v[176:179], v[40:43], v[80:83]
    v_add_u32 v17, 24576, v17
    ds_read_b64_tr_b16 v[32:33], v17 offset:16
    s_add_u32 m0, s76, 0
    v_mfma_f32_16x16x32_bf16 v[80:83], v[184:187], v[44:47], v[80:83]
    ds_read_b64_tr_b16 v[34:35], v17 offset:1296
    buffer_load_dwordx4 v8, s[4:7], s73 offen  lds
    v_mfma_f32_16x16x32_bf16 v[84:87], v[180:183], v[40:43], v[84:87]
    ds_read_b64_tr_b16 v[36:37], v17 offset:10256
    v_mfma_f32_16x16x32_bf16 v[84:87], v[188:191], v[44:47], v[84:87]
    ds_read_b64_tr_b16 v[38:39], v17 offset:11536
    s_waitcnt lgkmcnt(4)
    v_mfma_f32_16x16x32_bf16 v[48:51], v[192:195], v[24:27], v[48:51]
    ds_read_b64_tr_b16 v[40:41], v17 offset:80
    s_add_u32 m0, s76, 0
    v_mfma_f32_16x16x32_bf16 v[48:51], v[200:203], v[28:31], v[48:51]
    ds_read_b64_tr_b16 v[42:43], v17 offset:1360
    buffer_load_dwordx4 v9, s[4:7], s73 offen offset:1024  lds
    s_add_u32 s73, s73, 128
    s_cmp_eq_u32 s88, 1
    s_cmov_b32 s73, 0
    v_mfma_f32_16x16x32_bf16 v[52:55], v[196:199], v[24:27], v[52:55]
    ds_read_b64_tr_b16 v[44:45], v17 offset:10320
    v_mfma_f32_16x16x32_bf16 v[52:55], v[204:207], v[28:31], v[52:55]
    ds_read_b64_tr_b16 v[46:47], v17 offset:11600
    s_waitcnt lgkmcnt(4)
    v_mfma_f32_16x16x32_bf16 v[56:59], v[192:195], v[32:35], v[56:59]
    ds_read_b64_tr_b16 v[24:25], v16 offset:96
    v_mfma_f32_16x16x32_bf16 v[56:59], v[200:203], v[36:39], v[56:59]
    ds_read_b64_tr_b16 v[26:27], v16 offset:1376
    v_mfma_f32_16x16x32_bf16 v[60:63], v[196:199], v[32:35], v[60:63]
    ds_read_b64_tr_b16 v[28:29], v16 offset:10336
    v_mfma_f32_16x16x32_bf16 v[60:63], v[204:207], v[36:39], v[60:63]
    s_waitcnt vmcnt(5)
    s_barrier
    s_cmp_eq_u32 s91, 6
    s_cbranch_scc1 L_at_S1_6
L_at_S1_6b:
    ds_read_b64_tr_b16 v[30:31], v16 offset:11616
    ds_read_b128 v[208:211], v4 offset:49152
    s_waitcnt lgkmcnt(5)
    v_mfma_f32_16x16x32_bf16 v[64:67], v[192:195], v[40:43], v[64:67]
    v_add_u32 v6, 24576, v6
    ds_read_b64_tr_b16 v[32:33], v6 offset:0
    s_add_u32 m0, s77, 24576
    v_mfma_f32_16x16x32_bf16 v[64:67], v[200:203], v[44:47], v[64:67]
    ds_read_b64_tr_b16 v[34:35], v6 offset:1280
    ds_read_b128 v[212:215], v4 offset:51200
    buffer_load_dwordx4 v10, s[8:11], s74 offen  lds
    v_mfma_f32_16x16x32_bf16 v[68:71], v[196:199], v[40:43], v[68:71]
    ds_read_b64_tr_b16 v[36:37], v6 offset:10240
    s_add_u32 m0, s77, 24576
    v_mfma_f32_16x16x32_bf16 v[68:71], v[204:207], v[44:47], v[68:71]
    ds_read_b64_tr_b16 v[38:39], v6 offset:11520
    ds_read_b128 v[216:219], v5 offset:49152
    buffer_load_dwordx4 v11, s[8:11], s74 offen offset:1024  lds
    s_waitcnt lgkmcnt(7)
    v_mfma_f32_16x16x32_bf16 v[72:75], v[192:195], v[24:27], v[72:75]
    v_add_u32 v16, 24576, v16
    ds_read_b64_tr_b16 v[40:41], v16 offset:0
    v_mfma_f32_16x16x32_bf16 v[72:75], v[200:203], v[28:31], v[72:75]
    ds_read_b64_tr_b16 v[42:43], v16 offset:1280
    ds_read_b128 v[220:223], v5 offset:51200
    v_mfma_f32_16x16x32_bf16 v[76:79], v[196:199], v[24:27], v[76:79]
    ds_read_b64_tr_b16 v[44:45], v16 offset:10240
    s_add_u32 m0, s77, 24576
    v_mfma_f32_16x16x32_bf16 v[76:79], v[204:207], v[28:31], v[76:79]
    ds_read_b64_tr_b16 v[46:47], v16 offset:11520
    buffer_load_dwordx4 v12, s[8:11], s74 offen offset:2048  lds
    s_waitcnt lgkmcnt(6)
    v_mfma_f32_16x16x32_bf16 v[80:83], v[192:195], v[32:35], v[80:83]
    v_add_u32 v17, 24576, v17
    ds_read_b64_tr_b16 v[24:25], v17 offset:16
    s_add_u32 m0, s76, 16384
    v_mfma_f32_16x16x32_bf16 v[80:83], v[200:203], v[36:39], v[80:83]
    ds_read_b64_tr_b16 v[26:27], v17 offset:1296
    buffer_load_dwordx4 v8, s[4:7], s73 offen  lds
    v_mfma_f32_16x16x32_bf16 v[84:87], v[196:199], v[32:35], v[84:87]
    ds_read_b64_tr_b16 v[28:29], v17 offset:10256
    v_mfma_f32_16x16x32_bf16 v[84:87], v[204:207], v[36:39], v[84:87]
    ds_read_b64_tr_b16 v[30:31], v17 offset:11536
    s_waitcnt lgkmcnt(4)
    v_mfma_f32_16x16x32_bf16 v[48:51], v[208:211], v[40:43], v[48:51]
    ds_read_b64_tr_b16 v[32:33], v17 offset:80
    s_add_u32 m0, s76, 16384
    v_mfma_f32_16x16x32_bf16 v[48:51], v[216:219], v[44:47], v[48:51]
    ds_read_b64_tr_b16 v[34:35], v17 offset:1360
    buffer_load_dwordx4 v9, s[4:7], s73 offen offset:1024  lds
    v_mfma_f32_16x16x32_bf16 v[52:55], v[212:215], v[40:43], v[52:55]
    ds_read_b64_tr_b16 v[36:37], v17 offset:10320
    v_mfma_f32_16x16x32_bf16 v[52:55], v[220:223], v[44:47], v[52:55]
    ds_read_b64_tr_b16 v[38:39], v17 offset:11600
    s_waitcnt lgkmcnt(4)
    v_mfma_f32_16x16x32_bf16 v[56:59], v[208:211], v[24:27], v[56:59]
    ds_read_b64_tr_b16 v[40:41], v16 offset:96
    v_mfma_f32_16x16x32_bf16 v[56:59], v[216:219], v[28:31], v[56:59]
    ds_read_b64_tr_b16 v[42:43], v16 offset:1376
    v_mfma_f32_16x16x32_bf16 v[60:63], v[212:215], v[24:27], v[60:63]
    ds_read_b64_tr_b16 v[44:45], v16 offset:10336
    v_mfma_f32_16x16x32_bf16 v[60:63], v[220:223], v[28:31], v[60:63]
    s_waitcnt vmcnt(5)
    s_barrier
    s_cmp_eq_u32 s91, 7
    s_cbranch_scc1 L_at_S1_7
L_at_S1_7b:
    ds_read_b64_tr_b16 v[46:47], v16 offset:11616
    ds_read_b128 v[224:227], v4 offset:0
    s_add_u32 m0, s78, 49152
    s_nop 0
    buffer_load_dwordx4 v13, s[12:15], s75 offen  lds
    s_waitcnt lgkmcnt(5)
    v_mfma_f32_16x16x32_bf16 v[64:67], v[208:211], v[32:35], v[64:67]
    v_add_u32 v6, 24576, v6
    ds_read_b64_tr_b16 v[24:25], v6 offset:0
    s_add_u32 m0, s78, 49152
    v_mfma_f32_16x16x32_bf16 v[64:67], v[216:219], v[36:39], v[64:67]
    ds_read_b64_tr_b16 v[26:27], v6 offset:1280
    ds_read_b128 v[228:231], v4 offset:2048
    buffer_load_dwordx4 v14, s[12:15], s75 offen offset:1024  lds
    v_mfma_f32_16x16x32_bf16 v[68:71], v[212:215], v[32:35], v[68:71]
    ds_read_b64_tr_b16 v[28:29], v6 offset:10240
    v_mfma_f32_16x16x32_bf16 v[68:71], v[220:223], v[36:39], v[68:71]
    ds_read_b64_tr_b16 v[30:31], v6 offset:11520
    ds_read_b128 v[232:235], v5 offset:0
    s_mov_b32 s89, 5570560
    s_and_b32 s68, s64, 3
    s_lshl_b32 s68, s68, 9
    s_lshl_b32 s69, s39, 2
    s_add_u32 s68, s68, s69
    s_waitcnt lgkmcnt(7)
    v_mfma_f32_16x16x32_bf16 v[72:75], v[208:211], v[40:43], v[72:75]
    v_subrev_u32 v16, 73728, v16
    ds_read_b64_tr_b16 v[32:33], v16 offset:0
    v_mfma_f32_16x16x32_bf16 v[72:75], v[216:219], v[44:47], v[72:75]
    ds_read_b64_tr_b16 v[34:35], v16 offset:1280
    ds_read_b128 v[236:239], v5 offset:2048
    s_add_u32 s68, s68, s37
    s_mul_i32 s68, s68, 1280
    s_add_u32 s89, s89, s68
    v_lshrrev_b32 v1, 5, v0
    v_mul_u32_u24 v1, 640, v1
    v_mfma_f32_16x16x32_bf16 v[76:79], v[212:215], v[40:43], v[76:79]
    ds_read_b64_tr_b16 v[36:37], v16 offset:10240
    v_mfma_f32_16x16x32_bf16 v[76:79], v[220:223], v[44:47], v[76:79]
    ds_read_b64_tr_b16 v[38:39], v16 offset:11520
    v_bfe_u32 v8, v0, 4, 1
    v_bfe_u32 v3, v0, 3, 1
    v_mul_u32_u24 v10, 81920, v3
    v_add_u32 v10, v10, v1
    v_and_b32 v2, 7, v0
    s_waitcnt lgkmcnt(6)
    v_mfma_f32_16x16x32_bf16 v[80:83], v[208:211], v[24:27], v[80:83]
    v_subrev_u32 v17, 73728, v17
    ds_read_b64_tr_b16 v[40:41], v17 offset:16
    s_add_u32 m0, s78, 49152
    v_mfma_f32_16x16x32_bf16 v[80:83], v[216:219], v[28:31], v[80:83]
    ds_read_b64_tr_b16 v[42:43], v17 offset:1296
    buffer_load_dwordx4 v15, s[12:15], s75 offen offset:2048  lds
    s_add_u32 s75, s75, 221184
    s_cmp_eq_u32 s88, 9
    s_cmov_b32 s75, s93
    v_mfma_f32_16x16x32_bf16 v[84:87], v[212:215], v[24:27], v[84:87]
    ds_read_b64_tr_b16 v[44:45], v17 offset:10256
    v_mfma_f32_16x16x32_bf16 v[84:87], v[220:223], v[28:31], v[84:87]
    ds_read_b64_tr_b16 v[46:47], v17 offset:11536
    v_lshl_add_u32 v10, v2, 4, v10
    v_lshl_add_u32 v9, v8, 7, v10
    v_add_u32 v9, 128, v9
    v_mul_u32_u24 v2, 384, v8
    v_add_u32 v10, v10, v2
    s_waitcnt lgkmcnt(4)
    v_mfma_f32_16x16x32_bf16 v[48:51], v[224:227], v[32:35], v[48:51]
    ds_read_b64_tr_b16 v[24:25], v17 offset:80
    v_mfma_f32_16x16x32_bf16 v[48:51], v[232:235], v[36:39], v[48:51]
    ds_read_b64_tr_b16 v[26:27], v17 offset:1360
    v_bfe_u32 v2, v0, 2, 1
    v_lshl_add_u32 v2, v3, 2, v2
    v_mul_u32_u24 v2, 81920, v2
    v_lshlrev_b32 v8, 6, v8
    v_add3_u32 v2, v2, v1, v8
    v_mfma_f32_16x16x32_bf16 v[52:55], v[228:231], v[32:35], v[52:55]
    ds_read_b64_tr_b16 v[28:29], v17 offset:10320
    v_mfma_f32_16x16x32_bf16 v[52:55], v[236:239], v[36:39], v[52:55]
    ds_read_b64_tr_b16 v[30:31], v17 offset:11600
    v_and_b32 v3, 3, v0
    v_lshl_add_u32 v11, v3, 4, v2
    s_waitcnt lgkmcnt(4)
    v_mfma_f32_16x16x32_bf16 v[56:59], v[224:227], v[40:43], v[56:59]
    ds_read_b64_tr_b16 v[32:33], v16 offset:96
    v_mfma_f32_16x16x32_bf16 v[56:59], v[232:235], v[44:47], v[56:59]
    ds_read_b64_tr_b16 v[34:35], v16 offset:1376
    v_mfma_f32_16x16x32_bf16 v[60:63], v[228:231], v[40:43], v[60:63]
    ds_read_b64_tr_b16 v[36:37], v16 offset:10336
    v_mfma_f32_16x16x32_bf16 v[60:63], v[236:239], v[44:47], v[60:63]
    s_waitcnt vmcnt(3)
    s_barrier
    s_cmp_eq_u32 s91, 8
    s_cbranch_scc1 L_at_S1_8
L_at_S1_8b:
    ds_read_b64_tr_b16 v[38:39], v16 offset:11616
    ds_read_b128 v[240:243], v4 offset:16384
    s_waitcnt lgkmcnt(5)
    v_mfma_f32_16x16x32_bf16 v[64:67], v[224:227], v[24:27], v[64:67]
    v_subrev_u32 v6, 73728, v6
    ds_read_b64_tr_b16 v[40:41], v6 offset:0
    v_mfma_f32_16x16x32_bf16 v[64:67], v[232:235], v[28:31], v[64:67]
    ds_read_b64_tr_b16 v[42:43], v6 offset:1280
    ds_read_b128 v[244:247], v4 offset:18432
    v_mfma_f32_16x16x32_bf16 v[68:71], v[228:231], v[24:27], v[68:71]
    ds_read_b64_tr_b16 v[44:45], v6 offset:10240
    s_add_u32 m0, s78, 73728
    v_mfma_f32_16x16x32_bf16 v[68:71], v[236:239], v[28:31], v[68:71]
    ds_read_b64_tr_b16 v[46:47], v6 offset:11520
    ds_read_b128 v[248:251], v5 offset:16384
    buffer_load_dwordx4 v13, s[12:15], s75 offen  lds
    s_waitcnt lgkmcnt(7)
    v_mfma_f32_16x16x32_bf16 v[72:75], v[224:227], v[32:35], v[72:75]
    v_add_u32 v16, 24576, v16
    ds_read_b64_tr_b16 v[24:25], v16 offset:0
    v_mfma_f32_16x16x32_bf16 v[72:75], v[232:235], v[36:39], v[72:75]
    ds_read_b64_tr_b16 v[26:27], v16 offset:1280
    ds_read_b128 v[252:255], v5 offset:18432
    v_mfma_f32_16x16x32_bf16 v[76:79], v[228:231], v[32:35], v[76:79]
    ds_read_b64_tr_b16 v[28:29], v16 offset:10240
    s_add_u32 m0, s78, 73728
    v_mfma_f32_16x16x32_bf16 v[76:79], v[236:239], v[36:39], v[76:79]
    ds_read_b64_tr_b16 v[30:31], v16 offset:11520
    buffer_load_dwordx4 v14, s[12:15], s75 offen offset:1024  lds
    s_waitcnt lgkmcnt(6)
    v_mfma_f32_16x16x32_bf16 v[80:83], v[224:227], v[40:43], v[80:83]
    v_add_u32 v17, 24576, v17
    ds_read_b64_tr_b16 v[32:33], v17 offset:16
    v_mfma_f32_16x16x32_bf16 v[80:83], v[232:235], v[44:47], v[80:83]
    ds_read_b64_tr_b16 v[34:35], v17 offset:1296
    v_mfma_f32_16x16x32_bf16 v[84:87], v[228:231], v[40:43], v[84:87]
    ds_read_b64_tr_b16 v[36:37], v17 offset:10256
    s_add_u32 m0, s78, 73728
    v_mfma_f32_16x16x32_bf16 v[84:87], v[236:239], v[44:47], v[84:87]
    ds_read_b64_tr_b16 v[38:39], v17 offset:11536
    buffer_load_dwordx4 v15, s[12:15], s75 offen offset:2048  lds
    s_add_u32 s75, s75, 221184
    s_cmp_eq_u32 s88, 8
    s_cmov_b32 s75, s93
    s_waitcnt lgkmcnt(4)
    v_mfma_f32_16x16x32_bf16 v[48:51], v[240:243], v[24:27], v[48:51]
    ds_read_b64_tr_b16 v[40:41], v17 offset:80
    v_mfma_f32_16x16x32_bf16 v[48:51], v[248:251], v[28:31], v[48:51]
    ds_read_b64_tr_b16 v[42:43], v17 offset:1360
    v_mfma_f32_16x16x32_bf16 v[52:55], v[244:247], v[24:27], v[52:55]
    ds_read_b64_tr_b16 v[44:45], v17 offset:10320
    v_mfma_f32_16x16x32_bf16 v[52:55], v[252:255], v[28:31], v[52:55]
    ds_read_b64_tr_b16 v[46:47], v17 offset:11600
    s_waitcnt lgkmcnt(4)
    v_mfma_f32_16x16x32_bf16 v[56:59], v[240:243], v[32:35], v[56:59]
    ds_read_b64_tr_b16 v[24:25], v16 offset:96
    v_mfma_f32_16x16x32_bf16 v[56:59], v[248:251], v[36:39], v[56:59]
    ds_read_b64_tr_b16 v[26:27], v16 offset:1376
    v_mfma_f32_16x16x32_bf16 v[60:63], v[244:247], v[32:35], v[60:63]
    ds_read_b64_tr_b16 v[28:29], v16 offset:10336
    v_mfma_f32_16x16x32_bf16 v[60:63], v[252:255], v[36:39], v[60:63]
    s_waitcnt vmcnt(3)
    s_barrier
    ds_read_b64_tr_b16 v[30:31], v16 offset:11616
    s_waitcnt lgkmcnt(4)
    v_mfma_f32_16x16x32_bf16 v[64:67], v[240:243], v[40:43], v[64:67]
    v_add_u32 v6, 24576, v6
    ds_read_b64_tr_b16 v[32:33], v6 offset:0
    v_mfma_f32_16x16x32_bf16 v[64:67], v[248:251], v[44:47], v[64:67]
    ds_read_b64_tr_b16 v[34:35], v6 offset:1280
    v_mfma_f32_16x16x32_bf16 v[68:71], v[244:247], v[40:43], v[68:71]
    ds_read_b64_tr_b16 v[36:37], v6 offset:10240
    s_add_u32 m0, s78, 0
    v_mfma_f32_16x16x32_bf16 v[68:71], v[252:255], v[44:47], v[68:71]
    ds_read_b64_tr_b16 v[38:39], v6 offset:11520
    buffer_load_dwordx4 v13, s[12:15], s75 offen  lds
    s_waitcnt lgkmcnt(4)
    v_mfma_f32_16x16x32_bf16 v[72:75], v[240:243], v[24:27], v[72:75]
    v_mfma_f32_16x16x32_bf16 v[72:75], v[248:251], v[28:31], v[72:75]
    v_mfma_f32_16x16x32_bf16 v[76:79], v[244:247], v[24:27], v[76:79]
    s_add_u32 m0, s78, 0
    v_mfma_f32_16x16x32_bf16 v[76:79], v[252:255], v[28:31], v[76:79]
    buffer_load_dwordx4 v14, s[12:15], s75 offen offset:1024  lds
    s_waitcnt lgkmcnt(0)
    v_mfma_f32_16x16x32_bf16 v[80:83], v[240:243], v[32:35], v[80:83]
    ds_read_b64_tr_b16 v[24:25], v18 offset:0
    v_mfma_f32_16x16x32_bf16 v[80:83], v[248:251], v[36:39], v[80:83]
    ds_read_b64_tr_b16 v[26:27], v18 offset:768
    v_mfma_f32_16x16x32_bf16 v[84:87], v[244:247], v[32:35], v[84:87]
    ds_read_b64_tr_b16 v[28:29], v18 offset:6144
    s_add_u32 m0, s78, 0
    v_mfma_f32_16x16x32_bf16 v[84:87], v[252:255], v[36:39], v[84:87]
    ds_read_b64_tr_b16 v[30:31], v18 offset:6912
    buffer_load_dwordx4 v15, s[12:15], s75 offen offset:2048  lds
    s_add_u32 s75, s75, 221184
    s_cmp_eq_u32 s88, 7
    s_cmov_b32 s75, s93
    ds_read_b64_tr_b16 v[32:33], v18 offset:12288
    ds_read_b64_tr_b16 v[34:35], v18 offset:13056
    ds_read_b64_tr_b16 v[36:37], v18 offset:18432
    ds_read_b64_tr_b16 v[38:39], v18 offset:19200
    ds_read_b64_tr_b16 v[40:41], v19 offset:0
    ds_read_b64_tr_b16 v[42:43], v19 offset:768
    ds_read_b64_tr_b16 v[44:45], v19 offset:6144
    ds_read_b64_tr_b16 v[46:47], v19 offset:6912
    s_add_u32 s68, s89, 327680
    v_cvt_pk_bf16_f32 v48, v48, v49
    v_cvt_pk_bf16_f32 v49, v50, v51
    v_cvt_pk_bf16_f32 v50, v52, v53
    v_cvt_pk_bf16_f32 v51, v54, v55
    buffer_store_dwordx4 v[48:51], v10, s[16:19], s68 offen offset:0 sc1
    v_cvt_pk_bf16_f32 v56, v56, v57
    v_cvt_pk_bf16_f32 v57, v58, v59
    v_cvt_pk_bf16_f32 v58, v60, v61
    v_cvt_pk_bf16_f32 v59, v62, v63
    buffer_store_dwordx4 v[56:59], v9, s[16:19], s68 offen offset:0 sc1
    s_add_u32 s68, s89, 491520
    v_cvt_pk_bf16_f32 v64, v64, v65
    v_cvt_pk_bf16_f32 v65, v66, v67
    v_cvt_pk_bf16_f32 v66, v68, v69
    v_cvt_pk_bf16_f32 v67, v70, v71
    buffer_store_dwordx4 v[64:67], v10, s[16:19], s68 offen offset:0 sc1
    v_cvt_pk_bf16_f32 v72, v72, v73
    v_cvt_pk_bf16_f32 v73, v74, v75
    v_cvt_pk_bf16_f32 v74, v76, v77
    v_cvt_pk_bf16_f32 v75, v78, v79
    buffer_store_dwordx4 v[72:75], v9, s[16:19], s68 offen offset:0 sc1
    s_add_u32 s68, s89, 163840
    v_cvt_pk_bf16_f32 v80, v80, v81
    v_cvt_pk_bf16_f32 v81, v82, v83
    v_cvt_pk_bf16_f32 v82, v84, v85
    v_cvt_pk_bf16_f32 v83, v86, v87
    buffer_store_dwordx4 v[80:83], v11, s[16:19], s68 offen offset:512 sc1
    v_mov_b32 v12, 1073741824
    buffer_load_dword v17, v12, s[32:35], 0 offen
    s_branch L_pass2
L_E0:
    v_lshlrev_b32 v1, 7, v21
    v_lshl_add_u32 v1, v23, 3, v1
    v_bfe_u32 v2, v0, 3, 1
    v_lshl_add_u32 v2, v2, 1, v22
    s_lshl_b32 s68, s38, 1
    v_xor_b32 v2, s68, v2
    v_xor_b32 v3, 0, v2
    v_lshl_add_u32 v16, v3, 5, v1
    v_xor_b32 v3, 1, v2
    v_lshl_add_u32 v17, v3, 5, v1
    s_and_b32 s68, s2, 1
    s_lshl_b32 s68, s68, 7
    s_cmp_eq_u32 s36, 0
    s_cselect_b32 s68, s68, 1073741824
    v_mov_b32 v22, 1073741824
    v_writelane_b32 v22, s68, 0
    v_mov_b32 v21, 1
    s_bfe_u32 s91, s2, 0x30003
    s_add_u32 s91, s91, 1
    s_cmp_eq_u32 s36, 0
    s_cselect_b32 s91, s91, 0
    s_lshl_b32 s68, s80, 6
    s_add_u32 s69, s68, s37
    s_mul_i32 s69, s69, 1280
    s_cmp_eq_u32 s38, 0
    s_mov_b32 s82, 5570560
    s_cselect_b32 s82, 2949120, s82
    s_add_u32 s82, s82, s69
    s_mul_i32 s83, s36, 1280
    s_add_u32 s83, s83, 122880
    s_and_b32 s96, s36, 1
    s_lshl_b32 s96, s96, 1
    s_add_u32 s96, s96, s38
    s_lshr_b32 s97, s37, 1
    s_lshl_b32 s68, s81, 2
    s_lshr_b32 s69, s36, 1
    s_add_u32 s68, s68, s69
    s_mul_i32 s68, s68, 19
    s_and_b32 s69, s36, 1
    s_add_u32 s68, s68, s69
    s_mul_i32 s68, s68, 5120
    s_add_u32 s84, s68, 17891328
    s_lshl_b32 s68, s80, 1
    s_add_u32 s68, s68, s97
    s_mul_i32 s68, s68, 108
    s_mul_i32 s69, s96, 14
    s_add_u32 s68, s68, s69
    s_lshr_b32 s69, s96, 1
    s_sub_u32 s68, s68, s69
    s_lshl_b32 s68, s68, 10
    s_add_u32 s68, s68, 10813440
    s_mul_i32 s69, s38, 55296
    s_add_u32 s86, s68, s69
    s_sub_u32 s68, s68, s69
    s_add_u32 s98, s68, 55296
    s_mul_i32 s69, s38, 14336
    s_sub_u32 s69, 13312, s69
    s_add_u32 s92, s86, s69
    s_mov_b64 exec, 0x7777
    buffer_load_dwordx2 v[254:255], v28, s[8:11], s89 offen offset:60
    s_mov_b64 exec, -1
    global_load_dwordx2 v[254:255], v[30:31], off offset:60
    buffer_store_dword v33, v32, s[16:19], 0 offen sc1
    s_waitcnt vmcnt(7)
    s_barrier
    ds_read_b128 v[96:99], v4 offset:0
    ds_read_b128 v[100:103], v4 offset:2048
    ds_read_b128 v[104:107], v5 offset:0
    ds_read_b128 v[108:111], v5 offset:2048
    ds_read_b64_tr_b16 v[24:25], v16 offset:0
    ds_read_b64_tr_b16 v[26:27], v16 offset:512
    ds_read_b64_tr_b16 v[28:29], v16 offset:4096
    ds_read_b64_tr_b16 v[30:31], v16 offset:4608
    ds_read_b64_tr_b16 v[32:33], v16 offset:8192
    ds_read_b64_tr_b16 v[34:35], v16 offset:8704
    ds_read_b64_tr_b16 v[36:37], v16 offset:12288
    ds_read_b64_tr_b16 v[38:39], v16 offset:12800
    ds_read_b64_tr_b16 v[40:41], v17 offset:0
    ds_read_b64_tr_b16 v[42:43], v17 offset:512
    ds_read_b64_tr_b16 v[44:45], v17 offset:4096
    ds_read_b64_tr_b16 v[46:47], v17 offset:4608
    s_waitcnt lgkmcnt(8)
    v_mfma_f32_16x16x32_bf16 v[48:51], v[24:27], v[96:99], 0
    s_add_u32 m0, s77, 49152
    v_mfma_f32_16x16x32_bf16 v[48:51], v[28:31], v[104:107], v[48:51]
    buffer_load_dwordx4 v10, s[8:11], s74 offen  lds
    v_mfma_f32_16x16x32_bf16 v[52:55], v[24:27], v[100:103], 0
    v_mfma_f32_16x16x32_bf16 v[52:55], v[28:31], v[108:111], v[52:55]
    s_add_u32 m0, s77, 49152
    s_nop 0
    buffer_load_dwordx4 v11, s[8:11], s74 offen offset:1024  lds
    s_add_u32 s74, s74, s79
    s_cmp_eq_u32 s88, 7
    s_cmov_b32 s74, s90
    s_add_u32 m0, s76, 32768
    s_nop 0
    buffer_load_dwordx4 v8, s[4:7], s73 offen  lds
    s_add_u32 m0, s76, 32768
    s_nop 0
    buffer_load_dwordx4 v9, s[4:7], s73 offen offset:1024  lds
    s_add_u32 s73, s73, 128
    s_cmp_eq_u32 s88, 7
    s_cmov_b32 s73, 0
    s_waitcnt vmcnt(7)
    s_barrier
    ds_read_b128 v[112:115], v4 offset:16384
    s_add_u32 m0, s77, 73728
    s_nop 0
    buffer_load_dwordx4 v10, s[8:11], s74 offen  lds
    s_waitcnt lgkmcnt(5)
    v_mfma_f32_16x16x32_bf16 v[56:59], v[32:35], v[96:99], 0
    ds_read_b64_tr_b16 v[24:25], v17 offset:8192
    v_mfma_f32_16x16x32_bf16 v[56:59], v[36:39], v[104:107], v[56:59]
    ds_read_b64_tr_b16 v[26:27], v17 offset:8704
    ds_read_b128 v[116:119], v4 offset:18432
    v_mfma_f32_16x16x32_bf16 v[60:63], v[32:35], v[100:103], 0
    ds_read_b64_tr_b16 v[28:29], v17 offset:12288
    s_add_u32 m0, s77, 73728
    v_mfma_f32_16x16x32_bf16 v[60:63], v[36:39], v[108:111], v[60:63]
    ds_read_b64_tr_b16 v[30:31], v17 offset:12800
    ds_read_b128 v[120:123], v5 offset:16384
    buffer_load_dwordx4 v11, s[8:11], s74 offen offset:1024  lds
    s_add_u32 s74, s74, s79
    s_cmp_eq_u32 s88, 6
    s_cmov_b32 s74, s90
    s_waitcnt lgkmcnt(7)
    v_mfma_f32_16x16x32_bf16 v[64:67], v[40:43], v[96:99], 0
    v_add_u32 v16, 24576, v16
    ds_read_b64_tr_b16 v[32:33], v16 offset:0
    s_add_u32 m0, s76, 49152
    v_mfma_f32_16x16x32_bf16 v[64:67], v[44:47], v[104:107], v[64:67]
    ds_read_b64_tr_b16 v[34:35], v16 offset:512
    ds_read_b128 v[124:127], v5 offset:18432
    buffer_load_dwordx4 v8, s[4:7], s73 offen  lds
    v_mfma_f32_16x16x32_bf16 v[68:71], v[40:43], v[100:103], 0
    ds_read_b64_tr_b16 v[36:37], v16 offset:4096
    v_mfma_f32_16x16x32_bf16 v[68:71], v[44:47], v[108:111], v[68:71]
    ds_read_b64_tr_b16 v[38:39], v16 offset:4608
    s_waitcnt lgkmcnt(6)
    v_mfma_f32_16x16x32_bf16 v[72:75], v[24:27], v[96:99], 0
    ds_read_b64_tr_b16 v[40:41], v16 offset:8192
    s_add_u32 m0, s76, 49152
    v_mfma_f32_16x16x32_bf16 v[72:75], v[28:31], v[104:107], v[72:75]
    ds_read_b64_tr_b16 v[42:43], v16 offset:8704
    buffer_load_dwordx4 v9, s[4:7], s73 offen offset:1024  lds
    s_add_u32 s73, s73, 128
    s_cmp_eq_u32 s88, 6
    s_cmov_b32 s73, 0
    v_mfma_f32_16x16x32_bf16 v[76:79], v[24:27], v[100:103], 0
    ds_read_b64_tr_b16 v[44:45], v16 offset:12288
    v_mfma_f32_16x16x32_bf16 v[76:79], v[28:31], v[108:111], v[76:79]
    ds_read_b64_tr_b16 v[46:47], v16 offset:12800
    s_waitcnt lgkmcnt(4)
    v_mfma_f32_16x16x32_bf16 v[48:51], v[32:35], v[112:115], v[48:51]
    v_add_u32 v17, 24576, v17
    ds_read_b64_tr_b16 v[24:25], v17 offset:0
    v_mfma_f32_16x16x32_bf16 v[48:51], v[36:39], v[120:123], v[48:51]
    ds_read_b64_tr_b16 v[26:27], v17 offset:512
    v_mfma_f32_16x16x32_bf16 v[52:55], v[32:35], v[116:119], v[52:55]
    ds_read_b64_tr_b16 v[28:29], v17 offset:4096
    v_mfma_f32_16x16x32_bf16 v[52:55], v[36:39], v[124:127], v[52:55]
    s_waitcnt vmcnt(4)
    s_barrier
    s_cmp_eq_u32 s91, 1
    s_cbranch_scc1 L_at_E0_1
L_at_E0_1b:
    ds_read_b64_tr_b16 v[30:31], v17 offset:4608
    ds_read_b128 v[128:131], v4 offset:32768
    s_waitcnt lgkmcnt(5)
    v_mfma_f32_16x16x32_bf16 v[56:59], v[40:43], v[112:115], v[56:59]
    ds_read_b64_tr_b16 v[32:33], v17 offset:8192
    s_add_u32 m0, s77, 0
    v_mfma_f32_16x16x32_bf16 v[56:59], v[44:47], v[120:123], v[56:59]
    ds_read_b64_tr_b16 v[34:35], v17 offset:8704
    ds_read_b128 v[132:135], v4 offset:34816
    buffer_load_dwordx4 v10, s[8:11], s74 offen  lds
    v_mfma_f32_16x16x32_bf16 v[60:63], v[40:43], v[116:119], v[60:63]
    ds_read_b64_tr_b16 v[36:37], v17 offset:12288
    s_add_u32 m0, s77, 0
    v_mfma_f32_16x16x32_bf16 v[60:63], v[44:47], v[124:127], v[60:63]
    ds_read_b64_tr_b16 v[38:39], v17 offset:12800
    ds_read_b128 v[136:139], v5 offset:32768
    buffer_load_dwordx4 v11, s[8:11], s74 offen offset:1024  lds
    s_add_u32 s74, s74, s79
    s_cmp_eq_u32 s88, 5
    s_cmov_b32 s74, s90
    s_waitcnt lgkmcnt(7)
    v_mfma_f32_16x16x32_bf16 v[64:67], v[24:27], v[112:115], v[64:67]
    v_add_u32 v16, 24576, v16
    ds_read_b64_tr_b16 v[40:41], v16 offset:0
    v_mfma_f32_16x16x32_bf16 v[64:67], v[28:31], v[120:123], v[64:67]
    ds_read_b64_tr_b16 v[42:43], v16 offset:512
    ds_read_b128 v[140:143], v5 offset:34816
    v_mfma_f32_16x16x32_bf16 v[68:71], v[24:27], v[116:119], v[68:71]
    ds_read_b64_tr_b16 v[44:45], v16 offset:4096
    s_add_u32 m0, s76, 0
    v_mfma_f32_16x16x32_bf16 v[68:71], v[28:31], v[124:127], v[68:71]
    ds_read_b64_tr_b16 v[46:47], v16 offset:4608
    buffer_load_dwordx4 v8, s[4:7], s73 offen  lds
    s_waitcnt lgkmcnt(6)
    v_mfma_f32_16x16x32_bf16 v[72:75], v[32:35], v[112:115], v[72:75]
    ds_read_b64_tr_b16 v[24:25], v16 offset:8192
    s_add_u32 m0, s76, 0
    v_mfma_f32_16x16x32_bf16 v[72:75], v[36:39], v[120:123], v[72:75]
    ds_read_b64_tr_b16 v[26:27], v16 offset:8704
    buffer_load_dwordx4 v9, s[4:7], s73 offen offset:1024  lds
    s_add_u32 s73, s73, 128
    s_cmp_eq_u32 s88, 5
    s_cmov_b32 s73, 0
    v_mfma_f32_16x16x32_bf16 v[76:79], v[32:35], v[116:119], v[76:79]
    ds_read_b64_tr_b16 v[28:29], v16 offset:12288
    v_mfma_f32_16x16x32_bf16 v[76:79], v[36:39], v[124:127], v[76:79]
    ds_read_b64_tr_b16 v[30:31], v16 offset:12800
    s_mov_b64 exec, 0xff
    buffer_load_dword v7, v7, s[12:15], s85 offen
    s_mov_b64 exec, -1
    s_waitcnt lgkmcnt(4)
    v_mfma_f32_16x16x32_bf16 v[48:51], v[40:43], v[128:131], v[48:51]
    v_add_u32 v17, 24576, v17
    ds_read_b64_tr_b16 v[32:33], v17 offset:0
    v_mfma_f32_16x16x32_bf16 v[48:51], v[44:47], v[136:139], v[48:51]
    ds_read_b64_tr_b16 v[34:35], v17 offset:512
    v_mfma_f32_16x16x32_bf16 v[52:55], v[40:43], v[132:135], v[52:55]
    ds_read_b64_tr_b16 v[36:37], v17 offset:4096
    v_mfma_f32_16x16x32_bf16 v[52:55], v[44:47], v[140:143], v[52:55]
    s_waitcnt vmcnt(5)
    s_barrier
    s_cmp_eq_u32 s91, 2
    s_cbranch_scc1 L_at_E0_2
L_at_E0_2b:
    ds_read_b64_tr_b16 v[38:39], v17 offset:4608
    ds_read_b128 v[144:147], v4 offset:49152
    s_waitcnt lgkmcnt(5)
    v_mfma_f32_16x16x32_bf16 v[56:59], v[24:27], v[128:131], v[56:59]
    ds_read_b64_tr_b16 v[40:41], v17 offset:8192
    s_add_u32 m0, s77, 24576
    v_mfma_f32_16x16x32_bf16 v[56:59], v[28:31], v[136:139], v[56:59]
    ds_read_b64_tr_b16 v[42:43], v17 offset:8704
    ds_read_b128 v[148:151], v4 offset:51200
    buffer_load_dwordx4 v10, s[8:11], s74 offen  lds
    v_mfma_f32_16x16x32_bf16 v[60:63], v[24:27], v[132:135], v[60:63]
    ds_read_b64_tr_b16 v[44:45], v17 offset:12288
    s_add_u32 m0, s77, 24576
    v_mfma_f32_16x16x32_bf16 v[60:63], v[28:31], v[140:143], v[60:63]
    ds_read_b64_tr_b16 v[46:47], v17 offset:12800
    ds_read_b128 v[152:155], v5 offset:49152
    buffer_load_dwordx4 v11, s[8:11], s74 offen offset:1024  lds
    s_add_u32 s74, s74, s79
    s_cmp_eq_u32 s88, 4
    s_cmov_b32 s74, s90
    s_waitcnt lgkmcnt(7)
    v_mfma_f32_16x16x32_bf16 v[64:67], v[32:35], v[128:131], v[64:67]
    v_add_u32 v16, 24576, v16
    ds_read_b64_tr_b16 v[24:25], v16 offset:0
    v_mfma_f32_16x16x32_bf16 v[64:67], v[36:39], v[136:139], v[64:67]
    ds_read_b64_tr_b16 v[26:27], v16 offset:512
    ds_read_b128 v[156:159], v5 offset:51200
    v_mfma_f32_16x16x32_bf16 v[68:71], v[32:35], v[132:135], v[68:71]
    ds_read_b64_tr_b16 v[28:29], v16 offset:4096
    s_add_u32 m0, s76, 16384
    v_mfma_f32_16x16x32_bf16 v[68:71], v[36:39], v[140:143], v[68:71]
    ds_read_b64_tr_b16 v[30:31], v16 offset:4608
    buffer_load_dwordx4 v8, s[4:7], s73 offen  lds
    s_waitcnt lgkmcnt(6)
    v_mfma_f32_16x16x32_bf16 v[72:75], v[40:43], v[128:131], v[72:75]
    ds_read_b64_tr_b16 v[32:33], v16 offset:8192
    s_add_u32 m0, s76, 16384
    v_mfma_f32_16x16x32_bf16 v[72:75], v[44:47], v[136:139], v[72:75]
    ds_read_b64_tr_b16 v[34:35], v16 offset:8704
    buffer_load_dwordx4 v9, s[4:7], s73 offen offset:1024  lds
    s_add_u32 s73, s73, 128
    s_cmp_eq_u32 s88, 4
    s_cmov_b32 s73, 0
    v_mfma_f32_16x16x32_bf16 v[76:79], v[40:43], v[132:135], v[76:79]
    ds_read_b64_tr_b16 v[36:37], v16 offset:12288
    v_mfma_f32_16x16x32_bf16 v[76:79], v[44:47], v[140:143], v[76:79]
    ds_read_b64_tr_b16 v[38:39], v16 offset:12800
    s_waitcnt lgkmcnt(4)
    v_mfma_f32_16x16x32_bf16 v[48:51], v[24:27], v[144:147], v[48:51]
    v_add_u32 v17, 24576, v17
    ds_read_b64_tr_b16 v[40:41], v17 offset:0
    v_mfma_f32_16x16x32_bf16 v[48:51], v[28:31], v[152:155], v[48:51]
    ds_read_b64_tr_b16 v[42:43], v17 offset:512
    v_mfma_f32_16x16x32_bf16 v[52:55], v[24:27], v[148:151], v[52:55]
    ds_read_b64_tr_b16 v[44:45], v17 offset:4096
    v_mfma_f32_16x16x32_bf16 v[52:55], v[28:31], v[156:159], v[52:55]
    s_waitcnt vmcnt(5)
    s_barrier
    s_cmp_eq_u32 s91, 3
    s_cbranch_scc1 L_at_E0_3
L_at_E0_3b:
    ds_read_b64_tr_b16 v[46:47], v17 offset:4608
    ds_read_b128 v[160:163], v4 offset:0
    s_waitcnt lgkmcnt(5)
    v_mfma_f32_16x16x32_bf16 v[56:59], v[32:35], v[144:147], v[56:59]
    ds_read_b64_tr_b16 v[24:25], v17 offset:8192
    s_add_u32 m0, s77, 49152
    v_mfma_f32_16x16x32_bf16 v[56:59], v[36:39], v[152:155], v[56:59]
    ds_read_b64_tr_b16 v[26:27], v17 offset:8704
    ds_read_b128 v[164:167], v4 offset:2048
    buffer_load_dwordx4 v10, s[8:11], s74 offen  lds
    v_mfma_f32_16x16x32_bf16 v[60:63], v[32:35], v[148:151], v[60:63]
    ds_read_b64_tr_b16 v[28:29], v17 offset:12288
    s_add_u32 m0, s77, 49152
    v_mfma_f32_16x16x32_bf16 v[60:63], v[36:39], v[156:159], v[60:63]
    ds_read_b64_tr_b16 v[30:31], v17 offset:12800
    ds_read_b128 v[168:171], v5 offset:0
    buffer_load_dwordx4 v11, s[8:11], s74 offen offset:1024  lds
    s_add_u32 s74, s74, s79
    s_cmp_eq_u32 s88, 3
    s_cmov_b32 s74, s90
    s_waitcnt lgkmcnt(7)
    v_mfma_f32_16x16x32_bf16 v[64:67], v[40:43], v[144:147], v[64:67]
    v_subrev_u32 v16, 73728, v16
    ds_read_b64_tr_b16 v[32:33], v16 offset:0
    v_mfma_f32_16x16x32_bf16 v[64:67], v[44:47], v[152:155], v[64:67]
    ds_read_b64_tr_b16 v[34:35], v16 offset:512
    ds_read_b128 v[172:175], v5 offset:2048
    v_mfma_f32_16x16x32_bf16 v[68:71], v[40:43], v[148:151], v[68:71]
    ds_read_b64_tr_b16 v[36:37], v16 offset:4096
    s_add_u32 m0, s76, 32768
    v_mfma_f32_16x16x32_bf16 v[68:71], v[44:47], v[156:159], v[68:71]
    ds_read_b64_tr_b16 v[38:39], v16 offset:4608
    buffer_load_dwordx4 v8, s[4:7], s73 offen  lds
    s_waitcnt lgkmcnt(6)
    v_mfma_f32_16x16x32_bf16 v[72:75], v[24:27], v[144:147], v[72:75]
    ds_read_b64_tr_b16 v[40:41], v16 offset:8192
    s_add_u32 m0, s76, 32768
    v_mfma_f32_16x16x32_bf16 v[72:75], v[28:31], v[152:155], v[72:75]
    ds_read_b64_tr_b16 v[42:43], v16 offset:8704
    buffer_load_dwordx4 v9, s[4:7], s73 offen offset:1024  lds
    s_add_u32 s73, s73, 128
    s_cmp_eq_u32 s88, 3
    s_cmov_b32 s73, 0
    v_mfma_f32_16x16x32_bf16 v[76:79], v[24:27], v[148:151], v[76:79]
    ds_read_b64_tr_b16 v[44:45], v16 offset:12288
    v_mfma_f32_16x16x32_bf16 v[76:79], v[28:31], v[156:159], v[76:79]
    ds_read_b64_tr_b16 v[46:47], v16 offset:12800
    s_waitcnt lgkmcnt(4)
    v_mfma_f32_16x16x32_bf16 v[48:51], v[32:35], v[160:163], v[48:51]
    v_subrev_u32 v17, 73728, v17
    ds_read_b64_tr_b16 v[24:25], v17 offset:0
    v_mfma_f32_16x16x32_bf16 v[48:51], v[36:39], v[168:171], v[48:51]
    ds_read_b64_tr_b16 v[26:27], v17 offset:512
    v_mfma_f32_16x16x32_bf16 v[52:55], v[32:35], v[164:167], v[52:55]
    ds_read_b64_tr_b16 v[28:29], v17 offset:4096
    v_mfma_f32_16x16x32_bf16 v[52:55], v[36:39], v[172:175], v[52:55]
    s_waitcnt vmcnt(4)
    s_barrier
    s_cmp_eq_u32 s91, 4
    s_cbranch_scc1 L_at_E0_4
L_at_E0_4b:
    ds_read_b64_tr_b16 v[30:31], v17 offset:4608
    ds_read_b128 v[176:179], v4 offset:16384
    s_waitcnt lgkmcnt(5)
    v_mfma_f32_16x16x32_bf16 v[56:59], v[40:43], v[160:163], v[56:59]
    ds_read_b64_tr_b16 v[32:33], v17 offset:8192
    s_add_u32 m0, s77, 73728
    v_mfma_f32_16x16x32_bf16 v[56:59], v[44:47], v[168:171], v[56:59]
    ds_read_b64_tr_b16 v[34:35], v17 offset:8704
    ds_read_b128 v[180:183], v4 offset:18432
    buffer_load_dwordx4 v10, s[8:11], s74 offen  lds
    v_mfma_f32_16x16x32_bf16 v[60:63], v[40:43], v[164:167], v[60:63]
    ds_read_b64_tr_b16 v[36:37], v17 offset:12288
    s_add_u32 m0, s77, 73728
    v_mfma_f32_16x16x32_bf16 v[60:63], v[44:47], v[172:175], v[60:63]
    ds_read_b64_tr_b16 v[38:39], v17 offset:12800
    ds_read_b128 v[184:187], v5 offset:16384
    buffer_load_dwordx4 v11, s[8:11], s74 offen offset:1024  lds
    s_add_u32 s74, s74, s79
    s_cmp_eq_u32 s88, 2
    s_cmov_b32 s74, s90
    s_waitcnt lgkmcnt(7)
    v_mfma_f32_16x16x32_bf16 v[64:67], v[24:27], v[160:163], v[64:67]
    v_add_u32 v16, 24576, v16
    ds_read_b64_tr_b16 v[40:41], v16 offset:0
    v_mfma_f32_16x16x32_bf16 v[64:67], v[28:31], v[168:171], v[64:67]
    ds_read_b64_tr_b16 v[42:43], v16 offset:512
    ds_read_b128 v[188:191], v5 offset:18432
    v_mfma_f32_16x16x32_bf16 v[68:71], v[24:27], v[164:167], v[68:71]
    ds_read_b64_tr_b16 v[44:45], v16 offset:4096
    s_add_u32 m0, s76, 49152
    v_mfma_f32_16x16x32_bf16 v[68:71], v[28:31], v[172:175], v[68:71]
    ds_read_b64_tr_b16 v[46:47], v16 offset:4608
    buffer_load_dwordx4 v8, s[4:7], s73 offen  lds
    s_waitcnt lgkmcnt(6)
    v_mfma_f32_16x16x32_bf16 v[72:75], v[32:35], v[160:163], v[72:75]
    ds_read_b64_tr_b16 v[24:25], v16 offset:8192
    s_add_u32 m0, s76, 49152
    v_mfma_f32_16x16x32_bf16 v[72:75], v[36:39], v[168:171], v[72:75]
    ds_read_b64_tr_b16 v[26:27], v16 offset:8704
    buffer_load_dwordx4 v9, s[4:7], s73 offen offset:1024  lds
    s_add_u32 s73, s73, 128
    s_cmp_eq_u32 s88, 2
    s_cmov_b32 s73, 0
    v_mfma_f32_16x16x32_bf16 v[76:79], v[32:35], v[164:167], v[76:79]
    ds_read_b64_tr_b16 v[28:29], v16 offset:12288
    v_mfma_f32_16x16x32_bf16 v[76:79], v[36:39], v[172:175], v[76:79]
    ds_read_b64_tr_b16 v[30:31], v16 offset:12800
    s_waitcnt lgkmcnt(4)
    v_mfma_f32_16x16x32_bf16 v[48:51], v[40:43], v[176:179], v[48:51]
    v_add_u32 v17, 24576, v17
    ds_read_b64_tr_b16 v[32:33], v17 offset:0
    v_mfma_f32_16x16x32_bf16 v[48:51], v[44:47], v[184:187], v[48:51]
    ds_read_b64_tr_b16 v[34:35], v17 offset:512
    v_mfma_f32_16x16x32_bf16 v[52:55], v[40:43], v[180:183], v[52:55]
    ds_read_b64_tr_b16 v[36:37], v17 offset:4096
    v_mfma_f32_16x16x32_bf16 v[52:55], v[44:47], v[188:191], v[52:55]
    s_waitcnt vmcnt(4)
    s_barrier
    s_cmp_eq_u32 s91, 5
    s_cbranch_scc1 L_at_E0_5
L_at_E0_5b:
    ds_read_b64_tr_b16 v[38:39], v17 offset:4608
    ds_read_b128 v[192:195], v4 offset:32768
    s_waitcnt lgkmcnt(5)
    v_mfma_f32_16x16x32_bf16 v[56:59], v[24:27], v[176:179], v[56:59]
    ds_read_b64_tr_b16 v[40:41], v17 offset:8192
    s_add_u32 m0, s77, 0
    v_mfma_f32_16x16x32_bf16 v[56:59], v[28:31], v[184:187], v[56:59]
    ds_read_b64_tr_b16 v[42:43], v17 offset:8704
    ds_read_b128 v[196:199], v4 offset:34816
    buffer_load_dwordx4 v10, s[8:11], s74 offen  lds
    v_mfma_f32_16x16x32_bf16 v[60:63], v[24:27], v[180:183], v[60:63]
    ds_read_b64_tr_b16 v[44:45], v17 offset:12288
    s_add_u32 m0, s77, 0
    v_mfma_f32_16x16x32_bf16 v[60:63], v[28:31], v[188:191], v[60:63]
    ds_read_b64_tr_b16 v[46:47], v17 offset:12800
    ds_read_b128 v[200:203], v5 offset:32768
    buffer_load_dwordx4 v11, s[8:11], s74 offen offset:1024  lds
    s_add_u32 s74, s74, s79
    s_cmp_eq_u32 s88, 1
    s_cmov_b32 s74, s90
    s_waitcnt lgkmcnt(7)
    v_mfma_f32_16x16x32_bf16 v[64:67], v[32:35], v[176:179], v[64:67]
    v_add_u32 v16, 24576, v16
    ds_read_b64_tr_b16 v[24:25], v16 offset:0
    v_mfma_f32_16x16x32_bf16 v[64:67], v[36:39], v[184:187], v[64:67]
    ds_read_b64_tr_b16 v[26:27], v16 offset:512
    ds_read_b128 v[204:207], v5 offset:34816
    v_mfma_f32_16x16x32_bf16 v[68:71], v[32:35], v[180:183], v[68:71]
    ds_read_b64_tr_b16 v[28:29], v16 offset:4096
    s_add_u32 m0, s76, 0
    v_mfma_f32_16x16x32_bf16 v[68:71], v[36:39], v[188:191], v[68:71]
    ds_read_b64_tr_b16 v[30:31], v16 offset:4608
    buffer_load_dwordx4 v8, s[4:7], s73 offen  lds
    s_waitcnt lgkmcnt(6)
    v_mfma_f32_16x16x32_bf16 v[72:75], v[40:43], v[176:179], v[72:75]
    ds_read_b64_tr_b16 v[32:33], v16 offset:8192
    s_add_u32 m0, s76, 0
    v_mfma_f32_16x16x32_bf16 v[72:75], v[44:47], v[184:187], v[72:75]
    ds_read_b64_tr_b16 v[34:35], v16 offset:8704
    buffer_load_dwordx4 v9, s[4:7], s73 offen offset:1024  lds
    s_add_u32 s73, s73, 128
    s_cmp_eq_u32 s88, 1
    s_cmov_b32 s73, 0
    v_mfma_f32_16x16x32_bf16 v[76:79], v[40:43], v[180:183], v[76:79]
    ds_read_b64_tr_b16 v[36:37], v16 offset:12288
    v_mfma_f32_16x16x32_bf16 v[76:79], v[44:47], v[188:191], v[76:79]
    ds_read_b64_tr_b16 v[38:39], v16 offset:12800
    s_waitcnt lgkmcnt(4)
    v_mfma_f32_16x16x32_bf16 v[48:51], v[24:27], v[192:195], v[48:51]
    v_add_u32 v17, 24576, v17
    ds_read_b64_tr_b16 v[40:41], v17 offset:0
    v_mfma_f32_16x16x32_bf16 v[48:51], v[28:31], v[200:203], v[48:51]
    ds_read_b64_tr_b16 v[42:43], v17 offset:512
    v_mfma_f32_16x16x32_bf16 v[52:55], v[24:27], v[196:199], v[52:55]
    ds_read_b64_tr_b16 v[44:45], v17 offset:4096
    v_mfma_f32_16x16x32_bf16 v[52:55], v[28:31], v[204:207], v[52:55]
    s_waitcnt vmcnt(4)
    s_barrier
    s_cmp_eq_u32 s91, 6
    s_cbranch_scc1 L_at_E0_6
L_at_E0_6b:
    ds_read_b64_tr_b16 v[46:47], v17 offset:4608
    ds_read_b128 v[208:211], v4 offset:49152
    s_waitcnt lgkmcnt(5)
    v_mfma_f32_16x16x32_bf16 v[56:59], v[32:35], v[192:195], v[56:59]
    ds_read_b64_tr_b16 v[24:25], v17 offset:8192
    s_add_u32 m0, s77, 24576
    v_mfma_f32_16x16x32_bf16 v[56:59], v[36:39], v[200:203], v[56:59]
    ds_read_b64_tr_b16 v[26:27], v17 offset:8704
    ds_read_b128 v[212:215], v4 offset:51200
    buffer_load_dwordx4 v10, s[8:11], s74 offen  lds
    v_mfma_f32_16x16x32_bf16 v[60:63], v[32:35], v[196:199], v[60:63]
    ds_read_b64_tr_b16 v[28:29], v17 offset:12288
    s_add_u32 m0, s77, 24576
    v_mfma_f32_16x16x32_bf16 v[60:63], v[36:39], v[204:207], v[60:63]
    ds_read_b64_tr_b16 v[30:31], v17 offset:12800
    ds_read_b128 v[216:219], v5 offset:49152
    buffer_load_dwordx4 v11, s[8:11], s74 offen offset:1024  lds
    s_waitcnt lgkmcnt(7)
    v_mfma_f32_16x16x32_bf16 v[64:67], v[40:43], v[192:195], v[64:67]
    v_add_u32 v16, 24576, v16
    ds_read_b64_tr_b16 v[32:33], v16 offset:0
    v_mfma_f32_16x16x32_bf16 v[64:67], v[44:47], v[200:203], v[64:67]
    ds_read_b64_tr_b16 v[34:35], v16 offset:512
    ds_read_b128 v[220:223], v5 offset:51200
    v_mfma_f32_16x16x32_bf16 v[68:71], v[40:43], v[196:199], v[68:71]
    ds_read_b64_tr_b16 v[36:37], v16 offset:4096
    s_add_u32 m0, s76, 16384
    v_mfma_f32_16x16x32_bf16 v[68:71], v[44:47], v[204:207], v[68:71]
    ds_read_b64_tr_b16 v[38:39], v16 offset:4608
    buffer_load_dwordx4 v8, s[4:7], s73 offen  lds
    s_waitcnt lgkmcnt(6)
    v_mfma_f32_16x16x32_bf16 v[72:75], v[24:27], v[192:195], v[72:75]
    ds_read_b64_tr_b16 v[40:41], v16 offset:8192
    s_add_u32 m0, s76, 16384
    v_mfma_f32_16x16x32_bf16 v[72:75], v[28:31], v[200:203], v[72:75]
    ds_read_b64_tr_b16 v[42:43], v16 offset:8704
    buffer_load_dwordx4 v9, s[4:7], s73 offen offset:1024  lds
    v_mfma_f32_16x16x32_bf16 v[76:79], v[24:27], v[196:199], v[76:79]
    ds_read_b64_tr_b16 v[44:45], v16 offset:12288
    v_mfma_f32_16x16x32_bf16 v[76:79], v[28:31], v[204:207], v[76:79]
    ds_read_b64_tr_b16 v[46:47], v16 offset:12800
    s_waitcnt lgkmcnt(4)
    v_mfma_f32_16x16x32_bf16 v[48:51], v[32:35], v[208:211], v[48:51]
    v_add_u32 v17, 24576, v17
    ds_read_b64_tr_b16 v[24:25], v17 offset:0
    v_mfma_f32_16x16x32_bf16 v[48:51], v[36:39], v[216:219], v[48:51]
    ds_read_b64_tr_b16 v[26:27], v17 offset:512
    v_mfma_f32_16x16x32_bf16 v[52:55], v[32:35], v[212:215], v[52:55]
    ds_read_b64_tr_b16 v[28:29], v17 offset:4096
    v_mfma_f32_16x16x32_bf16 v[52:55], v[36:39], v[220:223], v[52:55]
    s_waitcnt vmcnt(4)
    s_barrier
    s_cmp_eq_u32 s91, 7
    s_cbranch_scc1 L_at_E0_7
L_at_E0_7b:
    ds_read_b64_tr_b16 v[30:31], v17 offset:4608
    ds_read_b128 v[224:227], v4 offset:0
    s_add_u32 m0, s78, 49152
    s_nop 0
    buffer_load_dwordx4 v13, s[12:15], s75 offen  lds
    s_add_u32 m0, s78, 49152
    s_nop 0
    buffer_load_dwordx4 v14, s[12:15], s75 offen offset:1024  lds
    s_waitcnt lgkmcnt(5)
    v_mfma_f32_16x16x32_bf16 v[56:59], v[40:43], v[208:211], v[56:59]
    ds_read_b64_tr_b16 v[32:33], v17 offset:8192
    v_mfma_f32_16x16x32_bf16 v[56:59], v[44:47], v[216:219], v[56:59]
    ds_read_b64_tr_b16 v[34:35], v17 offset:8704
    ds_read_b128 v[228:231], v4 offset:2048
    v_mfma_f32_16x16x32_bf16 v[60:63], v[40:43], v[212:215], v[60:63]
    ds_read_b64_tr_b16 v[36:37], v17 offset:12288
    v_mfma_f32_16x16x32_bf16 v[60:63], v[44:47], v[220:223], v[60:63]
    ds_read_b64_tr_b16 v[38:39], v17 offset:12800
    ds_read_b128 v[232:235], v5 offset:0
    s_waitcnt lgkmcnt(7)
    v_mfma_f32_16x16x32_bf16 v[64:67], v[24:27], v[208:211], v[64:67]
    v_subrev_u32 v16, 73728, v16
    ds_read_b64_tr_b16 v[40:41], v16 offset:0
    v_mfma_f32_16x16x32_bf16 v[64:67], v[28:31], v[216:219], v[64:67]
    ds_read_b64_tr_b16 v[42:43], v16 offset:512
    ds_read_b128 v[236:239], v5 offset:2048
    s_lshl_b32 s68, s39, 3
    s_lshl_b32 s69, s37, 1
    s_add_u32 s68, s68, s69
    s_mul_i32 s68, s68, 55296
    s_lshl_b32 s69, s67, 1
    v_mfma_f32_16x16x32_bf16 v[68:71], v[24:27], v[212:215], v[68:71]
    ds_read_b64_tr_b16 v[44:45], v16 offset:4096
    s_add_u32 m0, s78, 49152
    v_mfma_f32_16x16x32_bf16 v[68:71], v[28:31], v[220:223], v[68:71]
    ds_read_b64_tr_b16 v[46:47], v16 offset:4608
    buffer_load_dwordx4 v15, s[12:15], s75 offen offset:2048  lds
    s_add_u32 s75, s75, 221184
    s_cmp_eq_u32 s88, 9
    s_cmov_b32 s75, s93
    s_waitcnt lgkmcnt(6)
    v_mfma_f32_16x16x32_bf16 v[72:75], v[32:35], v[208:211], v[72:75]
    ds_read_b64_tr_b16 v[24:25], v16 offset:8192
    v_mfma_f32_16x16x32_bf16 v[72:75], v[36:39], v[216:219], v[72:75]
    ds_read_b64_tr_b16 v[26:27], v16 offset:8704
    s_add_u32 s69, s69, s38
    s_lshl_b32 s69, s69, 10
    s_add_u32 s68, s68, s69
    s_add_u32 s89, s68, 10862592
    v_bfe_u32 v10, v0, 4, 1
    v_mfma_f32_16x16x32_bf16 v[76:79], v[32:35], v[212:215], v[76:79]
    ds_read_b64_tr_b16 v[28:29], v16 offset:12288
    v_mfma_f32_16x16x32_bf16 v[76:79], v[36:39], v[220:223], v[76:79]
    ds_read_b64_tr_b16 v[30:31], v16 offset:12800
    v_mul_u32_u24 v10, 55296, v10
    v_lshrrev_b32 v2, 5, v0
    v_lshl_add_u32 v10, v2, 8, v10
    v_and_b32 v2, 15, v0
    v_lshl_add_u32 v10, v2, 4, v10
    s_waitcnt lgkmcnt(4)
    v_mfma_f32_16x16x32_bf16 v[48:51], v[40:43], v[224:227], v[48:51]
    v_subrev_u32 v17, 73728, v17
    ds_read_b64_tr_b16 v[32:33], v17 offset:0
    v_mfma_f32_16x16x32_bf16 v[48:51], v[44:47], v[232:235], v[48:51]
    ds_read_b64_tr_b16 v[34:35], v17 offset:512
    v_mfma_f32_16x16x32_bf16 v[52:55], v[40:43], v[228:231], v[52:55]
    ds_read_b64_tr_b16 v[36:37], v17 offset:4096
    v_mfma_f32_16x16x32_bf16 v[52:55], v[44:47], v[236:239], v[52:55]
    s_waitcnt vmcnt(3)
    s_barrier
    s_cmp_eq_u32 s91, 8
    s_cbranch_scc1 L_at_E0_8
L_at_E0_8b:
    ds_read_b64_tr_b16 v[38:39], v17 offset:4608
    ds_read_b128 v[240:243], v4 offset:16384
    s_waitcnt lgkmcnt(5)
    v_mfma_f32_16x16x32_bf16 v[56:59], v[24:27], v[224:227], v[56:59]
    ds_read_b64_tr_b16 v[40:41], v17 offset:8192
    s_add_u32 m0, s78, 73728
    v_mfma_f32_16x16x32_bf16 v[56:59], v[28:31], v[232:235], v[56:59]
    ds_read_b64_tr_b16 v[42:43], v17 offset:8704
    ds_read_b128 v[244:247], v4 offset:18432
    buffer_load_dwordx4 v13, s[12:15], s75 offen  lds
    v_mfma_f32_16x16x32_bf16 v[60:63], v[24:27], v[228:231], v[60:63]
    ds_read_b64_tr_b16 v[44:45], v17 offset:12288
    v_mfma_f32_16x16x32_bf16 v[60:63], v[28:31], v[236:239], v[60:63]
    ds_read_b64_tr_b16 v[46:47], v17 offset:12800
    ds_read_b128 v[248:251], v5 offset:16384
    s_waitcnt lgkmcnt(7)
    v_mfma_f32_16x16x32_bf16 v[64:67], v[32:35], v[224:227], v[64:67]
    v_add_u32 v16, 24576, v16
    ds_read_b64_tr_b16 v[24:25], v16 offset:0
    s_add_u32 m0, s78, 73728
    v_mfma_f32_16x16x32_bf16 v[64:67], v[36:39], v[232:235], v[64:67]
    ds_read_b64_tr_b16 v[26:27], v16 offset:512
    ds_read_b128 v[252:255], v5 offset:18432
    buffer_load_dwordx4 v14, s[12:15], s75 offen offset:1024  lds
    v_mfma_f32_16x16x32_bf16 v[68:71], v[32:35], v[228:231], v[68:71]
    ds_read_b64_tr_b16 v[28:29], v16 offset:4096
    v_mfma_f32_16x16x32_bf16 v[68:71], v[36:39], v[236:239], v[68:71]
    ds_read_b64_tr_b16 v[30:31], v16 offset:4608
    s_waitcnt lgkmcnt(6)
    v_mfma_f32_16x16x32_bf16 v[72:75], v[40:43], v[224:227], v[72:75]
    ds_read_b64_tr_b16 v[32:33], v16 offset:8192
    s_add_u32 m0, s78, 73728
    v_mfma_f32_16x16x32_bf16 v[72:75], v[44:47], v[232:235], v[72:75]
    ds_read_b64_tr_b16 v[34:35], v16 offset:8704
    buffer_load_dwordx4 v15, s[12:15], s75 offen offset:2048  lds
    s_add_u32 s75, s75, 221184
    s_cmp_eq_u32 s88, 8
    s_cmov_b32 s75, s93
    v_mfma_f32_16x16x32_bf16 v[76:79], v[40:43], v[228:231], v[76:79]
    ds_read_b64_tr_b16 v[36:37], v16 offset:12288
    v_mfma_f32_16x16x32_bf16 v[76:79], v[44:47], v[236:239], v[76:79]
    ds_read_b64_tr_b16 v[38:39], v16 offset:12800
    s_waitcnt lgkmcnt(4)
    v_mfma_f32_16x16x32_bf16 v[48:51], v[24:27], v[240:243], v[48:51]
    v_add_u32 v17, 24576, v17
    ds_read_b64_tr_b16 v[40:41], v17 offset:0
    v_mfma_f32_16x16x32_bf16 v[48:51], v[28:31], v[248:251], v[48:51]
    ds_read_b64_tr_b16 v[42:43], v17 offset:512
    v_mfma_f32_16x16x32_bf16 v[52:55], v[24:27], v[244:247], v[52:55]
    ds_read_b64_tr_b16 v[44:45], v17 offset:4096
    v_mfma_f32_16x16x32_bf16 v[52:55], v[28:31], v[252:255], v[52:55]
    s_waitcnt vmcnt(3)
    s_barrier
    ds_read_b64_tr_b16 v[46:47], v17 offset:4608
    s_waitcnt lgkmcnt(4)
    v_mfma_f32_16x16x32_bf16 v[56:59], v[32:35], v[240:243], v[56:59]
    ds_read_b64_tr_b16 v[24:25], v17 offset:8192
    s_add_u32 m0, s78, 0
    v_mfma_f32_16x16x32_bf16 v[56:59], v[36:39], v[248:251], v[56:59]
    ds_read_b64_tr_b16 v[26:27], v17 offset:8704
    buffer_load_dwordx4 v13, s[12:15], s75 offen  lds
    v_mfma_f32_16x16x32_bf16 v[60:63], v[32:35], v[244:247], v[60:63]
    ds_read_b64_tr_b16 v[28:29], v17 offset:12288
    v_mfma_f32_16x16x32_bf16 v[60:63], v[36:39], v[252:255], v[60:63]
    ds_read_b64_tr_b16 v[30:31], v17 offset:12800
    s_waitcnt lgkmcnt(4)
    v_mfma_f32_16x16x32_bf16 v[64:67], v[40:43], v[240:243], v[64:67]
    s_add_u32 m0, s78, 0
    v_mfma_f32_16x16x32_bf16 v[64:67], v[44:47], v[248:251], v[64:67]
    buffer_load_dwordx4 v14, s[12:15], s75 offen offset:1024  lds
    v_mfma_f32_16x16x32_bf16 v[68:71], v[40:43], v[244:247], v[68:71]
    v_mfma_f32_16x16x32_bf16 v[68:71], v[44:47], v[252:255], v[68:71]
    s_waitcnt lgkmcnt(0)
    v_mfma_f32_16x16x32_bf16 v[72:75], v[24:27], v[240:243], v[72:75]
    s_add_u32 m0, s78, 0
    v_mfma_f32_16x16x32_bf16 v[72:75], v[28:31], v[248:251], v[72:75]
    buffer_load_dwordx4 v15, s[12:15], s75 offen offset:2048  lds
    s_add_u32 s75, s75, 221184
    s_cmp_eq_u32 s88, 7
    s_cmov_b32 s75, s93
    v_mfma_f32_16x16x32_bf16 v[76:79], v[24:27], v[244:247], v[76:79]
    v_mfma_f32_16x16x32_bf16 v[76:79], v[28:31], v[252:255], v[76:79]
    ds_read_b64_tr_b16 v[24:25], v18 offset:0
    ds_read_b64_tr_b16 v[26:27], v18 offset:768
    ds_read_b64_tr_b16 v[28:29], v18 offset:6144
    ds_read_b64_tr_b16 v[30:31], v18 offset:6912
    ds_read_b64_tr_b16 v[32:33], v18 offset:12288
    ds_read_b64_tr_b16 v[34:35], v18 offset:13056
    ds_read_b64_tr_b16 v[36:37], v18 offset:18432
    ds_read_b64_tr_b16 v[38:39], v18 offset:19200
    ds_read_b64_tr_b16 v[40:41], v19 offset:0
    ds_read_b64_tr_b16 v[42:43], v19 offset:768
    ds_read_b64_tr_b16 v[44:45], v19 offset:6144
    ds_read_b64_tr_b16 v[46:47], v19 offset:6912
    v_pk_mul_f32 v[48:49], v[48:49], v[56:57]
    v_pk_mul_f32 v[50:51], v[50:51], v[58:59]
    v_pk_mul_f32 v[52:53], v[52:53], v[60:61]
    v_pk_mul_f32 v[54:55], v[54:55], v[62:63]
    v_cvt_pk_bf16_f32 v48, v48, v49
    v_cvt_pk_bf16_f32 v49, v50, v51
    v_cvt_pk_bf16_f32 v50, v52, v53
    v_cvt_pk_bf16_f32 v51, v54, v55
    s_nop 0
    v_permlane16_swap_b32 v48, v50
    v_permlane16_swap_b32 v49, v51
    buffer_store_dwordx4 v[48:51], v10, s[16:19], s89 offen offset:0 sc1
    v_pk_mul_f32 v[64:65], v[64:65], v[72:73]
    v_pk_mul_f32 v[66:67], v[66:67], v[74:75]
    v_pk_mul_f32 v[68:69], v[68:69], v[76:77]
    v_pk_mul_f32 v[70:71], v[70:71], v[78:79]
    v_cvt_pk_bf16_f32 v64, v64, v65
    v_cvt_pk_bf16_f32 v65, v66, v67
    v_cvt_pk_bf16_f32 v66, v68, v69
    v_cvt_pk_bf16_f32 v67, v70, v71
    s_nop 0
    v_permlane16_swap_b32 v64, v66
    v_permlane16_swap_b32 v65, v67
    buffer_store_dwordx4 v[64:67], v10, s[16:19], s89 offen offset:512 sc1
    v_mov_b32 v12, 1073741824
    buffer_load_dword v17, v12, s[32:35], 0 offen
    buffer_load_dword v17, v12, s[32:35], 0 offen
    buffer_load_dword v17, v12, s[32:35], 0 offen
    buffer_load_dword v17, v12, s[32:35], 0 offen
    s_branch L_pass2
L_E1:
    v_lshlrev_b32 v1, 4, v0
    v_lshlrev_b32 v2, 2, v0
    s_mov_b32 m0, 40960
    s_nop 0
    buffer_load_dwordx4 v1, s[32:35], 0 offen lds
    buffer_load_dword v2, s[32:35], 0 offen offset:1024 lds
    s_mov_b32 m0, 42240
    s_nop 0
    buffer_load_dwordx4 v1, s[32:35], 0 offen lds
    buffer_load_dword v2, s[32:35], 0 offen offset:1024 lds
    v_and_b32 v1, 48, v0
    s_lshl_b32 s68, s88, 7
    s_add_u32 s68, s68, 40960
    v_add_u32 v16, s68, v1
    s_and_b32 s68, s2, 1
    s_lshl_b32 s68, s68, 7
    s_cmp_eq_u32 s36, 0
    s_cselect_b32 s68, s68, 1073741824
    v_mov_b32 v22, 1073741824
    v_writelane_b32 v22, s68, 0
    v_mov_b32 v21, 1
    s_bfe_u32 s91, s2, 0x30003
    s_add_u32 s91, s91, 1
    s_cmp_eq_u32 s36, 0
    s_cselect_b32 s91, s91, 0
    s_lshl_b32 s68, s80, 6
    s_add_u32 s69, s68, s37
    s_mul_i32 s69, s69, 1280
    s_cmp_eq_u32 s38, 0
    s_mov_b32 s82, 5570560
    s_cselect_b32 s82, 2949120, s82
    s_add_u32 s82, s82, s69
    s_mul_i32 s83, s36, 1280
    s_add_u32 s83, s83, 122880
    s_and_b32 s96, s36, 1
    s_lshl_b32 s96, s96, 1
    s_add_u32 s96, s96, s38
    s_lshr_b32 s97, s37, 1
    s_lshl_b32 s68, s81, 2
    s_lshr_b32 s69, s36, 1
    s_add_u32 s68, s68, s69
    s_mul_i32 s68, s68, 19
    s_and_b32 s69, s36, 1
    s_add_u32 s68, s68, s69
    s_mul_i32 s68, s68, 5120
    s_add_u32 s84, s68, 17891328
    s_lshl_b32 s68, s80, 1
    s_add_u32 s68, s68, s97
    s_mul_i32 s68, s68, 108
    s_mul_i32 s69, s96, 14
    s_add_u32 s68, s68, s69
    s_lshr_b32 s69, s96, 1
    s_sub_u32 s68, s68, s69
    s_lshl_b32 s68, s68, 10
    s_add_u32 s68, s68, 10813440
    s_mul_i32 s69, s38, 55296
    s_add_u32 s86, s68, s69
    s_sub_u32 s68, s68, s69
    s_add_u32 s98, s68, 55296
    s_mul_i32 s69, s38, 14336
    s_sub_u32 s69, 13312, s69
    s_add_u32 s92, s86, s69
    s_mov_b64 exec, 0x7777
    buffer_load_dwordx2 v[254:255], v28, s[8:11], s89 offen offset:60
    s_mov_b64 exec, -1
    global_load_dwordx2 v[254:255], v[30:31], off offset:60
    buffer_store_dword v33, v32, s[16:19], 0 offen sc1
    s_waitcnt vmcnt(3)
    s_barrier
    ds_read_b128 v[96:99], v4 offset:0
    ds_read_b128 v[100:103], v4 offset:2048
    ds_read_b128 v[104:107], v5 offset:0
    ds_read_b128 v[108:111], v5 offset:2048
    ds_read_b128 v[24:27], v16 offset:0
    ds_read_b128 v[28:31], v16 offset:64
    s_waitcnt lgkmcnt(0)
    v_mfma_f32_16x16x32_bf16 v[48:51], v[24:27], v[96:99], 0
    v_mfma_f32_16x16x32_bf16 v[48:51], v[28:31], v[104:107], v[48:51]
    s_add_u32 m0, s76, 32768
    s_nop 0
    buffer_load_dwordx4 v8, s[4:7], s73 offen  lds
    s_add_u32 m0, s76, 32768
    s_nop 0
    buffer_load_dwordx4 v9, s[4:7], s73 offen offset:1024  lds
    s_add_u32 s73, s73, 128
    s_cmp_eq_u32 s88, 7
    s_cmov_b32 s73, 0
    s_barrier
    ds_read_b128 v[112:115], v4 offset:16384
    ds_read_b128 v[116:119], v4 offset:18432
    ds_read_b128 v[120:123], v5 offset:16384
    s_add_u32 m0, s76, 49152
    s_nop 0
    buffer_load_dwordx4 v8, s[4:7], s73 offen  lds
    s_add_u32 m0, s76, 49152
    s_nop 0
    buffer_load_dwordx4 v9, s[4:7], s73 offen offset:1024  lds
    s_add_u32 s73, s73, 128
    s_cmp_eq_u32 s88, 6
    s_cmov_b32 s73, 0
    v_mfma_f32_16x16x32_bf16 v[52:55], v[24:27], v[100:103], 0
    ds_read_b128 v[124:127], v5 offset:18432
    ds_read_b128 v[32:35], v16 offset:128
    v_mfma_f32_16x16x32_bf16 v[52:55], v[28:31], v[108:111], v[52:55]
    ds_read_b128 v[36:39], v16 offset:192
    s_waitcnt lgkmcnt(0)
    v_mfma_f32_16x16x32_bf16 v[48:51], v[32:35], v[112:115], v[48:51]
    v_mfma_f32_16x16x32_bf16 v[48:51], v[36:39], v[120:123], v[48:51]
    s_waitcnt vmcnt(2)
    s_barrier
    s_cmp_eq_u32 s91, 1
    s_cbranch_scc1 L_at_E1_1
L_at_E1_1b:
    ds_read_b128 v[128:131], v4 offset:32768
    ds_read_b128 v[132:135], v4 offset:34816
    ds_read_b128 v[136:139], v5 offset:32768
    s_add_u32 m0, s76, 0
    s_nop 0
    buffer_load_dwordx4 v8, s[4:7], s73 offen  lds
    s_add_u32 m0, s76, 0
    s_nop 0
    buffer_load_dwordx4 v9, s[4:7], s73 offen offset:1024  lds
    s_add_u32 s73, s73, 128
    s_cmp_eq_u32 s88, 5
    s_cmov_b32 s73, 0
    v_mfma_f32_16x16x32_bf16 v[52:55], v[32:35], v[116:119], v[52:55]
    ds_read_b128 v[140:143], v5 offset:34816
    ds_read_b128 v[24:27], v16 offset:256
    v_mfma_f32_16x16x32_bf16 v[52:55], v[36:39], v[124:127], v[52:55]
    ds_read_b128 v[28:31], v16 offset:320
    s_waitcnt lgkmcnt(0)
    v_mfma_f32_16x16x32_bf16 v[48:51], v[24:27], v[128:131], v[48:51]
    v_mfma_f32_16x16x32_bf16 v[48:51], v[28:31], v[136:139], v[48:51]
    s_waitcnt vmcnt(2)
    s_barrier
    s_cmp_eq_u32 s91, 2
    s_cbranch_scc1 L_at_E1_2
L_at_E1_2b:
    ds_read_b128 v[144:147], v4 offset:49152
    ds_read_b128 v[148:151], v4 offset:51200
    ds_read_b128 v[152:155], v5 offset:49152
    s_add_u32 m0, s76, 16384
    s_nop 0
    buffer_load_dwordx4 v8, s[4:7], s73 offen  lds
    s_add_u32 m0, s76, 16384
    s_nop 0
    buffer_load_dwordx4 v9, s[4:7], s73 offen offset:1024  lds
    s_add_u32 s73, s73, 128
    s_cmp_eq_u32 s88, 4
    s_cmov_b32 s73, 0
    v_mfma_f32_16x16x32_bf16 v[52:55], v[24:27], v[132:135], v[52:55]
    ds_read_b128 v[156:159], v5 offset:51200
    ds_read_b128 v[32:35], v16 offset:384
    v_mfma_f32_16x16x32_bf16 v[52:55], v[28:31], v[140:143], v[52:55]
    ds_read_b128 v[36:39], v16 offset:448
    s_mov_b64 exec, 0xff
    buffer_load_dword v7, v7, s[12:15], s85 offen
    s_mov_b64 exec, -1
    s_waitcnt lgkmcnt(0)
    v_mfma_f32_16x16x32_bf16 v[48:51], v[32:35], v[144:147], v[48:51]
    v_mfma_f32_16x16x32_bf16 v[48:51], v[36:39], v[152:155], v[48:51]
    s_waitcnt vmcnt(3)
    s_barrier
    s_cmp_eq_u32 s91, 3
    s_cbranch_scc1 L_at_E1_3
L_at_E1_3b:
    ds_read_b128 v[160:163], v4 offset:0
    ds_read_b128 v[164:167], v4 offset:2048
    ds_read_b128 v[168:171], v5 offset:0
    s_add_u32 m0, s76, 32768
    s_nop 0
    buffer_load_dwordx4 v8, s[4:7], s73 offen  lds
    s_add_u32 m0, s76, 32768
    s_nop 0
    buffer_load_dwordx4 v9, s[4:7], s73 offen offset:1024  lds
    s_add_u32 s73, s73, 128
    s_cmp_eq_u32 s88, 3
    s_cmov_b32 s73, 0
    v_mfma_f32_16x16x32_bf16 v[52:55], v[32:35], v[148:151], v[52:55]
    ds_read_b128 v[172:175], v5 offset:2048
    ds_read_b128 v[24:27], v16 offset:512
    v_mfma_f32_16x16x32_bf16 v[52:55], v[36:39], v[156:159], v[52:55]
    ds_read_b128 v[28:31], v16 offset:576
    s_waitcnt lgkmcnt(0)
    v_mfma_f32_16x16x32_bf16 v[48:51], v[24:27], v[160:163], v[48:51]
    v_mfma_f32_16x16x32_bf16 v[48:51], v[28:31], v[168:171], v[48:51]
    s_waitcnt vmcnt(3)
    s_barrier
    s_cmp_eq_u32 s91, 4
    s_cbranch_scc1 L_at_E1_4
L_at_E1_4b:
    ds_read_b128 v[176:179], v4 offset:16384
    ds_read_b128 v[180:183], v4 offset:18432
    ds_read_b128 v[184:187], v5 offset:16384
    s_add_u32 m0, s76, 49152
    s_nop 0
    buffer_load_dwordx4 v8, s[4:7], s73 offen  lds
    s_add_u32 m0, s76, 49152
    s_nop 0
    buffer_load_dwordx4 v9, s[4:7], s73 offen offset:1024  lds
    s_add_u32 s73, s73, 128
    s_cmp_eq_u32 s88, 2
    s_cmov_b32 s73, 0
    v_mfma_f32_16x16x32_bf16 v[52:55], v[24:27], v[164:167], v[52:55]
    ds_read_b128 v[188:191], v5 offset:18432
    ds_read_b128 v[32:35], v16 offset:640
    v_mfma_f32_16x16x32_bf16 v[52:55], v[28:31], v[172:175], v[52:55]
    ds_read_b128 v[36:39], v16 offset:704
    s_waitcnt lgkmcnt(0)
    v_mfma_f32_16x16x32_bf16 v[48:51], v[32:35], v[176:179], v[48:51]
    v_mfma_f32_16x16x32_bf16 v[48:51], v[36:39], v[184:187], v[48:51]
    s_waitcnt vmcnt(2)
    s_barrier
    s_cmp_eq_u32 s91, 5
    s_cbranch_scc1 L_at_E1_5
L_at_E1_5b:
    ds_read_b128 v[192:195], v4 offset:32768
    ds_read_b128 v[196:199], v4 offset:34816
    ds_read_b128 v[200:203], v5 offset:32768
    s_add_u32 m0, s76, 0
    s_nop 0
    buffer_load_dwordx4 v8, s[4:7], s73 offen  lds
    s_add_u32 m0, s76, 0
    s_nop 0
    buffer_load_dwordx4 v9, s[4:7], s73 offen offset:1024  lds
    s_add_u32 s73, s73, 128
    s_cmp_eq_u32 s88, 1
    s_cmov_b32 s73, 0
    v_mfma_f32_16x16x32_bf16 v[52:55], v[32:35], v[180:183], v[52:55]
    ds_read_b128 v[204:207], v5 offset:34816
    ds_read_b128 v[24:27], v16 offset:768
    v_mfma_f32_16x16x32_bf16 v[52:55], v[36:39], v[188:191], v[52:55]
    ds_read_b128 v[28:31], v16 offset:832
    s_waitcnt lgkmcnt(0)
    v_mfma_f32_16x16x32_bf16 v[48:51], v[24:27], v[192:195], v[48:51]
    v_mfma_f32_16x16x32_bf16 v[48:51], v[28:31], v[200:203], v[48:51]
    s_waitcnt vmcnt(2)
    s_barrier
    s_cmp_eq_u32 s91, 6
    s_cbranch_scc1 L_at_E1_6
L_at_E1_6b:
    ds_read_b128 v[208:211], v4 offset:49152
    ds_read_b128 v[212:215], v4 offset:51200
    ds_read_b128 v[216:219], v5 offset:49152
    s_add_u32 m0, s76, 16384
    s_nop 0
    buffer_load_dwordx4 v8, s[4:7], s73 offen  lds
    s_add_u32 m0, s76, 16384
    s_nop 0
    buffer_load_dwordx4 v9, s[4:7], s73 offen offset:1024  lds
    v_mfma_f32_16x16x32_bf16 v[52:55], v[24:27], v[196:199], v[52:55]
    ds_read_b128 v[220:223], v5 offset:51200
    ds_read_b128 v[32:35], v16 offset:896
    v_mfma_f32_16x16x32_bf16 v[52:55], v[28:31], v[204:207], v[52:55]
    ds_read_b128 v[36:39], v16 offset:960
    s_waitcnt lgkmcnt(0)
    v_mfma_f32_16x16x32_bf16 v[48:51], v[32:35], v[208:211], v[48:51]
    v_mfma_f32_16x16x32_bf16 v[48:51], v[36:39], v[216:219], v[48:51]
    s_waitcnt vmcnt(2)
    s_barrier
    s_cmp_eq_u32 s91, 7
    s_cbranch_scc1 L_at_E1_7
L_at_E1_7b:
    ds_read_b128 v[224:227], v4 offset:0
    ds_read_b128 v[228:231], v4 offset:2048
    ds_read_b128 v[232:235], v5 offset:0
    s_add_u32 m0, s78, 49152
    s_nop 0
    buffer_load_dwordx4 v13, s[12:15], s75 offen  lds
    s_add_u32 m0, s78, 49152
    s_nop 0
    buffer_load_dwordx4 v14, s[12:15], s75 offen offset:1024  lds
    s_add_u32 m0, s78, 49152
    s_nop 0
    buffer_load_dwordx4 v15, s[12:15], s75 offen offset:2048  lds
    s_add_u32 s75, s75, 221184
    s_cmp_eq_u32 s88, 9
    s_cmov_b32 s75, s93
    v_mfma_f32_16x16x32_bf16 v[52:55], v[32:35], v[212:215], v[52:55]
    ds_read_b128 v[236:239], v5 offset:2048
    ds_read_b128 v[24:27], v16 offset:1024
    v_mfma_f32_16x16x32_bf16 v[52:55], v[36:39], v[220:223], v[52:55]
    ds_read_b128 v[28:31], v16 offset:1088
    s_waitcnt lgkmcnt(0)
    v_mfma_f32_16x16x32_bf16 v[48:51], v[24:27], v[224:227], v[48:51]
    v_mfma_f32_16x16x32_bf16 v[48:51], v[28:31], v[232:235], v[48:51]
    s_waitcnt vmcnt(3)
    s_barrier
    s_cmp_eq_u32 s91, 8
    s_cbranch_scc1 L_at_E1_8
L_at_E1_8b:
    ds_read_b128 v[240:243], v4 offset:16384
    ds_read_b128 v[244:247], v4 offset:18432
    ds_read_b128 v[248:251], v5 offset:16384
    s_add_u32 m0, s78, 73728
    s_nop 0
    buffer_load_dwordx4 v13, s[12:15], s75 offen  lds
    s_add_u32 m0, s78, 73728
    s_nop 0
    buffer_load_dwordx4 v14, s[12:15], s75 offen offset:1024  lds
    s_add_u32 m0, s78, 73728
    s_nop 0
    buffer_load_dwordx4 v15, s[12:15], s75 offen offset:2048  lds
    s_add_u32 s75, s75, 221184
    s_cmp_eq_u32 s88, 8
    s_cmov_b32 s75, s93
    v_mfma_f32_16x16x32_bf16 v[52:55], v[24:27], v[228:231], v[52:55]
    ds_read_b128 v[252:255], v5 offset:18432
    ds_read_b128 v[32:35], v16 offset:1152
    v_mfma_f32_16x16x32_bf16 v[52:55], v[28:31], v[236:239], v[52:55]
    ds_read_b128 v[36:39], v16 offset:1216
    s_waitcnt lgkmcnt(0)
    v_mfma_f32_16x16x32_bf16 v[48:51], v[32:35], v[240:243], v[48:51]
    v_mfma_f32_16x16x32_bf16 v[48:51], v[36:39], v[248:251], v[48:51]
    s_waitcnt vmcnt(3)
    s_barrier
    ds_read_b64_tr_b16 v[24:25], v18 offset:0
    ds_read_b64_tr_b16 v[26:27], v18 offset:768
    ds_read_b64_tr_b16 v[28:29], v18 offset:6144
    s_add_u32 m0, s78, 0
    s_nop 0
    buffer_load_dwordx4 v13, s[12:15], s75 offen  lds
    s_add_u32 m0, s78, 0
    s_nop 0
    buffer_load_dwordx4 v14, s[12:15], s75 offen offset:1024  lds
    s_add_u32 m0, s78, 0
    s_nop 0
    buffer_load_dwordx4 v15, s[12:15], s75 offen offset:2048  lds
    s_add_u32 s75, s75, 221184
    s_cmp_eq_u32 s88, 7
    s_cmov_b32 s75, s93
    v_mfma_f32_16x16x32_bf16 v[52:55], v[32:35], v[244:247], v[52:55]
    ds_read_b64_tr_b16 v[30:31], v18 offset:6912
    v_mfma_f32_16x16x32_bf16 v[52:55], v[36:39], v[252:255], v[52:55]
    ds_read_b64_tr_b16 v[32:33], v18 offset:12288
    ds_read_b64_tr_b16 v[34:35], v18 offset:13056
    ds_read_b64_tr_b16 v[36:37], v18 offset:18432
    ds_read_b64_tr_b16 v[38:39], v18 offset:19200
    ds_read_b64_tr_b16 v[40:41], v19 offset:0
    ds_read_b64_tr_b16 v[42:43], v19 offset:768
    ds_read_b64_tr_b16 v[44:45], v19 offset:6144
    ds_read_b64_tr_b16 v[46:47], v19 offset:6912
    s_lshl_b32 s68, s39, 2
    s_add_u32 s68, s68, s37
    s_lshl_b32 s68, s68, 7
    s_add_u32 s68, s68, 32768
    s_cmp_eq_u32 s38, 0
    s_cselect_b32 s89, s68, 1073741824
    v_and_b32 v10, 31, v0
    v_lshlrev_b32 v10, 2, v10
    v_and_b32 v2, 16, v0
    v_cmp_eq_u32 vcc, 0, v2
    s_nop 1
    v_cndmask_b32 v1, v52, v48, vcc
    v_cvt_pk_bf16_f32 v1, v1, v1
    v_and_b32 v1, 0xffff0000, v1
    v_mul_f32 v1, 0xbfb8aa3b, v1
    v_exp_f32 v1, v1
    s_nop 0
    v_add_f32 v1, 1.0, v1
    v_rcp_f32 v1, v1
    s_nop 0
    v_cvt_pk_bf16_f32 v1, v1, v1
    v_and_b32 v1, 0xffff0000, v1
    buffer_store_dword v1, v10, s[16:19], s89 offen sc1
    v_mov_b32 v12, 1073741824
    buffer_load_dword v17, v12, s[32:35], 0 offen
    buffer_load_dword v17, v12, s[32:35], 0 offen
    buffer_load_dword v17, v12, s[32:35], 0 offen
    buffer_load_dword v17, v12, s[32:35], 0 offen
    buffer_load_dword v17, v12, s[32:35], 0 offen
    s_branch L_pass2
L_pass2:
    s_waitcnt lgkmcnt(8)
    v_mfma_f32_16x16x32_bf16 v[48:51], v[24:27], v[96:99], 0
    v_mfma_f32_16x16x32_bf16 v[48:51], v[28:31], v[104:107], v[48:51]
    s_lshl_b32 s68, s2, 7
    s_cmp_eq_u32 s36, 0
    s_cselect_b32 s68, s68, 1073741824
    v_mov_b32 v11, 1073741824
    v_writelane_b32 v11, s68, 0
    v_mfma_f32_16x16x32_bf16 v[52:55], v[24:27], v[100:103], 0
    v_mfma_f32_16x16x32_bf16 v[52:55], v[28:31], v[108:111], v[52:55]
    v_and_b32 v1, 31, v0
    s_lshl_b32 s68, s36, 12
    v_lshl_add_u32 v12, v1, 7, s68
    s_waitcnt lgkmcnt(4)
    v_mfma_f32_16x16x32_bf16 v[56:59], v[32:35], v[96:99], 0
    ds_read_b64_tr_b16 v[24:25], v19 offset:12288
    v_mfma_f32_16x16x32_bf16 v[56:59], v[36:39], v[104:107], v[56:59]
    ds_read_b64_tr_b16 v[26:27], v19 offset:13056
    v_mfma_f32_16x16x32_bf16 v[60:63], v[32:35], v[100:103], 0
    ds_read_b64_tr_b16 v[28:29], v19 offset:18432
    v_mfma_f32_16x16x32_bf16 v[60:63], v[36:39], v[108:111], v[60:63]
    ds_read_b64_tr_b16 v[30:31], v19 offset:19200
    s_waitcnt lgkmcnt(4)
    v_mfma_f32_16x16x32_bf16 v[64:67], v[40:43], v[96:99], 0
    ds_read_b64_tr_b16 v[32:33], v20 offset:0
    v_mfma_f32_16x16x32_bf16 v[64:67], v[44:47], v[104:107], v[64:67]
    ds_read_b64_tr_b16 v[34:35], v20 offset:768
    v_mfma_f32_16x16x32_bf16 v[68:71], v[40:43], v[100:103], 0
    ds_read_b64_tr_b16 v[36:37], v20 offset:6144
    v_mfma_f32_16x16x32_bf16 v[68:71], v[44:47], v[108:111], v[68:71]
    s_waitcnt vmcnt(9)
    s_barrier
    ds_read_b64_tr_b16 v[38:39], v20 offset:6912
    s_waitcnt lgkmcnt(4)
    v_mfma_f32_16x16x32_bf16 v[72:75], v[24:27], v[96:99], 0
    ds_read_b64_tr_b16 v[40:41], v20 offset:12288
    v_mfma_f32_16x16x32_bf16 v[72:75], v[28:31], v[104:107], v[72:75]
    ds_read_b64_tr_b16 v[42:43], v20 offset:13056
    v_mfma_f32_16x16x32_bf16 v[76:79], v[24:27], v[100:103], 0
    ds_read_b64_tr_b16 v[44:45], v20 offset:18432
    s_add_u32 m0, s78, 24576
    v_mfma_f32_16x16x32_bf16 v[76:79], v[28:31], v[108:111], v[76:79]
    ds_read_b64_tr_b16 v[46:47], v20 offset:19200
    buffer_load_dwordx4 v13, s[12:15], s75 offen  lds
    s_waitcnt lgkmcnt(4)
    v_mfma_f32_16x16x32_bf16 v[80:83], v[32:35], v[96:99], 0
    v_add_u32 v18, 24576, v18
    ds_read_b64_tr_b16 v[24:25], v18 offset:0
    v_mfma_f32_16x16x32_bf16 v[80:83], v[36:39], v[104:107], v[80:83]
    ds_read_b64_tr_b16 v[26:27], v18 offset:768
    v_mfma_f32_16x16x32_bf16 v[84:87], v[32:35], v[100:103], 0
    ds_read_b64_tr_b16 v[28:29], v18 offset:6144
    v_mfma_f32_16x16x32_bf16 v[84:87], v[36:39], v[108:111], v[84:87]
    ds_read_b64_tr_b16 v[30:31], v18 offset:6912
    s_waitcnt lgkmcnt(4)
    v_mfma_f32_16x16x32_bf16 v[88:91], v[40:43], v[96:99], 0
    ds_read_b64_tr_b16 v[32:33], v18 offset:12288
    s_add_u32 m0, s78, 24576
    v_mfma_f32_16x16x32_bf16 v[88:91], v[44:47], v[104:107], v[88:91]
    ds_read_b64_tr_b16 v[34:35], v18 offset:13056
    buffer_load_dwordx4 v14, s[12:15], s75 offen offset:1024  lds
    v_mfma_f32_16x16x32_bf16 v[92:95], v[40:43], v[100:103], 0
    ds_read_b64_tr_b16 v[36:37], v18 offset:18432
    v_mfma_f32_16x16x32_bf16 v[92:95], v[44:47], v[108:111], v[92:95]
    ds_read_b64_tr_b16 v[38:39], v18 offset:19200
    s_waitcnt lgkmcnt(4)
    v_mfma_f32_16x16x32_bf16 v[48:51], v[24:27], v[112:115], v[48:51]
    v_add_u32 v19, 24576, v19
    ds_read_b64_tr_b16 v[40:41], v19 offset:0
    v_mfma_f32_16x16x32_bf16 v[48:51], v[28:31], v[120:123], v[48:51]
    ds_read_b64_tr_b16 v[42:43], v19 offset:768
    v_lshlrev_b32 v9, 4, v0
    v_lshlrev_b32 v10, 2, v0
    v_add_u32 v4, 122880, v9
    v_and_b32 v1, 31, v0
    v_lshrrev_b32 v2, 5, v0
    v_mfma_f32_16x16x32_bf16 v[52:55], v[24:27], v[116:119], v[52:55]
    ds_read_b64_tr_b16 v[44:45], v19 offset:6144
    s_add_u32 m0, s78, 24576
    v_mfma_f32_16x16x32_bf16 v[52:55], v[28:31], v[124:127], v[52:55]
    ds_read_b64_tr_b16 v[46:47], v19 offset:6912
    buffer_load_dwordx4 v15, s[12:15], s75 offen offset:2048  lds
    s_add_u32 s75, s75, 221184
    s_cmp_eq_u32 s88, 6
    s_cmov_b32 s75, s93
    s_waitcnt lgkmcnt(4)
    v_mfma_f32_16x16x32_bf16 v[56:59], v[32:35], v[112:115], v[56:59]
    ds_read_b64_tr_b16 v[24:25], v19 offset:12288
    v_mfma_f32_16x16x32_bf16 v[56:59], v[36:39], v[120:123], v[56:59]
    ds_read_b64_tr_b16 v[26:27], v19 offset:13056
    v_and_b32 v3, 7, v0
    v_bfe_u32 v21, v0, 3, 1
    v_lshl_add_u32 v3, v21, 4, v3
    v_bfe_u32 v21, v0, 4, 1
    v_lshl_add_u32 v3, v21, 3, v3
    v_mfma_f32_16x16x32_bf16 v[60:63], v[32:35], v[116:119], v[60:63]
    ds_read_b64_tr_b16 v[28:29], v19 offset:18432
    v_mfma_f32_16x16x32_bf16 v[60:63], v[36:39], v[124:127], v[60:63]
    ds_read_b64_tr_b16 v[30:31], v19 offset:19200
    v_lshlrev_b32 v5, 3, v3
    v_add_u32 v5, 123904, v5
    v_lshlrev_b32 v3, 4, v1
    v_lshlrev_b32 v21, 7, v2
    v_xor_b32 v3, v3, v21
    s_waitcnt lgkmcnt(4)
    v_mfma_f32_16x16x32_bf16 v[64:67], v[40:43], v[112:115], v[64:67]
    v_add_u32 v20, 24576, v20
    ds_read_b64_tr_b16 v[32:33], v20 offset:0
    v_mfma_f32_16x16x32_bf16 v[64:67], v[44:47], v[120:123], v[64:67]
    ds_read_b64_tr_b16 v[34:35], v20 offset:768
    v_lshl_add_u32 v3, v2, 8, v3
    v_add_u32 v3, 128000, v3
    v_lshlrev_b32 v21, 6, v2
    v_lshl_add_u32 v21, v1, 4, v21
    v_add_u32 v21, 128256, v21
    v_mfma_f32_16x16x32_bf16 v[68:71], v[40:43], v[116:119], v[68:71]
    ds_read_b64_tr_b16 v[36:37], v20 offset:6144
    v_mfma_f32_16x16x32_bf16 v[68:71], v[44:47], v[124:127], v[68:71]
    s_waitcnt vmcnt(9)
    s_barrier
    ds_read_b64_tr_b16 v[38:39], v20 offset:6912
    v_cmp_gt_u32 vcc, 16, v1
    v_lshlrev_b32 v2, 6, v2
    v_xor_b32 v22, 64, v2
    v_cndmask_b32 v3, v21, v3, vcc
    v_cmp_gt_u32 vcc, 28, v1
    s_waitcnt lgkmcnt(4)
    v_mfma_f32_16x16x32_bf16 v[72:75], v[24:27], v[112:115], v[72:75]
    ds_read_b64_tr_b16 v[40:41], v20 offset:12288
    v_mfma_f32_16x16x32_bf16 v[72:75], v[28:31], v[120:123], v[72:75]
    ds_read_b64_tr_b16 v[42:43], v20 offset:13056
    v_add_u32 v21, 128, v2
    v_add_u32 v2, 128, v22
    v_cndmask_b32 v2, v2, v21, vcc
    v_cmp_gt_u32 vcc, 21, v1
    v_add_u32 v21, 20480, v3
    v_mfma_f32_16x16x32_bf16 v[76:79], v[24:27], v[116:119], v[76:79]
    ds_read_b64_tr_b16 v[44:45], v20 offset:18432
    s_add_u32 m0, s78, 49152
    v_mfma_f32_16x16x32_bf16 v[76:79], v[28:31], v[124:127], v[76:79]
    ds_read_b64_tr_b16 v[46:47], v20 offset:19200
    buffer_load_dwordx4 v13, s[12:15], s75 offen  lds
    s_waitcnt lgkmcnt(4)
    v_mfma_f32_16x16x32_bf16 v[80:83], v[32:35], v[112:115], v[80:83]
    v_subrev_u32 v18, 73728, v18
    ds_read_b64_tr_b16 v[24:25], v18 offset:0
    v_mfma_f32_16x16x32_bf16 v[80:83], v[36:39], v[120:123], v[80:83]
    ds_read_b64_tr_b16 v[26:27], v18 offset:768
    v_cndmask_b32 v22, v2, v22, vcc
    v_add_u32 v22, 153600, v22
    v_cmp_gt_u32 vcc, 20, v1
    v_add_u32 v2, 10240, v3
    s_nop 0
    v_cndmask_b32 v6, v22, v3, vcc
    v_mfma_f32_16x16x32_bf16 v[84:87], v[32:35], v[116:119], v[84:87]
    ds_read_b64_tr_b16 v[28:29], v18 offset:6144
    v_mfma_f32_16x16x32_bf16 v[84:87], v[36:39], v[124:127], v[84:87]
    ds_read_b64_tr_b16 v[30:31], v18 offset:6912
    v_cndmask_b32 v7, v22, v2, vcc
    v_cndmask_b32 v8, v22, v21, vcc
    v_lshrrev_b32 v1, 3, v0
    v_mul_u32_u24 v1, 640, v1
    v_bfe_u32 v2, v0, 1, 2
    s_waitcnt lgkmcnt(4)
    v_mfma_f32_16x16x32_bf16 v[88:91], v[40:43], v[112:115], v[88:91]
    ds_read_b64_tr_b16 v[32:33], v18 offset:12288
    s_add_u32 m0, s78, 49152
    v_mfma_f32_16x16x32_bf16 v[88:91], v[44:47], v[120:123], v[88:91]
    ds_read_b64_tr_b16 v[34:35], v18 offset:13056
    buffer_load_dwordx4 v14, s[12:15], s75 offen offset:1024  lds
    v_mfma_f32_16x16x32_bf16 v[92:95], v[40:43], v[116:119], v[92:95]
    ds_read_b64_tr_b16 v[36:37], v18 offset:18432
    v_mfma_f32_16x16x32_bf16 v[92:95], v[44:47], v[124:127], v[92:95]
    ds_read_b64_tr_b16 v[38:39], v18 offset:19200
    v_lshl_add_u32 v1, v2, 6, v1
    v_cmp_gt_u32 vcc, 2, v2
    v_and_b32 v2, 1, v0
    v_lshl_add_u32 v1, v2, 3, v1
    v_add_u32 v1, 153600, v1
    s_waitcnt lgkmcnt(4)
    v_mfma_f32_16x16x32_bf16 v[48:51], v[24:27], v[128:131], v[48:51]
    v_subrev_u32 v19, 73728, v19
    ds_read_b64_tr_b16 v[40:41], v19 offset:0
    v_mfma_f32_16x16x32_bf16 v[48:51], v[28:31], v[136:139], v[48:51]
    ds_read_b64_tr_b16 v[42:43], v19 offset:768
    v_mov_b32 v3, 0x3f803f80
    v_cndmask_b32 v2, 0, v3, vcc
    v_mov_b32 v3, v2
    v_mfma_f32_16x16x32_bf16 v[52:55], v[24:27], v[132:135], v[52:55]
    ds_read_b64_tr_b16 v[44:45], v19 offset:6144
    s_add_u32 m0, s78, 49152
    v_mfma_f32_16x16x32_bf16 v[52:55], v[28:31], v[140:143], v[52:55]
    ds_read_b64_tr_b16 v[46:47], v19 offset:6912
    buffer_load_dwordx4 v15, s[12:15], s75 offen offset:2048  lds
    s_add_u32 s75, s75, 221184
    s_cmp_eq_u32 s88, 5
    s_cmov_b32 s75, s93
    s_waitcnt lgkmcnt(4)
    v_mfma_f32_16x16x32_bf16 v[56:59], v[32:35], v[128:131], v[56:59]
    ds_read_b64_tr_b16 v[24:25], v19 offset:12288
    v_mfma_f32_16x16x32_bf16 v[56:59], v[36:39], v[136:139], v[56:59]
    ds_read_b64_tr_b16 v[26:27], v19 offset:13056
    ds_write_b64 v1, v[2:3]
    v_mfma_f32_16x16x32_bf16 v[60:63], v[32:35], v[132:135], v[60:63]
    ds_read_b64_tr_b16 v[28:29], v19 offset:18432
    v_mfma_f32_16x16x32_bf16 v[60:63], v[36:39], v[140:143], v[60:63]
    ds_read_b64_tr_b16 v[30:31], v19 offset:19200
    v_xor_b32 v1, 16, v1
    v_mov_b32 v2, 0x3f803f80
    v_mov_b32 v3, 0
    s_waitcnt lgkmcnt(5)
    v_mfma_f32_16x16x32_bf16 v[64:67], v[40:43], v[128:131], v[64:67]
    v_subrev_u32 v20, 73728, v20
    ds_read_b64_tr_b16 v[32:33], v20 offset:0
    v_mfma_f32_16x16x32_bf16 v[64:67], v[44:47], v[136:139], v[64:67]
    ds_read_b64_tr_b16 v[34:35], v20 offset:768
    ds_write_b64 v1, v[2:3]
    v_mfma_f32_16x16x32_bf16 v[68:71], v[40:43], v[132:135], v[68:71]
    ds_read_b64_tr_b16 v[36:37], v20 offset:6144
    v_mfma_f32_16x16x32_bf16 v[68:71], v[44:47], v[140:143], v[68:71]
    s_waitcnt vmcnt(3)
    s_barrier
    ds_read_b64_tr_b16 v[38:39], v20 offset:6912
    s_lshr_b32 s68, s80, 3
    s_lshl_b32 s69, s38, 2
    s_add_u32 s69, s69, s68
    s_add_u32 s69, s69, 4
    s_mul_i32 s70, s69, 86
    s_waitcnt lgkmcnt(5)
    v_mfma_f32_16x16x32_bf16 v[72:75], v[24:27], v[128:131], v[72:75]
    ds_read_b64_tr_b16 v[40:41], v20 offset:12288
    v_mfma_f32_16x16x32_bf16 v[72:75], v[28:31], v[136:139], v[72:75]
    ds_read_b64_tr_b16 v[42:43], v20 offset:13056
    s_lshr_b32 s70, s70, 8
    s_lshl_b32 s69, s69, 6
    s_mul_i32 s70, s70, 190
    s_sub_u32 s69, s69, s70
    s_mul_i32 s70, s68, 86
    v_mfma_f32_16x16x32_bf16 v[76:79], v[24:27], v[132:135], v[76:79]
    ds_read_b64_tr_b16 v[44:45], v20 offset:18432
    s_add_u32 m0, s78, 73728
    v_mfma_f32_16x16x32_bf16 v[76:79], v[28:31], v[140:143], v[76:79]
    ds_read_b64_tr_b16 v[46:47], v20 offset:19200
    buffer_load_dwordx4 v13, s[12:15], s75 offen  lds
    s_waitcnt lgkmcnt(4)
    v_mfma_f32_16x16x32_bf16 v[80:83], v[32:35], v[128:131], v[80:83]
    v_add_u32 v18, 24576, v18
    ds_read_b64_tr_b16 v[24:25], v18 offset:0
    v_mfma_f32_16x16x32_bf16 v[80:83], v[36:39], v[136:139], v[80:83]
    ds_read_b64_tr_b16 v[26:27], v18 offset:768
    s_lshr_b32 s70, s70, 8
    s_lshl_b32 s68, s68, 6
    s_mul_i32 s70, s70, 190
    s_sub_u32 s68, s68, s70
    s_lshl_b32 s70, s81, 1
    v_mfma_f32_16x16x32_bf16 v[84:87], v[32:35], v[132:135], v[84:87]
    ds_read_b64_tr_b16 v[28:29], v18 offset:6144
    v_mfma_f32_16x16x32_bf16 v[84:87], v[36:39], v[140:143], v[84:87]
    ds_read_b64_tr_b16 v[30:31], v18 offset:6912
    s_add_u32 s70, s70, s38
    s_and_b32 s71, s70, 7
    s_lshl_b32 s71, s71, 3
    s_add_u32 s68, s68, s71
    s_lshr_b32 s70, s70, 3
    s_waitcnt lgkmcnt(4)
    v_mfma_f32_16x16x32_bf16 v[88:91], v[40:43], v[128:131], v[88:91]
    ds_read_b64_tr_b16 v[32:33], v18 offset:12288
    s_add_u32 m0, s78, 73728
    v_mfma_f32_16x16x32_bf16 v[88:91], v[44:47], v[136:139], v[88:91]
    ds_read_b64_tr_b16 v[34:35], v18 offset:13056
    buffer_load_dwordx4 v14, s[12:15], s75 offen offset:1024  lds
    v_mfma_f32_16x16x32_bf16 v[92:95], v[40:43], v[132:135], v[92:95]
    ds_read_b64_tr_b16 v[36:37], v18 offset:18432
    v_mfma_f32_16x16x32_bf16 v[92:95], v[44:47], v[140:143], v[92:95]
    ds_read_b64_tr_b16 v[38:39], v18 offset:19200
    s_add_u32 s68, s68, s70
    s_lshl_b32 s68, s68, 7
    v_and_b32 v1, 7, v0
    v_lshl_add_u32 v1, v1, 3, s69
    v_bfe_u32 v2, v0, 3, 1
    s_waitcnt lgkmcnt(4)
    v_mfma_f32_16x16x32_bf16 v[48:51], v[24:27], v[144:147], v[48:51]
    v_add_u32 v19, 24576, v19
    ds_read_b64_tr_b16 v[40:41], v19 offset:0
    v_mfma_f32_16x16x32_bf16 v[48:51], v[28:31], v[152:155], v[48:51]
    ds_read_b64_tr_b16 v[42:43], v19 offset:768
    v_add_lshl_u32 v16, v1, v2, 7
    v_writelane_b32 v16, s68, 16
    v_mfma_f32_16x16x32_bf16 v[52:55], v[24:27], v[148:151], v[52:55]
    ds_read_b64_tr_b16 v[44:45], v19 offset:6144
    s_add_u32 m0, s78, 73728
    v_mfma_f32_16x16x32_bf16 v[52:55], v[28:31], v[156:159], v[52:55]
    ds_read_b64_tr_b16 v[46:47], v19 offset:6912
    buffer_load_dwordx4 v15, s[12:15], s75 offen offset:2048  lds
    s_add_u32 s75, s75, 221184
    s_cmp_eq_u32 s88, 4
    s_cmov_b32 s75, s93
    s_waitcnt lgkmcnt(4)
    v_mfma_f32_16x16x32_bf16 v[56:59], v[32:35], v[144:147], v[56:59]
    ds_read_b64_tr_b16 v[24:25], v19 offset:12288
    v_mfma_f32_16x16x32_bf16 v[56:59], v[36:39], v[152:155], v[56:59]
    ds_read_b64_tr_b16 v[26:27], v19 offset:13056
    v_mfma_f32_16x16x32_bf16 v[60:63], v[32:35], v[148:151], v[60:63]
    ds_read_b64_tr_b16 v[28:29], v19 offset:18432
    v_mfma_f32_16x16x32_bf16 v[60:63], v[36:39], v[156:159], v[60:63]
    ds_read_b64_tr_b16 v[30:31], v19 offset:19200
    s_waitcnt lgkmcnt(4)
    v_mfma_f32_16x16x32_bf16 v[64:67], v[40:43], v[144:147], v[64:67]
    v_add_u32 v20, 24576, v20
    ds_read_b64_tr_b16 v[32:33], v20 offset:0
    v_mfma_f32_16x16x32_bf16 v[64:67], v[44:47], v[152:155], v[64:67]
    ds_read_b64_tr_b16 v[34:35], v20 offset:768
    v_mfma_f32_16x16x32_bf16 v[68:71], v[40:43], v[148:151], v[68:71]
    ds_read_b64_tr_b16 v[36:37], v20 offset:6144
    v_mfma_f32_16x16x32_bf16 v[68:71], v[44:47], v[156:159], v[68:71]
    s_waitcnt vmcnt(3)
    s_barrier
    v_mov_b32 v23, 1
    buffer_store_dword v23, v11, s[16:19], 0 offen sc1
    ds_read_b64_tr_b16 v[38:39], v20 offset:6912
    s_waitcnt lgkmcnt(4)
    v_mfma_f32_16x16x32_bf16 v[72:75], v[24:27], v[144:147], v[72:75]
    ds_read_b64_tr_b16 v[40:41], v20 offset:12288
    v_mfma_f32_16x16x32_bf16 v[72:75], v[28:31], v[152:155], v[72:75]
    ds_read_b64_tr_b16 v[42:43], v20 offset:13056
    s_mul_i32 s69, s2, 4
    s_add_u32 s69, s69, s36
    s_mul_i32 s68, s69, 52429
    s_lshr_b32 s68, s68, 19
    s_mul_i32 s68, s68, 10
    v_mfma_f32_16x16x32_bf16 v[76:79], v[24:27], v[148:151], v[76:79]
    ds_read_b64_tr_b16 v[44:45], v20 offset:18432
    s_add_u32 m0, s78, 0
    v_mfma_f32_16x16x32_bf16 v[76:79], v[28:31], v[156:159], v[76:79]
    ds_read_b64_tr_b16 v[46:47], v20 offset:19200
    buffer_load_dwordx4 v13, s[12:15], s75 offen  lds
    s_waitcnt lgkmcnt(4)
    v_mfma_f32_16x16x32_bf16 v[80:83], v[32:35], v[144:147], v[80:83]
    v_add_u32 v18, 24576, v18
    ds_read_b64_tr_b16 v[24:25], v18 offset:0
    v_mfma_f32_16x16x32_bf16 v[80:83], v[36:39], v[152:155], v[80:83]
    ds_read_b64_tr_b16 v[26:27], v18 offset:768
    s_sub_u32 s69, s69, s68
    s_lshl_b32 s91, s69, 2
    s_mul_i32 s90, s94, 19
    s_add_u32 s90, s90, s95
    s_mul_i32 s90, s90, 5120
    v_mfma_f32_16x16x32_bf16 v[84:87], v[32:35], v[148:151], v[84:87]
    ds_read_b64_tr_b16 v[28:29], v18 offset:6144
    v_mfma_f32_16x16x32_bf16 v[84:87], v[36:39], v[156:159], v[84:87]
    ds_read_b64_tr_b16 v[30:31], v18 offset:6912
    s_add_u32 s90, s90, 17891328
    s_cmp_lt_u32 s94, 4
    s_cselect_b32 s90, s90, 1073741824
    s_mul_i32 s68, s94, 14
    s_lshr_b32 s70, s94, 1
    s_waitcnt lgkmcnt(4)
    v_mfma_f32_16x16x32_bf16 v[88:91], v[40:43], v[144:147], v[88:91]
    ds_read_b64_tr_b16 v[32:33], v18 offset:12288
    s_add_u32 m0, s78, 0
    v_mfma_f32_16x16x32_bf16 v[88:91], v[44:47], v[152:155], v[88:91]
    ds_read_b64_tr_b16 v[34:35], v18 offset:13056
    buffer_load_dwordx4 v14, s[12:15], s75 offen offset:1024  lds
    v_mfma_f32_16x16x32_bf16 v[92:95], v[40:43], v[148:151], v[92:95]
    ds_read_b64_tr_b16 v[36:37], v18 offset:18432
    v_mfma_f32_16x16x32_bf16 v[92:95], v[44:47], v[156:159], v[92:95]
    ds_read_b64_tr_b16 v[38:39], v18 offset:19200
    s_sub_u32 s68, s68, s70
    s_add_u32 s68, s68, s95
    s_lshl_b32 s68, s68, 5
    s_lshl_b32 s72, s94, 2
    s_add_u32 s72, s72, s95
    s_waitcnt lgkmcnt(4)
    v_mfma_f32_16x16x32_bf16 v[48:51], v[24:27], v[160:163], v[48:51]
    v_add_u32 v19, 24576, v19
    ds_read_b64_tr_b16 v[40:41], v19 offset:0
    v_mfma_f32_16x16x32_bf16 v[48:51], v[28:31], v[168:171], v[48:51]
    ds_read_b64_tr_b16 v[42:43], v19 offset:768
    s_sub_u32 s72, s72, 14
    s_mul_i32 s72, s72, 40
    s_add_u32 s72, s72, 4
    s_cmp_lt_u32 s95, 14
    s_cselect_b32 s68, s68, s72
    v_mfma_f32_16x16x32_bf16 v[52:55], v[24:27], v[164:167], v[52:55]
    ds_read_b64_tr_b16 v[44:45], v19 offset:6144
    s_add_u32 m0, s78, 0
    v_mfma_f32_16x16x32_bf16 v[52:55], v[28:31], v[172:175], v[52:55]
    ds_read_b64_tr_b16 v[46:47], v19 offset:6912
    buffer_load_dwordx4 v15, s[12:15], s75 offen offset:2048  lds
    s_add_u32 s75, s75, 221184
    s_cmp_eq_u32 s88, 3
    s_cmov_b32 s75, s93
    s_waitcnt lgkmcnt(4)
    v_mfma_f32_16x16x32_bf16 v[56:59], v[32:35], v[160:163], v[56:59]
    ds_read_b64_tr_b16 v[24:25], v19 offset:12288
    v_mfma_f32_16x16x32_bf16 v[56:59], v[36:39], v[168:171], v[56:59]
    ds_read_b64_tr_b16 v[26:27], v19 offset:13056
    s_mul_i32 s72, s94, 160
    s_mov_b32 s70, 102400
    s_mov_b32 s71, 45056
    s_cmp_lt_u32 s95, 18
    s_cselect_b32 s68, s68, s72
    s_mov_b32 s72, 49152
    s_cselect_b32 s70, 10240, s70
    s_cselect_b32 s71, 4096, s71
    v_mfma_f32_16x16x32_bf16 v[60:63], v[32:35], v[164:167], v[60:63]
    ds_read_b64_tr_b16 v[28:29], v19 offset:18432
    v_mfma_f32_16x16x32_bf16 v[60:63], v[36:39], v[172:175], v[60:63]
    ds_read_b64_tr_b16 v[30:31], v19 offset:19200
    s_cmp_lt_u32 s95, 18
    s_cselect_b32 s72, 18432, s72
    s_cmp_lt_u32 s95, 14
    s_cselect_b32 s70, 5120, s70
    s_cselect_b32 s71, 9216, s71
    s_waitcnt lgkmcnt(4)
    v_mfma_f32_16x16x32_bf16 v[64:67], v[40:43], v[160:163], v[64:67]
    v_add_u32 v20, 24576, v20
    ds_read_b64_tr_b16 v[32:33], v20 offset:0
    v_mfma_f32_16x16x32_bf16 v[64:67], v[44:47], v[168:171], v[64:67]
    ds_read_b64_tr_b16 v[34:35], v20 offset:768
    s_mul_i32 s68, s68, 1280
    s_lshl_b32 s69, s69, 7
    s_add_u32 s68, s68, s69
    s_cmp_lt_u32 s94, 4
    s_cselect_b32 s68, s68, 1073741824
    s_cselect_b64 s[4:5], -1, 1
    v_mfma_f32_16x16x32_bf16 v[68:71], v[40:43], v[164:167], v[68:71]
    ds_read_b64_tr_b16 v[36:37], v20 offset:6144
    v_mfma_f32_16x16x32_bf16 v[68:71], v[44:47], v[172:175], v[68:71]
    s_waitcnt vmcnt(4)
    s_barrier
    ds_read_b64_tr_b16 v[38:39], v20 offset:6912
    v_lshrrev_b32 v1, 5, v0
    v_mul_lo_u32 v1, v1, s70
    v_bfe_u32 v2, v0, 3, 2
    v_mul_u32_u24 v2, 1280, v2
    v_add_u32 v1, v1, v2
    s_waitcnt lgkmcnt(4)
    v_mfma_f32_16x16x32_bf16 v[72:75], v[24:27], v[160:163], v[72:75]
    ds_read_b64_tr_b16 v[40:41], v20 offset:12288
    v_mfma_f32_16x16x32_bf16 v[72:75], v[28:31], v[168:171], v[72:75]
    ds_read_b64_tr_b16 v[42:43], v20 offset:13056
    v_and_b32 v2, 7, v0
    v_bfe_u32 v3, v0, 4, 1
    v_lshlrev_b32 v3, 2, v3
    v_xor_b32 v2, v2, v3
    v_lshl_add_u32 v1, v2, 4, v1
    v_mfma_f32_16x16x32_bf16 v[76:79], v[24:27], v[164:167], v[76:79]
    ds_read_b64_tr_b16 v[44:45], v20 offset:18432
    s_add_u32 m0, s78, 24576
    v_mfma_f32_16x16x32_bf16 v[76:79], v[28:31], v[172:175], v[76:79]
    ds_read_b64_tr_b16 v[46:47], v20 offset:19200
    buffer_load_dwordx4 v13, s[12:15], s75 offen  lds
    s_waitcnt lgkmcnt(4)
    v_mfma_f32_16x16x32_bf16 v[80:83], v[32:35], v[160:163], v[80:83]
    v_add_u32 v18, 24576, v18
    ds_read_b64_tr_b16 v[24:25], v18 offset:0
    v_mfma_f32_16x16x32_bf16 v[80:83], v[36:39], v[168:171], v[80:83]
    ds_read_b64_tr_b16 v[26:27], v18 offset:768
    v_xor_b32 v3, 32, v1
    s_add_u32 s69, s68, s71
    s_min_u32 s70, s36, 4
    s_lshl_b32 s70, s70, 12
    s_mov_b32 s6, s68
    v_mfma_f32_16x16x32_bf16 v[84:87], v[32:35], v[164:167], v[84:87]
    ds_read_b64_tr_b16 v[28:29], v18 offset:6144
    v_mfma_f32_16x16x32_bf16 v[84:87], v[36:39], v[172:175], v[84:87]
    ds_read_b64_tr_b16 v[30:31], v18 offset:6912
    s_mov_b32 s7, s69
    s_mov_b32 s8, s72
    s_mov_b32 s9, s70
    v_mov_b32 v141, v1
    v_mov_b32 v142, v3
    s_waitcnt lgkmcnt(4)
    v_mfma_f32_16x16x32_bf16 v[88:91], v[40:43], v[160:163], v[88:91]
    ds_read_b64_tr_b16 v[32:33], v18 offset:12288
    s_add_u32 m0, s78, 24576
    v_mfma_f32_16x16x32_bf16 v[88:91], v[44:47], v[168:171], v[88:91]
    ds_read_b64_tr_b16 v[34:35], v18 offset:13056
    buffer_load_dwordx4 v14, s[12:15], s75 offen offset:1024  lds
    v_mfma_f32_16x16x32_bf16 v[92:95], v[40:43], v[164:167], v[92:95]
    ds_read_b64_tr_b16 v[36:37], v18 offset:18432
    v_mfma_f32_16x16x32_bf16 v[92:95], v[44:47], v[172:175], v[92:95]
    ds_read_b64_tr_b16 v[38:39], v18 offset:19200
    v_lshrrev_b32 v1, 4, v0
    v_bfe_u32 v2, v0, 2, 2
    v_lshl_add_u32 v1, v1, 3, v2
    v_lshlrev_b32 v1, 7, v1
    v_and_b32 v2, 3, v0
    s_waitcnt lgkmcnt(4)
    v_mfma_f32_16x16x32_bf16 v[48:51], v[24:27], v[176:179], v[48:51]
    v_add_u32 v19, 24576, v19
    ds_read_b64_tr_b16 v[40:41], v19 offset:0
    v_mfma_f32_16x16x32_bf16 v[48:51], v[28:31], v[184:187], v[48:51]
    ds_read_b64_tr_b16 v[42:43], v19 offset:768
    v_lshl_add_u32 v1, v2, 3, v1
    v_bfe_u32 v2, v0, 3, 1
    v_lshl_add_u32 v1, v2, 6, v1
    v_bfe_u32 v2, v0, 4, 1
    v_lshl_add_u32 v1, v2, 5, v1
    v_mfma_f32_16x16x32_bf16 v[52:55], v[24:27], v[180:183], v[52:55]
    ds_read_b64_tr_b16 v[44:45], v19 offset:6144
    s_add_u32 m0, s78, 24576
    v_mfma_f32_16x16x32_bf16 v[52:55], v[28:31], v[188:191], v[52:55]
    ds_read_b64_tr_b16 v[46:47], v19 offset:6912
    buffer_load_dwordx4 v15, s[12:15], s75 offen offset:2048  lds
    s_add_u32 s75, s75, 221184
    s_cmp_eq_u32 s88, 2
    s_cmov_b32 s75, s93
    s_waitcnt lgkmcnt(4)
    v_mfma_f32_16x16x32_bf16 v[56:59], v[32:35], v[176:179], v[56:59]
    ds_read_b64_tr_b16 v[24:25], v19 offset:12288
    v_mfma_f32_16x16x32_bf16 v[56:59], v[36:39], v[184:187], v[56:59]
    ds_read_b64_tr_b16 v[26:27], v19 offset:13056
    s_min_u32 s70, s36, 4
    s_lshl_b32 s70, s70, 12
    s_add_u32 s70, s70, 98304
    v_add_u32 v143, s70, v1
    v_and_b32 v21, 1, v0
    v_mfma_f32_16x16x32_bf16 v[60:63], v[32:35], v[180:183], v[60:63]
    ds_read_b64_tr_b16 v[28:29], v19 offset:18432
    v_mfma_f32_16x16x32_bf16 v[60:63], v[36:39], v[188:191], v[60:63]
    ds_read_b64_tr_b16 v[30:31], v19 offset:19200
    v_lshlrev_b32 v21, 7, v21
    s_waitcnt lgkmcnt(4)
    v_mfma_f32_16x16x32_bf16 v[64:67], v[40:43], v[176:179], v[64:67]
    v_add_u32 v20, 24576, v20
    ds_read_b64_tr_b16 v[32:33], v20 offset:0
    v_mfma_f32_16x16x32_bf16 v[64:67], v[44:47], v[184:187], v[64:67]
    ds_read_b64_tr_b16 v[34:35], v20 offset:768
    buffer_load_dword v22, v21, s[28:31], 0 offen sc1
    v_mfma_f32_16x16x32_bf16 v[68:71], v[40:43], v[180:183], v[68:71]
    ds_read_b64_tr_b16 v[36:37], v20 offset:6144
    v_mfma_f32_16x16x32_bf16 v[68:71], v[44:47], v[188:191], v[68:71]
    s_waitcnt vmcnt(4)
    s_barrier
    ds_read_b64_tr_b16 v[38:39], v20 offset:6912
    v_mov_b32 v2, 153616
    v_cmp_gt_u32 vcc, 32, v0
    v_add_u32 v139, 10240, v5
    v_add_u32 v140, 20480, v5
    v_cndmask_b32 v5, v2, v5, vcc
    v_cndmask_b32 v139, v2, v139, vcc
    v_cndmask_b32 v140, v2, v140, vcc
    s_waitcnt lgkmcnt(4)
    v_mfma_f32_16x16x32_bf16 v[72:75], v[24:27], v[176:179], v[72:75]
    ds_read_b64_tr_b16 v[40:41], v20 offset:12288
    v_mfma_f32_16x16x32_bf16 v[72:75], v[28:31], v[184:187], v[72:75]
    ds_read_b64_tr_b16 v[42:43], v20 offset:13056
    s_mul_i32 s68, s91, 13108
    s_lshr_b32 s68, s68, 16
    s_mul_i32 s69, s68, 384000
    s_lshl_b32 s70, s91, 10
    s_add_u32 s69, s69, s70
    v_mfma_f32_16x16x32_bf16 v[76:79], v[24:27], v[180:183], v[76:79]
    ds_read_b64_tr_b16 v[44:45], v20 offset:18432
    s_add_u32 m0, s78, 49152
    v_mfma_f32_16x16x32_bf16 v[76:79], v[28:31], v[188:191], v[76:79]
    ds_read_b64_tr_b16 v[46:47], v20 offset:19200
    buffer_load_dwordx4 v13, s[12:15], s75 offen  lds
    s_waitcnt lgkmcnt(4)
    v_mfma_f32_16x16x32_bf16 v[80:83], v[32:35], v[176:179], v[80:83]
    v_subrev_u32 v18, 73728, v18
    ds_read_b64_tr_b16 v[24:25], v18 offset:0
    v_mfma_f32_16x16x32_bf16 v[80:83], v[36:39], v[184:187], v[80:83]
    ds_read_b64_tr_b16 v[26:27], v18 offset:768
    s_add_u32 s73, s69, s90
    s_add_u32 s91, s91, 1
    v_mfma_f32_16x16x32_bf16 v[84:87], v[32:35], v[180:183], v[84:87]
    ds_read_b64_tr_b16 v[28:29], v18 offset:6144
    v_mfma_f32_16x16x32_bf16 v[84:87], v[36:39], v[188:191], v[84:87]
    ds_read_b64_tr_b16 v[30:31], v18 offset:6912
    s_mul_i32 s68, s91, 13108
    s_lshr_b32 s68, s68, 16
    s_mul_i32 s69, s68, 384000
    s_lshl_b32 s70, s91, 10
    s_add_u32 s69, s69, s70
    s_waitcnt lgkmcnt(4)
    v_mfma_f32_16x16x32_bf16 v[88:91], v[40:43], v[176:179], v[88:91]
    ds_read_b64_tr_b16 v[32:33], v18 offset:12288
    s_add_u32 m0, s78, 49152
    v_mfma_f32_16x16x32_bf16 v[88:91], v[44:47], v[184:187], v[88:91]
    ds_read_b64_tr_b16 v[34:35], v18 offset:13056
    buffer_load_dwordx4 v14, s[12:15], s75 offen offset:1024  lds
    v_mfma_f32_16x16x32_bf16 v[92:95], v[40:43], v[180:183], v[92:95]
    ds_read_b64_tr_b16 v[36:37], v18 offset:18432
    v_mfma_f32_16x16x32_bf16 v[92:95], v[44:47], v[188:191], v[92:95]
    ds_read_b64_tr_b16 v[38:39], v18 offset:19200
    s_add_u32 s74, s69, s90
    s_add_u32 s91, s91, 1
    s_waitcnt lgkmcnt(4)
    v_mfma_f32_16x16x32_bf16 v[48:51], v[24:27], v[192:195], v[48:51]
    v_subrev_u32 v19, 73728, v19
    ds_read_b64_tr_b16 v[40:41], v19 offset:0
    v_mfma_f32_16x16x32_bf16 v[48:51], v[28:31], v[200:203], v[48:51]
    ds_read_b64_tr_b16 v[42:43], v19 offset:768
    s_mul_i32 s68, s91, 13108
    s_lshr_b32 s68, s68, 16
    s_mul_i32 s69, s68, 384000
    s_lshl_b32 s70, s91, 10
    s_add_u32 s69, s69, s70
    v_mfma_f32_16x16x32_bf16 v[52:55], v[24:27], v[196:199], v[52:55]
    ds_read_b64_tr_b16 v[44:45], v19 offset:6144
    s_add_u32 m0, s78, 49152
    v_mfma_f32_16x16x32_bf16 v[52:55], v[28:31], v[204:207], v[52:55]
    ds_read_b64_tr_b16 v[46:47], v19 offset:6912
    buffer_load_dwordx4 v15, s[12:15], s75 offen offset:2048  lds
    s_add_u32 s75, s75, 221184
    s_cmp_eq_u32 s88, 1
    s_cmov_b32 s75, s93
    s_waitcnt lgkmcnt(4)
    v_mfma_f32_16x16x32_bf16 v[56:59], v[32:35], v[192:195], v[56:59]
    ds_read_b64_tr_b16 v[24:25], v19 offset:12288
    v_mfma_f32_16x16x32_bf16 v[56:59], v[36:39], v[200:203], v[56:59]
    ds_read_b64_tr_b16 v[26:27], v19 offset:13056
    s_add_u32 s76, s69, s90
    s_add_u32 s91, s91, 1
    v_mfma_f32_16x16x32_bf16 v[60:63], v[32:35], v[196:199], v[60:63]
    ds_read_b64_tr_b16 v[28:29], v19 offset:18432
    v_mfma_f32_16x16x32_bf16 v[60:63], v[36:39], v[204:207], v[60:63]
    ds_read_b64_tr_b16 v[30:31], v19 offset:19200
    s_mul_i32 s68, s91, 13108
    s_lshr_b32 s68, s68, 16
    s_mul_i32 s69, s68, 384000
    s_lshl_b32 s70, s91, 10
    s_add_u32 s69, s69, s70
    s_waitcnt lgkmcnt(4)
    v_mfma_f32_16x16x32_bf16 v[64:67], v[40:43], v[192:195], v[64:67]
    v_subrev_u32 v20, 73728, v20
    ds_read_b64_tr_b16 v[32:33], v20 offset:0
    v_mfma_f32_16x16x32_bf16 v[64:67], v[44:47], v[200:203], v[64:67]
    ds_read_b64_tr_b16 v[34:35], v20 offset:768
    s_add_u32 s77, s69, s90
    s_add_u32 s91, s91, 1
    v_mfma_f32_16x16x32_bf16 v[68:71], v[40:43], v[196:199], v[68:71]
    ds_read_b64_tr_b16 v[36:37], v20 offset:6144
    v_mfma_f32_16x16x32_bf16 v[68:71], v[44:47], v[204:207], v[68:71]
    s_waitcnt vmcnt(4)
    s_barrier
    ds_read_b64_tr_b16 v[38:39], v20 offset:6912
    v_bfe_u32 v166, v0, 4, 1
    v_mul_u32_u24 v166, 20480, v166
    v_and_b32 v2, 15, v0
    v_lshrrev_b32 v3, 5, v0
    v_lshl_add_u32 v165, v2, 3, v166
    s_waitcnt lgkmcnt(4)
    v_mfma_f32_16x16x32_bf16 v[72:75], v[24:27], v[192:195], v[72:75]
    ds_read_b64_tr_b16 v[40:41], v20 offset:12288
    v_mfma_f32_16x16x32_bf16 v[72:75], v[28:31], v[200:203], v[72:75]
    ds_read_b64_tr_b16 v[42:43], v20 offset:13056
    v_lshl_add_u32 v165, v3, 30, v165
    v_lshl_add_u32 v164, v2, 4, v166
    v_lshl_add_u32 v164, v3, 8, v164
    s_lshl_b32 s68, s81, 3
    s_add_u32 s68, s68, s36
    v_mfma_f32_16x16x32_bf16 v[76:79], v[24:27], v[196:199], v[76:79]
    ds_read_b64_tr_b16 v[44:45], v20 offset:18432
    s_add_u32 m0, s78, 73728
    v_mfma_f32_16x16x32_bf16 v[76:79], v[28:31], v[204:207], v[76:79]
    ds_read_b64_tr_b16 v[46:47], v20 offset:19200
    buffer_load_dwordx4 v13, s[12:15], s75 offen  lds
    s_waitcnt lgkmcnt(4)
    v_mfma_f32_16x16x32_bf16 v[80:83], v[32:35], v[192:195], v[80:83]
    v_add_u32 v18, 24576, v18
    ds_read_b64_tr_b16 v[24:25], v18 offset:0
    v_mfma_f32_16x16x32_bf16 v[80:83], v[36:39], v[200:203], v[80:83]
    ds_read_b64_tr_b16 v[26:27], v18 offset:768
    s_mul_i32 s69, s68, 40960
    s_add_u32 s69, s69, 8192000
    s_lshl_b32 s70, s80, 9
    s_add_u32 s70, s70, s69
    s_lshl_b32 s71, s80, 7
    v_mfma_f32_16x16x32_bf16 v[84:87], v[32:35], v[196:199], v[84:87]
    ds_read_b64_tr_b16 v[28:29], v18 offset:6144
    v_mfma_f32_16x16x32_bf16 v[84:87], v[36:39], v[204:207], v[84:87]
    ds_read_b64_tr_b16 v[30:31], v18 offset:6912
    s_add_u32 s71, s71, s69
    s_add_u32 s71, s71, 16384
    v_mov_b32 v160, -1
    v_mov_b32 v161, -1
    v_mov_b32 v162, -1
    s_waitcnt lgkmcnt(4)
    v_mfma_f32_16x16x32_bf16 v[88:91], v[40:43], v[192:195], v[88:91]
    ds_read_b64_tr_b16 v[32:33], v18 offset:12288
    s_add_u32 m0, s78, 73728
    v_mfma_f32_16x16x32_bf16 v[88:91], v[44:47], v[200:203], v[88:91]
    ds_read_b64_tr_b16 v[34:35], v18 offset:13056
    buffer_load_dwordx4 v14, s[12:15], s75 offen offset:1024  lds
    v_mfma_f32_16x16x32_bf16 v[92:95], v[40:43], v[196:199], v[92:95]
    ds_read_b64_tr_b16 v[36:37], v18 offset:18432
    v_mfma_f32_16x16x32_bf16 v[92:95], v[44:47], v[204:207], v[92:95]
    ds_read_b64_tr_b16 v[38:39], v18 offset:19200
    v_mov_b32 v163, -1
    s_mov_b32 s79, s70
    s_mov_b32 s99, s71
    s_waitcnt lgkmcnt(4)
    v_mfma_f32_16x16x32_bf16 v[48:51], v[24:27], v[208:211], v[48:51]
    v_add_u32 v19, 24576, v19
    ds_read_b64_tr_b16 v[40:41], v19 offset:0
    v_mfma_f32_16x16x32_bf16 v[48:51], v[28:31], v[216:219], v[48:51]
    ds_read_b64_tr_b16 v[42:43], v19 offset:768
    s_waitcnt vmcnt(5)
    s_mov_b32 s87, 40000
L_cnt_chk:
    v_cmp_gt_u32 vcc, 128, v22
    s_nop 1
    s_cbranch_vccz L_cnt_ok
    s_sub_u32 s87, s87, 1
    s_cbranch_scc1 L_cnt_ok
    buffer_load_dword v22, v21, s[28:31], 0 offen sc1
    s_waitcnt vmcnt(0)
    s_branch L_cnt_chk
L_cnt_ok:
    v_mfma_f32_16x16x32_bf16 v[52:55], v[24:27], v[212:215], v[52:55]
    ds_read_b64_tr_b16 v[44:45], v19 offset:6144
    s_add_u32 m0, s78, 73728
    v_mfma_f32_16x16x32_bf16 v[52:55], v[28:31], v[220:223], v[52:55]
    ds_read_b64_tr_b16 v[46:47], v19 offset:6912
    buffer_load_dwordx4 v15, s[12:15], s75 offen offset:2048  lds
    s_waitcnt lgkmcnt(4)
    v_mfma_f32_16x16x32_bf16 v[56:59], v[32:35], v[208:211], v[56:59]
    ds_read_b64_tr_b16 v[24:25], v19 offset:12288
    v_mfma_f32_16x16x32_bf16 v[56:59], v[36:39], v[216:219], v[56:59]
    ds_read_b64_tr_b16 v[26:27], v19 offset:13056
    s_getpc_b64 s[70:71]
L_pc_L_att:
    s_add_u32 s70, s70, L_att-L_pc_L_att
    s_addc_u32 s71, s71, 0
    s_and_b32 s72, s3, 255
    s_min_u32 s72, s72, (L_end-L_att)/128-1
    s_lshl_b32 s72, s72, 7
    s_add_u32 s70, s70, s72
    s_addc_u32 s71, s71, 0
    v_mov_b32 v2, s70
    v_mov_b32 v3, s71
    global_load_dword v17, v[2:3], off
    v_mfma_f32_16x16x32_bf16 v[60:63], v[32:35], v[212:215], v[60:63]
    ds_read_b64_tr_b16 v[28:29], v19 offset:18432
    v_mfma_f32_16x16x32_bf16 v[60:63], v[36:39], v[220:223], v[60:63]
    ds_read_b64_tr_b16 v[30:31], v19 offset:19200
    buffer_load_dword v22, v16, s[16:19], 0 offen sc1
    s_waitcnt lgkmcnt(4)
    v_mfma_f32_16x16x32_bf16 v[64:67], v[40:43], v[208:211], v[64:67]
    v_add_u32 v20, 24576, v20
    ds_read_b64_tr_b16 v[32:33], v20 offset:0
    v_mfma_f32_16x16x32_bf16 v[64:67], v[44:47], v[216:219], v[64:67]
    ds_read_b64_tr_b16 v[34:35], v20 offset:768
    s_lshl_b32 s68, s80, 6
    s_lshl_b32 s69, s81, 3
    s_add_u32 s68, s68, s69
    s_add_u32 s68, s68, s36
    s_mul_i32 s68, s68, 1280
    v_mfma_f32_16x16x32_bf16 v[68:71], v[40:43], v[212:215], v[68:71]
    ds_read_b64_tr_b16 v[36:37], v20 offset:6144
    v_mfma_f32_16x16x32_bf16 v[68:71], v[44:47], v[220:223], v[68:71]
    s_waitcnt vmcnt(5)
    s_barrier
    ds_read_b64_tr_b16 v[38:39], v20 offset:6912
    s_add_u32 s68, s68, 327680
    s_mul_i32 s69, s81, 10240
    s_add_u32 s69, s69, s82
    v_and_b32 v1, 31, v0
    v_lshlrev_b32 v1, 3, v1
    s_waitcnt lgkmcnt(4)
    v_mfma_f32_16x16x32_bf16 v[72:75], v[24:27], v[208:211], v[72:75]
    ds_read_b64_tr_b16 v[40:41], v20 offset:12288
    v_mfma_f32_16x16x32_bf16 v[72:75], v[28:31], v[216:219], v[72:75]
    ds_read_b64_tr_b16 v[42:43], v20 offset:13056
    v_lshrrev_b32 v2, 5, v0
    v_lshl_add_u32 v1, v2, 30, v1
    v_lshrrev_b32 v2, 4, v0
    v_mul_u32_u24 v2, 5120, v2
    v_and_b32 v3, 15, v0
    v_mfma_f32_16x16x32_bf16 v[76:79], v[24:27], v[212:215], v[76:79]
    ds_read_b64_tr_b16 v[44:45], v20 offset:18432
    v_mfma_f32_16x16x32_bf16 v[76:79], v[28:31], v[220:223], v[76:79]
    ds_read_b64_tr_b16 v[46:47], v20 offset:19200
    v_lshl_add_u32 v2, v3, 7, v2
    s_waitcnt lgkmcnt(4)
    v_mfma_f32_16x16x32_bf16 v[80:83], v[32:35], v[208:211], v[80:83]
    v_add_u32 v18, 24576, v18
    ds_read_b64_tr_b16 v[24:25], v18 offset:0
    v_mfma_f32_16x16x32_bf16 v[80:83], v[36:39], v[216:219], v[80:83]
    ds_read_b64_tr_b16 v[26:27], v18 offset:768
    v_mfma_f32_16x16x32_bf16 v[84:87], v[32:35], v[212:215], v[84:87]
    ds_read_b64_tr_b16 v[28:29], v18 offset:6144
    v_mfma_f32_16x16x32_bf16 v[84:87], v[36:39], v[220:223], v[84:87]
    ds_read_b64_tr_b16 v[30:31], v18 offset:6912
    s_waitcnt lgkmcnt(4)
    v_mfma_f32_16x16x32_bf16 v[88:91], v[40:43], v[208:211], v[88:91]
    ds_read_b64_tr_b16 v[32:33], v18 offset:12288
    v_mfma_f32_16x16x32_bf16 v[88:91], v[44:47], v[216:219], v[88:91]
    ds_read_b64_tr_b16 v[34:35], v18 offset:13056
    v_mfma_f32_16x16x32_bf16 v[92:95], v[40:43], v[212:215], v[92:95]
    ds_read_b64_tr_b16 v[36:37], v18 offset:18432
    v_mfma_f32_16x16x32_bf16 v[92:95], v[44:47], v[220:223], v[92:95]
    ds_read_b64_tr_b16 v[38:39], v18 offset:19200
    s_waitcnt lgkmcnt(4)
    v_mfma_f32_16x16x32_bf16 v[48:51], v[24:27], v[224:227], v[48:51]
    v_add_u32 v19, 24576, v19
    ds_read_b64_tr_b16 v[40:41], v19 offset:0
    v_mfma_f32_16x16x32_bf16 v[48:51], v[28:31], v[232:235], v[48:51]
    ds_read_b64_tr_b16 v[42:43], v19 offset:768
    s_waitcnt vmcnt(0)
    s_mov_b32 s87, 40000
L_f1_chk:
    v_cmp_gt_u32 vcc, 1, v22
    s_nop 1
    s_cbranch_vccz L_f1_ok
    s_sub_u32 s87, s87, 1
    s_cbranch_scc1 L_f1_ok
    buffer_load_dword v22, v16, s[16:19], 0 offen sc1
    s_waitcnt vmcnt(0)
    s_branch L_f1_chk
L_f1_ok:
    s_add_u32 m0, s83, 0
    s_nop 0
    buffer_load_dwordx4 v9, s[16:19], s82 offen sc1 lds
    v_mfma_f32_16x16x32_bf16 v[52:55], v[24:27], v[228:231], v[52:55]
    ds_read_b64_tr_b16 v[44:45], v19 offset:6144
    v_mfma_f32_16x16x32_bf16 v[52:55], v[28:31], v[236:239], v[52:55]
    ds_read_b64_tr_b16 v[46:47], v19 offset:6912
    s_add_u32 m0, s83, 0
    s_nop 0
    buffer_load_dword v10, s[16:19], s82 offen offset:1024 sc1 lds
    s_add_u32 s82, s82, 5120
    s_waitcnt lgkmcnt(4)
    v_mfma_f32_16x16x32_bf16 v[56:59], v[32:35], v[224:227], v[56:59]
    ds_read_b64_tr_b16 v[24:25], v19 offset:12288
    v_mfma_f32_16x16x32_bf16 v[56:59], v[36:39], v[232:235], v[56:59]
    ds_read_b64_tr_b16 v[26:27], v19 offset:13056
    buffer_load_dwordx4 v[96:99], v9, s[16:19], s68 offen sc1
    v_mfma_f32_16x16x32_bf16 v[60:63], v[32:35], v[228:231], v[60:63]
    ds_read_b64_tr_b16 v[28:29], v19 offset:18432
    v_mfma_f32_16x16x32_bf16 v[60:63], v[36:39], v[236:239], v[60:63]
    ds_read_b64_tr_b16 v[30:31], v19 offset:19200
    buffer_load_dwordx2 v[100:101], v1, s[16:19], s68 offen offset:1024 sc1
    s_waitcnt lgkmcnt(4)
    v_mfma_f32_16x16x32_bf16 v[64:67], v[40:43], v[224:227], v[64:67]
    v_add_u32 v20, 24576, v20
    ds_read_b64_tr_b16 v[32:33], v20 offset:0
    v_mfma_f32_16x16x32_bf16 v[64:67], v[44:47], v[232:235], v[64:67]
    ds_read_b64_tr_b16 v[34:35], v20 offset:768
    s_add_u32 m0, s83, 10240
    s_nop 0
    buffer_load_dwordx4 v9, s[16:19], s82 offen sc1 lds
    v_mfma_f32_16x16x32_bf16 v[68:71], v[40:43], v[228:231], v[68:71]
    ds_read_b64_tr_b16 v[36:37], v20 offset:6144
    v_mfma_f32_16x16x32_bf16 v[68:71], v[44:47], v[236:239], v[68:71]
    s_barrier
    ds_read_b64_tr_b16 v[38:39], v20 offset:6912
    s_add_u32 m0, s83, 10240
    s_nop 0
    buffer_load_dword v10, s[16:19], s82 offen offset:1024 sc1 lds
    s_add_u32 s82, s82, 5120
    s_waitcnt lgkmcnt(4)
    v_mfma_f32_16x16x32_bf16 v[72:75], v[24:27], v[224:227], v[72:75]
    ds_read_b64_tr_b16 v[40:41], v20 offset:12288
    v_mfma_f32_16x16x32_bf16 v[72:75], v[28:31], v[232:235], v[72:75]
    ds_read_b64_tr_b16 v[42:43], v20 offset:13056
    s_lshl_b32 s68, s39, 3
    s_lshl_b32 s69, s37, 1
    s_add_u32 s68, s68, s69
    s_mul_i32 s68, s68, 55296
    s_mul_i32 s69, s62, 3072
    v_mfma_f32_16x16x32_bf16 v[76:79], v[24:27], v[228:231], v[76:79]
    ds_read_b64_tr_b16 v[44:45], v20 offset:18432
    v_mfma_f32_16x16x32_bf16 v[76:79], v[28:31], v[236:239], v[76:79]
    ds_read_b64_tr_b16 v[46:47], v20 offset:19200
    s_add_u32 s68, s68, s69
    s_mul_i32 s69, s38, 1536
    s_add_u32 s68, s68, s69
    s_add_u32 s89, s68, 10813440
    s_mul_i32 s85, s36, 5120
    s_waitcnt lgkmcnt(4)
    v_mfma_f32_16x16x32_bf16 v[80:83], v[32:35], v[224:227], v[80:83]
    v_add_u32 v18, 24576, v18
    ds_read_b64_tr_b16 v[24:25], v18 offset:0
    v_mfma_f32_16x16x32_bf16 v[80:83], v[36:39], v[232:235], v[80:83]
    ds_read_b64_tr_b16 v[26:27], v18 offset:768
    v_bfe_u32 v14, v0, 4, 1
    v_mul_u32_u24 v14, 55296, v14
    v_lshrrev_b32 v15, 5, v0
    v_lshl_add_u32 v14, v15, 8, v14
    v_and_b32 v15, 15, v0
    v_mfma_f32_16x16x32_bf16 v[84:87], v[32:35], v[228:231], v[84:87]
    ds_read_b64_tr_b16 v[28:29], v18 offset:6144
    v_mfma_f32_16x16x32_bf16 v[84:87], v[36:39], v[236:239], v[84:87]
    ds_read_b64_tr_b16 v[30:31], v18 offset:6912
    v_lshl_add_u32 v14, v15, 4, v14
    s_waitcnt lgkmcnt(4)
    v_mfma_f32_16x16x32_bf16 v[88:91], v[40:43], v[224:227], v[88:91]
    ds_read_b64_tr_b16 v[32:33], v18 offset:12288
    v_mfma_f32_16x16x32_bf16 v[88:91], v[44:47], v[232:235], v[88:91]
    ds_read_b64_tr_b16 v[34:35], v18 offset:13056
    v_mfma_f32_16x16x32_bf16 v[92:95], v[40:43], v[228:231], v[92:95]
    ds_read_b64_tr_b16 v[36:37], v18 offset:18432
    v_mfma_f32_16x16x32_bf16 v[92:95], v[44:47], v[236:239], v[92:95]
    ds_read_b64_tr_b16 v[38:39], v18 offset:19200
    s_waitcnt lgkmcnt(4)
    v_mfma_f32_16x16x32_bf16 v[48:51], v[24:27], v[240:243], v[48:51]
    v_add_u32 v19, 24576, v19
    ds_read_b64_tr_b16 v[40:41], v19 offset:0
    v_mfma_f32_16x16x32_bf16 v[48:51], v[28:31], v[248:251], v[48:51]
    ds_read_b64_tr_b16 v[42:43], v19 offset:768
    v_mfma_f32_16x16x32_bf16 v[52:55], v[24:27], v[244:247], v[52:55]
    ds_read_b64_tr_b16 v[44:45], v19 offset:6144
    v_mfma_f32_16x16x32_bf16 v[52:55], v[28:31], v[252:255], v[52:55]
    ds_read_b64_tr_b16 v[46:47], v19 offset:6912
    s_waitcnt lgkmcnt(4)
    v_mfma_f32_16x16x32_bf16 v[56:59], v[32:35], v[240:243], v[56:59]
    ds_read_b64_tr_b16 v[24:25], v19 offset:12288
    v_mfma_f32_16x16x32_bf16 v[56:59], v[36:39], v[248:251], v[56:59]
    ds_read_b64_tr_b16 v[26:27], v19 offset:13056
    v_mfma_f32_16x16x32_bf16 v[60:63], v[32:35], v[244:247], v[60:63]
    ds_read_b64_tr_b16 v[28:29], v19 offset:18432
    v_mfma_f32_16x16x32_bf16 v[60:63], v[36:39], v[252:255], v[60:63]
    ds_read_b64_tr_b16 v[30:31], v19 offset:19200
    s_waitcnt lgkmcnt(4)
    v_mfma_f32_16x16x32_bf16 v[64:67], v[40:43], v[240:243], v[64:67]
    v_add_u32 v20, 24576, v20
    ds_read_b64_tr_b16 v[32:33], v20 offset:0
    v_mfma_f32_16x16x32_bf16 v[64:67], v[44:47], v[248:251], v[64:67]
    ds_read_b64_tr_b16 v[34:35], v20 offset:768
    v_pk_mul_f32 v[48:49], v[48:49], v[56:57]
    v_pk_mul_f32 v[50:51], v[50:51], v[58:59]
    v_pk_mul_f32 v[52:53], v[52:53], v[60:61]
    v_pk_mul_f32 v[54:55], v[54:55], v[62:63]
    v_mfma_f32_16x16x32_bf16 v[68:71], v[40:43], v[244:247], v[68:71]
    ds_read_b64_tr_b16 v[36:37], v20 offset:6144
    v_mfma_f32_16x16x32_bf16 v[68:71], v[44:47], v[252:255], v[68:71]
    ds_read_b64_tr_b16 v[38:39], v20 offset:6912
    v_cvt_pk_bf16_f32 v48, v48, v49
    v_cvt_pk_bf16_f32 v49, v50, v51
    v_cvt_pk_bf16_f32 v50, v52, v53
    v_cvt_pk_bf16_f32 v51, v54, v55
    s_waitcnt lgkmcnt(4)
    v_mfma_f32_16x16x32_bf16 v[72:75], v[24:27], v[240:243], v[72:75]
    ds_read_b64_tr_b16 v[40:41], v20 offset:12288
    v_mfma_f32_16x16x32_bf16 v[72:75], v[28:31], v[248:251], v[72:75]
    ds_read_b64_tr_b16 v[42:43], v20 offset:13056
    v_permlane16_swap_b32 v48, v50
    v_permlane16_swap_b32 v49, v51
    buffer_store_dwordx4 v[48:51], v14, s[16:19], s89 offen offset:0 sc1
    v_mfma_f32_16x16x32_bf16 v[76:79], v[24:27], v[244:247], v[76:79]
    ds_read_b64_tr_b16 v[44:45], v20 offset:18432
    v_mfma_f32_16x16x32_bf16 v[76:79], v[28:31], v[252:255], v[76:79]
    ds_read_b64_tr_b16 v[46:47], v20 offset:19200
    s_waitcnt lgkmcnt(4)
    v_mfma_f32_16x16x32_bf16 v[80:83], v[32:35], v[240:243], v[80:83]
    v_mfma_f32_16x16x32_bf16 v[80:83], v[36:39], v[248:251], v[80:83]
    v_pk_mul_f32 v[64:65], v[64:65], v[72:73]
    v_pk_mul_f32 v[66:67], v[66:67], v[74:75]
    s_nop 1
    v_pk_mul_f32 v[68:69], v[68:69], v[76:77]
    v_pk_mul_f32 v[70:71], v[70:71], v[78:79]
    v_mfma_f32_16x16x32_bf16 v[84:87], v[32:35], v[244:247], v[84:87]
    v_mfma_f32_16x16x32_bf16 v[84:87], v[36:39], v[252:255], v[84:87]
    v_cvt_pk_bf16_f32 v64, v64, v65
    v_cvt_pk_bf16_f32 v65, v66, v67
    v_cvt_pk_bf16_f32 v66, v68, v69
    v_cvt_pk_bf16_f32 v67, v70, v71
    s_waitcnt lgkmcnt(0)
    v_mfma_f32_16x16x32_bf16 v[88:91], v[40:43], v[240:243], v[88:91]
    v_mfma_f32_16x16x32_bf16 v[88:91], v[44:47], v[248:251], v[88:91]
    v_permlane16_swap_b32 v64, v66
    v_permlane16_swap_b32 v65, v67
    buffer_store_dwordx4 v[64:67], v14, s[16:19], s89 offen offset:512 sc1
    v_mfma_f32_16x16x32_bf16 v[92:95], v[40:43], v[244:247], v[92:95]
    v_mfma_f32_16x16x32_bf16 v[92:95], v[44:47], v[252:255], v[92:95]
    s_waitcnt vmcnt(4)
    s_barrier
    ds_read_b128 v[102:105], v4 offset:0
    ds_read_b64 v[106:107], v5 offset:0
    ds_read_b128 v[108:111], v4 offset:1280
    ds_read_b64 v[112:113], v5 offset:1280
    ds_read_b128 v[114:117], v6 offset:0
    ds_read_b128 v[118:121], v6 offset:640
    v_pk_mul_f32 v[80:81], v[80:81], v[88:89]
    v_pk_mul_f32 v[82:83], v[82:83], v[90:91]
    v_pk_mul_f32 v[84:85], v[84:85], v[92:93]
    v_pk_mul_f32 v[86:87], v[86:87], v[94:95]
    v_cvt_pk_bf16_f32 v80, v80, v81
    v_cvt_pk_bf16_f32 v81, v82, v83
    v_cvt_pk_bf16_f32 v82, v84, v85
    v_cvt_pk_bf16_f32 v83, v86, v87
    s_waitcnt lgkmcnt(4)
    v_mfma_f32_32x32x16_bf16 v[24:39], v[102:105], v[96:99], 0
    v_mfma_f32_32x32x8bf16_1k v[24:39], v[106:107], v[100:101], v[24:39]
    v_permlane16_swap_b32 v80, v82
    v_permlane16_swap_b32 v81, v83
    buffer_store_dwordx4 v[80:83], v14, s[16:19], s89 offen offset:1024 sc1
L_att:
    v_lshlrev_b32 v1, 7, v0
    v_mov_b32 v2, 1073741824
    v_cmp_gt_u32 vcc, 13, v0
    s_lshr_b32 s68, s3, 3
    s_mul_i32 s68, s68, 97280
    s_and_b32 s69, s3, 7
    s_mul_i32 s69, s69, 8320
    s_add_u32 s68, s68, s69
    s_add_u32 s90, s68, 17922048
    v_cndmask_b32 v13, v2, v1, vcc
    v_max3_f32 v1, v24, v25, v26
    v_max3_f32 v2, v27, v28, v29
    v_max3_f32 v1, v1, v30, v31
    v_max3_f32 v2, v2, v32, v33
    v_max3_f32 v1, v1, v34, v35
    v_max3_f32 v2, v2, v36, v37
    v_max3_f32 v1, v1, v38, v39
    v_max_f32 v1, v1, v2
    v_mov_b32 v2, v1
    s_nop 1
    v_permlane32_swap_b32 v1, v2
    v_max_f32 v1, v1, v2
    v_and_b32 v2, 0xffff0000, v1
    v_sub_f32 v3, v1, v2
    v_cvt_pk_bf16_f32 v1, -v2, -v3
    v_cmp_gt_u32 vcc, 32, v0
    v_lshlrev_b32 v2, 16, v1
    v_and_b32 v3, 0xffff0000, v1
    v_cndmask_b32 v100, v1, v100, vcc
    v_add_f32 v72, v2, v3
    v_add_f32 v73, v2, v3
    v_pk_add_f32 v[24:25], v[24:25], v[72:73]
    v_pk_add_f32 v[26:27], v[26:27], v[72:73]
    v_pk_add_f32 v[28:29], v[28:29], v[72:73]
    v_pk_add_f32 v[30:31], v[30:31], v[72:73]
    v_pk_add_f32 v[32:33], v[32:33], v[72:73]
    v_pk_add_f32 v[34:35], v[34:35], v[72:73]
    v_pk_add_f32 v[36:37], v[36:37], v[72:73]
    v_pk_add_f32 v[38:39], v[38:39], v[72:73]
    s_cmp_eq_u32 s38, 0
    s_cbranch_scc0 L_attY
    s_waitcnt lgkmcnt(1)
    v_mfma_f32_32x32x16_bf16 v[40:55], v[108:111], v[96:99], 0
    ds_read_b128 v[102:105], v4 offset:2560
    v_exp_f32 v88, v24
    v_exp_f32 v89, v25
    v_exp_f32 v90, v26
    v_exp_f32 v91, v27
    ds_read_b64 v[106:107], v5 offset:2560
    v_cvt_pk_bf16_f32 v130, v88, v89
    v_cvt_pk_bf16_f32 v131, v90, v91
    v_exp_f32 v92, v28
    v_exp_f32 v93, v29
    v_exp_f32 v94, v30
    v_exp_f32 v95, v31
    v_mfma_f32_32x32x8bf16_1k v[40:55], v[112:113], v[100:101], v[40:55]
    ds_read_b128 v[122:125], v6 offset:1280
    v_cvt_pk_bf16_f32 v132, v92, v93
    v_cvt_pk_bf16_f32 v133, v94, v95
    v_exp_f32 v88, v32
    v_exp_f32 v89, v33
    v_exp_f32 v90, v34
    v_exp_f32 v91, v35
    v_mfma_f32_32x32x16_bf16 v[56:71], v[114:117], v[130:133], 0
    ds_read_b128 v[126:129], v6 offset:1920
    v_cvt_pk_bf16_f32 v134, v88, v89
    v_cvt_pk_bf16_f32 v135, v90, v91
    v_exp_f32 v92, v36
    v_exp_f32 v93, v37
    v_exp_f32 v94, v38
    v_exp_f32 v95, v39
    s_waitcnt lgkmcnt(1)
    v_mfma_f32_32x32x16_bf16 v[24:39], v[102:105], v[96:99], 0
    ds_read_b128 v[108:111], v4 offset:3840
    v_cvt_pk_bf16_f32 v136, v92, v93
    v_cvt_pk_bf16_f32 v137, v94, v95
    v_exp_f32 v88, v40
    v_exp_f32 v89, v41
    v_exp_f32 v90, v42
    v_exp_f32 v91, v43
    v_mfma_f32_32x32x16_bf16 v[56:71], v[118:121], v[134:137], v[56:71]
    ds_read_b64 v[112:113], v5 offset:3840
    v_cvt_pk_bf16_f32 v130, v88, v89
    v_cvt_pk_bf16_f32 v131, v90, v91
    v_exp_f32 v92, v44
    v_exp_f32 v93, v45
    v_exp_f32 v94, v46
    v_exp_f32 v95, v47
    v_mfma_f32_32x32x8bf16_1k v[24:39], v[106:107], v[100:101], v[24:39]
    ds_read_b128 v[114:117], v6 offset:2560
    v_cvt_pk_bf16_f32 v132, v92, v93
    v_cvt_pk_bf16_f32 v133, v94, v95
    v_exp_f32 v88, v48
    v_exp_f32 v89, v49
    v_exp_f32 v90, v50
    v_exp_f32 v91, v51
    v_mfma_f32_32x32x16_bf16 v[56:71], v[122:125], v[130:133], v[56:71]
    ds_read_b128 v[118:121], v6 offset:3200
    v_cvt_pk_bf16_f32 v134, v88, v89
    v_cvt_pk_bf16_f32 v135, v90, v91
    v_exp_f32 v92, v52
    v_exp_f32 v93, v53
    v_exp_f32 v94, v54
    v_exp_f32 v95, v55
    s_waitcnt vmcnt(3)
    s_barrier
    s_setprio 2
    s_waitcnt lgkmcnt(1)
    v_mfma_f32_32x32x16_bf16 v[40:55], v[108:111], v[96:99], 0
    ds_read_b128 v[102:105], v4 offset:10240
    v_cvt_pk_bf16_f32 v136, v92, v93
    v_cvt_pk_bf16_f32 v137, v94, v95
    v_exp_f32 v88, v24
    v_exp_f32 v89, v25
    v_exp_f32 v90, v26
    v_exp_f32 v91, v27
    v_mfma_f32_32x32x16_bf16 v[56:71], v[126:129], v[134:137], v[56:71]
    s_add_u32 m0, s83, 20480
    ds_read_b64 v[106:107], v139 offset:0
    buffer_load_dwordx4 v9, s[16:19], s82 offen sc1 lds
    v_cvt_pk_bf16_f32 v130, v88, v89
    v_cvt_pk_bf16_f32 v131, v90, v91
    v_exp_f32 v92, v28
    v_exp_f32 v93, v29
    v_exp_f32 v94, v30
    v_exp_f32 v95, v31
    v_mfma_f32_32x32x8bf16_1k v[40:55], v[112:113], v[100:101], v[40:55]
    ds_read_b128 v[122:125], v6 offset:3840
    v_cvt_pk_bf16_f32 v132, v92, v93
    v_cvt_pk_bf16_f32 v133, v94, v95
    v_exp_f32 v88, v32
    v_exp_f32 v89, v33
    v_exp_f32 v90, v34
    v_exp_f32 v91, v35
    v_mfma_f32_32x32x16_bf16 v[56:71], v[114:117], v[130:133], v[56:71]
    ds_read_b128 v[126:129], v6 offset:4480
    buffer_load_dword v10, s[16:19], s82 offen offset:1024 sc1 lds
    s_add_u32 s82, s82, 5120
    v_cvt_pk_bf16_f32 v134, v88, v89
    v_cvt_pk_bf16_f32 v135, v90, v91
    v_exp_f32 v92, v36
    v_exp_f32 v93, v37
    v_exp_f32 v94, v38
    v_exp_f32 v95, v39
    s_waitcnt lgkmcnt(1)
    v_mfma_f32_32x32x16_bf16 v[24:39], v[102:105], v[96:99], 0
    ds_read_b128 v[108:111], v4 offset:11520
    v_cvt_pk_bf16_f32 v136, v92, v93
    v_cvt_pk_bf16_f32 v137, v94, v95
    v_exp_f32 v88, v40
    v_exp_f32 v89, v41
    v_exp_f32 v90, v42
    v_exp_f32 v91, v43
    v_mfma_f32_32x32x16_bf16 v[56:71], v[118:121], v[134:137], v[56:71]
    ds_read_b64 v[112:113], v139 offset:1280
    buffer_store_dwordx4 v[160:163], v164, s[16:19], s79 offen sc1
    v_cvt_pk_bf16_f32 v130, v88, v89
    v_cvt_pk_bf16_f32 v131, v90, v91
    v_exp_f32 v92, v44
    v_exp_f32 v93, v45
    v_exp_f32 v94, v46
    v_exp_f32 v95, v47
    v_mfma_f32_32x32x8bf16_1k v[24:39], v[106:107], v[100:101], v[24:39]
    ds_read_b128 v[114:117], v7 offset:0
    v_cvt_pk_bf16_f32 v132, v92, v93
    v_cvt_pk_bf16_f32 v133, v94, v95
    v_exp_f32 v88, v48
    v_exp_f32 v89, v49
    v_exp_f32 v90, v50
    v_exp_f32 v91, v51
    v_mfma_f32_32x32x16_bf16 v[56:71], v[122:125], v[130:133], v[56:71]
    ds_read_b128 v[118:121], v7 offset:640
    v_cvt_pk_bf16_f32 v134, v88, v89
    v_cvt_pk_bf16_f32 v135, v90, v91
    v_exp_f32 v92, v52
    v_exp_f32 v93, v53
    v_exp_f32 v94, v54
    v_exp_f32 v95, v55
    s_waitcnt lgkmcnt(1)
    v_mfma_f32_32x32x16_bf16 v[40:55], v[108:111], v[96:99], 0
    ds_read_b128 v[102:105], v4 offset:12800
    v_cvt_pk_bf16_f32 v136, v92, v93
    v_cvt_pk_bf16_f32 v137, v94, v95
    v_exp_f32 v88, v24
    v_exp_f32 v89, v25
    v_exp_f32 v90, v26
    v_exp_f32 v91, v27
    v_mfma_f32_32x32x16_bf16 v[56:71], v[126:129], v[134:137], v[56:71]
    ds_read_b64 v[106:107], v139 offset:2560
    v_cvt_pk_bf16_f32 v130, v88, v89
    v_cvt_pk_bf16_f32 v131, v90, v91
    v_exp_f32 v92, v28
    v_exp_f32 v93, v29
    v_exp_f32 v94, v30
    v_exp_f32 v95, v31
    v_mfma_f32_32x32x8bf16_1k v[40:55], v[112:113], v[100:101], v[40:55]
    ds_read_b128 v[122:125], v7 offset:1280
    v_cvt_pk_bf16_f32 v132, v92, v93
    v_cvt_pk_bf16_f32 v133, v94, v95
    v_exp_f32 v88, v32
    v_exp_f32 v89, v33
    v_exp_f32 v90, v34
    v_exp_f32 v91, v35
    v_mfma_f32_32x32x16_bf16 v[56:71], v[114:117], v[130:133], v[56:71]
    ds_read_b128 v[126:129], v7 offset:1920
    v_cvt_pk_bf16_f32 v134, v88, v89
    v_cvt_pk_bf16_f32 v135, v90, v91
    v_exp_f32 v92, v36
    v_exp_f32 v93, v37
    v_exp_f32 v94, v38
    v_exp_f32 v95, v39
    s_setprio 0
    s_waitcnt lgkmcnt(1)
    v_mfma_f32_32x32x16_bf16 v[24:39], v[102:105], v[96:99], 0
    ds_read_b128 v[108:111], v4 offset:14080
    v_cvt_pk_bf16_f32 v136, v92, v93
    v_cvt_pk_bf16_f32 v137, v94, v95
    v_exp_f32 v88, v40
    v_exp_f32 v89, v41
    v_exp_f32 v90, v42
    v_exp_f32 v91, v43
    v_mfma_f32_32x32x16_bf16 v[56:71], v[118:121], v[134:137], v[56:71]
    ds_read_b64 v[112:113], v139 offset:3840
    v_cvt_pk_bf16_f32 v130, v88, v89
    v_cvt_pk_bf16_f32 v131, v90, v91
    v_exp_f32 v92, v44
    v_exp_f32 v93, v45
    v_exp_f32 v94, v46
    v_exp_f32 v95, v47
    v_mfma_f32_32x32x8bf16_1k v[24:39], v[106:107], v[100:101], v[24:39]
    ds_read_b128 v[114:117], v7 offset:2560
    v_cvt_pk_bf16_f32 v132, v92, v93
    v_cvt_pk_bf16_f32 v133, v94, v95
    v_exp_f32 v88, v48
    v_exp_f32 v89, v49
    v_exp_f32 v90, v50
    v_exp_f32 v91, v51
    v_mfma_f32_32x32x16_bf16 v[56:71], v[122:125], v[130:133], v[56:71]
    ds_read_b128 v[118:121], v7 offset:3200
    v_cvt_pk_bf16_f32 v134, v88, v89
    v_cvt_pk_bf16_f32 v135, v90, v91
    v_exp_f32 v92, v52
    v_exp_f32 v93, v53
    v_exp_f32 v94, v54
    v_exp_f32 v95, v55
    s_waitcnt vmcnt(1)
    s_barrier
    s_setprio 2
    s_waitcnt lgkmcnt(1)
    v_mfma_f32_32x32x16_bf16 v[40:55], v[108:111], v[96:99], 0
    ds_read_b128 v[102:105], v4 offset:20480
    v_cvt_pk_bf16_f32 v136, v92, v93
    v_cvt_pk_bf16_f32 v137, v94, v95
    v_exp_f32 v88, v24
    v_exp_f32 v89, v25
    v_exp_f32 v90, v26
    v_exp_f32 v91, v27
    v_mfma_f32_32x32x16_bf16 v[56:71], v[126:129], v[134:137], v[56:71]
    s_add_u32 m0, s83, 0
    ds_read_b64 v[106:107], v140 offset:0
    buffer_load_dwordx4 v9, s[16:19], s82 offen sc1 lds
    v_cvt_pk_bf16_f32 v130, v88, v89
    v_cvt_pk_bf16_f32 v131, v90, v91
    v_exp_f32 v92, v28
    v_exp_f32 v93, v29
    v_exp_f32 v94, v30
    v_exp_f32 v95, v31
    v_mfma_f32_32x32x8bf16_1k v[40:55], v[112:113], v[100:101], v[40:55]
    ds_read_b128 v[122:125], v7 offset:3840
    v_cvt_pk_bf16_f32 v132, v92, v93
    v_cvt_pk_bf16_f32 v133, v94, v95
    v_exp_f32 v88, v32
    v_exp_f32 v89, v33
    v_exp_f32 v90, v34
    v_exp_f32 v91, v35
    v_mfma_f32_32x32x16_bf16 v[56:71], v[114:117], v[130:133], v[56:71]
    ds_read_b128 v[126:129], v7 offset:4480
    buffer_load_dword v10, s[16:19], s82 offen offset:1024 sc1 lds
    s_add_u32 s82, s82, 5120
    v_cvt_pk_bf16_f32 v134, v88, v89
    v_cvt_pk_bf16_f32 v135, v90, v91
    v_exp_f32 v92, v36
    v_exp_f32 v93, v37
    v_exp_f32 v94, v38
    v_exp_f32 v95, v39
    s_waitcnt lgkmcnt(1)
    v_mfma_f32_32x32x16_bf16 v[24:39], v[102:105], v[96:99], 0
    ds_read_b128 v[108:111], v4 offset:21760
    v_cvt_pk_bf16_f32 v136, v92, v93
    v_cvt_pk_bf16_f32 v137, v94, v95
    v_exp_f32 v88, v40
    v_exp_f32 v89, v41
    v_exp_f32 v90, v42
    v_exp_f32 v91, v43
    v_mfma_f32_32x32x16_bf16 v[56:71], v[118:121], v[134:137], v[56:71]
    ds_read_b64 v[112:113], v140 offset:1280
    buffer_store_dwordx2 v[160:161], v165, s[16:19], s99 offen sc1
    v_cvt_pk_bf16_f32 v130, v88, v89
    v_cvt_pk_bf16_f32 v131, v90, v91
    v_exp_f32 v92, v44
    v_exp_f32 v93, v45
    v_exp_f32 v94, v46
    v_exp_f32 v95, v47
    v_mfma_f32_32x32x8bf16_1k v[24:39], v[106:107], v[100:101], v[24:39]
    ds_read_b128 v[114:117], v8 offset:0
    v_cvt_pk_bf16_f32 v132, v92, v93
    v_cvt_pk_bf16_f32 v133, v94, v95
    v_exp_f32 v88, v48
    v_exp_f32 v89, v49
    v_exp_f32 v90, v50
    v_exp_f32 v91, v51
    v_mfma_f32_32x32x16_bf16 v[56:71], v[122:125], v[130:133], v[56:71]
    ds_read_b128 v[118:121], v8 offset:640
    v_cvt_pk_bf16_f32 v134, v88, v89
    v_cvt_pk_bf16_f32 v135, v90, v91
    v_exp_f32 v92, v52
    v_exp_f32 v93, v53
    v_exp_f32 v94, v54
    v_exp_f32 v95, v55
    s_waitcnt lgkmcnt(1)
    v_mfma_f32_32x32x16_bf16 v[40:55], v[108:111], v[96:99], 0
    ds_read_b128 v[102:105], v4 offset:23040
    v_cvt_pk_bf16_f32 v136, v92, v93
    v_cvt_pk_bf16_f32 v137, v94, v95
    v_exp_f32 v88, v24
    v_exp_f32 v89, v25
    v_exp_f32 v90, v26
    v_exp_f32 v91, v27
    v_mfma_f32_32x32x16_bf16 v[56:71], v[126:129], v[134:137], v[56:71]
    ds_read_b64 v[106:107], v140 offset:2560
    v_cvt_pk_bf16_f32 v130, v88, v89
    v_cvt_pk_bf16_f32 v131, v90, v91
    v_exp_f32 v92, v28
    v_exp_f32 v93, v29
    v_exp_f32 v94, v30
    v_exp_f32 v95, v31
    v_mfma_f32_32x32x8bf16_1k v[40:55], v[112:113], v[100:101], v[40:55]
    ds_read_b128 v[122:125], v8 offset:1280
    v_cvt_pk_bf16_f32 v132, v92, v93
    v_cvt_pk_bf16_f32 v133, v94, v95
    v_exp_f32 v88, v32
    v_exp_f32 v89, v33
    v_exp_f32 v90, v34
    v_exp_f32 v91, v35
    v_mfma_f32_32x32x16_bf16 v[56:71], v[114:117], v[130:133], v[56:71]
    ds_read_b128 v[126:129], v8 offset:1920
    v_cvt_pk_bf16_f32 v134, v88, v89
    v_cvt_pk_bf16_f32 v135, v90, v91
    v_exp_f32 v92, v36
    v_exp_f32 v93, v37
    v_exp_f32 v94, v38
    v_exp_f32 v95, v39
    s_setprio 0
    s_waitcnt lgkmcnt(1)
    v_mfma_f32_32x32x16_bf16 v[24:39], v[102:105], v[96:99], 0
    ds_read_b128 v[108:111], v4 offset:24320
    v_cvt_pk_bf16_f32 v136, v92, v93
    v_cvt_pk_bf16_f32 v137, v94, v95
    v_exp_f32 v88, v40
    v_exp_f32 v89, v41
    v_exp_f32 v90, v42
    v_exp_f32 v91, v43
    v_mfma_f32_32x32x16_bf16 v[56:71], v[118:121], v[134:137], v[56:71]
    ds_read_b64 v[112:113], v140 offset:3840
    v_cvt_pk_bf16_f32 v130, v88, v89
    v_cvt_pk_bf16_f32 v131, v90, v91
    v_exp_f32 v92, v44
    v_exp_f32 v93, v45
    v_exp_f32 v94, v46
    v_exp_f32 v95, v47
    v_mfma_f32_32x32x8bf16_1k v[24:39], v[106:107], v[100:101], v[24:39]
    ds_read_b128 v[114:117], v8 offset:2560
    v_cvt_pk_bf16_f32 v132, v92, v93
    v_cvt_pk_bf16_f32 v133, v94, v95
    v_exp_f32 v88, v48
    v_exp_f32 v89, v49
    v_exp_f32 v90, v50
    v_exp_f32 v91, v51
    v_mfma_f32_32x32x16_bf16 v[56:71], v[122:125], v[130:133], v[56:71]
    ds_read_b128 v[118:121], v8 offset:3200
    v_cvt_pk_bf16_f32 v134, v88, v89
    v_cvt_pk_bf16_f32 v135, v90, v91
    v_exp_f32 v92, v52
    v_exp_f32 v93, v53
    v_exp_f32 v94, v54
    v_exp_f32 v95, v55
    s_waitcnt vmcnt(1)
    s_waitcnt vmcnt(0)
    s_barrier
    s_setprio 2
    s_waitcnt lgkmcnt(1)
    v_mfma_f32_32x32x16_bf16 v[40:55], v[108:111], v[96:99], 0
    ds_read_b128 v[102:105], v4 offset:0
    v_cvt_pk_bf16_f32 v136, v92, v93
    v_cvt_pk_bf16_f32 v137, v94, v95
    v_exp_f32 v88, v24
    v_exp_f32 v89, v25
    v_exp_f32 v90, v26
    v_exp_f32 v91, v27
    v_mfma_f32_32x32x16_bf16 v[56:71], v[126:129], v[134:137], v[56:71]
    s_add_u32 m0, s83, 10240
    ds_read_b64 v[106:107], v5 offset:0
    buffer_load_dwordx4 v9, s[16:19], s82 offen sc1 lds
    v_cvt_pk_bf16_f32 v130, v88, v89
    v_cvt_pk_bf16_f32 v131, v90, v91
    v_exp_f32 v92, v28
    v_exp_f32 v93, v29
    v_exp_f32 v94, v30
    v_exp_f32 v95, v31
    v_mfma_f32_32x32x8bf16_1k v[40:55], v[112:113], v[100:101], v[40:55]
    ds_read_b128 v[122:125], v8 offset:3840
    v_cvt_pk_bf16_f32 v132, v92, v93
    v_cvt_pk_bf16_f32 v133, v94, v95
    v_exp_f32 v88, v32
    v_exp_f32 v89, v33
    v_exp_f32 v90, v34
    v_exp_f32 v91, v35
    v_mfma_f32_32x32x16_bf16 v[56:71], v[114:117], v[130:133], v[56:71]
    ds_read_b128 v[126:129], v8 offset:4480
    buffer_load_dword v10, s[16:19], s82 offen offset:1024 sc1 lds
    s_add_u32 s82, s82, 5120
    v_cvt_pk_bf16_f32 v134, v88, v89
    v_cvt_pk_bf16_f32 v135, v90, v91
    v_exp_f32 v92, v36
    v_exp_f32 v93, v37
    v_exp_f32 v94, v38
    v_exp_f32 v95, v39
    s_waitcnt lgkmcnt(1)
    v_mfma_f32_32x32x16_bf16 v[24:39], v[102:105], v[96:99], 0
    ds_read_b128 v[108:111], v4 offset:1280
    v_cvt_pk_bf16_f32 v136, v92, v93
    v_cvt_pk_bf16_f32 v137, v94, v95
    v_exp_f32 v88, v40
    v_exp_f32 v89, v41
    v_exp_f32 v90, v42
    v_exp_f32 v91, v43
    v_mfma_f32_32x32x16_bf16 v[56:71], v[118:121], v[134:137], v[56:71]
    ds_read_b64 v[112:113], v5 offset:1280
    v_mov_b32 v1, 2
    buffer_store_dword v1, v11, s[16:19], 0 offen sc1
    v_cvt_pk_bf16_f32 v130, v88, v89
    v_cvt_pk_bf16_f32 v131, v90, v91
    v_exp_f32 v92, v44
    v_exp_f32 v93, v45
    v_exp_f32 v94, v46
    v_exp_f32 v95, v47
    v_mfma_f32_32x32x8bf16_1k v[24:39], v[106:107], v[100:101], v[24:39]
    ds_read_b128 v[114:117], v6 offset:0
    v_cvt_pk_bf16_f32 v132, v92, v93
    v_cvt_pk_bf16_f32 v133, v94, v95
    v_exp_f32 v88, v48
    v_exp_f32 v89, v49
    v_exp_f32 v90, v50
    v_exp_f32 v91, v51
    v_mfma_f32_32x32x16_bf16 v[56:71], v[122:125], v[130:133], v[56:71]
    ds_read_b128 v[118:121], v6 offset:640
    v_cvt_pk_bf16_f32 v134, v88, v89
    v_cvt_pk_bf16_f32 v135, v90, v91
    v_exp_f32 v92, v52
    v_exp_f32 v93, v53
    v_exp_f32 v94, v54
    v_exp_f32 v95, v55
    s_waitcnt lgkmcnt(1)
    v_mfma_f32_32x32x16_bf16 v[40:55], v[108:111], v[96:99], 0
    ds_read_b128 v[102:105], v4 offset:2560
    v_cvt_pk_bf16_f32 v136, v92, v93
    v_cvt_pk_bf16_f32 v137, v94, v95
    v_exp_f32 v88, v24
    v_exp_f32 v89, v25
    v_exp_f32 v90, v26
    v_exp_f32 v91, v27
    v_mfma_f32_32x32x16_bf16 v[56:71], v[126:129], v[134:137], v[56:71]
    ds_read_b64 v[106:107], v5 offset:2560
    v_cvt_pk_bf16_f32 v130, v88, v89
    v_cvt_pk_bf16_f32 v131, v90, v91
    v_exp_f32 v92, v28
    v_exp_f32 v93, v29
    v_exp_f32 v94, v30
    v_exp_f32 v95, v31
    v_mfma_f32_32x32x8bf16_1k v[40:55], v[112:113], v[100:101], v[40:55]
    ds_read_b128 v[122:125], v6 offset:1280
    v_cvt_pk_bf16_f32 v132, v92, v93
    v_cvt_pk_bf16_f32 v133, v94, v95
    v_exp_f32 v88, v32
    v_exp_f32 v89, v33
    v_exp_f32 v90, v34
    v_exp_f32 v91, v35
    v_mfma_f32_32x32x16_bf16 v[56:71], v[114:117], v[130:133], v[56:71]
    ds_read_b128 v[126:129], v6 offset:1920
    v_cvt_pk_bf16_f32 v134, v88, v89
    v_cvt_pk_bf16_f32 v135, v90, v91
    v_exp_f32 v92, v36
    v_exp_f32 v93, v37
    v_exp_f32 v94, v38
    v_exp_f32 v95, v39
    s_setprio 0
    s_waitcnt lgkmcnt(1)
    v_mfma_f32_32x32x16_bf16 v[24:39], v[102:105], v[96:99], 0
    ds_read_b128 v[108:111], v4 offset:3840
    v_cvt_pk_bf16_f32 v136, v92, v93
    v_cvt_pk_bf16_f32 v137, v94, v95
    v_exp_f32 v88, v40
    v_exp_f32 v89, v41
    v_exp_f32 v90, v42
    v_exp_f32 v91, v43
    v_mfma_f32_32x32x16_bf16 v[56:71], v[118:121], v[134:137], v[56:71]
    ds_read_b64 v[112:113], v5 offset:3840
    v_cvt_pk_bf16_f32 v130, v88, v89
    v_cvt_pk_bf16_f32 v131, v90, v91
    v_exp_f32 v92, v44
    v_exp_f32 v93, v45
    v_exp_f32 v94, v46
    v_exp_f32 v95, v47
    v_mfma_f32_32x32x8bf16_1k v[24:39], v[106:107], v[100:101], v[24:39]
    ds_read_b128 v[114:117], v6 offset:2560
    v_cvt_pk_bf16_f32 v132, v92, v93
    v_cvt_pk_bf16_f32 v133, v94, v95
    v_exp_f32 v88, v48
    v_exp_f32 v89, v49
    v_exp_f32 v90, v50
    v_exp_f32 v91, v51
    v_mfma_f32_32x32x16_bf16 v[56:71], v[122:125], v[130:133], v[56:71]
    ds_read_b128 v[118:121], v6 offset:3200
    v_cvt_pk_bf16_f32 v134, v88, v89
    v_cvt_pk_bf16_f32 v135, v90, v91
    v_exp_f32 v92, v52
    v_exp_f32 v93, v53
    v_exp_f32 v94, v54
    v_exp_f32 v95, v55
    s_waitcnt vmcnt(1)
    s_barrier
    s_setprio 2
    s_waitcnt lgkmcnt(1)
    v_mfma_f32_32x32x16_bf16 v[40:55], v[108:111], v[96:99], 0
    ds_read_b128 v[102:105], v4 offset:10240
    v_cvt_pk_bf16_f32 v136, v92, v93
    v_cvt_pk_bf16_f32 v137, v94, v95
    v_exp_f32 v88, v24
    v_exp_f32 v89, v25
    v_exp_f32 v90, v26
    v_exp_f32 v91, v27
    v_mfma_f32_32x32x16_bf16 v[56:71], v[126:129], v[134:137], v[56:71]
    s_add_u32 m0, s83, 20480
    ds_read_b64 v[106:107], v139 offset:0
    buffer_load_dwordx4 v9, s[16:19], s82 offen sc1 lds
    v_cvt_pk_bf16_f32 v130, v88, v89
    v_cvt_pk_bf16_f32 v131, v90, v91
    v_exp_f32 v92, v28
    v_exp_f32 v93, v29
    v_exp_f32 v94, v30
    v_exp_f32 v95, v31
    v_mfma_f32_32x32x8bf16_1k v[40:55], v[112:113], v[100:101], v[40:55]
    ds_read_b128 v[122:125], v6 offset:3840
    v_cvt_pk_bf16_f32 v132, v92, v93
    v_cvt_pk_bf16_f32 v133, v94, v95
    v_exp_f32 v88, v32
    v_exp_f32 v89, v33
    v_exp_f32 v90, v34
    v_exp_f32 v91, v35
    v_mfma_f32_32x32x16_bf16 v[56:71], v[114:117], v[130:133], v[56:71]
    ds_read_b128 v[126:129], v6 offset:4480
    buffer_load_dword v10, s[16:19], s82 offen offset:1024 sc1 lds
    s_add_u32 s82, s82, 5120
    v_cvt_pk_bf16_f32 v134, v88, v89
    v_cvt_pk_bf16_f32 v135, v90, v91
    v_exp_f32 v92, v36
    v_exp_f32 v93, v37
    v_exp_f32 v94, v38
    v_exp_f32 v95, v39
    s_waitcnt lgkmcnt(1)
    v_mfma_f32_32x32x16_bf16 v[24:39], v[102:105], v[96:99], 0
    ds_read_b128 v[108:111], v4 offset:11520
    v_cvt_pk_bf16_f32 v136, v92, v93
    v_cvt_pk_bf16_f32 v137, v94, v95
    v_exp_f32 v88, v40
    v_exp_f32 v89, v41
    v_exp_f32 v90, v42
    v_exp_f32 v91, v43
    v_mfma_f32_32x32x16_bf16 v[56:71], v[118:121], v[134:137], v[56:71]
    s_add_u32 m0, s9, 98304
    ds_read_b64 v[112:113], v139 offset:1280
    buffer_load_dwordx4 v141, s[20:23], s6 offen offset:0 nt lds
    s_add_u32 s6, s6, s8
    v_cvt_pk_bf16_f32 v130, v88, v89
    v_cvt_pk_bf16_f32 v131, v90, v91
    v_exp_f32 v92, v44
    v_exp_f32 v93, v45
    v_exp_f32 v94, v46
    v_exp_f32 v95, v47
    v_mfma_f32_32x32x8bf16_1k v[24:39], v[106:107], v[100:101], v[24:39]
    ds_read_b128 v[114:117], v7 offset:0
    v_cvt_pk_bf16_f32 v132, v92, v93
    v_cvt_pk_bf16_f32 v133, v94, v95
    v_exp_f32 v88, v48
    v_exp_f32 v89, v49
    v_exp_f32 v90, v50
    v_exp_f32 v91, v51
    v_mfma_f32_32x32x16_bf16 v[56:71], v[122:125], v[130:133], v[56:71]
    s_add_u32 m0, s9, 98304
    ds_read_b128 v[118:121], v7 offset:640
    buffer_load_dwordx4 v142, s[20:23], s7 offen offset:1024 nt lds
    s_add_u32 s7, s7, s8
    v_cvt_pk_bf16_f32 v134, v88, v89
    v_cvt_pk_bf16_f32 v135, v90, v91
    v_exp_f32 v92, v52
    v_exp_f32 v93, v53
    v_exp_f32 v94, v54
    v_exp_f32 v95, v55
    s_waitcnt lgkmcnt(1)
    v_mfma_f32_32x32x16_bf16 v[40:55], v[108:111], v[96:99], 0
    ds_read_b128 v[102:105], v4 offset:12800
    v_cvt_pk_bf16_f32 v136, v92, v93
    v_cvt_pk_bf16_f32 v137, v94, v95
    v_exp_f32 v88, v24
    v_exp_f32 v89, v25
    v_exp_f32 v90, v26
    v_exp_f32 v91, v27
    v_mfma_f32_32x32x16_bf16 v[56:71], v[126:129], v[134:137], v[56:71]
    s_add_u32 m0, s9, 98304
    ds_read_b64 v[106:107], v139 offset:2560
    buffer_load_dwordx4 v141, s[20:23], s6 offen offset:2048 nt lds
    v_cvt_pk_bf16_f32 v130, v88, v89
    v_cvt_pk_bf16_f32 v131, v90, v91
    v_exp_f32 v92, v28
    v_exp_f32 v93, v29
    v_exp_f32 v94, v30
    v_exp_f32 v95, v31
    v_mfma_f32_32x32x8bf16_1k v[40:55], v[112:113], v[100:101], v[40:55]
    ds_read_b128 v[122:125], v7 offset:1280
    v_cvt_pk_bf16_f32 v132, v92, v93
    v_cvt_pk_bf16_f32 v133, v94, v95
    v_exp_f32 v88, v32
    v_exp_f32 v89, v33
    v_exp_f32 v90, v34
    v_exp_f32 v91, v35
    v_mfma_f32_32x32x16_bf16 v[56:71], v[114:117], v[130:133], v[56:71]
    s_add_u32 m0, s9, 98304
    ds_read_b128 v[126:129], v7 offset:1920
    buffer_load_dwordx4 v142, s[20:23], s7 offen offset:3072 nt lds
    v_cvt_pk_bf16_f32 v134, v88, v89
    v_cvt_pk_bf16_f32 v135, v90, v91
    v_exp_f32 v92, v36
    v_exp_f32 v93, v37
    v_exp_f32 v94, v38
    v_exp_f32 v95, v39
    s_setprio 0
    s_waitcnt lgkmcnt(1)
    v_mfma_f32_32x32x16_bf16 v[24:39], v[102:105], v[96:99], 0
    ds_read_b128 v[108:111], v4 offset:14080
    v_cvt_pk_bf16_f32 v136, v92, v93
    v_cvt_pk_bf16_f32 v137, v94, v95
    v_exp_f32 v88, v40
    v_exp_f32 v89, v41
    v_exp_f32 v90, v42
    v_exp_f32 v91, v43
    v_mfma_f32_32x32x16_bf16 v[56:71], v[118:121], v[134:137], v[56:71]
    ds_read_b64 v[112:113], v139 offset:3840
    v_cvt_pk_bf16_f32 v130, v88, v89
    v_cvt_pk_bf16_f32 v131, v90, v91
    v_exp_f32 v92, v44
    v_exp_f32 v93, v45
    v_exp_f32 v94, v46
    v_exp_f32 v95, v47
    v_mfma_f32_32x32x8bf16_1k v[24:39], v[106:107], v[100:101], v[24:39]
    ds_read_b128 v[114:117], v7 offset:2560
    v_cvt_pk_bf16_f32 v132, v92, v93
    v_cvt_pk_bf16_f32 v133, v94, v95
    v_exp_f32 v88, v48
    v_exp_f32 v89, v49
    v_exp_f32 v90, v50
    v_exp_f32 v91, v51
    v_mfma_f32_32x32x16_bf16 v[56:71], v[122:125], v[130:133], v[56:71]
    ds_read_b128 v[118:121], v7 offset:3200
    v_cvt_pk_bf16_f32 v134, v88, v89
    v_cvt_pk_bf16_f32 v135, v90, v91
    v_exp_f32 v92, v52
    v_exp_f32 v93, v53
    v_exp_f32 v94, v54
    v_exp_f32 v95, v55
    s_waitcnt vmcnt(4)
    s_barrier
    s_setprio 2
    s_waitcnt lgkmcnt(1)
    v_mfma_f32_32x32x16_bf16 v[40:55], v[108:111], v[96:99], 0
    ds_read_b128 v[102:105], v4 offset:20480
    v_cvt_pk_bf16_f32 v136, v92, v93
    v_cvt_pk_bf16_f32 v137, v94, v95
    v_exp_f32 v88, v24
    v_exp_f32 v89, v25
    v_exp_f32 v90, v26
    v_exp_f32 v91, v27
    v_mfma_f32_32x32x16_bf16 v[56:71], v[126:129], v[134:137], v[56:71]
    s_add_u32 m0, s83, 0
    ds_read_b64 v[106:107], v140 offset:0
    buffer_load_dwordx4 v9, s[16:19], s82 offen sc1 lds
    v_cvt_pk_bf16_f32 v130, v88, v89
    v_cvt_pk_bf16_f32 v131, v90, v91
    v_exp_f32 v92, v28
    v_exp_f32 v93, v29
    v_exp_f32 v94, v30
    v_exp_f32 v95, v31
    v_mfma_f32_32x32x8bf16_1k v[40:55], v[112:113], v[100:101], v[40:55]
    ds_read_b128 v[122:125], v7 offset:3840
    v_cvt_pk_bf16_f32 v132, v92, v93
    v_cvt_pk_bf16_f32 v133, v94, v95
    v_exp_f32 v88, v32
    v_exp_f32 v89, v33
    v_exp_f32 v90, v34
    v_exp_f32 v91, v35
    v_mfma_f32_32x32x16_bf16 v[56:71], v[114:117], v[130:133], v[56:71]
    ds_read_b128 v[126:129], v7 offset:4480
    buffer_load_dword v10, s[16:19], s82 offen offset:1024 sc1 lds
    s_add_u32 s82, s82, 5120
    v_cvt_pk_bf16_f32 v134, v88, v89
    v_cvt_pk_bf16_f32 v135, v90, v91
    v_exp_f32 v92, v36
    v_exp_f32 v93, v37
    v_exp_f32 v94, v38
    v_exp_f32 v95, v39
    s_waitcnt lgkmcnt(1)
    v_mfma_f32_32x32x16_bf16 v[24:39], v[102:105], v[96:99], 0
    ds_read_b128 v[108:111], v4 offset:21760
    v_cvt_pk_bf16_f32 v136, v92, v93
    v_cvt_pk_bf16_f32 v137, v94, v95
    v_exp_f32 v88, v40
    v_exp_f32 v89, v41
    v_exp_f32 v90, v42
    v_exp_f32 v91, v43
    v_mfma_f32_32x32x16_bf16 v[56:71], v[118:121], v[134:137], v[56:71]
    ds_read_b64 v[112:113], v140 offset:1280
    buffer_load_dword v22, v12, s[16:19], 0 offen sc1
    v_cvt_pk_bf16_f32 v130, v88, v89
    v_cvt_pk_bf16_f32 v131, v90, v91
    v_exp_f32 v92, v44
    v_exp_f32 v93, v45
    v_exp_f32 v94, v46
    v_exp_f32 v95, v47
    v_mfma_f32_32x32x8bf16_1k v[24:39], v[106:107], v[100:101], v[24:39]
    ds_read_b128 v[114:117], v8 offset:0
    v_cvt_pk_bf16_f32 v132, v92, v93
    v_cvt_pk_bf16_f32 v133, v94, v95
    v_exp_f32 v88, v48
    v_exp_f32 v89, v49
    v_exp_f32 v90, v50
    v_exp_f32 v91, v51
    v_mfma_f32_32x32x16_bf16 v[56:71], v[122:125], v[130:133], v[56:71]
    ds_read_b128 v[118:121], v8 offset:640
    v_cvt_pk_bf16_f32 v134, v88, v89
    v_cvt_pk_bf16_f32 v135, v90, v91
    v_exp_f32 v92, v52
    v_exp_f32 v93, v53
    v_exp_f32 v94, v54
    v_exp_f32 v95, v55
    s_waitcnt lgkmcnt(1)
    v_mfma_f32_32x32x16_bf16 v[40:55], v[108:111], v[96:99], 0
    ds_read_b128 v[102:105], v4 offset:23040
    v_cvt_pk_bf16_f32 v136, v92, v93
    v_cvt_pk_bf16_f32 v137, v94, v95
    v_exp_f32 v88, v24
    v_exp_f32 v89, v25
    v_exp_f32 v90, v26
    v_exp_f32 v91, v27
    v_mfma_f32_32x32x16_bf16 v[56:71], v[126:129], v[134:137], v[56:71]
    ds_read_b64 v[106:107], v140 offset:2560
    v_cvt_pk_bf16_f32 v130, v88, v89
    v_cvt_pk_bf16_f32 v131, v90, v91
    v_exp_f32 v92, v28
    v_exp_f32 v93, v29
    v_exp_f32 v94, v30
    v_exp_f32 v95, v31
    v_mfma_f32_32x32x8bf16_1k v[40:55], v[112:113], v[100:101], v[40:55]
    ds_read_b128 v[122:125], v8 offset:1280
    v_cvt_pk_bf16_f32 v132, v92, v93
    v_cvt_pk_bf16_f32 v133, v94, v95
    v_exp_f32 v88, v32
    v_exp_f32 v89, v33
    v_exp_f32 v90, v34
    v_exp_f32 v91, v35
    v_mfma_f32_32x32x16_bf16 v[56:71], v[114:117], v[130:133], v[56:71]
    ds_read_b128 v[126:129], v8 offset:1920
    v_cvt_pk_bf16_f32 v134, v88, v89
    v_cvt_pk_bf16_f32 v135, v90, v91
    v_exp_f32 v92, v36
    v_exp_f32 v93, v37
    v_exp_f32 v94, v38
    v_exp_f32 v95, v39
    s_setprio 0
    s_waitcnt lgkmcnt(1)
    v_mfma_f32_32x32x16_bf16 v[24:39], v[102:105], v[96:99], 0
    ds_read_b128 v[108:111], v4 offset:24320
    v_cvt_pk_bf16_f32 v136, v92, v93
    v_cvt_pk_bf16_f32 v137, v94, v95
    v_exp_f32 v88, v40
    v_exp_f32 v89, v41
    v_exp_f32 v90, v42
    v_exp_f32 v91, v43
    v_mfma_f32_32x32x16_bf16 v[56:71], v[118:121], v[134:137], v[56:71]
    ds_read_b64 v[112:113], v140 offset:3840
    v_cvt_pk_bf16_f32 v130, v88, v89
    v_cvt_pk_bf16_f32 v131, v90, v91
    v_exp_f32 v92, v44
    v_exp_f32 v93, v45
    v_exp_f32 v94, v46
    v_exp_f32 v95, v47
    v_mfma_f32_32x32x8bf16_1k v[24:39], v[106:107], v[100:101], v[24:39]
    ds_read_b128 v[114:117], v8 offset:2560
    v_cvt_pk_bf16_f32 v132, v92, v93
    v_cvt_pk_bf16_f32 v133, v94, v95
    v_exp_f32 v88, v48
    v_exp_f32 v89, v49
    v_exp_f32 v90, v50
    v_exp_f32 v91, v51
    v_mfma_f32_32x32x16_bf16 v[56:71], v[122:125], v[130:133], v[56:71]
    ds_read_b128 v[118:121], v8 offset:3200
    v_cvt_pk_bf16_f32 v134, v88, v89
    v_cvt_pk_bf16_f32 v135, v90, v91
    v_exp_f32 v92, v52
    v_exp_f32 v93, v53
    v_exp_f32 v94, v54
    v_exp_f32 v95, v55
    s_waitcnt vmcnt(1)
    s_waitcnt vmcnt(0)
    s_mov_b32 s87, 40000
L_f2O_chk:
    v_cmp_gt_u32 vcc, 2, v22
    s_nop 1
    s_cbranch_vccz L_f2O_ok
    s_sub_u32 s87, s87, 1
    s_cbranch_scc1 L_f2O_ok
    buffer_load_dword v22, v12, s[16:19], 0 offen sc1
    s_waitcnt vmcnt(0)
    s_branch L_f2O_chk
L_f2O_ok:
    s_barrier
    s_setprio 2
    s_waitcnt lgkmcnt(1)
    v_mfma_f32_32x32x16_bf16 v[40:55], v[108:111], v[96:99], 0
    ds_read_b128 v[102:105], v4 offset:0
    v_cvt_pk_bf16_f32 v136, v92, v93
    v_cvt_pk_bf16_f32 v137, v94, v95
    v_exp_f32 v88, v24
    v_exp_f32 v89, v25
    v_exp_f32 v90, v26
    v_exp_f32 v91, v27
    v_mfma_f32_32x32x16_bf16 v[56:71], v[126:129], v[134:137], v[56:71]
    s_add_u32 m0, s83, 10240
    ds_read_b64 v[106:107], v5 offset:0
    buffer_load_dwordx4 v9, s[16:19], s82 offen sc1 lds
    v_cvt_pk_bf16_f32 v130, v88, v89
    v_cvt_pk_bf16_f32 v131, v90, v91
    v_exp_f32 v92, v28
    v_exp_f32 v93, v29
    v_exp_f32 v94, v30
    v_exp_f32 v95, v31
    v_mfma_f32_32x32x8bf16_1k v[40:55], v[112:113], v[100:101], v[40:55]
    ds_read_b128 v[122:125], v8 offset:3840
    v_cvt_pk_bf16_f32 v132, v92, v93
    v_cvt_pk_bf16_f32 v133, v94, v95
    v_exp_f32 v88, v32
    v_exp_f32 v89, v33
    v_exp_f32 v90, v34
    v_exp_f32 v91, v35
    v_mfma_f32_32x32x16_bf16 v[56:71], v[114:117], v[130:133], v[56:71]
    ds_read_b128 v[126:129], v8 offset:4480
    buffer_load_dword v10, s[16:19], s82 offen offset:1024 sc1 lds
    s_add_u32 s82, s82, 5120
    v_cvt_pk_bf16_f32 v134, v88, v89
    v_cvt_pk_bf16_f32 v135, v90, v91
    v_exp_f32 v92, v36
    v_exp_f32 v93, v37
    v_exp_f32 v94, v38
    v_exp_f32 v95, v39
    s_waitcnt lgkmcnt(1)
    v_mfma_f32_32x32x16_bf16 v[24:39], v[102:105], v[96:99], 0
    ds_read_b128 v[108:111], v4 offset:1280
    v_cvt_pk_bf16_f32 v136, v92, v93
    v_cvt_pk_bf16_f32 v137, v94, v95
    v_exp_f32 v88, v40
    v_exp_f32 v89, v41
    v_exp_f32 v90, v42
    v_exp_f32 v91, v43
    v_mfma_f32_32x32x16_bf16 v[56:71], v[118:121], v[134:137], v[56:71]
    ds_read_b64 v[112:113], v5 offset:1280
    v_xor_b32 v2, 0, v143
    ds_read_b64_tr_b16 v[236:237], v2 offset:0
    ds_read_b64_tr_b16 v[238:239], v2 offset:512
    v_cvt_pk_bf16_f32 v130, v88, v89
    v_cvt_pk_bf16_f32 v131, v90, v91
    v_exp_f32 v92, v44
    v_exp_f32 v93, v45
    v_exp_f32 v94, v46
    v_exp_f32 v95, v47
    v_mfma_f32_32x32x8bf16_1k v[24:39], v[106:107], v[100:101], v[24:39]
    ds_read_b128 v[114:117], v6 offset:0
    v_cvt_pk_bf16_f32 v132, v92, v93
    v_cvt_pk_bf16_f32 v133, v94, v95
    v_exp_f32 v88, v48
    v_exp_f32 v89, v49
    v_exp_f32 v90, v50
    v_exp_f32 v91, v51
    v_mfma_f32_32x32x16_bf16 v[56:71], v[122:125], v[130:133], v[56:71]
    ds_read_b128 v[118:121], v6 offset:640
    v_xor_b32 v2, 32, v143
    ds_read_b64_tr_b16 v[240:241], v2 offset:0
    ds_read_b64_tr_b16 v[242:243], v2 offset:512
    v_cvt_pk_bf16_f32 v134, v88, v89
    v_cvt_pk_bf16_f32 v135, v90, v91
    v_exp_f32 v92, v52
    v_exp_f32 v93, v53
    v_exp_f32 v94, v54
    v_exp_f32 v95, v55
    s_waitcnt lgkmcnt(3)
    v_mfma_f32_32x32x16_bf16 v[40:55], v[108:111], v[96:99], 0
    ds_read_b128 v[102:105], v4 offset:2560
    v_cvt_pk_bf16_f32 v136, v92, v93
    v_cvt_pk_bf16_f32 v137, v94, v95
    v_exp_f32 v88, v24
    v_exp_f32 v89, v25
    v_exp_f32 v90, v26
    v_exp_f32 v91, v27
    v_mfma_f32_32x32x16_bf16 v[56:71], v[126:129], v[134:137], v[56:71]
    ds_read_b64 v[106:107], v5 offset:2560
    v_xor_b32 v2, 64, v143
    ds_read_b64_tr_b16 v[244:245], v2 offset:0
    ds_read_b64_tr_b16 v[246:247], v2 offset:512
    v_cvt_pk_bf16_f32 v130, v88, v89
    v_cvt_pk_bf16_f32 v131, v90, v91
    v_exp_f32 v92, v28
    v_exp_f32 v93, v29
    v_exp_f32 v94, v30
    v_exp_f32 v95, v31
    v_mfma_f32_32x32x8bf16_1k v[40:55], v[112:113], v[100:101], v[40:55]
    ds_read_b128 v[122:125], v6 offset:1280
    v_cvt_pk_bf16_f32 v132, v92, v93
    v_cvt_pk_bf16_f32 v133, v94, v95
    v_exp_f32 v88, v32
    v_exp_f32 v89, v33
    v_exp_f32 v90, v34
    v_exp_f32 v91, v35
    v_mfma_f32_32x32x16_bf16 v[56:71], v[114:117], v[130:133], v[56:71]
    ds_read_b128 v[126:129], v6 offset:1920
    v_xor_b32 v2, 96, v143
    ds_read_b64_tr_b16 v[248:249], v2 offset:0
    ds_read_b64_tr_b16 v[250:251], v2 offset:512
    v_cvt_pk_bf16_f32 v134, v88, v89
    v_cvt_pk_bf16_f32 v135, v90, v91
    v_exp_f32 v92, v36
    v_exp_f32 v93, v37
    v_exp_f32 v94, v38
    v_exp_f32 v95, v39
    s_setprio 0
    s_waitcnt lgkmcnt(3)
    v_mfma_f32_32x32x16_bf16 v[24:39], v[102:105], v[96:99], 0
    ds_read_b128 v[108:111], v4 offset:3840
    v_cvt_pk_bf16_f32 v136, v92, v93
    v_cvt_pk_bf16_f32 v137, v94, v95
    v_exp_f32 v88, v40
    v_exp_f32 v89, v41
    v_exp_f32 v90, v42
    v_exp_f32 v91, v43
    v_mfma_f32_32x32x16_bf16 v[56:71], v[118:121], v[134:137], v[56:71]
    ds_read_b64 v[112:113], v5 offset:3840
    s_lshl_b32 s68, s81, 3
    s_add_u32 s68, s68, s36
    s_lshl_b32 s68, s68, 7
    s_add_u32 s68, s68, 32768
    v_and_b32 v1, 31, v0
    v_lshlrev_b32 v1, 2, v1
    buffer_load_dword v138, v1, s[16:19], s68 offen sc1
    v_cvt_pk_bf16_f32 v130, v88, v89
    v_cvt_pk_bf16_f32 v131, v90, v91
    v_exp_f32 v92, v44
    v_exp_f32 v93, v45
    v_exp_f32 v94, v46
    v_exp_f32 v95, v47
    v_mfma_f32_32x32x8bf16_1k v[24:39], v[106:107], v[100:101], v[24:39]
    ds_read_b128 v[114:117], v6 offset:2560
    v_cvt_pk_bf16_f32 v132, v92, v93
    v_cvt_pk_bf16_f32 v133, v94, v95
    v_exp_f32 v88, v48
    v_exp_f32 v89, v49
    v_exp_f32 v90, v50
    v_exp_f32 v91, v51
    v_mfma_f32_32x32x16_bf16 v[56:71], v[122:125], v[130:133], v[56:71]
    ds_read_b128 v[118:121], v6 offset:3200
    s_lshl_b32 s68, s80, 1
    s_add_u32 s68, s68, s97
    s_lshl_b32 s68, s68, 7
    s_add_u32 s68, s68, 32768
    s_lshl_b32 s69, s38, 6
    v_and_b32 v1, 48, v0
    v_or_b32 v1, s69, v1
    buffer_load_dwordx4 v[14:17], v1, s[16:19], s68 offen sc1
    v_xor_b32 v1, 64, v1
    buffer_load_dwordx4 v[18:21], v1, s[16:19], s68 offen sc1
    v_cvt_pk_bf16_f32 v134, v88, v89
    v_cvt_pk_bf16_f32 v135, v90, v91
    v_exp_f32 v92, v52
    v_exp_f32 v93, v53
    v_exp_f32 v94, v54
    v_exp_f32 v95, v55
    s_waitcnt vmcnt(3)
    s_barrier
    s_setprio 2
    s_waitcnt lgkmcnt(1)
    v_mfma_f32_32x32x16_bf16 v[40:55], v[108:111], v[96:99], 0
    ds_read_b128 v[102:105], v4 offset:10240
    v_cvt_pk_bf16_f32 v136, v92, v93
    v_cvt_pk_bf16_f32 v137, v94, v95
    v_exp_f32 v88, v24
    v_exp_f32 v89, v25
    v_exp_f32 v90, v26
    v_exp_f32 v91, v27
    v_mfma_f32_32x32x16_bf16 v[56:71], v[126:129], v[134:137], v[56:71]
    s_add_u32 m0, s83, 20480
    ds_read_b64 v[106:107], v139 offset:0
    buffer_load_dwordx4 v9, s[16:19], s82 offen sc1 lds
    v_cvt_pk_bf16_f32 v130, v88, v89
    v_cvt_pk_bf16_f32 v131, v90, v91
    v_exp_f32 v92, v28
    v_exp_f32 v93, v29
    v_exp_f32 v94, v30
    v_exp_f32 v95, v31
    v_mfma_f32_32x32x8bf16_1k v[40:55], v[112:113], v[100:101], v[40:55]
    ds_read_b128 v[122:125], v6 offset:3840
    v_cvt_pk_bf16_f32 v132, v92, v93
    v_cvt_pk_bf16_f32 v133, v94, v95
    v_exp_f32 v88, v32
    v_exp_f32 v89, v33
    v_exp_f32 v90, v34
    v_exp_f32 v91, v35
    v_mfma_f32_32x32x16_bf16 v[56:71], v[114:117], v[130:133], v[56:71]
    ds_read_b128 v[126:129], v6 offset:4480
    buffer_load_dword v10, s[16:19], s82 offen offset:1024 sc1 lds
    s_add_u32 s82, s82, 5120
    v_cvt_pk_bf16_f32 v134, v88, v89
    v_cvt_pk_bf16_f32 v135, v90, v91
    v_exp_f32 v92, v36
    v_exp_f32 v93, v37
    v_exp_f32 v94, v38
    v_exp_f32 v95, v39
    s_waitcnt lgkmcnt(1)
    v_mfma_f32_32x32x16_bf16 v[24:39], v[102:105], v[96:99], 0
    ds_read_b128 v[108:111], v4 offset:11520
    v_cvt_pk_bf16_f32 v136, v92, v93
    v_cvt_pk_bf16_f32 v137, v94, v95
    v_exp_f32 v88, v40
    v_exp_f32 v89, v41
    v_exp_f32 v90, v42
    v_exp_f32 v91, v43
    v_mfma_f32_32x32x16_bf16 v[56:71], v[118:121], v[134:137], v[56:71]
    ds_read_b64 v[112:113], v139 offset:1280
    buffer_store_dwordx4 v[236:239], v9, s[16:19], s73 offen sc1
    v_cvt_pk_bf16_f32 v130, v88, v89
    v_cvt_pk_bf16_f32 v131, v90, v91
    v_exp_f32 v92, v44
    v_exp_f32 v93, v45
    v_exp_f32 v94, v46
    v_exp_f32 v95, v47
    v_mfma_f32_32x32x8bf16_1k v[24:39], v[106:107], v[100:101], v[24:39]
    ds_read_b128 v[114:117], v7 offset:0
    v_cvt_pk_bf16_f32 v132, v92, v93
    v_cvt_pk_bf16_f32 v133, v94, v95
    v_exp_f32 v88, v48
    v_exp_f32 v89, v49
    v_exp_f32 v90, v50
    v_exp_f32 v91, v51
    v_mfma_f32_32x32x16_bf16 v[56:71], v[122:125], v[130:133], v[56:71]
    ds_read_b128 v[118:121], v7 offset:640
    buffer_store_dwordx4 v[240:243], v9, s[16:19], s74 offen sc1
    v_cvt_pk_bf16_f32 v134, v88, v89
    v_cvt_pk_bf16_f32 v135, v90, v91
    v_exp_f32 v92, v52
    v_exp_f32 v93, v53
    v_exp_f32 v94, v54
    v_exp_f32 v95, v55
    s_waitcnt lgkmcnt(1)
    v_mfma_f32_32x32x16_bf16 v[40:55], v[108:111], v[96:99], 0
    ds_read_b128 v[102:105], v4 offset:12800
    v_cvt_pk_bf16_f32 v136, v92, v93
    v_cvt_pk_bf16_f32 v137, v94, v95
    v_exp_f32 v88, v24
    v_exp_f32 v89, v25
    v_exp_f32 v90, v26
    v_exp_f32 v91, v27
    v_mfma_f32_32x32x16_bf16 v[56:71], v[126:129], v[134:137], v[56:71]
    ds_read_b64 v[106:107], v139 offset:2560
    buffer_store_dwordx4 v[244:247], v9, s[16:19], s76 offen sc1
    v_cvt_pk_bf16_f32 v130, v88, v89
    v_cvt_pk_bf16_f32 v131, v90, v91
    v_exp_f32 v92, v28
    v_exp_f32 v93, v29
    v_exp_f32 v94, v30
    v_exp_f32 v95, v31
    v_mfma_f32_32x32x8bf16_1k v[40:55], v[112:113], v[100:101], v[40:55]
    ds_read_b128 v[122:125], v7 offset:1280
    v_cvt_pk_bf16_f32 v132, v92, v93
    v_cvt_pk_bf16_f32 v133, v94, v95
    v_exp_f32 v88, v32
    v_exp_f32 v89, v33
    v_exp_f32 v90, v34
    v_exp_f32 v91, v35
    v_mfma_f32_32x32x16_bf16 v[56:71], v[114:117], v[130:133], v[56:71]
    ds_read_b128 v[126:129], v7 offset:1920
    buffer_store_dwordx4 v[248:251], v9, s[16:19], s77 offen sc1
    v_cvt_pk_bf16_f32 v134, v88, v89
    v_cvt_pk_bf16_f32 v135, v90, v91
    v_exp_f32 v92, v36
    v_exp_f32 v93, v37
    v_exp_f32 v94, v38
    v_exp_f32 v95, v39
    s_setprio 0
    s_waitcnt lgkmcnt(1)
    v_mfma_f32_32x32x16_bf16 v[24:39], v[102:105], v[96:99], 0
    ds_read_b128 v[108:111], v4 offset:14080
    v_cvt_pk_bf16_f32 v136, v92, v93
    v_cvt_pk_bf16_f32 v137, v94, v95
    v_exp_f32 v88, v40
    v_exp_f32 v89, v41
    v_exp_f32 v90, v42
    v_exp_f32 v91, v43
    v_mfma_f32_32x32x16_bf16 v[56:71], v[118:121], v[134:137], v[56:71]
    ds_read_b64 v[112:113], v139 offset:3840
    buffer_load_dwordx4 v[144:147], v9, s[16:19], s86 offen sc1
    v_cvt_pk_bf16_f32 v130, v88, v89
    v_cvt_pk_bf16_f32 v131, v90, v91
    v_exp_f32 v92, v44
    v_exp_f32 v93, v45
    v_exp_f32 v94, v46
    v_exp_f32 v95, v47
    v_mfma_f32_32x32x8bf16_1k v[24:39], v[106:107], v[100:101], v[24:39]
    ds_read_b128 v[114:117], v7 offset:2560
    v_cvt_pk_bf16_f32 v132, v92, v93
    v_cvt_pk_bf16_f32 v133, v94, v95
    v_exp_f32 v88, v48
    v_exp_f32 v89, v49
    v_exp_f32 v90, v50
    v_exp_f32 v91, v51
    v_mfma_f32_32x32x16_bf16 v[56:71], v[122:125], v[130:133], v[56:71]
    ds_read_b128 v[118:121], v7 offset:3200
    buffer_load_dwordx4 v[148:151], v9, s[16:19], s98 offen sc1
    v_cvt_pk_bf16_f32 v134, v88, v89
    v_cvt_pk_bf16_f32 v135, v90, v91
    v_exp_f32 v92, v52
    v_exp_f32 v93, v53
    v_exp_f32 v94, v54
    v_exp_f32 v95, v55
    s_waitcnt vmcnt(6)
    s_waitcnt vmcnt(2)
    s_barrier
    s_setprio 2
    s_waitcnt lgkmcnt(1)
    v_mfma_f32_32x32x16_bf16 v[40:55], v[108:111], v[96:99], 0
    ds_read_b128 v[102:105], v4 offset:20480
    v_cvt_pk_bf16_f32 v136, v92, v93
    v_cvt_pk_bf16_f32 v137, v94, v95
    v_exp_f32 v88, v24
    v_exp_f32 v89, v25
    v_exp_f32 v90, v26
    v_exp_f32 v91, v27
    v_mfma_f32_32x32x16_bf16 v[56:71], v[126:129], v[134:137], v[56:71]
    s_add_u32 m0, s83, 0
    ds_read_b64 v[106:107], v140 offset:0
    buffer_load_dwordx4 v9, s[16:19], s82 offen sc1 lds
    v_cvt_pk_bf16_f32 v130, v88, v89
    v_cvt_pk_bf16_f32 v131, v90, v91
    v_exp_f32 v92, v28
    v_exp_f32 v93, v29
    v_exp_f32 v94, v30
    v_exp_f32 v95, v31
    v_mfma_f32_32x32x8bf16_1k v[40:55], v[112:113], v[100:101], v[40:55]
    ds_read_b128 v[122:125], v7 offset:3840
    v_cvt_pk_bf16_f32 v132, v92, v93
    v_cvt_pk_bf16_f32 v133, v94, v95
    v_exp_f32 v88, v32
    v_exp_f32 v89, v33
    v_exp_f32 v90, v34
    v_exp_f32 v91, v35
    v_mfma_f32_32x32x16_bf16 v[56:71], v[114:117], v[130:133], v[56:71]
    ds_read_b128 v[126:129], v7 offset:4480
    buffer_load_dword v10, s[16:19], s82 offen offset:1024 sc1 lds
    s_add_u32 s82, s82, 5120
    v_cvt_pk_bf16_f32 v134, v88, v89
    v_cvt_pk_bf16_f32 v135, v90, v91
    v_exp_f32 v92, v36
    v_exp_f32 v93, v37
    v_exp_f32 v94, v38
    v_exp_f32 v95, v39
    s_waitcnt lgkmcnt(1)
    v_mfma_f32_32x32x16_bf16 v[24:39], v[102:105], v[96:99], 0
    ds_read_b128 v[108:111], v4 offset:21760
    v_cvt_pk_bf16_f32 v136, v92, v93
    v_cvt_pk_bf16_f32 v137, v94, v95
    v_exp_f32 v88, v40
    v_exp_f32 v89, v41
    v_exp_f32 v90, v42
    v_exp_f32 v91, v43
    v_mfma_f32_32x32x16_bf16 v[56:71], v[118:121], v[134:137], v[56:71]
    ds_read_b64 v[112:113], v140 offset:1280
    v_mov_b32 v1, 3
    buffer_store_dword v1, v11, s[16:19], 0 offen sc1
    v_cvt_pk_bf16_f32 v130, v88, v89
    v_cvt_pk_bf16_f32 v131, v90, v91
    v_exp_f32 v92, v44
    v_exp_f32 v93, v45
    v_exp_f32 v94, v46
    v_exp_f32 v95, v47
    v_mfma_f32_32x32x8bf16_1k v[24:39], v[106:107], v[100:101], v[24:39]
    ds_read_b128 v[114:117], v8 offset:0
    v_cvt_pk_bf16_f32 v132, v92, v93
    v_cvt_pk_bf16_f32 v133, v94, v95
    v_exp_f32 v88, v48
    v_exp_f32 v89, v49
    v_exp_f32 v90, v50
    v_exp_f32 v91, v51
    v_mfma_f32_32x32x16_bf16 v[56:71], v[122:125], v[130:133], v[56:71]
    ds_read_b128 v[118:121], v8 offset:640
    buffer_load_dwordx4 v[152:155], v9, s[16:19], s86 offen offset:1024 sc1
    v_cvt_pk_bf16_f32 v134, v88, v89
    v_cvt_pk_bf16_f32 v135, v90, v91
    v_exp_f32 v92, v52
    v_exp_f32 v93, v53
    v_exp_f32 v94, v54
    v_exp_f32 v95, v55
    s_waitcnt lgkmcnt(1)
    v_mfma_f32_32x32x16_bf16 v[40:55], v[108:111], v[96:99], 0
    ds_read_b128 v[102:105], v4 offset:23040
    v_cvt_pk_bf16_f32 v136, v92, v93
    v_cvt_pk_bf16_f32 v137, v94, v95
    v_exp_f32 v88, v24
    v_exp_f32 v89, v25
    v_exp_f32 v90, v26
    v_exp_f32 v91, v27
    v_mfma_f32_32x32x16_bf16 v[56:71], v[126:129], v[134:137], v[56:71]
    ds_read_b64 v[106:107], v140 offset:2560
    buffer_load_dwordx4 v[156:159], v9, s[16:19], s98 offen offset:1024 sc1
    v_cvt_pk_bf16_f32 v130, v88, v89
    v_cvt_pk_bf16_f32 v131, v90, v91
    v_exp_f32 v92, v28
    v_exp_f32 v93, v29
    v_exp_f32 v94, v30
    v_exp_f32 v95, v31
    v_mfma_f32_32x32x8bf16_1k v[40:55], v[112:113], v[100:101], v[40:55]
    ds_read_b128 v[122:125], v8 offset:1280
    v_cvt_pk_bf16_f32 v132, v92, v93
    v_cvt_pk_bf16_f32 v133, v94, v95
    v_exp_f32 v88, v32
    v_exp_f32 v89, v33
    v_exp_f32 v90, v34
    v_exp_f32 v91, v35
    v_mfma_f32_32x32x16_bf16 v[56:71], v[114:117], v[130:133], v[56:71]
    ds_read_b128 v[126:129], v8 offset:1920
    buffer_load_dwordx4 v[160:163], v9, s[16:19], s86 offen offset:2048 sc1
    v_cvt_pk_bf16_f32 v134, v88, v89
    v_cvt_pk_bf16_f32 v135, v90, v91
    v_exp_f32 v92, v36
    v_exp_f32 v93, v37
    v_exp_f32 v94, v38
    v_exp_f32 v95, v39
    s_setprio 0
    s_waitcnt lgkmcnt(1)
    v_mfma_f32_32x32x16_bf16 v[24:39], v[102:105], v[96:99], 0
    ds_read_b128 v[108:111], v4 offset:24320
    v_cvt_pk_bf16_f32 v136, v92, v93
    v_cvt_pk_bf16_f32 v137, v94, v95
    v_exp_f32 v88, v40
    v_exp_f32 v89, v41
    v_exp_f32 v90, v42
    v_exp_f32 v91, v43
    v_mfma_f32_32x32x16_bf16 v[56:71], v[118:121], v[134:137], v[56:71]
    ds_read_b64 v[112:113], v140 offset:3840
    buffer_load_dwordx4 v[164:167], v9, s[16:19], s98 offen offset:2048 sc1
    v_cvt_pk_bf16_f32 v130, v88, v89
    v_cvt_pk_bf16_f32 v131, v90, v91
    v_exp_f32 v92, v44
    v_exp_f32 v93, v45
    v_exp_f32 v94, v46
    v_exp_f32 v95, v47
    v_mfma_f32_32x32x8bf16_1k v[24:39], v[106:107], v[100:101], v[24:39]
    ds_read_b128 v[114:117], v8 offset:2560
    v_cvt_pk_bf16_f32 v132, v92, v93
    v_cvt_pk_bf16_f32 v133, v94, v95
    v_exp_f32 v88, v48
    v_exp_f32 v89, v49
    v_exp_f32 v90, v50
    v_exp_f32 v91, v51
    v_mfma_f32_32x32x16_bf16 v[56:71], v[122:125], v[130:133], v[56:71]
    ds_read_b128 v[118:121], v8 offset:3200
    buffer_load_dwordx4 v[168:171], v9, s[16:19], s86 offen offset:3072 sc1
    s_add_u32 s86, s86, 4096
    v_cvt_pk_bf16_f32 v134, v88, v89
    v_cvt_pk_bf16_f32 v135, v90, v91
    v_exp_f32 v92, v52
    v_exp_f32 v93, v53
    v_exp_f32 v94, v54
    v_exp_f32 v95, v55
    s_waitcnt vmcnt(6)
    s_barrier
    s_setprio 2
    s_waitcnt lgkmcnt(1)
    v_mfma_f32_32x32x16_bf16 v[40:55], v[108:111], v[96:99], 0
    ds_read_b128 v[102:105], v4 offset:0
    v_cvt_pk_bf16_f32 v136, v92, v93
    v_cvt_pk_bf16_f32 v137, v94, v95
    v_exp_f32 v88, v24
    v_exp_f32 v89, v25
    v_exp_f32 v90, v26
    v_exp_f32 v91, v27
    v_mfma_f32_32x32x16_bf16 v[56:71], v[126:129], v[134:137], v[56:71]
    s_add_u32 m0, s83, 10240
    ds_read_b64 v[106:107], v5 offset:0
    buffer_load_dwordx4 v9, s[16:19], s82 offen sc1 lds
    v_cvt_pk_bf16_f32 v130, v88, v89
    v_cvt_pk_bf16_f32 v131, v90, v91
    v_exp_f32 v92, v28
    v_exp_f32 v93, v29
    v_exp_f32 v94, v30
    v_exp_f32 v95, v31
    v_mfma_f32_32x32x8bf16_1k v[40:55], v[112:113], v[100:101], v[40:55]
    ds_read_b128 v[122:125], v8 offset:3840
    v_cvt_pk_bf16_f32 v132, v92, v93
    v_cvt_pk_bf16_f32 v133, v94, v95
    v_exp_f32 v88, v32
    v_exp_f32 v89, v33
    v_exp_f32 v90, v34
    v_exp_f32 v91, v35
    v_mfma_f32_32x32x16_bf16 v[56:71], v[114:117], v[130:133], v[56:71]
    ds_read_b128 v[126:129], v8 offset:4480
    buffer_load_dword v10, s[16:19], s82 offen offset:1024 sc1 lds
    s_add_u32 s82, s82, 5120
    v_cvt_pk_bf16_f32 v134, v88, v89
    v_cvt_pk_bf16_f32 v135, v90, v91
    v_exp_f32 v92, v36
    v_exp_f32 v93, v37
    v_exp_f32 v94, v38
    v_exp_f32 v95, v39
    s_waitcnt lgkmcnt(1)
    v_mfma_f32_32x32x16_bf16 v[24:39], v[102:105], v[96:99], 0
    ds_read_b128 v[108:111], v4 offset:1280
    v_cvt_pk_bf16_f32 v136, v92, v93
    v_cvt_pk_bf16_f32 v137, v94, v95
    v_exp_f32 v88, v40
    v_exp_f32 v89, v41
    v_exp_f32 v90, v42
    v_exp_f32 v91, v43
    v_mfma_f32_32x32x16_bf16 v[56:71], v[118:121], v[134:137], v[56:71]
    ds_read_b64 v[112:113], v5 offset:1280
    buffer_load_dwordx4 v[172:175], v9, s[16:19], s98 offen offset:3072 sc1
    s_add_u32 s98, s98, 4096
    v_cvt_pk_bf16_f32 v130, v88, v89
    v_cvt_pk_bf16_f32 v131, v90, v91
    v_exp_f32 v92, v44
    v_exp_f32 v93, v45
    v_exp_f32 v94, v46
    v_exp_f32 v95, v47
    v_mfma_f32_32x32x8bf16_1k v[24:39], v[106:107], v[100:101], v[24:39]
    ds_read_b128 v[114:117], v6 offset:0
    v_cvt_pk_bf16_f32 v132, v92, v93
    v_cvt_pk_bf16_f32 v133, v94, v95
    v_exp_f32 v88, v48
    v_exp_f32 v89, v49
    v_exp_f32 v90, v50
    v_exp_f32 v91, v51
    v_mfma_f32_32x32x16_bf16 v[56:71], v[122:125], v[130:133], v[56:71]
    ds_read_b128 v[118:121], v6 offset:640
    buffer_load_dwordx4 v[176:179], v9, s[16:19], s86 offen sc1
    v_cvt_pk_bf16_f32 v134, v88, v89
    v_cvt_pk_bf16_f32 v135, v90, v91
    v_exp_f32 v92, v52
    v_exp_f32 v93, v53
    v_exp_f32 v94, v54
    v_exp_f32 v95, v55
    s_waitcnt lgkmcnt(1)
    v_mfma_f32_32x32x16_bf16 v[40:55], v[108:111], v[96:99], 0
    ds_read_b128 v[102:105], v4 offset:2560
    v_cvt_pk_bf16_f32 v136, v92, v93
    v_cvt_pk_bf16_f32 v137, v94, v95
    v_exp_f32 v88, v24
    v_exp_f32 v89, v25
    v_exp_f32 v90, v26
    v_exp_f32 v91, v27
    v_mfma_f32_32x32x16_bf16 v[56:71], v[126:129], v[134:137], v[56:71]
    ds_read_b64 v[106:107], v5 offset:2560
    buffer_load_dwordx4 v[180:183], v9, s[16:19], s98 offen sc1
    v_cvt_pk_bf16_f32 v130, v88, v89
    v_cvt_pk_bf16_f32 v131, v90, v91
    v_exp_f32 v92, v28
    v_exp_f32 v93, v29
    v_exp_f32 v94, v30
    v_exp_f32 v95, v31
    v_mfma_f32_32x32x8bf16_1k v[40:55], v[112:113], v[100:101], v[40:55]
    ds_read_b128 v[122:125], v6 offset:1280
    v_cvt_pk_bf16_f32 v132, v92, v93
    v_cvt_pk_bf16_f32 v133, v94, v95
    v_exp_f32 v88, v32
    v_exp_f32 v89, v33
    v_exp_f32 v90, v34
    v_exp_f32 v91, v35
    v_mfma_f32_32x32x16_bf16 v[56:71], v[114:117], v[130:133], v[56:71]
    ds_read_b128 v[126:129], v6 offset:1920
    buffer_load_dwordx4 v[184:187], v9, s[16:19], s86 offen offset:1024 sc1
    v_cvt_pk_bf16_f32 v134, v88, v89
    v_cvt_pk_bf16_f32 v135, v90, v91
    v_exp_f32 v92, v36
    v_exp_f32 v93, v37
    v_exp_f32 v94, v38
    v_exp_f32 v95, v39
    s_setprio 0
    s_waitcnt lgkmcnt(1)
    v_mfma_f32_32x32x16_bf16 v[24:39], v[102:105], v[96:99], 0
    ds_read_b128 v[108:111], v4 offset:3840
    v_cvt_pk_bf16_f32 v136, v92, v93
    v_cvt_pk_bf16_f32 v137, v94, v95
    v_exp_f32 v88, v40
    v_exp_f32 v89, v41
    v_exp_f32 v90, v42
    v_exp_f32 v91, v43
    v_mfma_f32_32x32x16_bf16 v[56:71], v[118:121], v[134:137], v[56:71]
    ds_read_b64 v[112:113], v5 offset:3840
    buffer_load_dwordx4 v[188:191], v9, s[16:19], s98 offen offset:1024 sc1
    v_cvt_pk_bf16_f32 v130, v88, v89
    v_cvt_pk_bf16_f32 v131, v90, v91
    v_exp_f32 v92, v44
    v_exp_f32 v93, v45
    v_exp_f32 v94, v46
    v_exp_f32 v95, v47
    v_mfma_f32_32x32x8bf16_1k v[24:39], v[106:107], v[100:101], v[24:39]
    ds_read_b128 v[114:117], v6 offset:2560
    v_cvt_pk_bf16_f32 v132, v92, v93
    v_cvt_pk_bf16_f32 v133, v94, v95
    v_exp_f32 v88, v48
    v_exp_f32 v89, v49
    v_exp_f32 v90, v50
    v_exp_f32 v91, v51
    v_mfma_f32_32x32x16_bf16 v[56:71], v[122:125], v[130:133], v[56:71]
    ds_read_b128 v[118:121], v6 offset:3200
    buffer_load_dwordx4 v[192:195], v9, s[16:19], s86 offen offset:2048 sc1
    v_cvt_pk_bf16_f32 v134, v88, v89
    v_cvt_pk_bf16_f32 v135, v90, v91
    v_exp_f32 v92, v52
    v_exp_f32 v93, v53
    v_exp_f32 v94, v54
    v_exp_f32 v95, v55
    s_waitcnt vmcnt(6)
    s_barrier
    s_setprio 2
    s_waitcnt lgkmcnt(1)
    v_mfma_f32_32x32x16_bf16 v[40:55], v[108:111], v[96:99], 0
    ds_read_b128 v[102:105], v4 offset:10240
    v_cvt_pk_bf16_f32 v136, v92, v93
    v_cvt_pk_bf16_f32 v137, v94, v95
    v_exp_f32 v88, v24
    v_exp_f32 v89, v25
    v_exp_f32 v90, v26
    v_exp_f32 v91, v27
    v_mfma_f32_32x32x16_bf16 v[56:71], v[126:129], v[134:137], v[56:71]
    s_add_u32 m0, s83, 20480
    ds_read_b64 v[106:107], v139 offset:0
    buffer_load_dwordx4 v9, s[16:19], s82 offen sc1 lds
    v_cvt_pk_bf16_f32 v130, v88, v89
    v_cvt_pk_bf16_f32 v131, v90, v91
    v_exp_f32 v92, v28
    v_exp_f32 v93, v29
    v_exp_f32 v94, v30
    v_exp_f32 v95, v31
    v_mfma_f32_32x32x8bf16_1k v[40:55], v[112:113], v[100:101], v[40:55]
    ds_read_b128 v[122:125], v6 offset:3840
    v_cvt_pk_bf16_f32 v132, v92, v93
    v_cvt_pk_bf16_f32 v133, v94, v95
    v_exp_f32 v88, v32
    v_exp_f32 v89, v33
    v_exp_f32 v90, v34
    v_exp_f32 v91, v35
    v_mfma_f32_32x32x16_bf16 v[56:71], v[114:117], v[130:133], v[56:71]
    ds_read_b128 v[126:129], v6 offset:4480
    buffer_load_dword v10, s[16:19], s82 offen offset:1024 sc1 lds
    s_add_u32 s82, s82, 5120
    v_cvt_pk_bf16_f32 v134, v88, v89
    v_cvt_pk_bf16_f32 v135, v90, v91
    v_exp_f32 v92, v36
    v_exp_f32 v93, v37
    v_exp_f32 v94, v38
    v_exp_f32 v95, v39
    s_waitcnt lgkmcnt(1)
    v_mfma_f32_32x32x16_bf16 v[24:39], v[102:105], v[96:99], 0
    ds_read_b128 v[108:111], v4 offset:11520
    v_cvt_pk_bf16_f32 v136, v92, v93
    v_cvt_pk_bf16_f32 v137, v94, v95
    v_exp_f32 v88, v40
    v_exp_f32 v89, v41
    v_exp_f32 v90, v42
    v_exp_f32 v91, v43
    v_mfma_f32_32x32x16_bf16 v[56:71], v[118:121], v[134:137], v[56:71]
    ds_read_b64 v[112:113], v139 offset:1280
    buffer_load_dword v22, v12, s[16:19], 0 offen sc1
    v_cvt_pk_bf16_f32 v130, v88, v89
    v_cvt_pk_bf16_f32 v131, v90, v91
    v_exp_f32 v92, v44
    v_exp_f32 v93, v45
    v_exp_f32 v94, v46
    v_exp_f32 v95, v47
    v_mfma_f32_32x32x8bf16_1k v[24:39], v[106:107], v[100:101], v[24:39]
    ds_read_b128 v[114:117], v7 offset:0
    v_cvt_pk_bf16_f32 v132, v92, v93
    v_cvt_pk_bf16_f32 v133, v94, v95
    v_exp_f32 v88, v48
    v_exp_f32 v89, v49
    v_exp_f32 v90, v50
    v_exp_f32 v91, v51
    v_mfma_f32_32x32x16_bf16 v[56:71], v[122:125], v[130:133], v[56:71]
    ds_read_b128 v[118:121], v7 offset:640
    buffer_load_dwordx4 v[196:199], v9, s[16:19], s98 offen offset:2048 sc1
    v_cvt_pk_bf16_f32 v134, v88, v89
    v_cvt_pk_bf16_f32 v135, v90, v91
    v_exp_f32 v92, v52
    v_exp_f32 v93, v53
    v_exp_f32 v94, v54
    v_exp_f32 v95, v55
    s_waitcnt lgkmcnt(1)
    v_mfma_f32_32x32x16_bf16 v[40:55], v[108:111], v[96:99], 0
    ds_read_b128 v[102:105], v4 offset:12800
    v_cvt_pk_bf16_f32 v136, v92, v93
    v_cvt_pk_bf16_f32 v137, v94, v95
    v_exp_f32 v88, v24
    v_exp_f32 v89, v25
    v_exp_f32 v90, v26
    v_exp_f32 v91, v27
    v_mfma_f32_32x32x16_bf16 v[56:71], v[126:129], v[134:137], v[56:71]
    ds_read_b64 v[106:107], v139 offset:2560
    buffer_load_dwordx4 v[200:203], v9, s[16:19], s86 offen offset:3072 sc1
    s_add_u32 s86, s86, 4096
    v_cvt_pk_bf16_f32 v130, v88, v89
    v_cvt_pk_bf16_f32 v131, v90, v91
    v_exp_f32 v92, v28
    v_exp_f32 v93, v29
    v_exp_f32 v94, v30
    v_exp_f32 v95, v31
    v_mfma_f32_32x32x8bf16_1k v[40:55], v[112:113], v[100:101], v[40:55]
    ds_read_b128 v[122:125], v7 offset:1280
    v_cvt_pk_bf16_f32 v132, v92, v93
    v_cvt_pk_bf16_f32 v133, v94, v95
    v_exp_f32 v88, v32
    v_exp_f32 v89, v33
    v_exp_f32 v90, v34
    v_exp_f32 v91, v35
    v_mfma_f32_32x32x16_bf16 v[56:71], v[114:117], v[130:133], v[56:71]
    ds_read_b128 v[126:129], v7 offset:1920
    buffer_load_dwordx4 v[204:207], v9, s[16:19], s98 offen offset:3072 sc1
    s_add_u32 s98, s98, 4096
    v_cvt_pk_bf16_f32 v134, v88, v89
    v_cvt_pk_bf16_f32 v135, v90, v91
    v_exp_f32 v92, v36
    v_exp_f32 v93, v37
    v_exp_f32 v94, v38
    v_exp_f32 v95, v39
    s_setprio 0
    s_waitcnt lgkmcnt(1)
    v_mfma_f32_32x32x16_bf16 v[24:39], v[102:105], v[96:99], 0
    ds_read_b128 v[108:111], v4 offset:14080
    v_cvt_pk_bf16_f32 v136, v92, v93
    v_cvt_pk_bf16_f32 v137, v94, v95
    v_exp_f32 v88, v40
    v_exp_f32 v89, v41
    v_exp_f32 v90, v42
    v_exp_f32 v91, v43
    v_mfma_f32_32x32x16_bf16 v[56:71], v[118:121], v[134:137], v[56:71]
    ds_read_b64 v[112:113], v139 offset:3840
    buffer_load_dwordx4 v[208:211], v9, s[16:19], s86 offen sc1
    v_cvt_pk_bf16_f32 v130, v88, v89
    v_cvt_pk_bf16_f32 v131, v90, v91
    v_exp_f32 v92, v44
    v_exp_f32 v93, v45
    v_exp_f32 v94, v46
    v_exp_f32 v95, v47
    v_mfma_f32_32x32x8bf16_1k v[24:39], v[106:107], v[100:101], v[24:39]
    ds_read_b128 v[114:117], v7 offset:2560
    v_cvt_pk_bf16_f32 v132, v92, v93
    v_cvt_pk_bf16_f32 v133, v94, v95
    v_exp_f32 v88, v48
    v_exp_f32 v89, v49
    v_exp_f32 v90, v50
    v_exp_f32 v91, v51
    v_mfma_f32_32x32x16_bf16 v[56:71], v[122:125], v[130:133], v[56:71]
    ds_read_b128 v[118:121], v7 offset:3200
    buffer_load_dwordx4 v[212:215], v9, s[16:19], s98 offen sc1
    v_cvt_pk_bf16_f32 v134, v88, v89
    v_cvt_pk_bf16_f32 v135, v90, v91
    v_exp_f32 v92, v52
    v_exp_f32 v93, v53
    v_exp_f32 v94, v54
    v_exp_f32 v95, v55
    s_waitcnt vmcnt(6)
    s_waitcnt vmcnt(5)
    s_mov_b32 s87, 40000
L_f3O_chk:
    v_cmp_gt_u32 vcc, 3, v22
    s_nop 1
    s_cbranch_vccz L_f3O_ok
    s_sub_u32 s87, s87, 1
    s_cbranch_scc1 L_f3O_ok
    buffer_load_dword v22, v12, s[16:19], 0 offen sc1
    s_waitcnt vmcnt(0)
    s_branch L_f3O_chk
L_f3O_ok:
    s_barrier
    s_setprio 2
    s_waitcnt lgkmcnt(1)
    v_mfma_f32_32x32x16_bf16 v[40:55], v[108:111], v[96:99], 0
    ds_read_b128 v[102:105], v4 offset:20480
    v_cvt_pk_bf16_f32 v136, v92, v93
    v_cvt_pk_bf16_f32 v137, v94, v95
    v_exp_f32 v88, v24
    v_exp_f32 v89, v25
    v_exp_f32 v90, v26
    v_exp_f32 v91, v27
    v_mfma_f32_32x32x16_bf16 v[56:71], v[126:129], v[134:137], v[56:71]
    s_add_u32 m0, s83, 0
    ds_read_b64 v[106:107], v140 offset:0
    buffer_load_dwordx4 v9, s[16:19], s82 offen sc1 lds
    v_cvt_pk_bf16_f32 v130, v88, v89
    v_cvt_pk_bf16_f32 v131, v90, v91
    v_exp_f32 v92, v28
    v_exp_f32 v93, v29
    v_exp_f32 v94, v30
    v_exp_f32 v95, v31
    v_mfma_f32_32x32x8bf16_1k v[40:55], v[112:113], v[100:101], v[40:55]
    ds_read_b128 v[122:125], v7 offset:3840
    v_cvt_pk_bf16_f32 v132, v92, v93
    v_cvt_pk_bf16_f32 v133, v94, v95
    v_exp_f32 v88, v32
    v_exp_f32 v89, v33
    v_exp_f32 v90, v34
    v_exp_f32 v91, v35
    v_mfma_f32_32x32x16_bf16 v[56:71], v[114:117], v[130:133], v[56:71]
    ds_read_b128 v[126:129], v7 offset:4480
    buffer_load_dword v10, s[16:19], s82 offen offset:1024 sc1 lds
    s_add_u32 s82, s82, 5120
    v_cvt_pk_bf16_f32 v134, v88, v89
    v_cvt_pk_bf16_f32 v135, v90, v91
    v_exp_f32 v92, v36
    v_exp_f32 v93, v37
    v_exp_f32 v94, v38
    v_exp_f32 v95, v39
    s_waitcnt lgkmcnt(1)
    v_mfma_f32_32x32x16_bf16 v[24:39], v[102:105], v[96:99], 0
    ds_read_b128 v[108:111], v4 offset:21760
    v_cvt_pk_bf16_f32 v136, v92, v93
    v_cvt_pk_bf16_f32 v137, v94, v95
    v_exp_f32 v88, v40
    v_exp_f32 v89, v41
    v_exp_f32 v90, v42
    v_exp_f32 v91, v43
    v_mfma_f32_32x32x16_bf16 v[56:71], v[118:121], v[134:137], v[56:71]
    s_add_u32 m0, s85, 0
    ds_read_b64 v[112:113], v140 offset:1280
    buffer_load_dwordx4 v9, s[16:19], s84 offen sc1 lds
    v_cvt_pk_bf16_f32 v130, v88, v89
    v_cvt_pk_bf16_f32 v131, v90, v91
    v_exp_f32 v92, v44
    v_exp_f32 v93, v45
    v_exp_f32 v94, v46
    v_exp_f32 v95, v47
    v_mfma_f32_32x32x8bf16_1k v[24:39], v[106:107], v[100:101], v[24:39]
    ds_read_b128 v[114:117], v8 offset:0
    v_cvt_pk_bf16_f32 v132, v92, v93
    v_cvt_pk_bf16_f32 v133, v94, v95
    v_exp_f32 v88, v48
    v_exp_f32 v89, v49
    v_exp_f32 v90, v50
    v_exp_f32 v91, v51
    v_mfma_f32_32x32x16_bf16 v[56:71], v[122:125], v[130:133], v[56:71]
    ds_read_b128 v[118:121], v8 offset:640
    buffer_load_dwordx4 v9, s[16:19], s84 offen offset:1024 sc1 lds
    v_cvt_pk_bf16_f32 v134, v88, v89
    v_cvt_pk_bf16_f32 v135, v90, v91
    v_exp_f32 v92, v52
    v_exp_f32 v93, v53
    v_exp_f32 v94, v54
    v_exp_f32 v95, v55
    s_waitcnt lgkmcnt(1)
    v_mfma_f32_32x32x16_bf16 v[40:55], v[108:111], v[96:99], 0
    ds_read_b128 v[102:105], v4 offset:23040
    v_cvt_pk_bf16_f32 v136, v92, v93
    v_cvt_pk_bf16_f32 v137, v94, v95
    v_exp_f32 v88, v24
    v_exp_f32 v89, v25
    v_exp_f32 v90, v26
    v_exp_f32 v91, v27
    v_mfma_f32_32x32x16_bf16 v[56:71], v[126:129], v[134:137], v[56:71]
    ds_read_b64 v[106:107], v140 offset:2560
    buffer_load_dwordx4 v9, s[16:19], s84 offen offset:2048 sc1 lds
    v_cvt_pk_bf16_f32 v130, v88, v89
    v_cvt_pk_bf16_f32 v131, v90, v91
    v_exp_f32 v92, v28
    v_exp_f32 v93, v29
    v_exp_f32 v94, v30
    v_exp_f32 v95, v31
    v_mfma_f32_32x32x8bf16_1k v[40:55], v[112:113], v[100:101], v[40:55]
    ds_read_b128 v[122:125], v8 offset:1280
    v_cvt_pk_bf16_f32 v132, v92, v93
    v_cvt_pk_bf16_f32 v133, v94, v95
    v_exp_f32 v88, v32
    v_exp_f32 v89, v33
    v_exp_f32 v90, v34
    v_exp_f32 v91, v35
    v_mfma_f32_32x32x16_bf16 v[56:71], v[114:117], v[130:133], v[56:71]
    ds_read_b128 v[126:129], v8 offset:1920
    buffer_load_dwordx4 v9, s[16:19], s84 offen offset:3072 sc1 lds
    v_cvt_pk_bf16_f32 v134, v88, v89
    v_cvt_pk_bf16_f32 v135, v90, v91
    v_exp_f32 v92, v36
    v_exp_f32 v93, v37
    v_exp_f32 v94, v38
    v_exp_f32 v95, v39
    s_setprio 0
    s_waitcnt lgkmcnt(1)
    v_mfma_f32_32x32x16_bf16 v[24:39], v[102:105], v[96:99], 0
    ds_read_b128 v[108:111], v4 offset:24320
    v_cvt_pk_bf16_f32 v136, v92, v93
    v_cvt_pk_bf16_f32 v137, v94, v95
    v_exp_f32 v88, v40
    v_exp_f32 v89, v41
    v_exp_f32 v90, v42
    v_exp_f32 v91, v43
    v_mfma_f32_32x32x16_bf16 v[56:71], v[118:121], v[134:137], v[56:71]
    s_add_u32 m0, s85, 4096
    ds_read_b64 v[112:113], v140 offset:3840
    s_add_u32 s68, s84, 4096
    buffer_load_dwordx4 v9, s[16:19], s68 offen sc1 lds
    s_add_u32 s84, s84, 10240
    v_cvt_pk_bf16_f32 v130, v88, v89
    v_cvt_pk_bf16_f32 v131, v90, v91
    v_exp_f32 v92, v44
    v_exp_f32 v93, v45
    v_exp_f32 v94, v46
    v_exp_f32 v95, v47
    v_mfma_f32_32x32x8bf16_1k v[24:39], v[106:107], v[100:101], v[24:39]
    ds_read_b128 v[114:117], v8 offset:2560
    v_cvt_pk_bf16_f32 v132, v92, v93
    v_cvt_pk_bf16_f32 v133, v94, v95
    v_exp_f32 v88, v48
    v_exp_f32 v89, v49
    v_exp_f32 v90, v50
    v_exp_f32 v91, v51
    v_mfma_f32_32x32x16_bf16 v[56:71], v[122:125], v[130:133], v[56:71]
    ds_read_b128 v[118:121], v8 offset:3200
    buffer_load_dwordx4 v[216:219], v9, s[16:19], s86 offen offset:1024 sc1
    v_cvt_pk_bf16_f32 v134, v88, v89
    v_cvt_pk_bf16_f32 v135, v90, v91
    v_exp_f32 v92, v52
    v_exp_f32 v93, v53
    v_exp_f32 v94, v54
    v_exp_f32 v95, v55
    s_waitcnt vmcnt(6)
    s_barrier
    s_setprio 2
    s_waitcnt lgkmcnt(1)
    v_mfma_f32_32x32x16_bf16 v[40:55], v[108:111], v[96:99], 0
    ds_read_b128 v[102:105], v4 offset:0
    v_cvt_pk_bf16_f32 v136, v92, v93
    v_cvt_pk_bf16_f32 v137, v94, v95
    v_exp_f32 v88, v24
    v_exp_f32 v89, v25
    v_exp_f32 v90, v26
    v_exp_f32 v91, v27
    v_mfma_f32_32x32x16_bf16 v[56:71], v[126:129], v[134:137], v[56:71]
    s_add_u32 m0, s83, 10240
    ds_read_b64 v[106:107], v5 offset:0
    buffer_load_dwordx4 v9, s[16:19], s82 offen sc1 lds
    v_cvt_pk_bf16_f32 v130, v88, v89
    v_cvt_pk_bf16_f32 v131, v90, v91
    v_exp_f32 v92, v28
    v_exp_f32 v93, v29
    v_exp_f32 v94, v30
    v_exp_f32 v95, v31
    v_mfma_f32_32x32x8bf16_1k v[40:55], v[112:113], v[100:101], v[40:55]
    ds_read_b128 v[122:125], v8 offset:3840
    v_cvt_pk_bf16_f32 v132, v92, v93
    v_cvt_pk_bf16_f32 v133, v94, v95
    v_exp_f32 v88, v32
    v_exp_f32 v89, v33
    v_exp_f32 v90, v34
    v_exp_f32 v91, v35
    v_mfma_f32_32x32x16_bf16 v[56:71], v[114:117], v[130:133], v[56:71]
    ds_read_b128 v[126:129], v8 offset:4480
    buffer_load_dword v10, s[16:19], s82 offen offset:1024 sc1 lds
    s_add_u32 s82, s82, 5120
    v_cvt_pk_bf16_f32 v134, v88, v89
    v_cvt_pk_bf16_f32 v135, v90, v91
    v_exp_f32 v92, v36
    v_exp_f32 v93, v37
    v_exp_f32 v94, v38
    v_exp_f32 v95, v39
    s_waitcnt lgkmcnt(1)
    v_mfma_f32_32x32x16_bf16 v[24:39], v[102:105], v[96:99], 0
    ds_read_b128 v[108:111], v4 offset:1280
    v_cvt_pk_bf16_f32 v136, v92, v93
    v_cvt_pk_bf16_f32 v137, v94, v95
    v_exp_f32 v88, v40
    v_exp_f32 v89, v41
    v_exp_f32 v90, v42
    v_exp_f32 v91, v43
    v_mfma_f32_32x32x16_bf16 v[56:71], v[118:121], v[134:137], v[56:71]
    s_add_u32 m0, s85, 40960
    ds_read_b64 v[112:113], v5 offset:1280
    buffer_load_dwordx4 v9, s[16:19], s84 offen sc1 lds
    v_cvt_pk_bf16_f32 v130, v88, v89
    v_cvt_pk_bf16_f32 v131, v90, v91
    v_exp_f32 v92, v44
    v_exp_f32 v93, v45
    v_exp_f32 v94, v46
    v_exp_f32 v95, v47
    v_mfma_f32_32x32x8bf16_1k v[24:39], v[106:107], v[100:101], v[24:39]
    ds_read_b128 v[114:117], v6 offset:0
    v_cvt_pk_bf16_f32 v132, v92, v93
    v_cvt_pk_bf16_f32 v133, v94, v95
    v_exp_f32 v88, v48
    v_exp_f32 v89, v49
    v_exp_f32 v90, v50
    v_exp_f32 v91, v51
    v_mfma_f32_32x32x16_bf16 v[56:71], v[122:125], v[130:133], v[56:71]
    ds_read_b128 v[118:121], v6 offset:640
    buffer_load_dwordx4 v9, s[16:19], s84 offen offset:1024 sc1 lds
    v_cvt_pk_bf16_f32 v134, v88, v89
    v_cvt_pk_bf16_f32 v135, v90, v91
    v_exp_f32 v92, v52
    v_exp_f32 v93, v53
    v_exp_f32 v94, v54
    v_exp_f32 v95, v55
    s_waitcnt lgkmcnt(1)
    v_mfma_f32_32x32x16_bf16 v[40:55], v[108:111], v[96:99], 0
    ds_read_b128 v[102:105], v4 offset:2560
    v_cvt_pk_bf16_f32 v136, v92, v93
    v_cvt_pk_bf16_f32 v137, v94, v95
    v_exp_f32 v88, v24
    v_exp_f32 v89, v25
    v_exp_f32 v90, v26
    v_exp_f32 v91, v27
    v_mfma_f32_32x32x16_bf16 v[56:71], v[126:129], v[134:137], v[56:71]
    ds_read_b64 v[106:107], v5 offset:2560
    buffer_load_dwordx4 v9, s[16:19], s84 offen offset:2048 sc1 lds
    v_cvt_pk_bf16_f32 v130, v88, v89
    v_cvt_pk_bf16_f32 v131, v90, v91
    v_exp_f32 v92, v28
    v_exp_f32 v93, v29
    v_exp_f32 v94, v30
    v_exp_f32 v95, v31
    v_mfma_f32_32x32x8bf16_1k v[40:55], v[112:113], v[100:101], v[40:55]
    ds_read_b128 v[122:125], v6 offset:1280
    v_cvt_pk_bf16_f32 v132, v92, v93
    v_cvt_pk_bf16_f32 v133, v94, v95
    v_exp_f32 v88, v32
    v_exp_f32 v89, v33
    v_exp_f32 v90, v34
    v_exp_f32 v91, v35
    v_mfma_f32_32x32x16_bf16 v[56:71], v[114:117], v[130:133], v[56:71]
    ds_read_b128 v[126:129], v6 offset:1920
    buffer_load_dwordx4 v9, s[16:19], s84 offen offset:3072 sc1 lds
    v_cvt_pk_bf16_f32 v134, v88, v89
    v_cvt_pk_bf16_f32 v135, v90, v91
    v_exp_f32 v92, v36
    v_exp_f32 v93, v37
    v_exp_f32 v94, v38
    v_exp_f32 v95, v39
    s_setprio 0
    s_waitcnt lgkmcnt(1)
    v_mfma_f32_32x32x16_bf16 v[24:39], v[102:105], v[96:99], 0
    ds_read_b128 v[108:111], v4 offset:3840
    v_cvt_pk_bf16_f32 v136, v92, v93
    v_cvt_pk_bf16_f32 v137, v94, v95
    v_exp_f32 v88, v40
    v_exp_f32 v89, v41
    v_exp_f32 v90, v42
    v_exp_f32 v91, v43
    v_mfma_f32_32x32x16_bf16 v[56:71], v[118:121], v[134:137], v[56:71]
    s_add_u32 m0, s85, 45056
    ds_read_b64 v[112:113], v5 offset:3840
    s_add_u32 s68, s84, 4096
    buffer_load_dwordx4 v9, s[16:19], s68 offen sc1 lds
    s_add_u32 s84, s84, 10240
    v_cvt_pk_bf16_f32 v130, v88, v89
    v_cvt_pk_bf16_f32 v131, v90, v91
    v_exp_f32 v92, v44
    v_exp_f32 v93, v45
    v_exp_f32 v94, v46
    v_exp_f32 v95, v47
    v_mfma_f32_32x32x8bf16_1k v[24:39], v[106:107], v[100:101], v[24:39]
    ds_read_b128 v[114:117], v6 offset:2560
    v_cvt_pk_bf16_f32 v132, v92, v93
    v_cvt_pk_bf16_f32 v133, v94, v95
    v_exp_f32 v88, v48
    v_exp_f32 v89, v49
    v_exp_f32 v90, v50
    v_exp_f32 v91, v51
    v_mfma_f32_32x32x16_bf16 v[56:71], v[122:125], v[130:133], v[56:71]
    ds_read_b128 v[118:121], v6 offset:3200
    buffer_load_dwordx2 v[22:23], v13, s[16:19], s90 offen offset:60 sc1
    v_cvt_pk_bf16_f32 v134, v88, v89
    v_cvt_pk_bf16_f32 v135, v90, v91
    v_exp_f32 v92, v52
    v_exp_f32 v93, v53
    v_exp_f32 v94, v54
    v_exp_f32 v95, v55
    s_waitcnt vmcnt(6)
    s_barrier
    s_setprio 2
    s_waitcnt lgkmcnt(1)
    v_mfma_f32_32x32x16_bf16 v[40:55], v[108:111], v[96:99], 0
    ds_read_b128 v[102:105], v4 offset:10240
    v_cvt_pk_bf16_f32 v136, v92, v93
    v_cvt_pk_bf16_f32 v137, v94, v95
    v_exp_f32 v88, v24
    v_exp_f32 v89, v25
    v_exp_f32 v90, v26
    v_exp_f32 v91, v27
    v_mfma_f32_32x32x16_bf16 v[56:71], v[126:129], v[134:137], v[56:71]
    s_add_u32 m0, s83, 20480
    ds_read_b64 v[106:107], v139 offset:0
    buffer_load_dwordx4 v9, s[16:19], s82 offen sc1 lds
    v_cvt_pk_bf16_f32 v130, v88, v89
    v_cvt_pk_bf16_f32 v131, v90, v91
    v_exp_f32 v92, v28
    v_exp_f32 v93, v29
    v_exp_f32 v94, v30
    v_exp_f32 v95, v31
    v_mfma_f32_32x32x8bf16_1k v[40:55], v[112:113], v[100:101], v[40:55]
    ds_read_b128 v[122:125], v6 offset:3840
    v_cvt_pk_bf16_f32 v132, v92, v93
    v_cvt_pk_bf16_f32 v133, v94, v95
    v_exp_f32 v88, v32
    v_exp_f32 v89, v33
    v_exp_f32 v90, v34
    v_exp_f32 v91, v35
    v_mfma_f32_32x32x16_bf16 v[56:71], v[114:117], v[130:133], v[56:71]
    ds_read_b128 v[126:129], v6 offset:4480
    buffer_load_dword v10, s[16:19], s82 offen offset:1024 sc1 lds
    s_add_u32 s82, s82, 5120
    v_cvt_pk_bf16_f32 v134, v88, v89
    v_cvt_pk_bf16_f32 v135, v90, v91
    v_exp_f32 v92, v36
    v_exp_f32 v93, v37
    v_exp_f32 v94, v38
    v_exp_f32 v95, v39
    s_waitcnt lgkmcnt(1)
    v_mfma_f32_32x32x16_bf16 v[24:39], v[102:105], v[96:99], 0
    ds_read_b128 v[108:111], v4 offset:11520
    v_cvt_pk_bf16_f32 v136, v92, v93
    v_cvt_pk_bf16_f32 v137, v94, v95
    v_exp_f32 v88, v40
    v_exp_f32 v89, v41
    v_exp_f32 v90, v42
    v_exp_f32 v91, v43
    v_mfma_f32_32x32x16_bf16 v[56:71], v[118:121], v[134:137], v[56:71]
    s_add_u32 m0, s85, 81920
    ds_read_b64 v[112:113], v139 offset:1280
    buffer_load_dwordx4 v9, s[16:19], s84 offen sc1 lds
    v_cvt_pk_bf16_f32 v130, v88, v89
    v_cvt_pk_bf16_f32 v131, v90, v91
    v_exp_f32 v92, v44
    v_exp_f32 v93, v45
    v_exp_f32 v94, v46
    v_exp_f32 v95, v47
    v_mfma_f32_32x32x8bf16_1k v[24:39], v[106:107], v[100:101], v[24:39]
    ds_read_b128 v[114:117], v7 offset:0
    v_cvt_pk_bf16_f32 v132, v92, v93
    v_cvt_pk_bf16_f32 v133, v94, v95
    v_exp_f32 v88, v48
    v_exp_f32 v89, v49
    v_exp_f32 v90, v50
    v_exp_f32 v91, v51
    v_mfma_f32_32x32x16_bf16 v[56:71], v[122:125], v[130:133], v[56:71]
    ds_read_b128 v[118:121], v7 offset:640
    buffer_load_dwordx4 v9, s[16:19], s84 offen offset:1024 sc1 lds
    v_cvt_pk_bf16_f32 v134, v88, v89
    v_cvt_pk_bf16_f32 v135, v90, v91
    v_exp_f32 v92, v52
    v_exp_f32 v93, v53
    v_exp_f32 v94, v54
    v_exp_f32 v95, v55
    s_waitcnt lgkmcnt(1)
    v_mfma_f32_32x32x16_bf16 v[40:55], v[108:111], v[96:99], 0
    ds_read_b128 v[102:105], v4 offset:12800
    v_cvt_pk_bf16_f32 v136, v92, v93
    v_cvt_pk_bf16_f32 v137, v94, v95
    v_exp_f32 v88, v24
    v_exp_f32 v89, v25
    v_exp_f32 v90, v26
    v_exp_f32 v91, v27
    v_mfma_f32_32x32x16_bf16 v[56:71], v[126:129], v[134:137], v[56:71]
    ds_read_b64 v[106:107], v139 offset:2560
    buffer_load_dwordx4 v9, s[16:19], s84 offen offset:2048 sc1 lds
    v_cvt_pk_bf16_f32 v130, v88, v89
    v_cvt_pk_bf16_f32 v131, v90, v91
    v_exp_f32 v92, v28
    v_exp_f32 v93, v29
    v_exp_f32 v94, v30
    v_exp_f32 v95, v31
    v_mfma_f32_32x32x8bf16_1k v[40:55], v[112:113], v[100:101], v[40:55]
    ds_read_b128 v[122:125], v7 offset:1280
    v_cvt_pk_bf16_f32 v132, v92, v93
    v_cvt_pk_bf16_f32 v133, v94, v95
    v_exp_f32 v88, v32
    v_exp_f32 v89, v33
    v_exp_f32 v90, v34
    v_exp_f32 v91, v35
    v_mfma_f32_32x32x16_bf16 v[56:71], v[114:117], v[130:133], v[56:71]
    ds_read_b128 v[126:129], v7 offset:1920
    buffer_load_dwordx4 v9, s[16:19], s84 offen offset:3072 sc1 lds
    v_cvt_pk_bf16_f32 v134, v88, v89
    v_cvt_pk_bf16_f32 v135, v90, v91
    v_exp_f32 v92, v36
    v_exp_f32 v93, v37
    v_exp_f32 v94, v38
    v_exp_f32 v95, v39
    s_setprio 0
    s_waitcnt lgkmcnt(1)
    v_mfma_f32_32x32x16_bf16 v[24:39], v[102:105], v[96:99], 0
    ds_read_b128 v[108:111], v4 offset:14080
    v_cvt_pk_bf16_f32 v136, v92, v93
    v_cvt_pk_bf16_f32 v137, v94, v95
    v_exp_f32 v88, v40
    v_exp_f32 v89, v41
    v_exp_f32 v90, v42
    v_exp_f32 v91, v43
    v_mfma_f32_32x32x16_bf16 v[56:71], v[118:121], v[134:137], v[56:71]
    s_add_u32 m0, s85, 86016
    ds_read_b64 v[112:113], v139 offset:3840
    s_add_u32 s68, s84, 4096
    buffer_load_dwordx4 v9, s[16:19], s68 offen sc1 lds
    s_add_u32 s84, s84, 10240
    v_cvt_pk_bf16_f32 v130, v88, v89
    v_cvt_pk_bf16_f32 v131, v90, v91
    v_exp_f32 v92, v44
    v_exp_f32 v93, v45
    v_exp_f32 v94, v46
    v_exp_f32 v95, v47
    v_mfma_f32_32x32x8bf16_1k v[24:39], v[106:107], v[100:101], v[24:39]
    ds_read_b128 v[114:117], v7 offset:2560
    v_cvt_pk_bf16_f32 v132, v92, v93
    v_cvt_pk_bf16_f32 v133, v94, v95
    v_exp_f32 v88, v48
    v_exp_f32 v89, v49
    v_exp_f32 v90, v50
    v_exp_f32 v91, v51
    v_mfma_f32_32x32x16_bf16 v[56:71], v[122:125], v[130:133], v[56:71]
    ds_read_b128 v[118:121], v7 offset:3200
    buffer_load_dwordx2 v[22:23], v13, s[16:19], s90 offen offset:1724 sc1
    s_add_u32 s90, s90, 3328
    v_cvt_pk_bf16_f32 v134, v88, v89
    v_cvt_pk_bf16_f32 v135, v90, v91
    v_exp_f32 v92, v52
    v_exp_f32 v93, v53
    v_exp_f32 v94, v54
    v_exp_f32 v95, v55
    s_waitcnt vmcnt(6)
    s_barrier
    s_setprio 2
    s_waitcnt lgkmcnt(1)
    v_mfma_f32_32x32x16_bf16 v[40:55], v[108:111], v[96:99], 0
    ds_read_b128 v[102:105], v4 offset:20480
    v_cvt_pk_bf16_f32 v136, v92, v93
    v_cvt_pk_bf16_f32 v137, v94, v95
    v_exp_f32 v88, v24
    v_exp_f32 v89, v25
    v_exp_f32 v90, v26
    v_exp_f32 v91, v27
    v_mfma_f32_32x32x16_bf16 v[56:71], v[126:129], v[134:137], v[56:71]
    s_add_u32 m0, s83, 0
    ds_read_b64 v[106:107], v140 offset:0
    buffer_load_dwordx4 v9, s[16:19], s82 offen sc1 lds
    v_cvt_pk_bf16_f32 v130, v88, v89
    v_cvt_pk_bf16_f32 v131, v90, v91
    v_exp_f32 v92, v28
    v_exp_f32 v93, v29
    v_exp_f32 v94, v30
    v_exp_f32 v95, v31
    v_mfma_f32_32x32x8bf16_1k v[40:55], v[112:113], v[100:101], v[40:55]
    ds_read_b128 v[122:125], v7 offset:3840
    v_cvt_pk_bf16_f32 v132, v92, v93
    v_cvt_pk_bf16_f32 v133, v94, v95
    v_exp_f32 v88, v32
    v_exp_f32 v89, v33
    v_exp_f32 v90, v34
    v_exp_f32 v91, v35
    v_mfma_f32_32x32x16_bf16 v[56:71], v[114:117], v[130:133], v[56:71]
    ds_read_b128 v[126:129], v7 offset:4480
    buffer_load_dword v10, s[16:19], s82 offen offset:1024 sc1 lds
    s_add_u32 s82, s82, 5120
    v_cvt_pk_bf16_f32 v134, v88, v89
    v_cvt_pk_bf16_f32 v135, v90, v91
    v_exp_f32 v92, v36
    v_exp_f32 v93, v37
    v_exp_f32 v94, v38
    v_exp_f32 v95, v39
    s_waitcnt lgkmcnt(1)
    v_mfma_f32_32x32x16_bf16 v[24:39], v[102:105], v[96:99], 0
    ds_read_b128 v[108:111], v4 offset:21760
    v_cvt_pk_bf16_f32 v136, v92, v93
    v_cvt_pk_bf16_f32 v137, v94, v95
    v_exp_f32 v88, v40
    v_exp_f32 v89, v41
    v_exp_f32 v90, v42
    v_exp_f32 v91, v43
    v_mfma_f32_32x32x16_bf16 v[56:71], v[118:121], v[134:137], v[56:71]
    ds_read_b64 v[112:113], v140 offset:1280
    buffer_load_dwordx4 v[220:223], v9, s[16:19], s98 offen offset:1024 sc1
    v_cvt_pk_bf16_f32 v130, v88, v89
    v_cvt_pk_bf16_f32 v131, v90, v91
    v_exp_f32 v92, v44
    v_exp_f32 v93, v45
    v_exp_f32 v94, v46
    v_exp_f32 v95, v47
    v_mfma_f32_32x32x8bf16_1k v[24:39], v[106:107], v[100:101], v[24:39]
    ds_read_b128 v[114:117], v8 offset:0
    v_cvt_pk_bf16_f32 v132, v92, v93
    v_cvt_pk_bf16_f32 v133, v94, v95
    v_exp_f32 v88, v48
    v_exp_f32 v89, v49
    v_exp_f32 v90, v50
    v_exp_f32 v91, v51
    v_mfma_f32_32x32x16_bf16 v[56:71], v[122:125], v[130:133], v[56:71]
    ds_read_b128 v[118:121], v8 offset:640
    buffer_load_dwordx4 v[224:227], v9, s[16:19], s86 offen offset:2048 sc1
    v_cvt_pk_bf16_f32 v134, v88, v89
    v_cvt_pk_bf16_f32 v135, v90, v91
    v_exp_f32 v92, v52
    v_exp_f32 v93, v53
    v_exp_f32 v94, v54
    v_exp_f32 v95, v55
    s_waitcnt lgkmcnt(1)
    v_mfma_f32_32x32x16_bf16 v[40:55], v[108:111], v[96:99], 0
    ds_read_b128 v[102:105], v4 offset:23040
    v_cvt_pk_bf16_f32 v136, v92, v93
    v_cvt_pk_bf16_f32 v137, v94, v95
    v_exp_f32 v88, v24
    v_exp_f32 v89, v25
    v_exp_f32 v90, v26
    v_exp_f32 v91, v27
    v_mfma_f32_32x32x16_bf16 v[56:71], v[126:129], v[134:137], v[56:71]
    ds_read_b64 v[106:107], v140 offset:2560
    buffer_load_dwordx4 v[228:231], v9, s[16:19], s98 offen offset:2048 sc1
    v_cvt_pk_bf16_f32 v130, v88, v89
    v_cvt_pk_bf16_f32 v131, v90, v91
    v_exp_f32 v92, v28
    v_exp_f32 v93, v29
    v_exp_f32 v94, v30
    v_exp_f32 v95, v31
    v_mfma_f32_32x32x8bf16_1k v[40:55], v[112:113], v[100:101], v[40:55]
    ds_read_b128 v[122:125], v8 offset:1280
    v_cvt_pk_bf16_f32 v132, v92, v93
    v_cvt_pk_bf16_f32 v133, v94, v95
    v_exp_f32 v88, v32
    v_exp_f32 v89, v33
    v_exp_f32 v90, v34
    v_exp_f32 v91, v35
    v_mfma_f32_32x32x16_bf16 v[56:71], v[114:117], v[130:133], v[56:71]
    ds_read_b128 v[126:129], v8 offset:1920
    buffer_load_dwordx4 v[232:235], v9, s[16:19], s86 offen offset:3072 sc1
    s_add_u32 s86, s86, 4096
    v_cvt_pk_bf16_f32 v134, v88, v89
    v_cvt_pk_bf16_f32 v135, v90, v91
    v_exp_f32 v92, v36
    v_exp_f32 v93, v37
    v_exp_f32 v94, v38
    v_exp_f32 v95, v39
    s_setprio 0
    s_waitcnt lgkmcnt(1)
    v_mfma_f32_32x32x16_bf16 v[24:39], v[102:105], v[96:99], 0
    ds_read_b128 v[108:111], v4 offset:24320
    v_cvt_pk_bf16_f32 v136, v92, v93
    v_cvt_pk_bf16_f32 v137, v94, v95
    v_exp_f32 v88, v40
    v_exp_f32 v89, v41
    v_exp_f32 v90, v42
    v_exp_f32 v91, v43
    v_mfma_f32_32x32x16_bf16 v[56:71], v[118:121], v[134:137], v[56:71]
    ds_read_b64 v[112:113], v140 offset:3840
    buffer_load_dwordx4 v[236:239], v9, s[16:19], s98 offen offset:3072 sc1
    s_add_u32 s98, s98, 4096
    v_cvt_pk_bf16_f32 v130, v88, v89
    v_cvt_pk_bf16_f32 v131, v90, v91
    v_exp_f32 v92, v44
    v_exp_f32 v93, v45
    v_exp_f32 v94, v46
    v_exp_f32 v95, v47
    v_mfma_f32_32x32x8bf16_1k v[24:39], v[106:107], v[100:101], v[24:39]
    ds_read_b128 v[114:117], v8 offset:2560
    v_cvt_pk_bf16_f32 v132, v92, v93
    v_cvt_pk_bf16_f32 v133, v94, v95
    v_exp_f32 v88, v48
    v_exp_f32 v89, v49
    v_exp_f32 v90, v50
    v_exp_f32 v91, v51
    v_mfma_f32_32x32x16_bf16 v[56:71], v[122:125], v[130:133], v[56:71]
    ds_read_b128 v[118:121], v8 offset:3200
    buffer_load_dwordx2 v[22:23], v13, s[16:19], s90 offen offset:60 sc1
    v_cvt_pk_bf16_f32 v134, v88, v89
    v_cvt_pk_bf16_f32 v135, v90, v91
    v_exp_f32 v92, v52
    v_exp_f32 v93, v53
    v_exp_f32 v94, v54
    v_exp_f32 v95, v55
    s_waitcnt vmcnt(6)
    s_barrier
    s_setprio 2
    s_waitcnt lgkmcnt(1)
    v_mfma_f32_32x32x16_bf16 v[40:55], v[108:111], v[96:99], 0
    ds_read_b128 v[102:105], v4 offset:0
    v_cvt_pk_bf16_f32 v136, v92, v93
    v_cvt_pk_bf16_f32 v137, v94, v95
    v_exp_f32 v88, v24
    v_exp_f32 v89, v25
    v_exp_f32 v90, v26
    v_exp_f32 v91, v27
    v_mfma_f32_32x32x16_bf16 v[56:71], v[126:129], v[134:137], v[56:71]
    ds_read_b64 v[106:107], v5 offset:0
    buffer_load_dwordx4 v[240:243], v9, s[16:19], s86 offen sc1
    v_cvt_pk_bf16_f32 v130, v88, v89
    v_cvt_pk_bf16_f32 v131, v90, v91
    v_exp_f32 v92, v28
    v_exp_f32 v93, v29
    v_exp_f32 v94, v30
    v_exp_f32 v95, v31
    v_mfma_f32_32x32x8bf16_1k v[40:55], v[112:113], v[100:101], v[40:55]
    ds_read_b128 v[122:125], v8 offset:3840
    v_cvt_pk_bf16_f32 v132, v92, v93
    v_cvt_pk_bf16_f32 v133, v94, v95
    v_exp_f32 v88, v32
    v_exp_f32 v89, v33
    v_exp_f32 v90, v34
    v_exp_f32 v91, v35
    v_mfma_f32_32x32x16_bf16 v[56:71], v[114:117], v[130:133], v[56:71]
    ds_read_b128 v[126:129], v8 offset:4480
    buffer_load_dwordx4 v[244:247], v9, s[16:19], s98 offen sc1
    v_cvt_pk_bf16_f32 v134, v88, v89
    v_cvt_pk_bf16_f32 v135, v90, v91
    v_exp_f32 v92, v36
    v_exp_f32 v93, v37
    v_exp_f32 v94, v38
    v_exp_f32 v95, v39
    s_waitcnt lgkmcnt(1)
    v_mfma_f32_32x32x16_bf16 v[24:39], v[102:105], v[96:99], 0
    ds_read_b128 v[108:111], v4 offset:1280
    v_cvt_pk_bf16_f32 v136, v92, v93
    v_cvt_pk_bf16_f32 v137, v94, v95
    v_exp_f32 v88, v40
    v_exp_f32 v89, v41
    v_exp_f32 v90, v42
    v_exp_f32 v91, v43
    v_mfma_f32_32x32x16_bf16 v[56:71], v[118:121], v[134:137], v[56:71]
    ds_read_b64 v[112:113], v5 offset:1280
    buffer_load_dwordx4 v[248:251], v9, s[16:19], s92 offen sc1
    v_cvt_pk_bf16_f32 v130, v88, v89
    v_cvt_pk_bf16_f32 v131, v90, v91
    v_exp_f32 v92, v44
    v_exp_f32 v93, v45
    v_exp_f32 v94, v46
    v_exp_f32 v95, v47
    v_mfma_f32_32x32x8bf16_1k v[24:39], v[106:107], v[100:101], v[24:39]
    ds_read_b128 v[114:117], v6 offset:0
    v_cvt_pk_bf16_f32 v132, v92, v93
    v_cvt_pk_bf16_f32 v133, v94, v95
    v_exp_f32 v88, v48
    v_exp_f32 v89, v49
    v_exp_f32 v90, v50
    v_exp_f32 v91, v51
    v_mfma_f32_32x32x16_bf16 v[56:71], v[122:125], v[130:133], v[56:71]
    ds_read_b128 v[118:121], v6 offset:640
    buffer_load_dwordx2 v[22:23], v13, s[16:19], s90 offen offset:60 sc1
    v_cvt_pk_bf16_f32 v134, v88, v89
    v_cvt_pk_bf16_f32 v135, v90, v91
    v_exp_f32 v92, v52
    v_exp_f32 v93, v53
    v_exp_f32 v94, v54
    v_exp_f32 v95, v55
    s_waitcnt lgkmcnt(1)
    v_mfma_f32_32x32x16_bf16 v[40:55], v[108:111], v[96:99], 0
    ds_read_b128 v[102:105], v4 offset:2560
    v_cvt_pk_bf16_f32 v136, v92, v93
    v_cvt_pk_bf16_f32 v137, v94, v95
    v_exp_f32 v88, v24
    v_exp_f32 v89, v25
    v_exp_f32 v90, v26
    v_exp_f32 v91, v27
    v_mfma_f32_32x32x16_bf16 v[56:71], v[126:129], v[134:137], v[56:71]
    ds_read_b64 v[106:107], v5 offset:2560
    buffer_load_dwordx2 v[22:23], v13, s[16:19], s90 offen offset:1724 sc1
    s_add_u32 s90, s90, 3328
    v_cvt_pk_bf16_f32 v130, v88, v89
    v_cvt_pk_bf16_f32 v131, v90, v91
    v_exp_f32 v92, v28
    v_exp_f32 v93, v29
    v_exp_f32 v94, v30
    v_exp_f32 v95, v31
    v_mfma_f32_32x32x8bf16_1k v[40:55], v[112:113], v[100:101], v[40:55]
    ds_read_b128 v[122:125], v6 offset:1280
    v_cvt_pk_bf16_f32 v132, v92, v93
    v_cvt_pk_bf16_f32 v133, v94, v95
    v_exp_f32 v88, v32
    v_exp_f32 v89, v33
    v_exp_f32 v90, v34
    v_exp_f32 v91, v35
    v_mfma_f32_32x32x16_bf16 v[56:71], v[114:117], v[130:133], v[56:71]
    ds_read_b128 v[126:129], v6 offset:1920
    s_getpc_b64 s[70:71]
L_pc_L_normO:
    s_add_u32 s70, s70, L_norm-L_pc_L_normO
    s_addc_u32 s71, s71, 0
    s_and_b32 s72, s3, 63
    s_min_u32 s72, s72, (L_end-L_norm)/128-1
    s_lshl_b32 s72, s72, 7
    s_add_u32 s70, s70, s72
    s_addc_u32 s71, s71, 0
    v_mov_b32 v2, s70
    v_mov_b32 v3, s71
    global_load_dword v1, v[2:3], off
    v_cvt_pk_bf16_f32 v134, v88, v89
    v_cvt_pk_bf16_f32 v135, v90, v91
    v_exp_f32 v92, v36
    v_exp_f32 v93, v37
    v_exp_f32 v94, v38
    v_exp_f32 v95, v39
    s_setprio 0
    s_waitcnt lgkmcnt(1)
    v_mfma_f32_32x32x16_bf16 v[24:39], v[102:105], v[96:99], 0
    ds_read_b128 v[108:111], v4 offset:3840
    v_cvt_pk_bf16_f32 v136, v92, v93
    v_cvt_pk_bf16_f32 v137, v94, v95
    v_exp_f32 v88, v40
    v_exp_f32 v89, v41
    v_exp_f32 v90, v42
    v_exp_f32 v91, v43
    v_mfma_f32_32x32x16_bf16 v[56:71], v[118:121], v[134:137], v[56:71]
    ds_read_b64 v[112:113], v5 offset:3840
    v_cvt_pk_bf16_f32 v130, v88, v89
    v_cvt_pk_bf16_f32 v131, v90, v91
    v_exp_f32 v92, v44
    v_exp_f32 v93, v45
    v_exp_f32 v94, v46
    v_exp_f32 v95, v47
    v_mfma_f32_32x32x8bf16_1k v[24:39], v[106:107], v[100:101], v[24:39]
    ds_read_b128 v[114:117], v6 offset:2560
    v_cvt_pk_bf16_f32 v132, v92, v93
    v_cvt_pk_bf16_f32 v133, v94, v95
    v_exp_f32 v88, v48
    v_exp_f32 v89, v49
    v_exp_f32 v90, v50
    v_exp_f32 v91, v51
    v_mfma_f32_32x32x16_bf16 v[56:71], v[122:125], v[130:133], v[56:71]
    ds_read_b128 v[118:121], v6 offset:3200
    v_cvt_pk_bf16_f32 v134, v88, v89
    v_cvt_pk_bf16_f32 v135, v90, v91
    v_exp_f32 v92, v52
    v_exp_f32 v93, v53
    v_exp_f32 v94, v54
    v_exp_f32 v95, v55
    s_waitcnt lgkmcnt(1)
    v_mfma_f32_32x32x16_bf16 v[40:55], v[108:111], v[96:99], 0
    v_cvt_pk_bf16_f32 v136, v92, v93
    v_cvt_pk_bf16_f32 v137, v94, v95
    v_exp_f32 v88, v24
    v_exp_f32 v89, v25
    v_exp_f32 v90, v26
    v_exp_f32 v91, v27
    v_mfma_f32_32x32x16_bf16 v[56:71], v[126:129], v[134:137], v[56:71]
    v_cvt_pk_bf16_f32 v130, v88, v89
    v_cvt_pk_bf16_f32 v131, v90, v91
    v_exp_f32 v92, v28
    v_exp_f32 v93, v29
    v_exp_f32 v94, v30
    v_exp_f32 v95, v31
    v_mfma_f32_32x32x8bf16_1k v[40:55], v[112:113], v[100:101], v[40:55]
    ds_read_b128 v[122:125], v6 offset:3840
    v_cvt_pk_bf16_f32 v132, v92, v93
    v_cvt_pk_bf16_f32 v133, v94, v95
    v_exp_f32 v88, v32
    v_exp_f32 v89, v33
    v_exp_f32 v90, v34
    v_exp_f32 v91, v35
    v_mfma_f32_32x32x16_bf16 v[56:71], v[114:117], v[130:133], v[56:71]
    ds_read_b128 v[126:129], v6 offset:4480
    v_cvt_pk_bf16_f32 v134, v88, v89
    v_cvt_pk_bf16_f32 v135, v90, v91
    v_exp_f32 v92, v36
    v_exp_f32 v93, v37
    v_exp_f32 v94, v38
    v_exp_f32 v95, v39
    v_cvt_pk_bf16_f32 v136, v92, v93
    v_cvt_pk_bf16_f32 v137, v94, v95
    v_exp_f32 v88, v40
    v_exp_f32 v89, v41
    v_exp_f32 v90, v42
    v_exp_f32 v91, v43
    s_waitcnt lgkmcnt(2)
    v_mfma_f32_32x32x16_bf16 v[56:71], v[118:121], v[134:137], v[56:71]
    v_cvt_pk_bf16_f32 v130, v88, v89
    v_cvt_pk_bf16_f32 v131, v90, v91
    v_exp_f32 v92, v44
    v_exp_f32 v93, v45
    v_exp_f32 v94, v46
    v_exp_f32 v95, v47
    v_cvt_pk_bf16_f32 v132, v92, v93
    v_cvt_pk_bf16_f32 v133, v94, v95
    v_exp_f32 v88, v48
    v_exp_f32 v89, v49
    v_exp_f32 v90, v50
    v_exp_f32 v91, v51
    s_waitcnt lgkmcnt(1)
    v_mfma_f32_32x32x16_bf16 v[56:71], v[122:125], v[130:133], v[56:71]
    v_cvt_pk_bf16_f32 v134, v88, v89
    v_cvt_pk_bf16_f32 v135, v90, v91
    v_exp_f32 v92, v52
    v_exp_f32 v93, v53
    v_exp_f32 v94, v54
    v_exp_f32 v95, v55
    v_cvt_pk_bf16_f32 v136, v92, v93
    v_cvt_pk_bf16_f32 v137, v94, v95
    s_waitcnt lgkmcnt(0)
    s_nop 0
    v_mfma_f32_32x32x16_bf16 v[56:71], v[126:129], v[134:137], v[56:71]
    s_setprio 0
    s_branch L_attE
L_attY:
    s_setprio 1
    s_waitcnt lgkmcnt(1)
    v_mfma_f32_32x32x16_bf16 v[40:55], v[108:111], v[96:99], 0
    ds_read_b128 v[102:105], v4 offset:2560
    v_exp_f32 v88, v24
    v_exp_f32 v89, v25
    v_exp_f32 v90, v26
    v_exp_f32 v91, v27
    ds_read_b64 v[106:107], v5 offset:2560
    v_cvt_pk_bf16_f32 v130, v88, v89
    v_cvt_pk_bf16_f32 v131, v90, v91
    v_exp_f32 v92, v28
    v_exp_f32 v93, v29
    v_exp_f32 v94, v30
    v_exp_f32 v95, v31
    v_mfma_f32_32x32x8bf16_1k v[40:55], v[112:113], v[100:101], v[40:55]
    ds_read_b128 v[122:125], v6 offset:1280
    v_cvt_pk_bf16_f32 v132, v92, v93
    v_cvt_pk_bf16_f32 v133, v94, v95
    v_exp_f32 v88, v32
    v_exp_f32 v89, v33
    v_exp_f32 v90, v34
    v_exp_f32 v91, v35
    v_mfma_f32_32x32x16_bf16 v[56:71], v[114:117], v[130:133], 0
    ds_read_b128 v[126:129], v6 offset:1920
    v_cvt_pk_bf16_f32 v134, v88, v89
    v_cvt_pk_bf16_f32 v135, v90, v91
    v_exp_f32 v92, v36
    v_exp_f32 v93, v37
    v_exp_f32 v94, v38
    v_exp_f32 v95, v39
    s_waitcnt lgkmcnt(1)
    v_mfma_f32_32x32x16_bf16 v[24:39], v[102:105], v[96:99], 0
    ds_read_b128 v[108:111], v4 offset:3840
    v_cvt_pk_bf16_f32 v136, v92, v93
    v_cvt_pk_bf16_f32 v137, v94, v95
    v_exp_f32 v88, v40
    v_exp_f32 v89, v41
    v_exp_f32 v90, v42
    v_exp_f32 v91, v43
    v_mfma_f32_32x32x16_bf16 v[56:71], v[118:121], v[134:137], v[56:71]
    ds_read_b64 v[112:113], v5 offset:3840
    v_cvt_pk_bf16_f32 v130, v88, v89
    v_cvt_pk_bf16_f32 v131, v90, v91
    v_exp_f32 v92, v44
    v_exp_f32 v93, v45
    v_exp_f32 v94, v46
    v_exp_f32 v95, v47
    v_mfma_f32_32x32x8bf16_1k v[24:39], v[106:107], v[100:101], v[24:39]
    ds_read_b128 v[114:117], v6 offset:2560
    v_cvt_pk_bf16_f32 v132, v92, v93
    v_cvt_pk_bf16_f32 v133, v94, v95
    v_exp_f32 v88, v48
    v_exp_f32 v89, v49
    v_exp_f32 v90, v50
    v_exp_f32 v91, v51
    v_mfma_f32_32x32x16_bf16 v[56:71], v[122:125], v[130:133], v[56:71]
    ds_read_b128 v[118:121], v6 offset:3200
    v_cvt_pk_bf16_f32 v134, v88, v89
    v_cvt_pk_bf16_f32 v135, v90, v91
    v_exp_f32 v92, v52
    v_exp_f32 v93, v53
    v_exp_f32 v94, v54
    v_exp_f32 v95, v55
    s_waitcnt vmcnt(3)
    s_barrier
    s_waitcnt lgkmcnt(1)
    v_mfma_f32_32x32x16_bf16 v[40:55], v[108:111], v[96:99], 0
    ds_read_b128 v[102:105], v4 offset:10240
    v_cvt_pk_bf16_f32 v136, v92, v93
    v_cvt_pk_bf16_f32 v137, v94, v95
    v_exp_f32 v88, v24
    v_exp_f32 v89, v25
    v_exp_f32 v90, v26
    v_exp_f32 v91, v27
    v_mfma_f32_32x32x16_bf16 v[56:71], v[126:129], v[134:137], v[56:71]
    s_add_u32 m0, s83, 20480
    ds_read_b64 v[106:107], v139 offset:0
    buffer_load_dwordx4 v9, s[16:19], s82 offen sc1 lds
    v_cvt_pk_bf16_f32 v130, v88, v89
    v_cvt_pk_bf16_f32 v131, v90, v91
    v_exp_f32 v92, v28
    v_exp_f32 v93, v29
    v_exp_f32 v94, v30
    v_exp_f32 v95, v31
    v_mfma_f32_32x32x8bf16_1k v[40:55], v[112:113], v[100:101], v[40:55]
    ds_read_b128 v[122:125], v6 offset:3840
    v_cvt_pk_bf16_f32 v132, v92, v93
    v_cvt_pk_bf16_f32 v133, v94, v95
    v_exp_f32 v88, v32
    v_exp_f32 v89, v33
    v_exp_f32 v90, v34
    v_exp_f32 v91, v35
    v_mfma_f32_32x32x16_bf16 v[56:71], v[114:117], v[130:133], v[56:71]
    ds_read_b128 v[126:129], v6 offset:4480
    buffer_load_dword v10, s[16:19], s82 offen offset:1024 sc1 lds
    s_add_u32 s82, s82, 5120
    v_cvt_pk_bf16_f32 v134, v88, v89
    v_cvt_pk_bf16_f32 v135, v90, v91
    v_exp_f32 v92, v36
    v_exp_f32 v93, v37
    v_exp_f32 v94, v38
    v_exp_f32 v95, v39
    s_waitcnt lgkmcnt(1)
    v_mfma_f32_32x32x16_bf16 v[24:39], v[102:105], v[96:99], 0
    ds_read_b128 v[108:111], v4 offset:11520
    v_cvt_pk_bf16_f32 v136, v92, v93
    v_cvt_pk_bf16_f32 v137, v94, v95
    v_exp_f32 v88, v40
    v_exp_f32 v89, v41
    v_exp_f32 v90, v42
    v_exp_f32 v91, v43
    v_mfma_f32_32x32x16_bf16 v[56:71], v[118:121], v[134:137], v[56:71]
    ds_read_b64 v[112:113], v139 offset:1280
    buffer_store_dwordx4 v[160:163], v164, s[16:19], s79 offen sc1
    v_cvt_pk_bf16_f32 v130, v88, v89
    v_cvt_pk_bf16_f32 v131, v90, v91
    v_exp_f32 v92, v44
    v_exp_f32 v93, v45
    v_exp_f32 v94, v46
    v_exp_f32 v95, v47
    v_mfma_f32_32x32x8bf16_1k v[24:39], v[106:107], v[100:101], v[24:39]
    ds_read_b128 v[114:117], v7 offset:0
    v_cvt_pk_bf16_f32 v132, v92, v93
    v_cvt_pk_bf16_f32 v133, v94, v95
    v_exp_f32 v88, v48
    v_exp_f32 v89, v49
    v_exp_f32 v90, v50
    v_exp_f32 v91, v51
    v_mfma_f32_32x32x16_bf16 v[56:71], v[122:125], v[130:133], v[56:71]
    ds_read_b128 v[118:121], v7 offset:640
    v_cvt_pk_bf16_f32 v134, v88, v89
    v_cvt_pk_bf16_f32 v135, v90, v91
    v_exp_f32 v92, v52
    v_exp_f32 v93, v53
    v_exp_f32 v94, v54
    v_exp_f32 v95, v55
    s_waitcnt lgkmcnt(1)
    v_mfma_f32_32x32x16_bf16 v[40:55], v[108:111], v[96:99], 0
    ds_read_b128 v[102:105], v4 offset:12800
    v_cvt_pk_bf16_f32 v136, v92, v93
    v_cvt_pk_bf16_f32 v137, v94, v95
    v_exp_f32 v88, v24
    v_exp_f32 v89, v25
    v_exp_f32 v90, v26
    v_exp_f32 v91, v27
    v_mfma_f32_32x32x16_bf16 v[56:71], v[126:129], v[134:137], v[56:71]
    ds_read_b64 v[106:107], v139 offset:2560
    v_cvt_pk_bf16_f32 v130, v88, v89
    v_cvt_pk_bf16_f32 v131, v90, v91
    v_exp_f32 v92, v28
    v_exp_f32 v93, v29
    v_exp_f32 v94, v30
    v_exp_f32 v95, v31
    v_mfma_f32_32x32x8bf16_1k v[40:55], v[112:113], v[100:101], v[40:55]
    ds_read_b128 v[122:125], v7 offset:1280
    v_cvt_pk_bf16_f32 v132, v92, v93
    v_cvt_pk_bf16_f32 v133, v94, v95
    v_exp_f32 v88, v32
    v_exp_f32 v89, v33
    v_exp_f32 v90, v34
    v_exp_f32 v91, v35
    v_mfma_f32_32x32x16_bf16 v[56:71], v[114:117], v[130:133], v[56:71]
    ds_read_b128 v[126:129], v7 offset:1920
    v_cvt_pk_bf16_f32 v134, v88, v89
    v_cvt_pk_bf16_f32 v135, v90, v91
    v_exp_f32 v92, v36
    v_exp_f32 v93, v37
    v_exp_f32 v94, v38
    v_exp_f32 v95, v39
    s_waitcnt lgkmcnt(1)
    v_mfma_f32_32x32x16_bf16 v[24:39], v[102:105], v[96:99], 0
    ds_read_b128 v[108:111], v4 offset:14080
    v_cvt_pk_bf16_f32 v136, v92, v93
    v_cvt_pk_bf16_f32 v137, v94, v95
    v_exp_f32 v88, v40
    v_exp_f32 v89, v41
    v_exp_f32 v90, v42
    v_exp_f32 v91, v43
    v_mfma_f32_32x32x16_bf16 v[56:71], v[118:121], v[134:137], v[56:71]
    ds_read_b64 v[112:113], v139 offset:3840
    v_cvt_pk_bf16_f32 v130, v88, v89
    v_cvt_pk_bf16_f32 v131, v90, v91
    v_exp_f32 v92, v44
    v_exp_f32 v93, v45
    v_exp_f32 v94, v46
    v_exp_f32 v95, v47
    v_mfma_f32_32x32x8bf16_1k v[24:39], v[106:107], v[100:101], v[24:39]
    ds_read_b128 v[114:117], v7 offset:2560
    v_cvt_pk_bf16_f32 v132, v92, v93
    v_cvt_pk_bf16_f32 v133, v94, v95
    v_exp_f32 v88, v48
    v_exp_f32 v89, v49
    v_exp_f32 v90, v50
    v_exp_f32 v91, v51
    v_mfma_f32_32x32x16_bf16 v[56:71], v[122:125], v[130:133], v[56:71]
    ds_read_b128 v[118:121], v7 offset:3200
    v_cvt_pk_bf16_f32 v134, v88, v89
    v_cvt_pk_bf16_f32 v135, v90, v91
    v_exp_f32 v92, v52
    v_exp_f32 v93, v53
    v_exp_f32 v94, v54
    v_exp_f32 v95, v55
    s_waitcnt vmcnt(1)
    s_barrier
    s_waitcnt lgkmcnt(1)
    v_mfma_f32_32x32x16_bf16 v[40:55], v[108:111], v[96:99], 0
    ds_read_b128 v[102:105], v4 offset:20480
    v_cvt_pk_bf16_f32 v136, v92, v93
    v_cvt_pk_bf16_f32 v137, v94, v95
    v_exp_f32 v88, v24
    v_exp_f32 v89, v25
    v_exp_f32 v90, v26
    v_exp_f32 v91, v27
    v_mfma_f32_32x32x16_bf16 v[56:71], v[126:129], v[134:137], v[56:71]
    s_add_u32 m0, s83, 0
    ds_read_b64 v[106:107], v140 offset:0
    buffer_load_dwordx4 v9, s[16:19], s82 offen sc1 lds
    v_cvt_pk_bf16_f32 v130, v88, v89
    v_cvt_pk_bf16_f32 v131, v90, v91
    v_exp_f32 v92, v28
    v_exp_f32 v93, v29
    v_exp_f32 v94, v30
    v_exp_f32 v95, v31
    v_mfma_f32_32x32x8bf16_1k v[40:55], v[112:113], v[100:101], v[40:55]
    ds_read_b128 v[122:125], v7 offset:3840
    v_cvt_pk_bf16_f32 v132, v92, v93
    v_cvt_pk_bf16_f32 v133, v94, v95
    v_exp_f32 v88, v32
    v_exp_f32 v89, v33
    v_exp_f32 v90, v34
    v_exp_f32 v91, v35
    v_mfma_f32_32x32x16_bf16 v[56:71], v[114:117], v[130:133], v[56:71]
    ds_read_b128 v[126:129], v7 offset:4480
    buffer_load_dword v10, s[16:19], s82 offen offset:1024 sc1 lds
    s_add_u32 s82, s82, 5120
    v_cvt_pk_bf16_f32 v134, v88, v89
    v_cvt_pk_bf16_f32 v135, v90, v91
    v_exp_f32 v92, v36
    v_exp_f32 v93, v37
    v_exp_f32 v94, v38
    v_exp_f32 v95, v39
    s_waitcnt lgkmcnt(1)
    v_mfma_f32_32x32x16_bf16 v[24:39], v[102:105], v[96:99], 0
    ds_read_b128 v[108:111], v4 offset:21760
    v_cvt_pk_bf16_f32 v136, v92, v93
    v_cvt_pk_bf16_f32 v137, v94, v95
    v_exp_f32 v88, v40
    v_exp_f32 v89, v41
    v_exp_f32 v90, v42
    v_exp_f32 v91, v43
    v_mfma_f32_32x32x16_bf16 v[56:71], v[118:121], v[134:137], v[56:71]
    ds_read_b64 v[112:113], v140 offset:1280
    buffer_store_dwordx2 v[160:161], v165, s[16:19], s99 offen sc1
    v_cvt_pk_bf16_f32 v130, v88, v89
    v_cvt_pk_bf16_f32 v131, v90, v91
    v_exp_f32 v92, v44
    v_exp_f32 v93, v45
    v_exp_f32 v94, v46
    v_exp_f32 v95, v47
    v_mfma_f32_32x32x8bf16_1k v[24:39], v[106:107], v[100:101], v[24:39]
    ds_read_b128 v[114:117], v8 offset:0
    v_cvt_pk_bf16_f32 v132, v92, v93
    v_cvt_pk_bf16_f32 v133, v94, v95
    v_exp_f32 v88, v48
    v_exp_f32 v89, v49
    v_exp_f32 v90, v50
    v_exp_f32 v91, v51
    v_mfma_f32_32x32x16_bf16 v[56:71], v[122:125], v[130:133], v[56:71]
    ds_read_b128 v[118:121], v8 offset:640
    v_cvt_pk_bf16_f32 v134, v88, v89
    v_cvt_pk_bf16_f32 v135, v90, v91
    v_exp_f32 v92, v52
    v_exp_f32 v93, v53
    v_exp_f32 v94, v54
    v_exp_f32 v95, v55
    s_waitcnt lgkmcnt(1)
    v_mfma_f32_32x32x16_bf16 v[40:55], v[108:111], v[96:99], 0
    ds_read_b128 v[102:105], v4 offset:23040
    v_cvt_pk_bf16_f32 v136, v92, v93
    v_cvt_pk_bf16_f32 v137, v94, v95
    v_exp_f32 v88, v24
    v_exp_f32 v89, v25
    v_exp_f32 v90, v26
    v_exp_f32 v91, v27
    v_mfma_f32_32x32x16_bf16 v[56:71], v[126:129], v[134:137], v[56:71]
    ds_read_b64 v[106:107], v140 offset:2560
    v_cvt_pk_bf16_f32 v130, v88, v89
    v_cvt_pk_bf16_f32 v131, v90, v91
    v_exp_f32 v92, v28
    v_exp_f32 v93, v29
    v_exp_f32 v94, v30
    v_exp_f32 v95, v31
    v_mfma_f32_32x32x8bf16_1k v[40:55], v[112:113], v[100:101], v[40:55]
    ds_read_b128 v[122:125], v8 offset:1280
    v_cvt_pk_bf16_f32 v132, v92, v93
    v_cvt_pk_bf16_f32 v133, v94, v95
    v_exp_f32 v88, v32
    v_exp_f32 v89, v33
    v_exp_f32 v90, v34
    v_exp_f32 v91, v35
    v_mfma_f32_32x32x16_bf16 v[56:71], v[114:117], v[130:133], v[56:71]
    ds_read_b128 v[126:129], v8 offset:1920
    v_cvt_pk_bf16_f32 v134, v88, v89
    v_cvt_pk_bf16_f32 v135, v90, v91
    v_exp_f32 v92, v36
    v_exp_f32 v93, v37
    v_exp_f32 v94, v38
    v_exp_f32 v95, v39
    s_waitcnt lgkmcnt(1)
    v_mfma_f32_32x32x16_bf16 v[24:39], v[102:105], v[96:99], 0
    ds_read_b128 v[108:111], v4 offset:24320
    v_cvt_pk_bf16_f32 v136, v92, v93
    v_cvt_pk_bf16_f32 v137, v94, v95
    v_exp_f32 v88, v40
    v_exp_f32 v89, v41
    v_exp_f32 v90, v42
    v_exp_f32 v91, v43
    v_mfma_f32_32x32x16_bf16 v[56:71], v[118:121], v[134:137], v[56:71]
    ds_read_b64 v[112:113], v140 offset:3840
    v_cvt_pk_bf16_f32 v130, v88, v89
    v_cvt_pk_bf16_f32 v131, v90, v91
    v_exp_f32 v92, v44
    v_exp_f32 v93, v45
    v_exp_f32 v94, v46
    v_exp_f32 v95, v47
    v_mfma_f32_32x32x8bf16_1k v[24:39], v[106:107], v[100:101], v[24:39]
    ds_read_b128 v[114:117], v8 offset:2560
    v_cvt_pk_bf16_f32 v132, v92, v93
    v_cvt_pk_bf16_f32 v133, v94, v95
    v_exp_f32 v88, v48
    v_exp_f32 v89, v49
    v_exp_f32 v90, v50
    v_exp_f32 v91, v51
    v_mfma_f32_32x32x16_bf16 v[56:71], v[122:125], v[130:133], v[56:71]
    ds_read_b128 v[118:121], v8 offset:3200
    v_cvt_pk_bf16_f32 v134, v88, v89
    v_cvt_pk_bf16_f32 v135, v90, v91
    v_exp_f32 v92, v52
    v_exp_f32 v93, v53
    v_exp_f32 v94, v54
    v_exp_f32 v95, v55
    s_waitcnt vmcnt(1)
    s_waitcnt vmcnt(0)
    s_barrier
    s_waitcnt lgkmcnt(1)
    v_mfma_f32_32x32x16_bf16 v[40:55], v[108:111], v[96:99], 0
    ds_read_b128 v[102:105], v4 offset:0
    v_cvt_pk_bf16_f32 v136, v92, v93
    v_cvt_pk_bf16_f32 v137, v94, v95
    v_exp_f32 v88, v24
    v_exp_f32 v89, v25
    v_exp_f32 v90, v26
    v_exp_f32 v91, v27
    v_mfma_f32_32x32x16_bf16 v[56:71], v[126:129], v[134:137], v[56:71]
    s_add_u32 m0, s83, 10240
    ds_read_b64 v[106:107], v5 offset:0
    buffer_load_dwordx4 v9, s[16:19], s82 offen sc1 lds
    v_cvt_pk_bf16_f32 v130, v88, v89
    v_cvt_pk_bf16_f32 v131, v90, v91
    v_exp_f32 v92, v28
    v_exp_f32 v93, v29
    v_exp_f32 v94, v30
    v_exp_f32 v95, v31
    v_mfma_f32_32x32x8bf16_1k v[40:55], v[112:113], v[100:101], v[40:55]
    ds_read_b128 v[122:125], v8 offset:3840
    v_cvt_pk_bf16_f32 v132, v92, v93
    v_cvt_pk_bf16_f32 v133, v94, v95
    v_exp_f32 v88, v32
    v_exp_f32 v89, v33
    v_exp_f32 v90, v34
    v_exp_f32 v91, v35
    v_mfma_f32_32x32x16_bf16 v[56:71], v[114:117], v[130:133], v[56:71]
    ds_read_b128 v[126:129], v8 offset:4480
    buffer_load_dword v10, s[16:19], s82 offen offset:1024 sc1 lds
    s_add_u32 s82, s82, 5120
    v_cvt_pk_bf16_f32 v134, v88, v89
    v_cvt_pk_bf16_f32 v135, v90, v91
    v_exp_f32 v92, v36
    v_exp_f32 v93, v37
    v_exp_f32 v94, v38
    v_exp_f32 v95, v39
    s_waitcnt lgkmcnt(1)
    v_mfma_f32_32x32x16_bf16 v[24:39], v[102:105], v[96:99], 0
    ds_read_b128 v[108:111], v4 offset:1280
    v_cvt_pk_bf16_f32 v136, v92, v93
    v_cvt_pk_bf16_f32 v137, v94, v95
    v_exp_f32 v88, v40
    v_exp_f32 v89, v41
    v_exp_f32 v90, v42
    v_exp_f32 v91, v43
    v_mfma_f32_32x32x16_bf16 v[56:71], v[118:121], v[134:137], v[56:71]
    ds_read_b64 v[112:113], v5 offset:1280
    v_mov_b32 v1, 2
    buffer_store_dword v1, v11, s[16:19], 0 offen sc1
    v_cvt_pk_bf16_f32 v130, v88, v89
    v_cvt_pk_bf16_f32 v131, v90, v91
    v_exp_f32 v92, v44
    v_exp_f32 v93, v45
    v_exp_f32 v94, v46
    v_exp_f32 v95, v47
    v_mfma_f32_32x32x8bf16_1k v[24:39], v[106:107], v[100:101], v[24:39]
    ds_read_b128 v[114:117], v6 offset:0
    v_cvt_pk_bf16_f32 v132, v92, v93
    v_cvt_pk_bf16_f32 v133, v94, v95
    v_exp_f32 v88, v48
    v_exp_f32 v89, v49
    v_exp_f32 v90, v50
    v_exp_f32 v91, v51
    v_mfma_f32_32x32x16_bf16 v[56:71], v[122:125], v[130:133], v[56:71]
    ds_read_b128 v[118:121], v6 offset:640
    v_cvt_pk_bf16_f32 v134, v88, v89
    v_cvt_pk_bf16_f32 v135, v90, v91
    v_exp_f32 v92, v52
    v_exp_f32 v93, v53
    v_exp_f32 v94, v54
    v_exp_f32 v95, v55
    s_waitcnt lgkmcnt(1)
    v_mfma_f32_32x32x16_bf16 v[40:55], v[108:111], v[96:99], 0
    ds_read_b128 v[102:105], v4 offset:2560
    v_cvt_pk_bf16_f32 v136, v92, v93
    v_cvt_pk_bf16_f32 v137, v94, v95
    v_exp_f32 v88, v24
    v_exp_f32 v89, v25
    v_exp_f32 v90, v26
    v_exp_f32 v91, v27
    v_mfma_f32_32x32x16_bf16 v[56:71], v[126:129], v[134:137], v[56:71]
    ds_read_b64 v[106:107], v5 offset:2560
    v_cvt_pk_bf16_f32 v130, v88, v89
    v_cvt_pk_bf16_f32 v131, v90, v91
    v_exp_f32 v92, v28
    v_exp_f32 v93, v29
    v_exp_f32 v94, v30
    v_exp_f32 v95, v31
    v_mfma_f32_32x32x8bf16_1k v[40:55], v[112:113], v[100:101], v[40:55]
    ds_read_b128 v[122:125], v6 offset:1280
    v_cvt_pk_bf16_f32 v132, v92, v93
    v_cvt_pk_bf16_f32 v133, v94, v95
    v_exp_f32 v88, v32
    v_exp_f32 v89, v33
    v_exp_f32 v90, v34
    v_exp_f32 v91, v35
    v_mfma_f32_32x32x16_bf16 v[56:71], v[114:117], v[130:133], v[56:71]
    ds_read_b128 v[126:129], v6 offset:1920
    v_cvt_pk_bf16_f32 v134, v88, v89
    v_cvt_pk_bf16_f32 v135, v90, v91
    v_exp_f32 v92, v36
    v_exp_f32 v93, v37
    v_exp_f32 v94, v38
    v_exp_f32 v95, v39
    s_waitcnt lgkmcnt(1)
    v_mfma_f32_32x32x16_bf16 v[24:39], v[102:105], v[96:99], 0
    ds_read_b128 v[108:111], v4 offset:3840
    v_cvt_pk_bf16_f32 v136, v92, v93
    v_cvt_pk_bf16_f32 v137, v94, v95
    v_exp_f32 v88, v40
    v_exp_f32 v89, v41
    v_exp_f32 v90, v42
    v_exp_f32 v91, v43
    v_mfma_f32_32x32x16_bf16 v[56:71], v[118:121], v[134:137], v[56:71]
    ds_read_b64 v[112:113], v5 offset:3840
    v_cvt_pk_bf16_f32 v130, v88, v89
    v_cvt_pk_bf16_f32 v131, v90, v91
    v_exp_f32 v92, v44
    v_exp_f32 v93, v45
    v_exp_f32 v94, v46
    v_exp_f32 v95, v47
    v_mfma_f32_32x32x8bf16_1k v[24:39], v[106:107], v[100:101], v[24:39]
    ds_read_b128 v[114:117], v6 offset:2560
    v_cvt_pk_bf16_f32 v132, v92, v93
    v_cvt_pk_bf16_f32 v133, v94, v95
    v_exp_f32 v88, v48
    v_exp_f32 v89, v49
    v_exp_f32 v90, v50
    v_exp_f32 v91, v51
    v_mfma_f32_32x32x16_bf16 v[56:71], v[122:125], v[130:133], v[56:71]
    ds_read_b128 v[118:121], v6 offset:3200
    v_cvt_pk_bf16_f32 v134, v88, v89
    v_cvt_pk_bf16_f32 v135, v90, v91
    v_exp_f32 v92, v52
    v_exp_f32 v93, v53
    v_exp_f32 v94, v54
    v_exp_f32 v95, v55
    s_waitcnt vmcnt(1)
    s_barrier
    s_waitcnt lgkmcnt(1)
    v_mfma_f32_32x32x16_bf16 v[40:55], v[108:111], v[96:99], 0
    ds_read_b128 v[102:105], v4 offset:10240
    v_cvt_pk_bf16_f32 v136, v92, v93
    v_cvt_pk_bf16_f32 v137, v94, v95
    v_exp_f32 v88, v24
    v_exp_f32 v89, v25
    v_exp_f32 v90, v26
    v_exp_f32 v91, v27
    v_mfma_f32_32x32x16_bf16 v[56:71], v[126:129], v[134:137], v[56:71]
    s_add_u32 m0, s83, 20480
    ds_read_b64 v[106:107], v139 offset:0
    buffer_load_dwordx4 v9, s[16:19], s82 offen sc1 lds
    v_cvt_pk_bf16_f32 v130, v88, v89
    v_cvt_pk_bf16_f32 v131, v90, v91
    v_exp_f32 v92, v28
    v_exp_f32 v93, v29
    v_exp_f32 v94, v30
    v_exp_f32 v95, v31
    v_mfma_f32_32x32x8bf16_1k v[40:55], v[112:113], v[100:101], v[40:55]
    ds_read_b128 v[122:125], v6 offset:3840
    v_cvt_pk_bf16_f32 v132, v92, v93
    v_cvt_pk_bf16_f32 v133, v94, v95
    v_exp_f32 v88, v32
    v_exp_f32 v89, v33
    v_exp_f32 v90, v34
    v_exp_f32 v91, v35
    v_mfma_f32_32x32x16_bf16 v[56:71], v[114:117], v[130:133], v[56:71]
    ds_read_b128 v[126:129], v6 offset:4480
    buffer_load_dword v10, s[16:19], s82 offen offset:1024 sc1 lds
    s_add_u32 s82, s82, 5120
    v_cvt_pk_bf16_f32 v134, v88, v89
    v_cvt_pk_bf16_f32 v135, v90, v91
    v_exp_f32 v92, v36
    v_exp_f32 v93, v37
    v_exp_f32 v94, v38
    v_exp_f32 v95, v39
    s_waitcnt lgkmcnt(1)
    v_mfma_f32_32x32x16_bf16 v[24:39], v[102:105], v[96:99], 0
    ds_read_b128 v[108:111], v4 offset:11520
    v_cvt_pk_bf16_f32 v136, v92, v93
    v_cvt_pk_bf16_f32 v137, v94, v95
    v_exp_f32 v88, v40
    v_exp_f32 v89, v41
    v_exp_f32 v90, v42
    v_exp_f32 v91, v43
    v_mfma_f32_32x32x16_bf16 v[56:71], v[118:121], v[134:137], v[56:71]
    ds_read_b64 v[112:113], v139 offset:1280
    v_cvt_pk_bf16_f32 v130, v88, v89
    v_cvt_pk_bf16_f32 v131, v90, v91
    v_exp_f32 v92, v44
    v_exp_f32 v93, v45
    v_exp_f32 v94, v46
    v_exp_f32 v95, v47
    v_mfma_f32_32x32x8bf16_1k v[24:39], v[106:107], v[100:101], v[24:39]
    ds_read_b128 v[114:117], v7 offset:0
    v_cvt_pk_bf16_f32 v132, v92, v93
    v_cvt_pk_bf16_f32 v133, v94, v95
    v_exp_f32 v88, v48
    v_exp_f32 v89, v49
    v_exp_f32 v90, v50
    v_exp_f32 v91, v51
    v_mfma_f32_32x32x16_bf16 v[56:71], v[122:125], v[130:133], v[56:71]
    ds_read_b128 v[118:121], v7 offset:640
    v_cvt_pk_bf16_f32 v134, v88, v89
    v_cvt_pk_bf16_f32 v135, v90, v91
    v_exp_f32 v92, v52
    v_exp_f32 v93, v53
    v_exp_f32 v94, v54
    v_exp_f32 v95, v55
    s_waitcnt lgkmcnt(1)
    v_mfma_f32_32x32x16_bf16 v[40:55], v[108:111], v[96:99], 0
    ds_read_b128 v[102:105], v4 offset:12800
    v_cvt_pk_bf16_f32 v136, v92, v93
    v_cvt_pk_bf16_f32 v137, v94, v95
    v_exp_f32 v88, v24
    v_exp_f32 v89, v25
    v_exp_f32 v90, v26
    v_exp_f32 v91, v27
    v_mfma_f32_32x32x16_bf16 v[56:71], v[126:129], v[134:137], v[56:71]
    ds_read_b64 v[106:107], v139 offset:2560
    v_cvt_pk_bf16_f32 v130, v88, v89
    v_cvt_pk_bf16_f32 v131, v90, v91
    v_exp_f32 v92, v28
    v_exp_f32 v93, v29
    v_exp_f32 v94, v30
    v_exp_f32 v95, v31
    v_mfma_f32_32x32x8bf16_1k v[40:55], v[112:113], v[100:101], v[40:55]
    ds_read_b128 v[122:125], v7 offset:1280
    v_cvt_pk_bf16_f32 v132, v92, v93
    v_cvt_pk_bf16_f32 v133, v94, v95
    v_exp_f32 v88, v32
    v_exp_f32 v89, v33
    v_exp_f32 v90, v34
    v_exp_f32 v91, v35
    v_mfma_f32_32x32x16_bf16 v[56:71], v[114:117], v[130:133], v[56:71]
    ds_read_b128 v[126:129], v7 offset:1920
    v_cvt_pk_bf16_f32 v134, v88, v89
    v_cvt_pk_bf16_f32 v135, v90, v91
    v_exp_f32 v92, v36
    v_exp_f32 v93, v37
    v_exp_f32 v94, v38
    v_exp_f32 v95, v39
    s_waitcnt lgkmcnt(1)
    v_mfma_f32_32x32x16_bf16 v[24:39], v[102:105], v[96:99], 0
    ds_read_b128 v[108:111], v4 offset:14080
    v_cvt_pk_bf16_f32 v136, v92, v93
    v_cvt_pk_bf16_f32 v137, v94, v95
    v_exp_f32 v88, v40
    v_exp_f32 v89, v41
    v_exp_f32 v90, v42
    v_exp_f32 v91, v43
    v_mfma_f32_32x32x16_bf16 v[56:71], v[118:121], v[134:137], v[56:71]
    ds_read_b64 v[112:113], v139 offset:3840
    v_cvt_pk_bf16_f32 v130, v88, v89
    v_cvt_pk_bf16_f32 v131, v90, v91
    v_exp_f32 v92, v44
    v_exp_f32 v93, v45
    v_exp_f32 v94, v46
    v_exp_f32 v95, v47
    v_mfma_f32_32x32x8bf16_1k v[24:39], v[106:107], v[100:101], v[24:39]
    ds_read_b128 v[114:117], v7 offset:2560
    v_cvt_pk_bf16_f32 v132, v92, v93
    v_cvt_pk_bf16_f32 v133, v94, v95
    v_exp_f32 v88, v48
    v_exp_f32 v89, v49
    v_exp_f32 v90, v50
    v_exp_f32 v91, v51
    v_mfma_f32_32x32x16_bf16 v[56:71], v[122:125], v[130:133], v[56:71]
    ds_read_b128 v[118:121], v7 offset:3200
    v_cvt_pk_bf16_f32 v134, v88, v89
    v_cvt_pk_bf16_f32 v135, v90, v91
    v_exp_f32 v92, v52
    v_exp_f32 v93, v53
    v_exp_f32 v94, v54
    v_exp_f32 v95, v55
    s_waitcnt vmcnt(0)
    s_barrier
    s_waitcnt lgkmcnt(1)
    v_mfma_f32_32x32x16_bf16 v[40:55], v[108:111], v[96:99], 0
    ds_read_b128 v[102:105], v4 offset:20480
    v_cvt_pk_bf16_f32 v136, v92, v93
    v_cvt_pk_bf16_f32 v137, v94, v95
    v_exp_f32 v88, v24
    v_exp_f32 v89, v25
    v_exp_f32 v90, v26
    v_exp_f32 v91, v27
    v_mfma_f32_32x32x16_bf16 v[56:71], v[126:129], v[134:137], v[56:71]
    s_add_u32 m0, s83, 0
    ds_read_b64 v[106:107], v140 offset:0
    buffer_load_dwordx4 v9, s[16:19], s82 offen sc1 lds
    v_cvt_pk_bf16_f32 v130, v88, v89
    v_cvt_pk_bf16_f32 v131, v90, v91
    v_exp_f32 v92, v28
    v_exp_f32 v93, v29
    v_exp_f32 v94, v30
    v_exp_f32 v95, v31
    v_mfma_f32_32x32x8bf16_1k v[40:55], v[112:113], v[100:101], v[40:55]
    ds_read_b128 v[122:125], v7 offset:3840
    v_cvt_pk_bf16_f32 v132, v92, v93
    v_cvt_pk_bf16_f32 v133, v94, v95
    v_exp_f32 v88, v32
    v_exp_f32 v89, v33
    v_exp_f32 v90, v34
    v_exp_f32 v91, v35
    v_mfma_f32_32x32x16_bf16 v[56:71], v[114:117], v[130:133], v[56:71]
    ds_read_b128 v[126:129], v7 offset:4480
    buffer_load_dword v10, s[16:19], s82 offen offset:1024 sc1 lds
    s_add_u32 s82, s82, 5120
    v_cvt_pk_bf16_f32 v134, v88, v89
    v_cvt_pk_bf16_f32 v135, v90, v91
    v_exp_f32 v92, v36
    v_exp_f32 v93, v37
    v_exp_f32 v94, v38
    v_exp_f32 v95, v39
    s_waitcnt lgkmcnt(1)
    v_mfma_f32_32x32x16_bf16 v[24:39], v[102:105], v[96:99], 0
    ds_read_b128 v[108:111], v4 offset:21760
    v_cvt_pk_bf16_f32 v136, v92, v93
    v_cvt_pk_bf16_f32 v137, v94, v95
    v_exp_f32 v88, v40
    v_exp_f32 v89, v41
    v_exp_f32 v90, v42
    v_exp_f32 v91, v43
    v_mfma_f32_32x32x16_bf16 v[56:71], v[118:121], v[134:137], v[56:71]
    ds_read_b64 v[112:113], v140 offset:1280
    buffer_load_dword v22, v12, s[16:19], 0 offen sc1
    v_cvt_pk_bf16_f32 v130, v88, v89
    v_cvt_pk_bf16_f32 v131, v90, v91
    v_exp_f32 v92, v44
    v_exp_f32 v93, v45
    v_exp_f32 v94, v46
    v_exp_f32 v95, v47
    v_mfma_f32_32x32x8bf16_1k v[24:39], v[106:107], v[100:101], v[24:39]
    ds_read_b128 v[114:117], v8 offset:0
    v_cvt_pk_bf16_f32 v132, v92, v93
    v_cvt_pk_bf16_f32 v133, v94, v95
    v_exp_f32 v88, v48
    v_exp_f32 v89, v49
    v_exp_f32 v90, v50
    v_exp_f32 v91, v51
    v_mfma_f32_32x32x16_bf16 v[56:71], v[122:125], v[130:133], v[56:71]
    ds_read_b128 v[118:121], v8 offset:640
    v_cvt_pk_bf16_f32 v134, v88, v89
    v_cvt_pk_bf16_f32 v135, v90, v91
    v_exp_f32 v92, v52
    v_exp_f32 v93, v53
    v_exp_f32 v94, v54
    v_exp_f32 v95, v55
    s_waitcnt lgkmcnt(1)
    v_mfma_f32_32x32x16_bf16 v[40:55], v[108:111], v[96:99], 0
    ds_read_b128 v[102:105], v4 offset:23040
    v_cvt_pk_bf16_f32 v136, v92, v93
    v_cvt_pk_bf16_f32 v137, v94, v95
    v_exp_f32 v88, v24
    v_exp_f32 v89, v25
    v_exp_f32 v90, v26
    v_exp_f32 v91, v27
    v_mfma_f32_32x32x16_bf16 v[56:71], v[126:129], v[134:137], v[56:71]
    ds_read_b64 v[106:107], v140 offset:2560
    v_cvt_pk_bf16_f32 v130, v88, v89
    v_cvt_pk_bf16_f32 v131, v90, v91
    v_exp_f32 v92, v28
    v_exp_f32 v93, v29
    v_exp_f32 v94, v30
    v_exp_f32 v95, v31
    v_mfma_f32_32x32x8bf16_1k v[40:55], v[112:113], v[100:101], v[40:55]
    ds_read_b128 v[122:125], v8 offset:1280
    v_cvt_pk_bf16_f32 v132, v92, v93
    v_cvt_pk_bf16_f32 v133, v94, v95
    v_exp_f32 v88, v32
    v_exp_f32 v89, v33
    v_exp_f32 v90, v34
    v_exp_f32 v91, v35
    v_mfma_f32_32x32x16_bf16 v[56:71], v[114:117], v[130:133], v[56:71]
    ds_read_b128 v[126:129], v8 offset:1920
    v_cvt_pk_bf16_f32 v134, v88, v89
    v_cvt_pk_bf16_f32 v135, v90, v91
    v_exp_f32 v92, v36
    v_exp_f32 v93, v37
    v_exp_f32 v94, v38
    v_exp_f32 v95, v39
    s_waitcnt lgkmcnt(1)
    v_mfma_f32_32x32x16_bf16 v[24:39], v[102:105], v[96:99], 0
    ds_read_b128 v[108:111], v4 offset:24320
    v_cvt_pk_bf16_f32 v136, v92, v93
    v_cvt_pk_bf16_f32 v137, v94, v95
    v_exp_f32 v88, v40
    v_exp_f32 v89, v41
    v_exp_f32 v90, v42
    v_exp_f32 v91, v43
    v_mfma_f32_32x32x16_bf16 v[56:71], v[118:121], v[134:137], v[56:71]
    ds_read_b64 v[112:113], v140 offset:3840
    v_cvt_pk_bf16_f32 v130, v88, v89
    v_cvt_pk_bf16_f32 v131, v90, v91
    v_exp_f32 v92, v44
    v_exp_f32 v93, v45
    v_exp_f32 v94, v46
    v_exp_f32 v95, v47
    v_mfma_f32_32x32x8bf16_1k v[24:39], v[106:107], v[100:101], v[24:39]
    ds_read_b128 v[114:117], v8 offset:2560
    v_cvt_pk_bf16_f32 v132, v92, v93
    v_cvt_pk_bf16_f32 v133, v94, v95
    v_exp_f32 v88, v48
    v_exp_f32 v89, v49
    v_exp_f32 v90, v50
    v_exp_f32 v91, v51
    v_mfma_f32_32x32x16_bf16 v[56:71], v[122:125], v[130:133], v[56:71]
    ds_read_b128 v[118:121], v8 offset:3200
    v_cvt_pk_bf16_f32 v134, v88, v89
    v_cvt_pk_bf16_f32 v135, v90, v91
    v_exp_f32 v92, v52
    v_exp_f32 v93, v53
    v_exp_f32 v94, v54
    v_exp_f32 v95, v55
    s_waitcnt vmcnt(1)
    s_waitcnt vmcnt(0)
    s_mov_b32 s87, 40000
L_f2Y_chk:
    v_cmp_gt_u32 vcc, 2, v22
    s_nop 1
    s_cbranch_vccz L_f2Y_ok
    s_sub_u32 s87, s87, 1
    s_cbranch_scc1 L_f2Y_ok
    buffer_load_dword v22, v12, s[16:19], 0 offen sc1
    s_waitcnt vmcnt(0)
    s_branch L_f2Y_chk
L_f2Y_ok:
    s_barrier
    s_waitcnt lgkmcnt(1)
    v_mfma_f32_32x32x16_bf16 v[40:55], v[108:111], v[96:99], 0
    ds_read_b128 v[102:105], v4 offset:0
    v_cvt_pk_bf16_f32 v136, v92, v93
    v_cvt_pk_bf16_f32 v137, v94, v95
    v_exp_f32 v88, v24
    v_exp_f32 v89, v25
    v_exp_f32 v90, v26
    v_exp_f32 v91, v27
    v_mfma_f32_32x32x16_bf16 v[56:71], v[126:129], v[134:137], v[56:71]
    s_add_u32 m0, s83, 10240
    ds_read_b64 v[106:107], v5 offset:0
    buffer_load_dwordx4 v9, s[16:19], s82 offen sc1 lds
    v_cvt_pk_bf16_f32 v130, v88, v89
    v_cvt_pk_bf16_f32 v131, v90, v91
    v_exp_f32 v92, v28
    v_exp_f32 v93, v29
    v_exp_f32 v94, v30
    v_exp_f32 v95, v31
    v_mfma_f32_32x32x8bf16_1k v[40:55], v[112:113], v[100:101], v[40:55]
    ds_read_b128 v[122:125], v8 offset:3840
    v_cvt_pk_bf16_f32 v132, v92, v93
    v_cvt_pk_bf16_f32 v133, v94, v95
    v_exp_f32 v88, v32
    v_exp_f32 v89, v33
    v_exp_f32 v90, v34
    v_exp_f32 v91, v35
    v_mfma_f32_32x32x16_bf16 v[56:71], v[114:117], v[130:133], v[56:71]
    ds_read_b128 v[126:129], v8 offset:4480
    buffer_load_dword v10, s[16:19], s82 offen offset:1024 sc1 lds
    s_add_u32 s82, s82, 5120
    v_cvt_pk_bf16_f32 v134, v88, v89
    v_cvt_pk_bf16_f32 v135, v90, v91
    v_exp_f32 v92, v36
    v_exp_f32 v93, v37
    v_exp_f32 v94, v38
    v_exp_f32 v95, v39
    s_waitcnt lgkmcnt(1)
    v_mfma_f32_32x32x16_bf16 v[24:39], v[102:105], v[96:99], 0
    ds_read_b128 v[108:111], v4 offset:1280
    v_cvt_pk_bf16_f32 v136, v92, v93
    v_cvt_pk_bf16_f32 v137, v94, v95
    v_exp_f32 v88, v40
    v_exp_f32 v89, v41
    v_exp_f32 v90, v42
    v_exp_f32 v91, v43
    v_mfma_f32_32x32x16_bf16 v[56:71], v[118:121], v[134:137], v[56:71]
    ds_read_b64 v[112:113], v5 offset:1280
    s_lshl_b32 s68, s81, 3
    s_add_u32 s68, s68, s36
    s_lshl_b32 s68, s68, 7
    s_add_u32 s68, s68, 32768
    v_and_b32 v1, 31, v0
    v_lshlrev_b32 v1, 2, v1
    buffer_load_dword v138, v1, s[16:19], s68 offen sc1
    v_cvt_pk_bf16_f32 v130, v88, v89
    v_cvt_pk_bf16_f32 v131, v90, v91
    v_exp_f32 v92, v44
    v_exp_f32 v93, v45
    v_exp_f32 v94, v46
    v_exp_f32 v95, v47
    v_mfma_f32_32x32x8bf16_1k v[24:39], v[106:107], v[100:101], v[24:39]
    ds_read_b128 v[114:117], v6 offset:0
    v_cvt_pk_bf16_f32 v132, v92, v93
    v_cvt_pk_bf16_f32 v133, v94, v95
    v_exp_f32 v88, v48
    v_exp_f32 v89, v49
    v_exp_f32 v90, v50
    v_exp_f32 v91, v51
    v_mfma_f32_32x32x16_bf16 v[56:71], v[122:125], v[130:133], v[56:71]
    ds_read_b128 v[118:121], v6 offset:640
    s_lshl_b32 s68, s80, 1
    s_add_u32 s68, s68, s97
    s_lshl_b32 s68, s68, 7
    s_add_u32 s68, s68, 32768
    s_lshl_b32 s69, s38, 6
    v_and_b32 v1, 48, v0
    v_or_b32 v1, s69, v1
    buffer_load_dwordx4 v[14:17], v1, s[16:19], s68 offen sc1
    v_xor_b32 v1, 64, v1
    buffer_load_dwordx4 v[18:21], v1, s[16:19], s68 offen sc1
    v_cvt_pk_bf16_f32 v134, v88, v89
    v_cvt_pk_bf16_f32 v135, v90, v91
    v_exp_f32 v92, v52
    v_exp_f32 v93, v53
    v_exp_f32 v94, v54
    v_exp_f32 v95, v55
    s_waitcnt lgkmcnt(1)
    v_mfma_f32_32x32x16_bf16 v[40:55], v[108:111], v[96:99], 0
    ds_read_b128 v[102:105], v4 offset:2560
    v_cvt_pk_bf16_f32 v136, v92, v93
    v_cvt_pk_bf16_f32 v137, v94, v95
    v_exp_f32 v88, v24
    v_exp_f32 v89, v25
    v_exp_f32 v90, v26
    v_exp_f32 v91, v27
    v_mfma_f32_32x32x16_bf16 v[56:71], v[126:129], v[134:137], v[56:71]
    ds_read_b64 v[106:107], v5 offset:2560
    v_cvt_pk_bf16_f32 v130, v88, v89
    v_cvt_pk_bf16_f32 v131, v90, v91
    v_exp_f32 v92, v28
    v_exp_f32 v93, v29
    v_exp_f32 v94, v30
    v_exp_f32 v95, v31
    v_mfma_f32_32x32x8bf16_1k v[40:55], v[112:113], v[100:101], v[40:55]
    ds_read_b128 v[122:125], v6 offset:1280
    v_cvt_pk_bf16_f32 v132, v92, v93
    v_cvt_pk_bf16_f32 v133, v94, v95
    v_exp_f32 v88, v32
    v_exp_f32 v89, v33
    v_exp_f32 v90, v34
    v_exp_f32 v91, v35
    v_mfma_f32_32x32x16_bf16 v[56:71], v[114:117], v[130:133], v[56:71]
    ds_read_b128 v[126:129], v6 offset:1920
    v_cvt_pk_bf16_f32 v134, v88, v89
    v_cvt_pk_bf16_f32 v135, v90, v91
    v_exp_f32 v92, v36
    v_exp_f32 v93, v37
    v_exp_f32 v94, v38
    v_exp_f32 v95, v39
    s_waitcnt lgkmcnt(1)
    v_mfma_f32_32x32x16_bf16 v[24:39], v[102:105], v[96:99], 0
    ds_read_b128 v[108:111], v4 offset:3840
    v_cvt_pk_bf16_f32 v136, v92, v93
    v_cvt_pk_bf16_f32 v137, v94, v95
    v_exp_f32 v88, v40
    v_exp_f32 v89, v41
    v_exp_f32 v90, v42
    v_exp_f32 v91, v43
    v_mfma_f32_32x32x16_bf16 v[56:71], v[118:121], v[134:137], v[56:71]
    ds_read_b64 v[112:113], v5 offset:3840
    v_cvt_pk_bf16_f32 v130, v88, v89
    v_cvt_pk_bf16_f32 v131, v90, v91
    v_exp_f32 v92, v44
    v_exp_f32 v93, v45
    v_exp_f32 v94, v46
    v_exp_f32 v95, v47
    v_mfma_f32_32x32x8bf16_1k v[24:39], v[106:107], v[100:101], v[24:39]
    ds_read_b128 v[114:117], v6 offset:2560
    v_cvt_pk_bf16_f32 v132, v92, v93
    v_cvt_pk_bf16_f32 v133, v94, v95
    v_exp_f32 v88, v48
    v_exp_f32 v89, v49
    v_exp_f32 v90, v50
    v_exp_f32 v91, v51
    v_mfma_f32_32x32x16_bf16 v[56:71], v[122:125], v[130:133], v[56:71]
    ds_read_b128 v[118:121], v6 offset:3200
    v_cvt_pk_bf16_f32 v134, v88, v89
    v_cvt_pk_bf16_f32 v135, v90, v91
    v_exp_f32 v92, v52
    v_exp_f32 v93, v53
    v_exp_f32 v94, v54
    v_exp_f32 v95, v55
    s_waitcnt vmcnt(3)
    s_barrier
    s_waitcnt lgkmcnt(1)
    v_mfma_f32_32x32x16_bf16 v[40:55], v[108:111], v[96:99], 0
    ds_read_b128 v[102:105], v4 offset:10240
    v_cvt_pk_bf16_f32 v136, v92, v93
    v_cvt_pk_bf16_f32 v137, v94, v95
    v_exp_f32 v88, v24
    v_exp_f32 v89, v25
    v_exp_f32 v90, v26
    v_exp_f32 v91, v27
    v_mfma_f32_32x32x16_bf16 v[56:71], v[126:129], v[134:137], v[56:71]
    s_add_u32 m0, s83, 20480
    ds_read_b64 v[106:107], v139 offset:0
    buffer_load_dwordx4 v9, s[16:19], s82 offen sc1 lds
    v_cvt_pk_bf16_f32 v130, v88, v89
    v_cvt_pk_bf16_f32 v131, v90, v91
    v_exp_f32 v92, v28
    v_exp_f32 v93, v29
    v_exp_f32 v94, v30
    v_exp_f32 v95, v31
    v_mfma_f32_32x32x8bf16_1k v[40:55], v[112:113], v[100:101], v[40:55]
    ds_read_b128 v[122:125], v6 offset:3840
    v_cvt_pk_bf16_f32 v132, v92, v93
    v_cvt_pk_bf16_f32 v133, v94, v95
    v_exp_f32 v88, v32
    v_exp_f32 v89, v33
    v_exp_f32 v90, v34
    v_exp_f32 v91, v35
    v_mfma_f32_32x32x16_bf16 v[56:71], v[114:117], v[130:133], v[56:71]
    ds_read_b128 v[126:129], v6 offset:4480
    buffer_load_dword v10, s[16:19], s82 offen offset:1024 sc1 lds
    s_add_u32 s82, s82, 5120
    v_cvt_pk_bf16_f32 v134, v88, v89
    v_cvt_pk_bf16_f32 v135, v90, v91
    v_exp_f32 v92, v36
    v_exp_f32 v93, v37
    v_exp_f32 v94, v38
    v_exp_f32 v95, v39
    s_waitcnt lgkmcnt(1)
    v_mfma_f32_32x32x16_bf16 v[24:39], v[102:105], v[96:99], 0
    ds_read_b128 v[108:111], v4 offset:11520
    v_cvt_pk_bf16_f32 v136, v92, v93
    v_cvt_pk_bf16_f32 v137, v94, v95
    v_exp_f32 v88, v40
    v_exp_f32 v89, v41
    v_exp_f32 v90, v42
    v_exp_f32 v91, v43
    v_mfma_f32_32x32x16_bf16 v[56:71], v[118:121], v[134:137], v[56:71]
    ds_read_b64 v[112:113], v139 offset:1280
    buffer_load_dwordx4 v[144:147], v9, s[16:19], s86 offen sc1
    v_cvt_pk_bf16_f32 v130, v88, v89
    v_cvt_pk_bf16_f32 v131, v90, v91
    v_exp_f32 v92, v44
    v_exp_f32 v93, v45
    v_exp_f32 v94, v46
    v_exp_f32 v95, v47
    v_mfma_f32_32x32x8bf16_1k v[24:39], v[106:107], v[100:101], v[24:39]
    ds_read_b128 v[114:117], v7 offset:0
    v_cvt_pk_bf16_f32 v132, v92, v93
    v_cvt_pk_bf16_f32 v133, v94, v95
    v_exp_f32 v88, v48
    v_exp_f32 v89, v49
    v_exp_f32 v90, v50
    v_exp_f32 v91, v51
    v_mfma_f32_32x32x16_bf16 v[56:71], v[122:125], v[130:133], v[56:71]
    ds_read_b128 v[118:121], v7 offset:640
    buffer_load_dwordx4 v[148:151], v9, s[16:19], s98 offen sc1
    v_cvt_pk_bf16_f32 v134, v88, v89
    v_cvt_pk_bf16_f32 v135, v90, v91
    v_exp_f32 v92, v52
    v_exp_f32 v93, v53
    v_exp_f32 v94, v54
    v_exp_f32 v95, v55
    s_waitcnt lgkmcnt(1)
    v_mfma_f32_32x32x16_bf16 v[40:55], v[108:111], v[96:99], 0
    ds_read_b128 v[102:105], v4 offset:12800
    v_cvt_pk_bf16_f32 v136, v92, v93
    v_cvt_pk_bf16_f32 v137, v94, v95
    v_exp_f32 v88, v24
    v_exp_f32 v89, v25
    v_exp_f32 v90, v26
    v_exp_f32 v91, v27
    v_mfma_f32_32x32x16_bf16 v[56:71], v[126:129], v[134:137], v[56:71]
    ds_read_b64 v[106:107], v139 offset:2560
    v_cvt_pk_bf16_f32 v130, v88, v89
    v_cvt_pk_bf16_f32 v131, v90, v91
    v_exp_f32 v92, v28
    v_exp_f32 v93, v29
    v_exp_f32 v94, v30
    v_exp_f32 v95, v31
    v_mfma_f32_32x32x8bf16_1k v[40:55], v[112:113], v[100:101], v[40:55]
    ds_read_b128 v[122:125], v7 offset:1280
    v_cvt_pk_bf16_f32 v132, v92, v93
    v_cvt_pk_bf16_f32 v133, v94, v95
    v_exp_f32 v88, v32
    v_exp_f32 v89, v33
    v_exp_f32 v90, v34
    v_exp_f32 v91, v35
    v_mfma_f32_32x32x16_bf16 v[56:71], v[114:117], v[130:133], v[56:71]
    ds_read_b128 v[126:129], v7 offset:1920
    v_cvt_pk_bf16_f32 v134, v88, v89
    v_cvt_pk_bf16_f32 v135, v90, v91
    v_exp_f32 v92, v36
    v_exp_f32 v93, v37
    v_exp_f32 v94, v38
    v_exp_f32 v95, v39
    s_waitcnt lgkmcnt(1)
    v_mfma_f32_32x32x16_bf16 v[24:39], v[102:105], v[96:99], 0
    ds_read_b128 v[108:111], v4 offset:14080
    v_cvt_pk_bf16_f32 v136, v92, v93
    v_cvt_pk_bf16_f32 v137, v94, v95
    v_exp_f32 v88, v40
    v_exp_f32 v89, v41
    v_exp_f32 v90, v42
    v_exp_f32 v91, v43
    v_mfma_f32_32x32x16_bf16 v[56:71], v[118:121], v[134:137], v[56:71]
    ds_read_b64 v[112:113], v139 offset:3840
    v_cvt_pk_bf16_f32 v130, v88, v89
    v_cvt_pk_bf16_f32 v131, v90, v91
    v_exp_f32 v92, v44
    v_exp_f32 v93, v45
    v_exp_f32 v94, v46
    v_exp_f32 v95, v47
    v_mfma_f32_32x32x8bf16_1k v[24:39], v[106:107], v[100:101], v[24:39]
    ds_read_b128 v[114:117], v7 offset:2560
    v_cvt_pk_bf16_f32 v132, v92, v93
    v_cvt_pk_bf16_f32 v133, v94, v95
    v_exp_f32 v88, v48
    v_exp_f32 v89, v49
    v_exp_f32 v90, v50
    v_exp_f32 v91, v51
    v_mfma_f32_32x32x16_bf16 v[56:71], v[122:125], v[130:133], v[56:71]
    ds_read_b128 v[118:121], v7 offset:3200
    v_cvt_pk_bf16_f32 v134, v88, v89
    v_cvt_pk_bf16_f32 v135, v90, v91
    v_exp_f32 v92, v52
    v_exp_f32 v93, v53
    v_exp_f32 v94, v54
    v_exp_f32 v95, v55
    s_waitcnt vmcnt(2)
    s_barrier
    s_waitcnt lgkmcnt(1)
    v_mfma_f32_32x32x16_bf16 v[40:55], v[108:111], v[96:99], 0
    ds_read_b128 v[102:105], v4 offset:20480
    v_cvt_pk_bf16_f32 v136, v92, v93
    v_cvt_pk_bf16_f32 v137, v94, v95
    v_exp_f32 v88, v24
    v_exp_f32 v89, v25
    v_exp_f32 v90, v26
    v_exp_f32 v91, v27
    v_mfma_f32_32x32x16_bf16 v[56:71], v[126:129], v[134:137], v[56:71]
    s_add_u32 m0, s83, 0
    ds_read_b64 v[106:107], v140 offset:0
    buffer_load_dwordx4 v9, s[16:19], s82 offen sc1 lds
    v_cvt_pk_bf16_f32 v130, v88, v89
    v_cvt_pk_bf16_f32 v131, v90, v91
    v_exp_f32 v92, v28
    v_exp_f32 v93, v29
    v_exp_f32 v94, v30
    v_exp_f32 v95, v31
    v_mfma_f32_32x32x8bf16_1k v[40:55], v[112:113], v[100:101], v[40:55]
    ds_read_b128 v[122:125], v7 offset:3840
    v_cvt_pk_bf16_f32 v132, v92, v93
    v_cvt_pk_bf16_f32 v133, v94, v95
    v_exp_f32 v88, v32
    v_exp_f32 v89, v33
    v_exp_f32 v90, v34
    v_exp_f32 v91, v35
    v_mfma_f32_32x32x16_bf16 v[56:71], v[114:117], v[130:133], v[56:71]
    ds_read_b128 v[126:129], v7 offset:4480
    buffer_load_dword v10, s[16:19], s82 offen offset:1024 sc1 lds
    s_add_u32 s82, s82, 5120
    v_cvt_pk_bf16_f32 v134, v88, v89
    v_cvt_pk_bf16_f32 v135, v90, v91
    v_exp_f32 v92, v36
    v_exp_f32 v93, v37
    v_exp_f32 v94, v38
    v_exp_f32 v95, v39
    s_waitcnt lgkmcnt(1)
    v_mfma_f32_32x32x16_bf16 v[24:39], v[102:105], v[96:99], 0
    ds_read_b128 v[108:111], v4 offset:21760
    v_cvt_pk_bf16_f32 v136, v92, v93
    v_cvt_pk_bf16_f32 v137, v94, v95
    v_exp_f32 v88, v40
    v_exp_f32 v89, v41
    v_exp_f32 v90, v42
    v_exp_f32 v91, v43
    v_mfma_f32_32x32x16_bf16 v[56:71], v[118:121], v[134:137], v[56:71]
    ds_read_b64 v[112:113], v140 offset:1280
    v_mov_b32 v1, 3
    buffer_store_dword v1, v11, s[16:19], 0 offen sc1
    v_cvt_pk_bf16_f32 v130, v88, v89
    v_cvt_pk_bf16_f32 v131, v90, v91
    v_exp_f32 v92, v44
    v_exp_f32 v93, v45
    v_exp_f32 v94, v46
    v_exp_f32 v95, v47
    v_mfma_f32_32x32x8bf16_1k v[24:39], v[106:107], v[100:101], v[24:39]
    ds_read_b128 v[114:117], v8 offset:0
    v_cvt_pk_bf16_f32 v132, v92, v93
    v_cvt_pk_bf16_f32 v133, v94, v95
    v_exp_f32 v88, v48
    v_exp_f32 v89, v49
    v_exp_f32 v90, v50
    v_exp_f32 v91, v51
    v_mfma_f32_32x32x16_bf16 v[56:71], v[122:125], v[130:133], v[56:71]
    ds_read_b128 v[118:121], v8 offset:640
    buffer_load_dwordx4 v[152:155], v9, s[16:19], s86 offen offset:1024 sc1
    v_cvt_pk_bf16_f32 v134, v88, v89
    v_cvt_pk_bf16_f32 v135, v90, v91
    v_exp_f32 v92, v52
    v_exp_f32 v93, v53
    v_exp_f32 v94, v54
    v_exp_f32 v95, v55
    s_waitcnt lgkmcnt(1)
    v_mfma_f32_32x32x16_bf16 v[40:55], v[108:111], v[96:99], 0
    ds_read_b128 v[102:105], v4 offset:23040
    v_cvt_pk_bf16_f32 v136, v92, v93
    v_cvt_pk_bf16_f32 v137, v94, v95
    v_exp_f32 v88, v24
    v_exp_f32 v89, v25
    v_exp_f32 v90, v26
    v_exp_f32 v91, v27
    v_mfma_f32_32x32x16_bf16 v[56:71], v[126:129], v[134:137], v[56:71]
    ds_read_b64 v[106:107], v140 offset:2560
    buffer_load_dwordx4 v[156:159], v9, s[16:19], s98 offen offset:1024 sc1
    v_cvt_pk_bf16_f32 v130, v88, v89
    v_cvt_pk_bf16_f32 v131, v90, v91
    v_exp_f32 v92, v28
    v_exp_f32 v93, v29
    v_exp_f32 v94, v30
    v_exp_f32 v95, v31
    v_mfma_f32_32x32x8bf16_1k v[40:55], v[112:113], v[100:101], v[40:55]
    ds_read_b128 v[122:125], v8 offset:1280
    v_cvt_pk_bf16_f32 v132, v92, v93
    v_cvt_pk_bf16_f32 v133, v94, v95
    v_exp_f32 v88, v32
    v_exp_f32 v89, v33
    v_exp_f32 v90, v34
    v_exp_f32 v91, v35
    v_mfma_f32_32x32x16_bf16 v[56:71], v[114:117], v[130:133], v[56:71]
    ds_read_b128 v[126:129], v8 offset:1920
    buffer_load_dwordx4 v[160:163], v9, s[16:19], s86 offen offset:2048 sc1
    v_cvt_pk_bf16_f32 v134, v88, v89
    v_cvt_pk_bf16_f32 v135, v90, v91
    v_exp_f32 v92, v36
    v_exp_f32 v93, v37
    v_exp_f32 v94, v38
    v_exp_f32 v95, v39
    s_waitcnt lgkmcnt(1)
    v_mfma_f32_32x32x16_bf16 v[24:39], v[102:105], v[96:99], 0
    ds_read_b128 v[108:111], v4 offset:24320
    v_cvt_pk_bf16_f32 v136, v92, v93
    v_cvt_pk_bf16_f32 v137, v94, v95
    v_exp_f32 v88, v40
    v_exp_f32 v89, v41
    v_exp_f32 v90, v42
    v_exp_f32 v91, v43
    v_mfma_f32_32x32x16_bf16 v[56:71], v[118:121], v[134:137], v[56:71]
    ds_read_b64 v[112:113], v140 offset:3840
    buffer_load_dwordx4 v[164:167], v9, s[16:19], s98 offen offset:2048 sc1
    v_cvt_pk_bf16_f32 v130, v88, v89
    v_cvt_pk_bf16_f32 v131, v90, v91
    v_exp_f32 v92, v44
    v_exp_f32 v93, v45
    v_exp_f32 v94, v46
    v_exp_f32 v95, v47
    v_mfma_f32_32x32x8bf16_1k v[24:39], v[106:107], v[100:101], v[24:39]
    ds_read_b128 v[114:117], v8 offset:2560
    v_cvt_pk_bf16_f32 v132, v92, v93
    v_cvt_pk_bf16_f32 v133, v94, v95
    v_exp_f32 v88, v48
    v_exp_f32 v89, v49
    v_exp_f32 v90, v50
    v_exp_f32 v91, v51
    v_mfma_f32_32x32x16_bf16 v[56:71], v[122:125], v[130:133], v[56:71]
    ds_read_b128 v[118:121], v8 offset:3200
    buffer_load_dwordx4 v[168:171], v9, s[16:19], s86 offen offset:3072 sc1
    s_add_u32 s86, s86, 4096
    v_cvt_pk_bf16_f32 v134, v88, v89
    v_cvt_pk_bf16_f32 v135, v90, v91
    v_exp_f32 v92, v52
    v_exp_f32 v93, v53
    v_exp_f32 v94, v54
    v_exp_f32 v95, v55
    s_waitcnt vmcnt(6)
    s_barrier
    s_waitcnt lgkmcnt(1)
    v_mfma_f32_32x32x16_bf16 v[40:55], v[108:111], v[96:99], 0
    ds_read_b128 v[102:105], v4 offset:0
    v_cvt_pk_bf16_f32 v136, v92, v93
    v_cvt_pk_bf16_f32 v137, v94, v95
    v_exp_f32 v88, v24
    v_exp_f32 v89, v25
    v_exp_f32 v90, v26
    v_exp_f32 v91, v27
    v_mfma_f32_32x32x16_bf16 v[56:71], v[126:129], v[134:137], v[56:71]
    s_add_u32 m0, s83, 10240
    ds_read_b64 v[106:107], v5 offset:0
    buffer_load_dwordx4 v9, s[16:19], s82 offen sc1 lds
    v_cvt_pk_bf16_f32 v130, v88, v89
    v_cvt_pk_bf16_f32 v131, v90, v91
    v_exp_f32 v92, v28
    v_exp_f32 v93, v29
    v_exp_f32 v94, v30
    v_exp_f32 v95, v31
    v_mfma_f32_32x32x8bf16_1k v[40:55], v[112:113], v[100:101], v[40:55]
    ds_read_b128 v[122:125], v8 offset:3840
    v_cvt_pk_bf16_f32 v132, v92, v93
    v_cvt_pk_bf16_f32 v133, v94, v95
    v_exp_f32 v88, v32
    v_exp_f32 v89, v33
    v_exp_f32 v90, v34
    v_exp_f32 v91, v35
    v_mfma_f32_32x32x16_bf16 v[56:71], v[114:117], v[130:133], v[56:71]
    ds_read_b128 v[126:129], v8 offset:4480
    buffer_load_dword v10, s[16:19], s82 offen offset:1024 sc1 lds
    s_add_u32 s82, s82, 5120
    v_cvt_pk_bf16_f32 v134, v88, v89
    v_cvt_pk_bf16_f32 v135, v90, v91
    v_exp_f32 v92, v36
    v_exp_f32 v93, v37
    v_exp_f32 v94, v38
    v_exp_f32 v95, v39
    s_waitcnt lgkmcnt(1)
    v_mfma_f32_32x32x16_bf16 v[24:39], v[102:105], v[96:99], 0
    ds_read_b128 v[108:111], v4 offset:1280
    v_cvt_pk_bf16_f32 v136, v92, v93
    v_cvt_pk_bf16_f32 v137, v94, v95
    v_exp_f32 v88, v40
    v_exp_f32 v89, v41
    v_exp_f32 v90, v42
    v_exp_f32 v91, v43
    v_mfma_f32_32x32x16_bf16 v[56:71], v[118:121], v[134:137], v[56:71]
    ds_read_b64 v[112:113], v5 offset:1280
    buffer_load_dwordx4 v[172:175], v9, s[16:19], s98 offen offset:3072 sc1
    s_add_u32 s98, s98, 4096
    v_cvt_pk_bf16_f32 v130, v88, v89
    v_cvt_pk_bf16_f32 v131, v90, v91
    v_exp_f32 v92, v44
    v_exp_f32 v93, v45
    v_exp_f32 v94, v46
    v_exp_f32 v95, v47
    v_mfma_f32_32x32x8bf16_1k v[24:39], v[106:107], v[100:101], v[24:39]
    ds_read_b128 v[114:117], v6 offset:0
    v_cvt_pk_bf16_f32 v132, v92, v93
    v_cvt_pk_bf16_f32 v133, v94, v95
    v_exp_f32 v88, v48
    v_exp_f32 v89, v49
    v_exp_f32 v90, v50
    v_exp_f32 v91, v51
    v_mfma_f32_32x32x16_bf16 v[56:71], v[122:125], v[130:133], v[56:71]
    ds_read_b128 v[118:121], v6 offset:640
    buffer_load_dwordx4 v[176:179], v9, s[16:19], s86 offen sc1
    v_cvt_pk_bf16_f32 v134, v88, v89
    v_cvt_pk_bf16_f32 v135, v90, v91
    v_exp_f32 v92, v52
    v_exp_f32 v93, v53
    v_exp_f32 v94, v54
    v_exp_f32 v95, v55
    s_waitcnt lgkmcnt(1)
    v_mfma_f32_32x32x16_bf16 v[40:55], v[108:111], v[96:99], 0
    ds_read_b128 v[102:105], v4 offset:2560
    v_cvt_pk_bf16_f32 v136, v92, v93
    v_cvt_pk_bf16_f32 v137, v94, v95
    v_exp_f32 v88, v24
    v_exp_f32 v89, v25
    v_exp_f32 v90, v26
    v_exp_f32 v91, v27
    v_mfma_f32_32x32x16_bf16 v[56:71], v[126:129], v[134:137], v[56:71]
    ds_read_b64 v[106:107], v5 offset:2560
    buffer_load_dwordx4 v[180:183], v9, s[16:19], s98 offen sc1
    v_cvt_pk_bf16_f32 v130, v88, v89
    v_cvt_pk_bf16_f32 v131, v90, v91
    v_exp_f32 v92, v28
    v_exp_f32 v93, v29
    v_exp_f32 v94, v30
    v_exp_f32 v95, v31
    v_mfma_f32_32x32x8bf16_1k v[40:55], v[112:113], v[100:101], v[40:55]
    ds_read_b128 v[122:125], v6 offset:1280
    v_cvt_pk_bf16_f32 v132, v92, v93
    v_cvt_pk_bf16_f32 v133, v94, v95
    v_exp_f32 v88, v32
    v_exp_f32 v89, v33
    v_exp_f32 v90, v34
    v_exp_f32 v91, v35
    v_mfma_f32_32x32x16_bf16 v[56:71], v[114:117], v[130:133], v[56:71]
    ds_read_b128 v[126:129], v6 offset:1920
    buffer_load_dwordx4 v[184:187], v9, s[16:19], s86 offen offset:1024 sc1
    v_cvt_pk_bf16_f32 v134, v88, v89
    v_cvt_pk_bf16_f32 v135, v90, v91
    v_exp_f32 v92, v36
    v_exp_f32 v93, v37
    v_exp_f32 v94, v38
    v_exp_f32 v95, v39
    s_waitcnt lgkmcnt(1)
    v_mfma_f32_32x32x16_bf16 v[24:39], v[102:105], v[96:99], 0
    ds_read_b128 v[108:111], v4 offset:3840
    v_cvt_pk_bf16_f32 v136, v92, v93
    v_cvt_pk_bf16_f32 v137, v94, v95
    v_exp_f32 v88, v40
    v_exp_f32 v89, v41
    v_exp_f32 v90, v42
    v_exp_f32 v91, v43
    v_mfma_f32_32x32x16_bf16 v[56:71], v[118:121], v[134:137], v[56:71]
    ds_read_b64 v[112:113], v5 offset:3840
    buffer_load_dwordx4 v[188:191], v9, s[16:19], s98 offen offset:1024 sc1
    v_cvt_pk_bf16_f32 v130, v88, v89
    v_cvt_pk_bf16_f32 v131, v90, v91
    v_exp_f32 v92, v44
    v_exp_f32 v93, v45
    v_exp_f32 v94, v46
    v_exp_f32 v95, v47
    v_mfma_f32_32x32x8bf16_1k v[24:39], v[106:107], v[100:101], v[24:39]
    ds_read_b128 v[114:117], v6 offset:2560
    v_cvt_pk_bf16_f32 v132, v92, v93
    v_cvt_pk_bf16_f32 v133, v94, v95
    v_exp_f32 v88, v48
    v_exp_f32 v89, v49
    v_exp_f32 v90, v50
    v_exp_f32 v91, v51
    v_mfma_f32_32x32x16_bf16 v[56:71], v[122:125], v[130:133], v[56:71]
    ds_read_b128 v[118:121], v6 offset:3200
    buffer_load_dwordx4 v[192:195], v9, s[16:19], s86 offen offset:2048 sc1
    v_cvt_pk_bf16_f32 v134, v88, v89
    v_cvt_pk_bf16_f32 v135, v90, v91
    v_exp_f32 v92, v52
    v_exp_f32 v93, v53
    v_exp_f32 v94, v54
    v_exp_f32 v95, v55
    s_waitcnt vmcnt(6)
    s_barrier
    s_waitcnt lgkmcnt(1)
    v_mfma_f32_32x32x16_bf16 v[40:55], v[108:111], v[96:99], 0
    ds_read_b128 v[102:105], v4 offset:10240
    v_cvt_pk_bf16_f32 v136, v92, v93
    v_cvt_pk_bf16_f32 v137, v94, v95
    v_exp_f32 v88, v24
    v_exp_f32 v89, v25
    v_exp_f32 v90, v26
    v_exp_f32 v91, v27
    v_mfma_f32_32x32x16_bf16 v[56:71], v[126:129], v[134:137], v[56:71]
    s_add_u32 m0, s83, 20480
    ds_read_b64 v[106:107], v139 offset:0
    buffer_load_dwordx4 v9, s[16:19], s82 offen sc1 lds
    v_cvt_pk_bf16_f32 v130, v88, v89
    v_cvt_pk_bf16_f32 v131, v90, v91
    v_exp_f32 v92, v28
    v_exp_f32 v93, v29
    v_exp_f32 v94, v30
    v_exp_f32 v95, v31
    v_mfma_f32_32x32x8bf16_1k v[40:55], v[112:113], v[100:101], v[40:55]
    ds_read_b128 v[122:125], v6 offset:3840
    v_cvt_pk_bf16_f32 v132, v92, v93
    v_cvt_pk_bf16_f32 v133, v94, v95
    v_exp_f32 v88, v32
    v_exp_f32 v89, v33
    v_exp_f32 v90, v34
    v_exp_f32 v91, v35
    v_mfma_f32_32x32x16_bf16 v[56:71], v[114:117], v[130:133], v[56:71]
    ds_read_b128 v[126:129], v6 offset:4480
    buffer_load_dword v10, s[16:19], s82 offen offset:1024 sc1 lds
    s_add_u32 s82, s82, 5120
    v_cvt_pk_bf16_f32 v134, v88, v89
    v_cvt_pk_bf16_f32 v135, v90, v91
    v_exp_f32 v92, v36
    v_exp_f32 v93, v37
    v_exp_f32 v94, v38
    v_exp_f32 v95, v39
    s_waitcnt lgkmcnt(1)
    v_mfma_f32_32x32x16_bf16 v[24:39], v[102:105], v[96:99], 0
    ds_read_b128 v[108:111], v4 offset:11520
    v_cvt_pk_bf16_f32 v136, v92, v93
    v_cvt_pk_bf16_f32 v137, v94, v95
    v_exp_f32 v88, v40
    v_exp_f32 v89, v41
    v_exp_f32 v90, v42
    v_exp_f32 v91, v43
    v_mfma_f32_32x32x16_bf16 v[56:71], v[118:121], v[134:137], v[56:71]
    ds_read_b64 v[112:113], v139 offset:1280
    buffer_load_dword v22, v12, s[16:19], 0 offen sc1
    v_cvt_pk_bf16_f32 v130, v88, v89
    v_cvt_pk_bf16_f32 v131, v90, v91
    v_exp_f32 v92, v44
    v_exp_f32 v93, v45
    v_exp_f32 v94, v46
    v_exp_f32 v95, v47
    v_mfma_f32_32x32x8bf16_1k v[24:39], v[106:107], v[100:101], v[24:39]
    ds_read_b128 v[114:117], v7 offset:0
    v_cvt_pk_bf16_f32 v132, v92, v93
    v_cvt_pk_bf16_f32 v133, v94, v95
    v_exp_f32 v88, v48
    v_exp_f32 v89, v49
    v_exp_f32 v90, v50
    v_exp_f32 v91, v51
    v_mfma_f32_32x32x16_bf16 v[56:71], v[122:125], v[130:133], v[56:71]
    ds_read_b128 v[118:121], v7 offset:640
    buffer_load_dwordx4 v[196:199], v9, s[16:19], s98 offen offset:2048 sc1
    v_cvt_pk_bf16_f32 v134, v88, v89
    v_cvt_pk_bf16_f32 v135, v90, v91
    v_exp_f32 v92, v52
    v_exp_f32 v93, v53
    v_exp_f32 v94, v54
    v_exp_f32 v95, v55
    s_waitcnt lgkmcnt(1)
    v_mfma_f32_32x32x16_bf16 v[40:55], v[108:111], v[96:99], 0
    ds_read_b128 v[102:105], v4 offset:12800
    v_cvt_pk_bf16_f32 v136, v92, v93
    v_cvt_pk_bf16_f32 v137, v94, v95
    v_exp_f32 v88, v24
    v_exp_f32 v89, v25
    v_exp_f32 v90, v26
    v_exp_f32 v91, v27
    v_mfma_f32_32x32x16_bf16 v[56:71], v[126:129], v[134:137], v[56:71]
    ds_read_b64 v[106:107], v139 offset:2560
    buffer_load_dwordx4 v[200:203], v9, s[16:19], s86 offen offset:3072 sc1
    s_add_u32 s86, s86, 4096
    v_cvt_pk_bf16_f32 v130, v88, v89
    v_cvt_pk_bf16_f32 v131, v90, v91
    v_exp_f32 v92, v28
    v_exp_f32 v93, v29
    v_exp_f32 v94, v30
    v_exp_f32 v95, v31
    v_mfma_f32_32x32x8bf16_1k v[40:55], v[112:113], v[100:101], v[40:55]
    ds_read_b128 v[122:125], v7 offset:1280
    v_cvt_pk_bf16_f32 v132, v92, v93
    v_cvt_pk_bf16_f32 v133, v94, v95
    v_exp_f32 v88, v32
    v_exp_f32 v89, v33
    v_exp_f32 v90, v34
    v_exp_f32 v91, v35
    v_mfma_f32_32x32x16_bf16 v[56:71], v[114:117], v[130:133], v[56:71]
    ds_read_b128 v[126:129], v7 offset:1920
    buffer_load_dwordx4 v[204:207], v9, s[16:19], s98 offen offset:3072 sc1
    s_add_u32 s98, s98, 4096
    v_cvt_pk_bf16_f32 v134, v88, v89
    v_cvt_pk_bf16_f32 v135, v90, v91
    v_exp_f32 v92, v36
    v_exp_f32 v93, v37
    v_exp_f32 v94, v38
    v_exp_f32 v95, v39
    s_waitcnt lgkmcnt(1)
    v_mfma_f32_32x32x16_bf16 v[24:39], v[102:105], v[96:99], 0
    ds_read_b128 v[108:111], v4 offset:14080
    v_cvt_pk_bf16_f32 v136, v92, v93
    v_cvt_pk_bf16_f32 v137, v94, v95
    v_exp_f32 v88, v40
    v_exp_f32 v89, v41
    v_exp_f32 v90, v42
    v_exp_f32 v91, v43
    v_mfma_f32_32x32x16_bf16 v[56:71], v[118:121], v[134:137], v[56:71]
    ds_read_b64 v[112:113], v139 offset:3840
    buffer_load_dwordx4 v[208:211], v9, s[16:19], s86 offen sc1
    v_cvt_pk_bf16_f32 v130, v88, v89
    v_cvt_pk_bf16_f32 v131, v90, v91
    v_exp_f32 v92, v44
    v_exp_f32 v93, v45
    v_exp_f32 v94, v46
    v_exp_f32 v95, v47
    v_mfma_f32_32x32x8bf16_1k v[24:39], v[106:107], v[100:101], v[24:39]
    ds_read_b128 v[114:117], v7 offset:2560
    v_cvt_pk_bf16_f32 v132, v92, v93
    v_cvt_pk_bf16_f32 v133, v94, v95
    v_exp_f32 v88, v48
    v_exp_f32 v89, v49
    v_exp_f32 v90, v50
    v_exp_f32 v91, v51
    v_mfma_f32_32x32x16_bf16 v[56:71], v[122:125], v[130:133], v[56:71]
    ds_read_b128 v[118:121], v7 offset:3200
    buffer_load_dwordx4 v[212:215], v9, s[16:19], s98 offen sc1
    v_cvt_pk_bf16_f32 v134, v88, v89
    v_cvt_pk_bf16_f32 v135, v90, v91
    v_exp_f32 v92, v52
    v_exp_f32 v93, v53
    v_exp_f32 v94, v54
    v_exp_f32 v95, v55
    s_waitcnt vmcnt(6)
    s_waitcnt vmcnt(5)
    s_mov_b32 s87, 40000
L_f3Y_chk:
    v_cmp_gt_u32 vcc, 3, v22
    s_nop 1
    s_cbranch_vccz L_f3Y_ok
    s_sub_u32 s87, s87, 1
    s_cbranch_scc1 L_f3Y_ok
    buffer_load_dword v22, v12, s[16:19], 0 offen sc1
    s_waitcnt vmcnt(0)
    s_branch L_f3Y_chk
L_f3Y_ok:
    s_barrier
    s_waitcnt lgkmcnt(1)
    v_mfma_f32_32x32x16_bf16 v[40:55], v[108:111], v[96:99], 0
    ds_read_b128 v[102:105], v4 offset:20480
    v_cvt_pk_bf16_f32 v136, v92, v93
    v_cvt_pk_bf16_f32 v137, v94, v95
    v_exp_f32 v88, v24
    v_exp_f32 v89, v25
    v_exp_f32 v90, v26
    v_exp_f32 v91, v27
    v_mfma_f32_32x32x16_bf16 v[56:71], v[126:129], v[134:137], v[56:71]
    s_add_u32 m0, s83, 0
    ds_read_b64 v[106:107], v140 offset:0
    buffer_load_dwordx4 v9, s[16:19], s82 offen sc1 lds
    v_cvt_pk_bf16_f32 v130, v88, v89
    v_cvt_pk_bf16_f32 v131, v90, v91
    v_exp_f32 v92, v28
    v_exp_f32 v93, v29
    v_exp_f32 v94, v30
    v_exp_f32 v95, v31
    v_mfma_f32_32x32x8bf16_1k v[40:55], v[112:113], v[100:101], v[40:55]
    ds_read_b128 v[122:125], v7 offset:3840
    v_cvt_pk_bf16_f32 v132, v92, v93
    v_cvt_pk_bf16_f32 v133, v94, v95
    v_exp_f32 v88, v32
    v_exp_f32 v89, v33
    v_exp_f32 v90, v34
    v_exp_f32 v91, v35
    v_mfma_f32_32x32x16_bf16 v[56:71], v[114:117], v[130:133], v[56:71]
    ds_read_b128 v[126:129], v7 offset:4480
    buffer_load_dword v10, s[16:19], s82 offen offset:1024 sc1 lds
    s_add_u32 s82, s82, 5120
    v_cvt_pk_bf16_f32 v134, v88, v89
    v_cvt_pk_bf16_f32 v135, v90, v91
    v_exp_f32 v92, v36
    v_exp_f32 v93, v37
    v_exp_f32 v94, v38
    v_exp_f32 v95, v39
    s_waitcnt lgkmcnt(1)
    v_mfma_f32_32x32x16_bf16 v[24:39], v[102:105], v[96:99], 0
    ds_read_b128 v[108:111], v4 offset:21760
    v_cvt_pk_bf16_f32 v136, v92, v93
    v_cvt_pk_bf16_f32 v137, v94, v95
    v_exp_f32 v88, v40
    v_exp_f32 v89, v41
    v_exp_f32 v90, v42
    v_exp_f32 v91, v43
    v_mfma_f32_32x32x16_bf16 v[56:71], v[118:121], v[134:137], v[56:71]
    s_add_u32 m0, s85, 0
    ds_read_b64 v[112:113], v140 offset:1280
    buffer_load_dwordx4 v9, s[16:19], s84 offen sc1 lds
    v_cvt_pk_bf16_f32 v130, v88, v89
    v_cvt_pk_bf16_f32 v131, v90, v91
    v_exp_f32 v92, v44
    v_exp_f32 v93, v45
    v_exp_f32 v94, v46
    v_exp_f32 v95, v47
    v_mfma_f32_32x32x8bf16_1k v[24:39], v[106:107], v[100:101], v[24:39]
    ds_read_b128 v[114:117], v8 offset:0
    v_cvt_pk_bf16_f32 v132, v92, v93
    v_cvt_pk_bf16_f32 v133, v94, v95
    v_exp_f32 v88, v48
    v_exp_f32 v89, v49
    v_exp_f32 v90, v50
    v_exp_f32 v91, v51
    v_mfma_f32_32x32x16_bf16 v[56:71], v[122:125], v[130:133], v[56:71]
    ds_read_b128 v[118:121], v8 offset:640
    buffer_load_dwordx4 v9, s[16:19], s84 offen offset:1024 sc1 lds
    v_cvt_pk_bf16_f32 v134, v88, v89
    v_cvt_pk_bf16_f32 v135, v90, v91
    v_exp_f32 v92, v52
    v_exp_f32 v93, v53
    v_exp_f32 v94, v54
    v_exp_f32 v95, v55
    s_waitcnt lgkmcnt(1)
    v_mfma_f32_32x32x16_bf16 v[40:55], v[108:111], v[96:99], 0
    ds_read_b128 v[102:105], v4 offset:23040
    v_cvt_pk_bf16_f32 v136, v92, v93
    v_cvt_pk_bf16_f32 v137, v94, v95
    v_exp_f32 v88, v24
    v_exp_f32 v89, v25
    v_exp_f32 v90, v26
    v_exp_f32 v91, v27
    v_mfma_f32_32x32x16_bf16 v[56:71], v[126:129], v[134:137], v[56:71]
    ds_read_b64 v[106:107], v140 offset:2560
    buffer_load_dwordx4 v9, s[16:19], s84 offen offset:2048 sc1 lds
    v_cvt_pk_bf16_f32 v130, v88, v89
    v_cvt_pk_bf16_f32 v131, v90, v91
    v_exp_f32 v92, v28
    v_exp_f32 v93, v29
    v_exp_f32 v94, v30
    v_exp_f32 v95, v31
    v_mfma_f32_32x32x8bf16_1k v[40:55], v[112:113], v[100:101], v[40:55]
    ds_read_b128 v[122:125], v8 offset:1280
    v_cvt_pk_bf16_f32 v132, v92, v93
    v_cvt_pk_bf16_f32 v133, v94, v95
    v_exp_f32 v88, v32
    v_exp_f32 v89, v33
    v_exp_f32 v90, v34
    v_exp_f32 v91, v35
    v_mfma_f32_32x32x16_bf16 v[56:71], v[114:117], v[130:133], v[56:71]
    ds_read_b128 v[126:129], v8 offset:1920
    buffer_load_dwordx4 v9, s[16:19], s84 offen offset:3072 sc1 lds
    v_cvt_pk_bf16_f32 v134, v88, v89
    v_cvt_pk_bf16_f32 v135, v90, v91
    v_exp_f32 v92, v36
    v_exp_f32 v93, v37
    v_exp_f32 v94, v38
    v_exp_f32 v95, v39
    s_waitcnt lgkmcnt(1)
    v_mfma_f32_32x32x16_bf16 v[24:39], v[102:105], v[96:99], 0
    ds_read_b128 v[108:111], v4 offset:24320
    v_cvt_pk_bf16_f32 v136, v92, v93
    v_cvt_pk_bf16_f32 v137, v94, v95
    v_exp_f32 v88, v40
    v_exp_f32 v89, v41
    v_exp_f32 v90, v42
    v_exp_f32 v91, v43
    v_mfma_f32_32x32x16_bf16 v[56:71], v[118:121], v[134:137], v[56:71]
    s_add_u32 m0, s85, 4096
    ds_read_b64 v[112:113], v140 offset:3840
    s_add_u32 s68, s84, 4096
    buffer_load_dwordx4 v9, s[16:19], s68 offen sc1 lds
    s_add_u32 s84, s84, 10240
    v_cvt_pk_bf16_f32 v130, v88, v89
    v_cvt_pk_bf16_f32 v131, v90, v91
    v_exp_f32 v92, v44
    v_exp_f32 v93, v45
    v_exp_f32 v94, v46
    v_exp_f32 v95, v47
    v_mfma_f32_32x32x8bf16_1k v[24:39], v[106:107], v[100:101], v[24:39]
    ds_read_b128 v[114:117], v8 offset:2560
    v_cvt_pk_bf16_f32 v132, v92, v93
    v_cvt_pk_bf16_f32 v133, v94, v95
    v_exp_f32 v88, v48
    v_exp_f32 v89, v49
    v_exp_f32 v90, v50
    v_exp_f32 v91, v51
    v_mfma_f32_32x32x16_bf16 v[56:71], v[122:125], v[130:133], v[56:71]
    ds_read_b128 v[118:121], v8 offset:3200
    buffer_load_dwordx4 v[216:219], v9, s[16:19], s86 offen offset:1024 sc1
    v_cvt_pk_bf16_f32 v134, v88, v89
    v_cvt_pk_bf16_f32 v135, v90, v91
    v_exp_f32 v92, v52
    v_exp_f32 v93, v53
    v_exp_f32 v94, v54
    v_exp_f32 v95, v55
    s_waitcnt vmcnt(6)
    s_barrier
    s_waitcnt lgkmcnt(1)
    v_mfma_f32_32x32x16_bf16 v[40:55], v[108:111], v[96:99], 0
    ds_read_b128 v[102:105], v4 offset:0
    v_cvt_pk_bf16_f32 v136, v92, v93
    v_cvt_pk_bf16_f32 v137, v94, v95
    v_exp_f32 v88, v24
    v_exp_f32 v89, v25
    v_exp_f32 v90, v26
    v_exp_f32 v91, v27
    v_mfma_f32_32x32x16_bf16 v[56:71], v[126:129], v[134:137], v[56:71]
    s_add_u32 m0, s83, 10240
    ds_read_b64 v[106:107], v5 offset:0
    buffer_load_dwordx4 v9, s[16:19], s82 offen sc1 lds
    v_cvt_pk_bf16_f32 v130, v88, v89
    v_cvt_pk_bf16_f32 v131, v90, v91
    v_exp_f32 v92, v28
    v_exp_f32 v93, v29
    v_exp_f32 v94, v30
    v_exp_f32 v95, v31
    v_mfma_f32_32x32x8bf16_1k v[40:55], v[112:113], v[100:101], v[40:55]
    ds_read_b128 v[122:125], v8 offset:3840
    v_cvt_pk_bf16_f32 v132, v92, v93
    v_cvt_pk_bf16_f32 v133, v94, v95
    v_exp_f32 v88, v32
    v_exp_f32 v89, v33
    v_exp_f32 v90, v34
    v_exp_f32 v91, v35
    v_mfma_f32_32x32x16_bf16 v[56:71], v[114:117], v[130:133], v[56:71]
    ds_read_b128 v[126:129], v8 offset:4480
    buffer_load_dword v10, s[16:19], s82 offen offset:1024 sc1 lds
    s_add_u32 s82, s82, 5120
    v_cvt_pk_bf16_f32 v134, v88, v89
    v_cvt_pk_bf16_f32 v135, v90, v91
    v_exp_f32 v92, v36
    v_exp_f32 v93, v37
    v_exp_f32 v94, v38
    v_exp_f32 v95, v39
    s_waitcnt lgkmcnt(1)
    v_mfma_f32_32x32x16_bf16 v[24:39], v[102:105], v[96:99], 0
    ds_read_b128 v[108:111], v4 offset:1280
    v_cvt_pk_bf16_f32 v136, v92, v93
    v_cvt_pk_bf16_f32 v137, v94, v95
    v_exp_f32 v88, v40
    v_exp_f32 v89, v41
    v_exp_f32 v90, v42
    v_exp_f32 v91, v43
    v_mfma_f32_32x32x16_bf16 v[56:71], v[118:121], v[134:137], v[56:71]
    s_add_u32 m0, s85, 40960
    ds_read_b64 v[112:113], v5 offset:1280
    buffer_load_dwordx4 v9, s[16:19], s84 offen sc1 lds
    v_cvt_pk_bf16_f32 v130, v88, v89
    v_cvt_pk_bf16_f32 v131, v90, v91
    v_exp_f32 v92, v44
    v_exp_f32 v93, v45
    v_exp_f32 v94, v46
    v_exp_f32 v95, v47
    v_mfma_f32_32x32x8bf16_1k v[24:39], v[106:107], v[100:101], v[24:39]
    ds_read_b128 v[114:117], v6 offset:0
    v_cvt_pk_bf16_f32 v132, v92, v93
    v_cvt_pk_bf16_f32 v133, v94, v95
    v_exp_f32 v88, v48
    v_exp_f32 v89, v49
    v_exp_f32 v90, v50
    v_exp_f32 v91, v51
    v_mfma_f32_32x32x16_bf16 v[56:71], v[122:125], v[130:133], v[56:71]
    ds_read_b128 v[118:121], v6 offset:640
    buffer_load_dwordx4 v9, s[16:19], s84 offen offset:1024 sc1 lds
    v_cvt_pk_bf16_f32 v134, v88, v89
    v_cvt_pk_bf16_f32 v135, v90, v91
    v_exp_f32 v92, v52
    v_exp_f32 v93, v53
    v_exp_f32 v94, v54
    v_exp_f32 v95, v55
    s_waitcnt lgkmcnt(1)
    v_mfma_f32_32x32x16_bf16 v[40:55], v[108:111], v[96:99], 0
    ds_read_b128 v[102:105], v4 offset:2560
    v_cvt_pk_bf16_f32 v136, v92, v93
    v_cvt_pk_bf16_f32 v137, v94, v95
    v_exp_f32 v88, v24
    v_exp_f32 v89, v25
    v_exp_f32 v90, v26
    v_exp_f32 v91, v27
    v_mfma_f32_32x32x16_bf16 v[56:71], v[126:129], v[134:137], v[56:71]
    ds_read_b64 v[106:107], v5 offset:2560
    buffer_load_dwordx4 v9, s[16:19], s84 offen offset:2048 sc1 lds
    v_cvt_pk_bf16_f32 v130, v88, v89
    v_cvt_pk_bf16_f32 v131, v90, v91
    v_exp_f32 v92, v28
    v_exp_f32 v93, v29
    v_exp_f32 v94, v30
    v_exp_f32 v95, v31
    v_mfma_f32_32x32x8bf16_1k v[40:55], v[112:113], v[100:101], v[40:55]
    ds_read_b128 v[122:125], v6 offset:1280
    v_cvt_pk_bf16_f32 v132, v92, v93
    v_cvt_pk_bf16_f32 v133, v94, v95
    v_exp_f32 v88, v32
    v_exp_f32 v89, v33
    v_exp_f32 v90, v34
    v_exp_f32 v91, v35
    v_mfma_f32_32x32x16_bf16 v[56:71], v[114:117], v[130:133], v[56:71]
    ds_read_b128 v[126:129], v6 offset:1920
    buffer_load_dwordx4 v9, s[16:19], s84 offen offset:3072 sc1 lds
    v_cvt_pk_bf16_f32 v134, v88, v89
    v_cvt_pk_bf16_f32 v135, v90, v91
    v_exp_f32 v92, v36
    v_exp_f32 v93, v37
    v_exp_f32 v94, v38
    v_exp_f32 v95, v39
    s_waitcnt lgkmcnt(1)
    v_mfma_f32_32x32x16_bf16 v[24:39], v[102:105], v[96:99], 0
    ds_read_b128 v[108:111], v4 offset:3840
    v_cvt_pk_bf16_f32 v136, v92, v93
    v_cvt_pk_bf16_f32 v137, v94, v95
    v_exp_f32 v88, v40
    v_exp_f32 v89, v41
    v_exp_f32 v90, v42
    v_exp_f32 v91, v43
    v_mfma_f32_32x32x16_bf16 v[56:71], v[118:121], v[134:137], v[56:71]
    s_add_u32 m0, s85, 45056
    ds_read_b64 v[112:113], v5 offset:3840
    s_add_u32 s68, s84, 4096
    buffer_load_dwordx4 v9, s[16:19], s68 offen sc1 lds
    s_add_u32 s84, s84, 10240
    v_cvt_pk_bf16_f32 v130, v88, v89
    v_cvt_pk_bf16_f32 v131, v90, v91
    v_exp_f32 v92, v44
    v_exp_f32 v93, v45
    v_exp_f32 v94, v46
    v_exp_f32 v95, v47
    v_mfma_f32_32x32x8bf16_1k v[24:39], v[106:107], v[100:101], v[24:39]
    ds_read_b128 v[114:117], v6 offset:2560
    v_cvt_pk_bf16_f32 v132, v92, v93
    v_cvt_pk_bf16_f32 v133, v94, v95
    v_exp_f32 v88, v48
    v_exp_f32 v89, v49
    v_exp_f32 v90, v50
    v_exp_f32 v91, v51
    v_mfma_f32_32x32x16_bf16 v[56:71], v[122:125], v[130:133], v[56:71]
    ds_read_b128 v[118:121], v6 offset:3200
    buffer_load_dwordx2 v[22:23], v13, s[16:19], s90 offen offset:60 sc1
    v_cvt_pk_bf16_f32 v134, v88, v89
    v_cvt_pk_bf16_f32 v135, v90, v91
    v_exp_f32 v92, v52
    v_exp_f32 v93, v53
    v_exp_f32 v94, v54
    v_exp_f32 v95, v55
    s_waitcnt vmcnt(6)
    s_barrier
    s_waitcnt lgkmcnt(1)
    v_mfma_f32_32x32x16_bf16 v[40:55], v[108:111], v[96:99], 0
    ds_read_b128 v[102:105], v4 offset:10240
    v_cvt_pk_bf16_f32 v136, v92, v93
    v_cvt_pk_bf16_f32 v137, v94, v95
    v_exp_f32 v88, v24
    v_exp_f32 v89, v25
    v_exp_f32 v90, v26
    v_exp_f32 v91, v27
    v_mfma_f32_32x32x16_bf16 v[56:71], v[126:129], v[134:137], v[56:71]
    s_add_u32 m0, s83, 20480
    ds_read_b64 v[106:107], v139 offset:0
    buffer_load_dwordx4 v9, s[16:19], s82 offen sc1 lds
    v_cvt_pk_bf16_f32 v130, v88, v89
    v_cvt_pk_bf16_f32 v131, v90, v91
    v_exp_f32 v92, v28
    v_exp_f32 v93, v29
    v_exp_f32 v94, v30
    v_exp_f32 v95, v31
    v_mfma_f32_32x32x8bf16_1k v[40:55], v[112:113], v[100:101], v[40:55]
    ds_read_b128 v[122:125], v6 offset:3840
    v_cvt_pk_bf16_f32 v132, v92, v93
    v_cvt_pk_bf16_f32 v133, v94, v95
    v_exp_f32 v88, v32
    v_exp_f32 v89, v33
    v_exp_f32 v90, v34
    v_exp_f32 v91, v35
    v_mfma_f32_32x32x16_bf16 v[56:71], v[114:117], v[130:133], v[56:71]
    ds_read_b128 v[126:129], v6 offset:4480
    buffer_load_dword v10, s[16:19], s82 offen offset:1024 sc1 lds
    s_add_u32 s82, s82, 5120
    v_cvt_pk_bf16_f32 v134, v88, v89
    v_cvt_pk_bf16_f32 v135, v90, v91
    v_exp_f32 v92, v36
    v_exp_f32 v93, v37
    v_exp_f32 v94, v38
    v_exp_f32 v95, v39
    s_waitcnt lgkmcnt(1)
    v_mfma_f32_32x32x16_bf16 v[24:39], v[102:105], v[96:99], 0
    ds_read_b128 v[108:111], v4 offset:11520
    v_cvt_pk_bf16_f32 v136, v92, v93
    v_cvt_pk_bf16_f32 v137, v94, v95
    v_exp_f32 v88, v40
    v_exp_f32 v89, v41
    v_exp_f32 v90, v42
    v_exp_f32 v91, v43
    v_mfma_f32_32x32x16_bf16 v[56:71], v[118:121], v[134:137], v[56:71]
    s_add_u32 m0, s85, 81920
    ds_read_b64 v[112:113], v139 offset:1280
    buffer_load_dwordx4 v9, s[16:19], s84 offen sc1 lds
    v_cvt_pk_bf16_f32 v130, v88, v89
    v_cvt_pk_bf16_f32 v131, v90, v91
    v_exp_f32 v92, v44
    v_exp_f32 v93, v45
    v_exp_f32 v94, v46
    v_exp_f32 v95, v47
    v_mfma_f32_32x32x8bf16_1k v[24:39], v[106:107], v[100:101], v[24:39]
    ds_read_b128 v[114:117], v7 offset:0
    v_cvt_pk_bf16_f32 v132, v92, v93
    v_cvt_pk_bf16_f32 v133, v94, v95
    v_exp_f32 v88, v48
    v_exp_f32 v89, v49
    v_exp_f32 v90, v50
    v_exp_f32 v91, v51
    v_mfma_f32_32x32x16_bf16 v[56:71], v[122:125], v[130:133], v[56:71]
    ds_read_b128 v[118:121], v7 offset:640
    buffer_load_dwordx4 v9, s[16:19], s84 offen offset:1024 sc1 lds
    v_cvt_pk_bf16_f32 v134, v88, v89
    v_cvt_pk_bf16_f32 v135, v90, v91
    v_exp_f32 v92, v52
    v_exp_f32 v93, v53
    v_exp_f32 v94, v54
    v_exp_f32 v95, v55
    s_waitcnt lgkmcnt(1)
    v_mfma_f32_32x32x16_bf16 v[40:55], v[108:111], v[96:99], 0
    ds_read_b128 v[102:105], v4 offset:12800
    v_cvt_pk_bf16_f32 v136, v92, v93
    v_cvt_pk_bf16_f32 v137, v94, v95
    v_exp_f32 v88, v24
    v_exp_f32 v89, v25
    v_exp_f32 v90, v26
    v_exp_f32 v91, v27
    v_mfma_f32_32x32x16_bf16 v[56:71], v[126:129], v[134:137], v[56:71]
    ds_read_b64 v[106:107], v139 offset:2560
    buffer_load_dwordx4 v9, s[16:19], s84 offen offset:2048 sc1 lds
    v_cvt_pk_bf16_f32 v130, v88, v89
    v_cvt_pk_bf16_f32 v131, v90, v91
    v_exp_f32 v92, v28
    v_exp_f32 v93, v29
    v_exp_f32 v94, v30
    v_exp_f32 v95, v31
    v_mfma_f32_32x32x8bf16_1k v[40:55], v[112:113], v[100:101], v[40:55]
    ds_read_b128 v[122:125], v7 offset:1280
    v_cvt_pk_bf16_f32 v132, v92, v93
    v_cvt_pk_bf16_f32 v133, v94, v95
    v_exp_f32 v88, v32
    v_exp_f32 v89, v33
    v_exp_f32 v90, v34
    v_exp_f32 v91, v35
    v_mfma_f32_32x32x16_bf16 v[56:71], v[114:117], v[130:133], v[56:71]
    ds_read_b128 v[126:129], v7 offset:1920
    buffer_load_dwordx4 v9, s[16:19], s84 offen offset:3072 sc1 lds
    v_cvt_pk_bf16_f32 v134, v88, v89
    v_cvt_pk_bf16_f32 v135, v90, v91
    v_exp_f32 v92, v36
    v_exp_f32 v93, v37
    v_exp_f32 v94, v38
    v_exp_f32 v95, v39
    s_waitcnt lgkmcnt(1)
    v_mfma_f32_32x32x16_bf16 v[24:39], v[102:105], v[96:99], 0
    ds_read_b128 v[108:111], v4 offset:14080
    v_cvt_pk_bf16_f32 v136, v92, v93
    v_cvt_pk_bf16_f32 v137, v94, v95
    v_exp_f32 v88, v40
    v_exp_f32 v89, v41
    v_exp_f32 v90, v42
    v_exp_f32 v91, v43
    v_mfma_f32_32x32x16_bf16 v[56:71], v[118:121], v[134:137], v[56:71]
    s_add_u32 m0, s85, 86016
    ds_read_b64 v[112:113], v139 offset:3840
    s_add_u32 s68, s84, 4096
    buffer_load_dwordx4 v9, s[16:19], s68 offen sc1 lds
    s_add_u32 s84, s84, 10240
    v_cvt_pk_bf16_f32 v130, v88, v89
    v_cvt_pk_bf16_f32 v131, v90, v91
    v_exp_f32 v92, v44
    v_exp_f32 v93, v45
    v_exp_f32 v94, v46
    v_exp_f32 v95, v47
    v_mfma_f32_32x32x8bf16_1k v[24:39], v[106:107], v[100:101], v[24:39]
    ds_read_b128 v[114:117], v7 offset:2560
    v_cvt_pk_bf16_f32 v132, v92, v93
    v_cvt_pk_bf16_f32 v133, v94, v95
    v_exp_f32 v88, v48
    v_exp_f32 v89, v49
    v_exp_f32 v90, v50
    v_exp_f32 v91, v51
    v_mfma_f32_32x32x16_bf16 v[56:71], v[122:125], v[130:133], v[56:71]
    ds_read_b128 v[118:121], v7 offset:3200
    buffer_load_dwordx2 v[22:23], v13, s[16:19], s90 offen offset:1724 sc1
    s_add_u32 s90, s90, 3328
    v_cvt_pk_bf16_f32 v134, v88, v89
    v_cvt_pk_bf16_f32 v135, v90, v91
    v_exp_f32 v92, v52
    v_exp_f32 v93, v53
    v_exp_f32 v94, v54
    v_exp_f32 v95, v55
    s_waitcnt vmcnt(6)
    s_barrier
    s_waitcnt lgkmcnt(1)
    v_mfma_f32_32x32x16_bf16 v[40:55], v[108:111], v[96:99], 0
    ds_read_b128 v[102:105], v4 offset:20480
    v_cvt_pk_bf16_f32 v136, v92, v93
    v_cvt_pk_bf16_f32 v137, v94, v95
    v_exp_f32 v88, v24
    v_exp_f32 v89, v25
    v_exp_f32 v90, v26
    v_exp_f32 v91, v27
    v_mfma_f32_32x32x16_bf16 v[56:71], v[126:129], v[134:137], v[56:71]
    s_add_u32 m0, s83, 0
    ds_read_b64 v[106:107], v140 offset:0
    buffer_load_dwordx4 v9, s[16:19], s82 offen sc1 lds
    v_cvt_pk_bf16_f32 v130, v88, v89
    v_cvt_pk_bf16_f32 v131, v90, v91
    v_exp_f32 v92, v28
    v_exp_f32 v93, v29
    v_exp_f32 v94, v30
    v_exp_f32 v95, v31
    v_mfma_f32_32x32x8bf16_1k v[40:55], v[112:113], v[100:101], v[40:55]
    ds_read_b128 v[122:125], v7 offset:3840
    v_cvt_pk_bf16_f32 v132, v92, v93
    v_cvt_pk_bf16_f32 v133, v94, v95
    v_exp_f32 v88, v32
    v_exp_f32 v89, v33
    v_exp_f32 v90, v34
    v_exp_f32 v91, v35
    v_mfma_f32_32x32x16_bf16 v[56:71], v[114:117], v[130:133], v[56:71]
    ds_read_b128 v[126:129], v7 offset:4480
    buffer_load_dword v10, s[16:19], s82 offen offset:1024 sc1 lds
    s_add_u32 s82, s82, 5120
    v_cvt_pk_bf16_f32 v134, v88, v89
    v_cvt_pk_bf16_f32 v135, v90, v91
    v_exp_f32 v92, v36
    v_exp_f32 v93, v37
    v_exp_f32 v94, v38
    v_exp_f32 v95, v39
    s_waitcnt lgkmcnt(1)
    v_mfma_f32_32x32x16_bf16 v[24:39], v[102:105], v[96:99], 0
    ds_read_b128 v[108:111], v4 offset:21760
    v_cvt_pk_bf16_f32 v136, v92, v93
    v_cvt_pk_bf16_f32 v137, v94, v95
    v_exp_f32 v88, v40
    v_exp_f32 v89, v41
    v_exp_f32 v90, v42
    v_exp_f32 v91, v43
    v_mfma_f32_32x32x16_bf16 v[56:71], v[118:121], v[134:137], v[56:71]
    ds_read_b64 v[112:113], v140 offset:1280
    buffer_load_dwordx4 v[220:223], v9, s[16:19], s98 offen offset:1024 sc1
    v_cvt_pk_bf16_f32 v130, v88, v89
    v_cvt_pk_bf16_f32 v131, v90, v91
    v_exp_f32 v92, v44
    v_exp_f32 v93, v45
    v_exp_f32 v94, v46
    v_exp_f32 v95, v47
    v_mfma_f32_32x32x8bf16_1k v[24:39], v[106:107], v[100:101], v[24:39]
    ds_read_b128 v[114:117], v8 offset:0
    v_cvt_pk_bf16_f32 v132, v92, v93
    v_cvt_pk_bf16_f32 v133, v94, v95
    v_exp_f32 v88, v48
    v_exp_f32 v89, v49
    v_exp_f32 v90, v50
    v_exp_f32 v91, v51
    v_mfma_f32_32x32x16_bf16 v[56:71], v[122:125], v[130:133], v[56:71]
    ds_read_b128 v[118:121], v8 offset:640
    buffer_load_dwordx4 v[224:227], v9, s[16:19], s86 offen offset:2048 sc1
    v_cvt_pk_bf16_f32 v134, v88, v89
    v_cvt_pk_bf16_f32 v135, v90, v91
    v_exp_f32 v92, v52
    v_exp_f32 v93, v53
    v_exp_f32 v94, v54
    v_exp_f32 v95, v55
    s_waitcnt lgkmcnt(1)
    v_mfma_f32_32x32x16_bf16 v[40:55], v[108:111], v[96:99], 0
    ds_read_b128 v[102:105], v4 offset:23040
    v_cvt_pk_bf16_f32 v136, v92, v93
    v_cvt_pk_bf16_f32 v137, v94, v95
    v_exp_f32 v88, v24
    v_exp_f32 v89, v25
    v_exp_f32 v90, v26
    v_exp_f32 v91, v27
    v_mfma_f32_32x32x16_bf16 v[56:71], v[126:129], v[134:137], v[56:71]
    ds_read_b64 v[106:107], v140 offset:2560
    buffer_load_dwordx4 v[228:231], v9, s[16:19], s98 offen offset:2048 sc1
    v_cvt_pk_bf16_f32 v130, v88, v89
    v_cvt_pk_bf16_f32 v131, v90, v91
    v_exp_f32 v92, v28
    v_exp_f32 v93, v29
    v_exp_f32 v94, v30
    v_exp_f32 v95, v31
    v_mfma_f32_32x32x8bf16_1k v[40:55], v[112:113], v[100:101], v[40:55]
    ds_read_b128 v[122:125], v8 offset:1280
    v_cvt_pk_bf16_f32 v132, v92, v93
    v_cvt_pk_bf16_f32 v133, v94, v95
    v_exp_f32 v88, v32
    v_exp_f32 v89, v33
    v_exp_f32 v90, v34
    v_exp_f32 v91, v35
    v_mfma_f32_32x32x16_bf16 v[56:71], v[114:117], v[130:133], v[56:71]
    ds_read_b128 v[126:129], v8 offset:1920
    buffer_load_dwordx4 v[232:235], v9, s[16:19], s86 offen offset:3072 sc1
    s_add_u32 s86, s86, 4096
    v_cvt_pk_bf16_f32 v134, v88, v89
    v_cvt_pk_bf16_f32 v135, v90, v91
    v_exp_f32 v92, v36
    v_exp_f32 v93, v37
    v_exp_f32 v94, v38
    v_exp_f32 v95, v39
    s_waitcnt lgkmcnt(1)
    v_mfma_f32_32x32x16_bf16 v[24:39], v[102:105], v[96:99], 0
    ds_read_b128 v[108:111], v4 offset:24320
    v_cvt_pk_bf16_f32 v136, v92, v93
    v_cvt_pk_bf16_f32 v137, v94, v95
    v_exp_f32 v88, v40
    v_exp_f32 v89, v41
    v_exp_f32 v90, v42
    v_exp_f32 v91, v43
    v_mfma_f32_32x32x16_bf16 v[56:71], v[118:121], v[134:137], v[56:71]
    ds_read_b64 v[112:113], v140 offset:3840
    buffer_load_dwordx4 v[236:239], v9, s[16:19], s98 offen offset:3072 sc1
    s_add_u32 s98, s98, 4096
    v_cvt_pk_bf16_f32 v130, v88, v89
    v_cvt_pk_bf16_f32 v131, v90, v91
    v_exp_f32 v92, v44
    v_exp_f32 v93, v45
    v_exp_f32 v94, v46
    v_exp_f32 v95, v47
    v_mfma_f32_32x32x8bf16_1k v[24:39], v[106:107], v[100:101], v[24:39]
    ds_read_b128 v[114:117], v8 offset:2560
    v_cvt_pk_bf16_f32 v132, v92, v93
    v_cvt_pk_bf16_f32 v133, v94, v95
    v_exp_f32 v88, v48
    v_exp_f32 v89, v49
    v_exp_f32 v90, v50
    v_exp_f32 v91, v51
    v_mfma_f32_32x32x16_bf16 v[56:71], v[122:125], v[130:133], v[56:71]
    ds_read_b128 v[118:121], v8 offset:3200
    buffer_load_dwordx2 v[22:23], v13, s[16:19], s90 offen offset:60 sc1
    v_cvt_pk_bf16_f32 v134, v88, v89
    v_cvt_pk_bf16_f32 v135, v90, v91
    v_exp_f32 v92, v52
    v_exp_f32 v93, v53
    v_exp_f32 v94, v54
    v_exp_f32 v95, v55
    s_waitcnt vmcnt(6)
    s_barrier
    s_waitcnt lgkmcnt(1)
    v_mfma_f32_32x32x16_bf16 v[40:55], v[108:111], v[96:99], 0
    ds_read_b128 v[102:105], v4 offset:0
    v_cvt_pk_bf16_f32 v136, v92, v93
    v_cvt_pk_bf16_f32 v137, v94, v95
    v_exp_f32 v88, v24
    v_exp_f32 v89, v25
    v_exp_f32 v90, v26
    v_exp_f32 v91, v27
    v_mfma_f32_32x32x16_bf16 v[56:71], v[126:129], v[134:137], v[56:71]
    ds_read_b64 v[106:107], v5 offset:0
    buffer_load_dwordx4 v[240:243], v9, s[16:19], s86 offen sc1
    v_cvt_pk_bf16_f32 v130, v88, v89
    v_cvt_pk_bf16_f32 v131, v90, v91
    v_exp_f32 v92, v28
    v_exp_f32 v93, v29
    v_exp_f32 v94, v30
    v_exp_f32 v95, v31
    v_mfma_f32_32x32x8bf16_1k v[40:55], v[112:113], v[100:101], v[40:55]
    ds_read_b128 v[122:125], v8 offset:3840
    v_cvt_pk_bf16_f32 v132, v92, v93
    v_cvt_pk_bf16_f32 v133, v94, v95
    v_exp_f32 v88, v32
    v_exp_f32 v89, v33
    v_exp_f32 v90, v34
    v_exp_f32 v91, v35
    v_mfma_f32_32x32x16_bf16 v[56:71], v[114:117], v[130:133], v[56:71]
    ds_read_b128 v[126:129], v8 offset:4480
    buffer_load_dwordx4 v[244:247], v9, s[16:19], s98 offen sc1
    v_cvt_pk_bf16_f32 v134, v88, v89
    v_cvt_pk_bf16_f32 v135, v90, v91
    v_exp_f32 v92, v36
    v_exp_f32 v93, v37
    v_exp_f32 v94, v38
    v_exp_f32 v95, v39
    s_waitcnt lgkmcnt(1)
    v_mfma_f32_32x32x16_bf16 v[24:39], v[102:105], v[96:99], 0
    ds_read_b128 v[108:111], v4 offset:1280
    v_cvt_pk_bf16_f32 v136, v92, v93
    v_cvt_pk_bf16_f32 v137, v94, v95
    v_exp_f32 v88, v40
    v_exp_f32 v89, v41
    v_exp_f32 v90, v42
    v_exp_f32 v91, v43
    v_mfma_f32_32x32x16_bf16 v[56:71], v[118:121], v[134:137], v[56:71]
    ds_read_b64 v[112:113], v5 offset:1280
    buffer_load_dwordx4 v[248:251], v9, s[16:19], s92 offen sc1
    v_cvt_pk_bf16_f32 v130, v88, v89
    v_cvt_pk_bf16_f32 v131, v90, v91
    v_exp_f32 v92, v44
    v_exp_f32 v93, v45
    v_exp_f32 v94, v46
    v_exp_f32 v95, v47
    v_mfma_f32_32x32x8bf16_1k v[24:39], v[106:107], v[100:101], v[24:39]
    ds_read_b128 v[114:117], v6 offset:0
    v_cvt_pk_bf16_f32 v132, v92, v93
    v_cvt_pk_bf16_f32 v133, v94, v95
    v_exp_f32 v88, v48
    v_exp_f32 v89, v49
    v_exp_f32 v90, v50
    v_exp_f32 v91, v51
    v_mfma_f32_32x32x16_bf16 v[56:71], v[122:125], v[130:133], v[56:71]
    ds_read_b128 v[118:121], v6 offset:640
    buffer_load_dwordx2 v[22:23], v13, s[16:19], s90 offen offset:60 sc1
    v_cvt_pk_bf16_f32 v134, v88, v89
    v_cvt_pk_bf16_f32 v135, v90, v91
    v_exp_f32 v92, v52
    v_exp_f32 v93, v53
    v_exp_f32 v94, v54
    v_exp_f32 v95, v55
    s_waitcnt lgkmcnt(1)
    v_mfma_f32_32x32x16_bf16 v[40:55], v[108:111], v[96:99], 0
    ds_read_b128 v[102:105], v4 offset:2560
    v_cvt_pk_bf16_f32 v136, v92, v93
    v_cvt_pk_bf16_f32 v137, v94, v95
    v_exp_f32 v88, v24
    v_exp_f32 v89, v25
    v_exp_f32 v90, v26
    v_exp_f32 v91, v27
    v_mfma_f32_32x32x16_bf16 v[56:71], v[126:129], v[134:137], v[56:71]
    ds_read_b64 v[106:107], v5 offset:2560
    buffer_load_dwordx2 v[22:23], v13, s[16:19], s90 offen offset:1724 sc1
    s_add_u32 s90, s90, 3328
    v_cvt_pk_bf16_f32 v130, v88, v89
    v_cvt_pk_bf16_f32 v131, v90, v91
    v_exp_f32 v92, v28
    v_exp_f32 v93, v29
    v_exp_f32 v94, v30
    v_exp_f32 v95, v31
    v_mfma_f32_32x32x8bf16_1k v[40:55], v[112:113], v[100:101], v[40:55]
    ds_read_b128 v[122:125], v6 offset:1280
    v_cvt_pk_bf16_f32 v132, v92, v93
    v_cvt_pk_bf16_f32 v133, v94, v95
    v_exp_f32 v88, v32
    v_exp_f32 v89, v33
    v_exp_f32 v90, v34
    v_exp_f32 v91, v35
    v_mfma_f32_32x32x16_bf16 v[56:71], v[114:117], v[130:133], v[56:71]
    ds_read_b128 v[126:129], v6 offset:1920
    s_getpc_b64 s[70:71]
L_pc_L_normY:
    s_add_u32 s70, s70, L_norm-L_pc_L_normY
    s_addc_u32 s71, s71, 0
    s_and_b32 s72, s3, 63
    s_min_u32 s72, s72, (L_end-L_norm)/128-1
    s_lshl_b32 s72, s72, 7
    s_add_u32 s70, s70, s72
    s_addc_u32 s71, s71, 0
    v_mov_b32 v2, s70
    v_mov_b32 v3, s71
    global_load_dword v1, v[2:3], off
    v_cvt_pk_bf16_f32 v134, v88, v89
    v_cvt_pk_bf16_f32 v135, v90, v91
    v_exp_f32 v92, v36
    v_exp_f32 v93, v37
    v_exp_f32 v94, v38
    v_exp_f32 v95, v39
    s_waitcnt lgkmcnt(1)
    v_mfma_f32_32x32x16_bf16 v[24:39], v[102:105], v[96:99], 0
    ds_read_b128 v[108:111], v4 offset:3840
    v_cvt_pk_bf16_f32 v136, v92, v93
    v_cvt_pk_bf16_f32 v137, v94, v95
    v_exp_f32 v88, v40
    v_exp_f32 v89, v41
    v_exp_f32 v90, v42
    v_exp_f32 v91, v43
    v_mfma_f32_32x32x16_bf16 v[56:71], v[118:121], v[134:137], v[56:71]
    ds_read_b64 v[112:113], v5 offset:3840
    v_cvt_pk_bf16_f32 v130, v88, v89
    v_cvt_pk_bf16_f32 v131, v90, v91
    v_exp_f32 v92, v44
    v_exp_f32 v93, v45
    v_exp_f32 v94, v46
    v_exp_f32 v95, v47
    v_mfma_f32_32x32x8bf16_1k v[24:39], v[106:107], v[100:101], v[24:39]
    ds_read_b128 v[114:117], v6 offset:2560
    v_cvt_pk_bf16_f32 v132, v92, v93
    v_cvt_pk_bf16_f32 v133, v94, v95
    v_exp_f32 v88, v48
    v_exp_f32 v89, v49
    v_exp_f32 v90, v50
    v_exp_f32 v91, v51
    v_mfma_f32_32x32x16_bf16 v[56:71], v[122:125], v[130:133], v[56:71]
    ds_read_b128 v[118:121], v6 offset:3200
    v_cvt_pk_bf16_f32 v134, v88, v89
    v_cvt_pk_bf16_f32 v135, v90, v91
    v_exp_f32 v92, v52
    v_exp_f32 v93, v53
    v_exp_f32 v94, v54
    v_exp_f32 v95, v55
    s_waitcnt lgkmcnt(1)
    v_mfma_f32_32x32x16_bf16 v[40:55], v[108:111], v[96:99], 0
    v_cvt_pk_bf16_f32 v136, v92, v93
    v_cvt_pk_bf16_f32 v137, v94, v95
    v_exp_f32 v88, v24
    v_exp_f32 v89, v25
    v_exp_f32 v90, v26
    v_exp_f32 v91, v27
    v_mfma_f32_32x32x16_bf16 v[56:71], v[126:129], v[134:137], v[56:71]
    v_cvt_pk_bf16_f32 v130, v88, v89
    v_cvt_pk_bf16_f32 v131, v90, v91
    v_exp_f32 v92, v28
    v_exp_f32 v93, v29
    v_exp_f32 v94, v30
    v_exp_f32 v95, v31
    v_mfma_f32_32x32x8bf16_1k v[40:55], v[112:113], v[100:101], v[40:55]
    ds_read_b128 v[122:125], v6 offset:3840
    v_cvt_pk_bf16_f32 v132, v92, v93
    v_cvt_pk_bf16_f32 v133, v94, v95
    v_exp_f32 v88, v32
    v_exp_f32 v89, v33
    v_exp_f32 v90, v34
    v_exp_f32 v91, v35
    v_mfma_f32_32x32x16_bf16 v[56:71], v[114:117], v[130:133], v[56:71]
    ds_read_b128 v[126:129], v6 offset:4480
    v_cvt_pk_bf16_f32 v134, v88, v89
    v_cvt_pk_bf16_f32 v135, v90, v91
    v_exp_f32 v92, v36
    v_exp_f32 v93, v37
    v_exp_f32 v94, v38
    v_exp_f32 v95, v39
    v_cvt_pk_bf16_f32 v136, v92, v93
    v_cvt_pk_bf16_f32 v137, v94, v95
    v_exp_f32 v88, v40
    v_exp_f32 v89, v41
    v_exp_f32 v90, v42
    v_exp_f32 v91, v43
    s_waitcnt lgkmcnt(2)
    v_mfma_f32_32x32x16_bf16 v[56:71], v[118:121], v[134:137], v[56:71]
    v_cvt_pk_bf16_f32 v130, v88, v89
    v_cvt_pk_bf16_f32 v131, v90, v91
    v_exp_f32 v92, v44
    v_exp_f32 v93, v45
    v_exp_f32 v94, v46
    v_exp_f32 v95, v47
    v_cvt_pk_bf16_f32 v132, v92, v93
    v_cvt_pk_bf16_f32 v133, v94, v95
    v_exp_f32 v88, v48
    v_exp_f32 v89, v49
    v_exp_f32 v90, v50
    v_exp_f32 v91, v51
    s_waitcnt lgkmcnt(1)
    v_mfma_f32_32x32x16_bf16 v[56:71], v[122:125], v[130:133], v[56:71]
    v_cvt_pk_bf16_f32 v134, v88, v89
    v_cvt_pk_bf16_f32 v135, v90, v91
    v_exp_f32 v92, v52
    v_exp_f32 v93, v53
    v_exp_f32 v94, v54
    v_exp_f32 v95, v55
    v_cvt_pk_bf16_f32 v136, v92, v93
    v_cvt_pk_bf16_f32 v137, v94, v95
    s_waitcnt lgkmcnt(0)
    s_nop 0
    v_mfma_f32_32x32x16_bf16 v[56:71], v[126:129], v[134:137], v[56:71]
    s_setprio 0
L_attE:
    s_nop 7
    s_waitcnt vmcnt(0)
    v_bfe_u32 v1, v0, 4, 1
    v_mul_u32_u24 v1, 20480, v1
    v_and_b32 v2, 15, v0
    v_lshrrev_b32 v3, 5, v0
    v_lshl_add_u32 v22, v2, 3, v1
    v_lshl_add_u32 v22, v3, 30, v22
    v_lshl_add_u32 v23, v2, 4, v1
    v_lshl_add_u32 v23, v3, 8, v23
    s_lshl_b32 s68, s81, 3
    s_add_u32 s68, s68, s36
    s_mul_i32 s69, s68, 40960
    s_add_u32 s69, s69, 8192000
    s_lshl_b32 s70, s80, 9
    s_add_u32 s70, s70, s69
    s_lshl_b32 s71, s80, 7
    s_add_u32 s71, s71, s69
    s_add_u32 s71, s71, 16384
    s_mov_b32 s88, 0x71800000
    s_mov_b32 s87, 0x2b800000
    v_pk_mul_f32 v[2:3], v[56:57], 0
    v_pk_fma_f32 v[2:3], v[58:59], 0, v[2:3]
    v_pk_fma_f32 v[2:3], v[60:61], 0, v[2:3]
    v_pk_fma_f32 v[2:3], v[62:63], 0, v[2:3]
    v_pk_fma_f32 v[2:3], v[64:65], 0, v[2:3]
    v_pk_fma_f32 v[2:3], v[66:67], 0, v[2:3]
    v_add_f32 v1, v2, v3
    v_mov_b32 v2, v64
    v_mov_b32 v3, v64
    s_nop 1
    v_permlane32_swap_b32 v2, v3
    v_add_f32 v1, v1, v3
    v_cmp_nge_f32 vcc, s88, v1
    v_cmp_nle_f32 s[4:5], s87, v1
    s_nop 1
    s_or_b64 vcc, vcc, s[4:5]
    s_cbranch_vccnz L_fallback
L_norm:
    v_rcp_f32 v2, v3
    s_nop 0
    v_mul_f32 v2, v2, v138
    v_mov_b32 v3, v2
    v_pk_mul_f32 v[56:57], v[56:57], v[2:3]
    v_pk_mul_f32 v[58:59], v[58:59], v[2:3]
    v_pk_mul_f32 v[60:61], v[60:61], v[2:3]
    v_pk_mul_f32 v[62:63], v[62:63], v[2:3]
    v_pk_mul_f32 v[64:65], v[64:65], v[2:3]
    v_pk_mul_f32 v[66:67], v[66:67], v[2:3]
    v_cvt_pk_bf16_f32 v56, v56, v57
    v_cvt_pk_bf16_f32 v57, v58, v59
    v_cvt_pk_bf16_f32 v58, v60, v61
    v_cvt_pk_bf16_f32 v59, v62, v63
    v_min_u32 v56, -2, v56
    v_min_u32 v57, -2, v57
    v_min_u32 v58, -2, v58
    v_min_u32 v59, -2, v59
    buffer_store_dwordx4 v[56:59], v23, s[16:19], s70 offen sc1
    v_cvt_pk_bf16_f32 v64, v64, v65
    v_cvt_pk_bf16_f32 v65, v66, v67
    v_min_u32 v64, -2, v64
    v_min_u32 v65, -2, v65
    buffer_store_dwordx2 v[64:65], v22, s[16:19], s71 offen sc1
    s_mul_i32 s68, s96, 10240
    v_add_u32 v4, s68, v9
    s_mov_b32 s88, 76800
    s_barrier
    ds_read_b128 v[64:67], v4 offset:0
    ds_read_b128 v[84:87], v4 offset:5120
    ds_read_b128 v[68:71], v4 offset:1024
    ds_read_b128 v[88:91], v4 offset:6144
    ds_read_b128 v[72:75], v4 offset:2048
    ds_read_b128 v[92:95], v4 offset:7168
    ds_read_b128 v[76:79], v4 offset:3072
    ds_read_b128 v[96:99], v4 offset:8192
    ds_read_b128 v[80:83], v4 offset:4096
    ds_read_b128 v[100:103], v4 offset:9216
    s_waitcnt lgkmcnt(8)
    v_mfma_f32_16x16x32_bf16 v[24:27], v[144:147], v[64:67], 0
    v_mfma_f32_16x16x32_bf16 v[24:27], v[152:155], v[84:87], v[24:27]
    s_lshl_b32 s72, s80, 1
    s_add_u32 s72, s72, s97
    s_mul_i32 s72, s72, 40960
    s_add_u32 s72, s72, 8192000
    v_mfma_f32_16x16x32_bf16 v[44:47], v[148:151], v[64:67], 0
    s_add_u32 m0, s85, 122880
    v_mfma_f32_16x16x32_bf16 v[44:47], v[156:159], v[84:87], v[44:47]
    buffer_load_dwordx4 v9, s[16:19], s84 offen sc1 lds
    s_waitcnt lgkmcnt(6)
    v_mfma_f32_16x16x32_bf16 v[28:31], v[144:147], v[68:71], 0
    v_add_u32 v4, 40960, v4
    ds_read_b128 v[64:67], v4 offset:0
    v_mfma_f32_16x16x32_bf16 v[28:31], v[152:155], v[88:91], v[28:31]
    s_mul_i32 s71, s38, 20480
    s_add_u32 s70, s72, 20480
    s_sub_u32 s70, s70, s71
    s_add_u32 s72, s72, s71
    v_mfma_f32_16x16x32_bf16 v[48:51], v[148:151], v[68:71], 0
    ds_read_b128 v[84:87], v4 offset:5120
    s_add_u32 m0, s85, 122880
    v_mfma_f32_16x16x32_bf16 v[48:51], v[156:159], v[88:91], v[48:51]
    buffer_load_dwordx4 v9, s[16:19], s84 offen offset:1024 sc1 lds
    s_waitcnt lgkmcnt(6)
    v_mfma_f32_16x16x32_bf16 v[32:35], v[144:147], v[72:75], 0
    ds_read_b128 v[68:71], v4 offset:1024
    s_add_u32 m0, s85, 122880
    v_mfma_f32_16x16x32_bf16 v[32:35], v[152:155], v[92:95], v[32:35]
    buffer_load_dwordx4 v9, s[16:19], s84 offen offset:2048 sc1 lds
    v_mfma_f32_16x16x32_bf16 v[52:55], v[148:151], v[72:75], 0
    ds_read_b128 v[88:91], v4 offset:6144
    v_mfma_f32_16x16x32_bf16 v[52:55], v[156:159], v[92:95], v[52:55]
    s_lshl_b32 s71, s96, 12
    s_add_u32 s86, s71, s72
    s_add_u32 s98, s71, s70
    s_lshl_b32 s71, s96, 10
    s_waitcnt lgkmcnt(6)
    v_mfma_f32_16x16x32_bf16 v[36:39], v[144:147], v[76:79], 0
    ds_read_b128 v[72:75], v4 offset:2048
    s_add_u32 m0, s85, 122880
    v_mfma_f32_16x16x32_bf16 v[36:39], v[152:155], v[96:99], v[36:39]
    buffer_load_dwordx4 v9, s[16:19], s84 offen offset:3072 sc1 lds
    v_mfma_f32_16x16x32_bf16 v[56:59], v[148:151], v[76:79], 0
    ds_read_b128 v[92:95], v4 offset:7168
    v_mfma_f32_16x16x32_bf16 v[56:59], v[156:159], v[96:99], v[56:59]
    s_add_u32 s71, s71, 16384
    s_add_u32 s82, s71, s72
    s_add_u32 s83, s71, s70
    v_and_b32 v1, 15, v0
    s_waitcnt lgkmcnt(6)
    v_mfma_f32_16x16x32_bf16 v[40:43], v[144:147], v[80:83], 0
    ds_read_b128 v[76:79], v4 offset:3072
    s_add_u32 m0, s85, 126976
    v_mfma_f32_16x16x32_bf16 v[40:43], v[152:155], v[100:103], v[40:43]
    s_add_u32 s68, s84, 4096
    buffer_load_dwordx4 v9, s[16:19], s68 offen sc1 lds
    s_add_u32 s84, s84, 10240
    v_mfma_f32_16x16x32_bf16 v[60:63], v[148:151], v[80:83], 0
    ds_read_b128 v[96:99], v4 offset:8192
    v_mfma_f32_16x16x32_bf16 v[60:63], v[156:159], v[100:103], v[60:63]
    v_lshrrev_b32 v2, 4, v0
    v_lshlrev_b32 v2, 7, v2
    v_lshl_add_u32 v8, v1, 3, v2
    v_sub_f32 v14, 1.0, v14
    ds_read_b128 v[80:83], v4 offset:4096
    ds_read_b128 v[100:103], v4 offset:9216
    s_waitcnt lgkmcnt(8)
    v_mfma_f32_16x16x32_bf16 v[24:27], v[160:163], v[64:67], v[24:27]
    v_mfma_f32_16x16x32_bf16 v[24:27], v[168:171], v[84:87], v[24:27]
    s_barrier
    v_cvt_pk_bf16_f32 v14, v14, v14
    v_and_b32 v14, 0xffff0000, v14
    v_sub_f32 v15, 1.0, v15
    v_cvt_pk_bf16_f32 v15, v15, v15
    v_mfma_f32_16x16x32_bf16 v[44:47], v[164:167], v[64:67], v[44:47]
    s_add_u32 m0, s85, 0
    v_mfma_f32_16x16x32_bf16 v[44:47], v[172:175], v[84:87], v[44:47]
    buffer_load_dwordx4 v9, s[16:19], s84 offen sc1 lds
    s_waitcnt lgkmcnt(6)
    v_mfma_f32_16x16x32_bf16 v[28:31], v[160:163], v[68:71], v[28:31]
    v_add_u32 v4, 40960, v4
    ds_read_b128 v[64:67], v4 offset:0
    v_mfma_f32_16x16x32_bf16 v[28:31], v[168:171], v[88:91], v[28:31]
    v_and_b32 v15, 0xffff0000, v15
    v_sub_f32 v16, 1.0, v16
    v_cvt_pk_bf16_f32 v16, v16, v16
    v_and_b32 v16, 0xffff0000, v16
    v_mfma_f32_16x16x32_bf16 v[48:51], v[164:167], v[68:71], v[48:51]
    ds_read_b128 v[84:87], v4 offset:5120
    s_add_u32 m0, s85, 0
    v_mfma_f32_16x16x32_bf16 v[48:51], v[172:175], v[88:91], v[48:51]
    buffer_load_dwordx4 v9, s[16:19], s84 offen offset:1024 sc1 lds
    s_waitcnt lgkmcnt(6)
    v_mfma_f32_16x16x32_bf16 v[32:35], v[160:163], v[72:75], v[32:35]
    ds_read_b128 v[68:71], v4 offset:1024
    s_add_u32 m0, s85, 0
    v_mfma_f32_16x16x32_bf16 v[32:35], v[168:171], v[92:95], v[32:35]
    buffer_load_dwordx4 v9, s[16:19], s84 offen offset:2048 sc1 lds
    v_mfma_f32_16x16x32_bf16 v[52:55], v[164:167], v[72:75], v[52:55]
    ds_read_b128 v[88:91], v4 offset:6144
    v_mfma_f32_16x16x32_bf16 v[52:55], v[172:175], v[92:95], v[52:55]
    v_sub_f32 v17, 1.0, v17
    v_cvt_pk_bf16_f32 v17, v17, v17
    v_and_b32 v17, 0xffff0000, v17
    v_sub_f32 v18, 1.0, v18
    s_waitcnt lgkmcnt(6)
    v_mfma_f32_16x16x32_bf16 v[36:39], v[160:163], v[76:79], v[36:39]
    ds_read_b128 v[72:75], v4 offset:2048
    s_add_u32 m0, s85, 0
    v_mfma_f32_16x16x32_bf16 v[36:39], v[168:171], v[96:99], v[36:39]
    buffer_load_dwordx4 v9, s[16:19], s84 offen offset:3072 sc1 lds
    v_mfma_f32_16x16x32_bf16 v[56:59], v[164:167], v[76:79], v[56:59]
    ds_read_b128 v[92:95], v4 offset:7168
    v_mfma_f32_16x16x32_bf16 v[56:59], v[172:175], v[96:99], v[56:59]
    v_cvt_pk_bf16_f32 v18, v18, v18
    v_and_b32 v18, 0xffff0000, v18
    v_sub_f32 v19, 1.0, v19
    v_cvt_pk_bf16_f32 v19, v19, v19
    s_waitcnt lgkmcnt(6)
    v_mfma_f32_16x16x32_bf16 v[40:43], v[160:163], v[80:83], v[40:43]
    ds_read_b128 v[76:79], v4 offset:3072
    s_add_u32 m0, s85, 4096
    v_mfma_f32_16x16x32_bf16 v[40:43], v[168:171], v[100:103], v[40:43]
    s_add_u32 s68, s84, 4096
    buffer_load_dwordx4 v9, s[16:19], s68 offen sc1 lds
    s_add_u32 s84, s84, 10240
    v_mfma_f32_16x16x32_bf16 v[60:63], v[164:167], v[80:83], v[60:63]
    ds_read_b128 v[96:99], v4 offset:8192
    v_mfma_f32_16x16x32_bf16 v[60:63], v[172:175], v[100:103], v[60:63]
    v_and_b32 v19, 0xffff0000, v19
    v_sub_f32 v20, 1.0, v20
    v_cvt_pk_bf16_f32 v20, v20, v20
    v_and_b32 v20, 0xffff0000, v20
    ds_read_b128 v[80:83], v4 offset:4096
    ds_read_b128 v[100:103], v4 offset:9216
    s_waitcnt lgkmcnt(8)
    v_mfma_f32_16x16x32_bf16 v[24:27], v[176:179], v[64:67], v[24:27]
    v_mfma_f32_16x16x32_bf16 v[24:27], v[184:187], v[84:87], v[24:27]
    s_waitcnt vmcnt(5)
    s_barrier
    v_sub_f32 v21, 1.0, v21
    v_cvt_pk_bf16_f32 v21, v21, v21
    v_and_b32 v21, 0xffff0000, v21
    s_lshl_b32 s72, s36, 3
    v_mfma_f32_16x16x32_bf16 v[44:47], v[180:183], v[64:67], v[44:47]
    s_add_u32 m0, s85, 40960
    v_mfma_f32_16x16x32_bf16 v[44:47], v[188:191], v[84:87], v[44:47]
    buffer_load_dwordx4 v9, s[16:19], s84 offen sc1 lds
    s_waitcnt lgkmcnt(6)
    v_mfma_f32_16x16x32_bf16 v[28:31], v[176:179], v[68:71], v[28:31]
    v_add_u32 v4, 40960, v4
    ds_read_b128 v[64:67], v4 offset:0
    v_mfma_f32_16x16x32_bf16 v[28:31], v[184:187], v[88:91], v[28:31]
    v_lshrrev_b32 v2, 3, v0
    v_add_u32 v2, s72, v2
    v_and_b32 v1, 7, v0
    v_lshrrev_b32 v3, 5, v2
    v_mfma_f32_16x16x32_bf16 v[48:51], v[180:183], v[68:71], v[48:51]
    ds_read_b128 v[84:87], v4 offset:5120
    s_add_u32 m0, s85, 40960
    v_mfma_f32_16x16x32_bf16 v[48:51], v[188:191], v[88:91], v[48:51]
    buffer_load_dwordx4 v9, s[16:19], s84 offen offset:1024 sc1 lds
    s_waitcnt lgkmcnt(6)
    v_mfma_f32_16x16x32_bf16 v[32:35], v[176:179], v[72:75], v[32:35]
    ds_read_b128 v[68:71], v4 offset:1024
    s_add_u32 m0, s85, 40960
    v_mfma_f32_16x16x32_bf16 v[32:35], v[184:187], v[92:95], v[32:35]
    buffer_load_dwordx4 v9, s[16:19], s84 offen offset:2048 sc1 lds
    v_mfma_f32_16x16x32_bf16 v[52:55], v[180:183], v[72:75], v[52:55]
    ds_read_b128 v[88:91], v4 offset:6144
    v_mfma_f32_16x16x32_bf16 v[52:55], v[188:191], v[92:95], v[52:55]
    v_mul_u32_u24 v3, 43264, v3
    v_bfe_u32 v5, v2, 4, 1
    v_mul_u32_u24 v5, 5408, v5
    v_add3_u32 v3, v3, v5, s88
    s_waitcnt lgkmcnt(6)
    v_mfma_f32_16x16x32_bf16 v[36:39], v[176:179], v[76:79], v[36:39]
    ds_read_b128 v[72:75], v4 offset:2048
    s_add_u32 m0, s85, 40960
    v_mfma_f32_16x16x32_bf16 v[36:39], v[184:187], v[96:99], v[36:39]
    buffer_load_dwordx4 v9, s[16:19], s84 offen offset:3072 sc1 lds
    v_mfma_f32_16x16x32_bf16 v[56:59], v[180:183], v[76:79], v[56:59]
    ds_read_b128 v[92:95], v4 offset:7168
    v_mfma_f32_16x16x32_bf16 v[56:59], v[188:191], v[96:99], v[56:59]
    v_lshrrev_b32 v5, 1, v1
    v_mul_u32_u24 v5, 1088, v5
    v_and_b32 v6, 1, v2
    v_mul_u32_u24 v6, 528, v6
    s_waitcnt lgkmcnt(6)
    v_mfma_f32_16x16x32_bf16 v[40:43], v[176:179], v[80:83], v[40:43]
    ds_read_b128 v[76:79], v4 offset:3072
    s_add_u32 m0, s85, 45056
    v_mfma_f32_16x16x32_bf16 v[40:43], v[184:187], v[100:103], v[40:43]
    s_add_u32 s68, s84, 4096
    buffer_load_dwordx4 v9, s[16:19], s68 offen sc1 lds
    s_add_u32 s84, s84, 10240
    v_mfma_f32_16x16x32_bf16 v[60:63], v[180:183], v[80:83], v[60:63]
    ds_read_b128 v[96:99], v4 offset:8192
    v_mfma_f32_16x16x32_bf16 v[60:63], v[188:191], v[100:103], v[60:63]
    v_add3_u32 v3, v3, v5, v6
    v_bfe_u32 v5, v2, 1, 1
    v_lshl_add_u32 v3, v5, 8, v3
    v_bfe_u32 v5, v2, 2, 2
    ds_read_b128 v[80:83], v4 offset:4096
    ds_read_b128 v[100:103], v4 offset:9216
    s_waitcnt lgkmcnt(8)
    v_mfma_f32_16x16x32_bf16 v[24:27], v[192:195], v[64:67], v[24:27]
    v_mfma_f32_16x16x32_bf16 v[24:27], v[200:203], v[84:87], v[24:27]
    s_waitcnt vmcnt(5)
    s_barrier
    s_and_b32 s69, s36, 3
    s_cmp_eq_u32 s69, 3
    s_cselect_b64 s[4:5], 1, -1
    v_lshl_add_u32 v3, v5, 6, v3
    v_and_b32 v5, 1, v1
    v_lshl_add_u32 v10, v5, 5, v3
    v_bfe_u32 v5, v2, 4, 1
    v_mfma_f32_16x16x32_bf16 v[44:47], v[196:199], v[64:67], v[44:47]
    s_add_u32 m0, s85, 81920
    v_mfma_f32_16x16x32_bf16 v[44:47], v[204:207], v[84:87], v[44:47]
    s_mov_b64 exec, s[4:5]
    buffer_load_dwordx4 v9, s[16:19], s84 offen sc1 lds
    s_mov_b64 exec, -1
    s_waitcnt lgkmcnt(6)
    v_mfma_f32_16x16x32_bf16 v[28:31], v[192:195], v[68:71], v[28:31]
    v_subrev_u32 v4, 122880, v4
    ds_read_b128 v[64:67], v4 offset:0
    v_mfma_f32_16x16x32_bf16 v[28:31], v[200:203], v[88:91], v[28:31]
    v_mul_u32_u24 v5, 10816, v5
    v_sub_u32 v5, 5408, v5
    v_add_u32 v7, v10, v5
    v_mul_u32_u24 v2, 1280, v2
    v_mfma_f32_16x16x32_bf16 v[48:51], v[196:199], v[68:71], v[48:51]
    ds_read_b128 v[84:87], v4 offset:5120
    s_add_u32 m0, s85, 81920
    v_mfma_f32_16x16x32_bf16 v[48:51], v[204:207], v[88:91], v[48:51]
    s_mov_b64 exec, s[4:5]
    buffer_load_dwordx4 v9, s[16:19], s84 offen offset:1024 sc1 lds
    s_mov_b64 exec, -1
    s_waitcnt lgkmcnt(6)
    v_mfma_f32_16x16x32_bf16 v[32:35], v[192:195], v[72:75], v[32:35]
    ds_read_b128 v[68:71], v4 offset:1024
    s_add_u32 m0, s85, 81920
    v_mfma_f32_16x16x32_bf16 v[32:35], v[200:203], v[92:95], v[32:35]
    s_mov_b64 exec, s[4:5]
    buffer_load_dwordx4 v9, s[16:19], s84 offen offset:2048 sc1 lds
    s_mov_b64 exec, -1
    v_mfma_f32_16x16x32_bf16 v[52:55], v[196:199], v[72:75], v[52:55]
    ds_read_b128 v[88:91], v4 offset:6144
    v_mfma_f32_16x16x32_bf16 v[52:55], v[204:207], v[92:95], v[52:55]
    v_lshl_add_u32 v11, v1, 4, v2
    s_lshl_b32 s72, s36, 3
    v_lshrrev_b32 v2, 1, v0
    v_add_u32 v2, s72, v2
    s_waitcnt lgkmcnt(6)
    v_mfma_f32_16x16x32_bf16 v[36:39], v[192:195], v[76:79], v[36:39]
    ds_read_b128 v[72:75], v4 offset:2048
    s_add_u32 m0, s85, 81920
    v_mfma_f32_16x16x32_bf16 v[36:39], v[200:203], v[96:99], v[36:39]
    s_mov_b64 exec, s[4:5]
    buffer_load_dwordx4 v9, s[16:19], s84 offen offset:3072 sc1 lds
    s_mov_b64 exec, -1
    v_mfma_f32_16x16x32_bf16 v[56:59], v[196:199], v[76:79], v[56:59]
    ds_read_b128 v[92:95], v4 offset:7168
    v_mfma_f32_16x16x32_bf16 v[56:59], v[204:207], v[96:99], v[56:59]
    v_and_b32 v1, 1, v0
    v_add_u32 v1, 8, v1
    v_lshrrev_b32 v3, 5, v2
    v_mul_u32_u24 v3, 43264, v3
    s_waitcnt lgkmcnt(6)
    v_mfma_f32_16x16x32_bf16 v[40:43], v[192:195], v[80:83], v[40:43]
    ds_read_b128 v[76:79], v4 offset:3072
    s_add_u32 m0, s85, 86016
    v_mfma_f32_16x16x32_bf16 v[40:43], v[200:203], v[100:103], v[40:43]
    s_add_u32 s68, s84, 4096
    s_mov_b64 exec, s[4:5]
    buffer_load_dwordx4 v9, s[16:19], s68 offen sc1 lds
    s_mov_b64 exec, -1
    s_add_u32 s84, s84, 10240
    v_mfma_f32_16x16x32_bf16 v[60:63], v[196:199], v[80:83], v[60:63]
    ds_read_b128 v[96:99], v4 offset:8192
    v_mfma_f32_16x16x32_bf16 v[60:63], v[204:207], v[100:103], v[60:63]
    v_bfe_u32 v5, v2, 4, 1
    v_mul_u32_u24 v5, 5408, v5
    v_add3_u32 v3, v3, v5, s88
    v_lshrrev_b32 v5, 1, v1
    ds_read_b128 v[80:83], v4 offset:4096
    ds_read_b128 v[100:103], v4 offset:9216
    s_waitcnt lgkmcnt(8)
    v_mfma_f32_16x16x32_bf16 v[24:27], v[208:211], v[64:67], v[24:27]
    v_mfma_f32_16x16x32_bf16 v[24:27], v[216:219], v[84:87], v[24:27]
    s_waitcnt vmcnt(5)
    s_barrier
    v_mul_u32_u24 v5, 1088, v5
    v_and_b32 v6, 1, v2
    v_mul_u32_u24 v6, 528, v6
    v_add3_u32 v3, v3, v5, v6
    v_mfma_f32_16x16x32_bf16 v[44:47], v[212:215], v[64:67], v[44:47]
    s_add_u32 m0, s85, 122880
    v_mfma_f32_16x16x32_bf16 v[44:47], v[220:223], v[84:87], v[44:47]
    buffer_load_dwordx4 v9, s[16:19], s84 offen sc1 lds
    s_waitcnt lgkmcnt(6)
    v_mfma_f32_16x16x32_bf16 v[28:31], v[208:211], v[68:71], v[28:31]
    v_add_u32 v4, 40960, v4
    ds_read_b128 v[64:67], v4 offset:0
    v_mfma_f32_16x16x32_bf16 v[28:31], v[216:219], v[88:91], v[28:31]
    v_bfe_u32 v5, v2, 1, 1
    v_lshl_add_u32 v3, v5, 8, v3
    v_bfe_u32 v5, v2, 2, 2
    v_lshl_add_u32 v3, v5, 6, v3
    v_mfma_f32_16x16x32_bf16 v[48:51], v[212:215], v[68:71], v[48:51]
    ds_read_b128 v[84:87], v4 offset:5120
    s_add_u32 m0, s85, 122880
    v_mfma_f32_16x16x32_bf16 v[48:51], v[220:223], v[88:91], v[48:51]
    buffer_load_dwordx4 v9, s[16:19], s84 offen offset:1024 sc1 lds
    s_waitcnt lgkmcnt(6)
    v_mfma_f32_16x16x32_bf16 v[32:35], v[208:211], v[72:75], v[32:35]
    ds_read_b128 v[68:71], v4 offset:1024
    s_add_u32 m0, s85, 122880
    v_mfma_f32_16x16x32_bf16 v[32:35], v[216:219], v[92:95], v[32:35]
    buffer_load_dwordx4 v9, s[16:19], s84 offen offset:2048 sc1 lds
    v_mfma_f32_16x16x32_bf16 v[52:55], v[212:215], v[72:75], v[52:55]
    ds_read_b128 v[88:91], v4 offset:6144
    v_mfma_f32_16x16x32_bf16 v[52:55], v[220:223], v[92:95], v[52:55]
    v_and_b32 v5, 1, v1
    v_lshl_add_u32 v12, v5, 5, v3
    v_bfe_u32 v5, v2, 4, 1
    v_mul_u32_u24 v5, 10816, v5
    s_waitcnt lgkmcnt(6)
    v_mfma_f32_16x16x32_bf16 v[36:39], v[208:211], v[76:79], v[36:39]
    ds_read_b128 v[72:75], v4 offset:2048
    s_add_u32 m0, s85, 122880
    v_mfma_f32_16x16x32_bf16 v[36:39], v[216:219], v[96:99], v[36:39]
    buffer_load_dwordx4 v9, s[16:19], s84 offen offset:3072 sc1 lds
    v_mfma_f32_16x16x32_bf16 v[56:59], v[212:215], v[76:79], v[56:59]
    ds_read_b128 v[92:95], v4 offset:7168
    v_mfma_f32_16x16x32_bf16 v[56:59], v[220:223], v[96:99], v[56:59]
    v_sub_u32 v5, 5408, v5
    v_add_u32 v253, v12, v5
    v_mul_u32_u24 v2, 1280, v2
    v_lshl_add_u32 v13, v1, 4, v2
    s_waitcnt lgkmcnt(6)
    v_mfma_f32_16x16x32_bf16 v[40:43], v[208:211], v[80:83], v[40:43]
    ds_read_b128 v[76:79], v4 offset:3072
    s_add_u32 m0, s85, 126976
    v_mfma_f32_16x16x32_bf16 v[40:43], v[216:219], v[100:103], v[40:43]
    s_add_u32 s68, s84, 4096
    buffer_load_dwordx4 v9, s[16:19], s68 offen sc1 lds
    s_add_u32 s84, s84, 10240
    v_mfma_f32_16x16x32_bf16 v[60:63], v[212:215], v[80:83], v[60:63]
    ds_read_b128 v[96:99], v4 offset:8192
    v_mfma_f32_16x16x32_bf16 v[60:63], v[220:223], v[100:103], v[60:63]
    s_lshl_b32 s72, s97, 2
    s_add_u32 s72, s72, s96
    s_mul_i32 s91, s72, 10816
    s_add_u32 s91, s91, 76800
    ds_read_b128 v[80:83], v4 offset:4096
    ds_read_b128 v[100:103], v4 offset:9216
    s_waitcnt lgkmcnt(8)
    v_mfma_f32_16x16x32_bf16 v[24:27], v[224:227], v[64:67], v[24:27]
    v_mfma_f32_16x16x32_bf16 v[24:27], v[232:235], v[84:87], v[24:27]
    s_waitcnt vmcnt(5)
    s_barrier
    s_mul_i32 s90, s80, 81920
    s_mul_i32 s72, s81, 160
    s_add_u32 s90, s90, s72
    v_mfma_f32_16x16x32_bf16 v[44:47], v[228:231], v[64:67], v[44:47]
    s_add_u32 m0, s85, 0
    v_mfma_f32_16x16x32_bf16 v[44:47], v[236:239], v[84:87], v[44:47]
    buffer_load_dwordx4 v9, s[16:19], s84 offen sc1 lds
    s_waitcnt lgkmcnt(6)
    v_mfma_f32_16x16x32_bf16 v[28:31], v[224:227], v[68:71], v[28:31]
    v_add_u32 v4, 40960, v4
    ds_read_b128 v[64:67], v4 offset:0
    v_mfma_f32_16x16x32_bf16 v[28:31], v[232:235], v[88:91], v[28:31]
    v_mfma_f32_16x16x32_bf16 v[48:51], v[228:231], v[68:71], v[48:51]
    s_mul_i32 s69, s38, 10240
    v_subrev_u32 v22, s69, v4
    ds_read_b128 v[84:87], v22 offset:5120
    s_add_u32 m0, s85, 0
    v_mfma_f32_16x16x32_bf16 v[48:51], v[236:239], v[88:91], v[48:51]
    buffer_load_dwordx4 v9, s[16:19], s84 offen offset:1024 sc1 lds
    s_waitcnt lgkmcnt(6)
    v_mfma_f32_16x16x32_bf16 v[32:35], v[224:227], v[72:75], v[32:35]
    ds_read_b128 v[68:71], v4 offset:1024
    s_add_u32 m0, s85, 0
    v_mfma_f32_16x16x32_bf16 v[32:35], v[232:235], v[92:95], v[32:35]
    buffer_load_dwordx4 v9, s[16:19], s84 offen offset:2048 sc1 lds
    v_mfma_f32_16x16x32_bf16 v[52:55], v[228:231], v[72:75], v[52:55]
    ds_read_b128 v[88:91], v22 offset:6144
    v_mfma_f32_16x16x32_bf16 v[52:55], v[236:239], v[92:95], v[52:55]
    s_waitcnt lgkmcnt(6)
    v_mfma_f32_16x16x32_bf16 v[36:39], v[224:227], v[76:79], v[36:39]
    ds_read_b128 v[72:75], v4 offset:2048
    s_add_u32 m0, s85, 0
    v_mfma_f32_16x16x32_bf16 v[36:39], v[232:235], v[96:99], v[36:39]
    buffer_load_dwordx4 v9, s[16:19], s84 offen offset:3072 sc1 lds
    v_mfma_f32_16x16x32_bf16 v[56:59], v[228:231], v[76:79], v[56:59]
    ds_read_b128 v[92:95], v22 offset:7168
    v_mfma_f32_16x16x32_bf16 v[56:59], v[236:239], v[96:99], v[56:59]
    s_waitcnt lgkmcnt(6)
    v_mfma_f32_16x16x32_bf16 v[40:43], v[224:227], v[80:83], v[40:43]
    ds_read_b128 v[76:79], v4 offset:3072
    s_add_u32 m0, s85, 4096
    v_mfma_f32_16x16x32_bf16 v[40:43], v[232:235], v[100:103], v[40:43]
    s_add_u32 s68, s84, 4096
    buffer_load_dwordx4 v9, s[16:19], s68 offen sc1 lds
    s_add_u32 s84, s84, 10240
    v_mfma_f32_16x16x32_bf16 v[60:63], v[228:231], v[80:83], v[60:63]
    ds_read_b128 v[96:99], v22 offset:8192
    v_mfma_f32_16x16x32_bf16 v[60:63], v[236:239], v[100:103], v[60:63]
    ds_read_b128 v[80:83], v4 offset:4096
    ds_read_b128 v[100:103], v22 offset:9216
    buffer_load_dwordx4 v[104:107], v9, s[16:19], s86 offen offset:0 sc1
    buffer_load_dwordx4 v[108:111], v9, s[16:19], s98 offen offset:0 sc1
    s_waitcnt lgkmcnt(8)
    v_mfma_f32_16x16x32_bf16 v[24:27], v[240:243], v[64:67], v[24:27]
    v_mfma_f32_16x16x32_bf16 v[24:27], v[248:251], v[84:87], v[24:27]
    s_waitcnt vmcnt(7)
    s_barrier
    s_and_b32 s69, s36, 1
    s_cmp_eq_u32 s69, 1
    s_cselect_b64 s[4:5], 1, -1
    buffer_load_dwordx4 v[112:115], v9, s[16:19], s86 offen offset:1024 sc1
    v_mfma_f32_16x16x32_bf16 v[44:47], v[244:247], v[64:67], v[44:47]
    s_add_u32 m0, s85, 40960
    s_mov_b64 exec, s[4:5]
    buffer_load_dwordx4 v9, s[16:19], s84 offen sc1 lds
    s_mov_b64 exec, -1
    s_waitcnt lgkmcnt(6)
    v_mfma_f32_16x16x32_bf16 v[28:31], v[240:243], v[68:71], v[28:31]
    v_add_u32 v4, 40960, v4
    ds_read_b128 v[64:67], v4 offset:0
    v_mfma_f32_16x16x32_bf16 v[28:31], v[248:251], v[88:91], v[28:31]
    buffer_load_dwordx4 v[116:119], v9, s[16:19], s98 offen offset:1024 sc1
    v_mfma_f32_16x16x32_bf16 v[48:51], v[244:247], v[68:71], v[48:51]
    ds_read_b128 v[84:87], v4 offset:5120
    s_add_u32 m0, s85, 40960
    s_mov_b64 exec, s[4:5]
    buffer_load_dwordx4 v9, s[16:19], s84 offen offset:1024 sc1 lds
    s_mov_b64 exec, -1
    s_waitcnt lgkmcnt(6)
    v_mfma_f32_16x16x32_bf16 v[32:35], v[240:243], v[72:75], v[32:35]
    ds_read_b128 v[68:71], v4 offset:1024
    s_add_u32 m0, s85, 40960
    v_mfma_f32_16x16x32_bf16 v[32:35], v[248:251], v[92:95], v[32:35]
    s_mov_b64 exec, s[4:5]
    buffer_load_dwordx4 v9, s[16:19], s84 offen offset:2048 sc1 lds
    s_mov_b64 exec, -1
    v_mfma_f32_16x16x32_bf16 v[52:55], v[244:247], v[72:75], v[52:55]
    ds_read_b128 v[88:91], v4 offset:6144
    buffer_load_dwordx4 v[120:123], v9, s[16:19], s86 offen offset:2048 sc1
    s_waitcnt lgkmcnt(6)
    v_mfma_f32_16x16x32_bf16 v[36:39], v[240:243], v[76:79], v[36:39]
    ds_read_b128 v[72:75], v4 offset:2048
    s_add_u32 m0, s85, 40960
    v_mfma_f32_16x16x32_bf16 v[36:39], v[248:251], v[96:99], v[36:39]
    s_mov_b64 exec, s[4:5]
    buffer_load_dwordx4 v9, s[16:19], s84 offen offset:3072 sc1 lds
    s_mov_b64 exec, -1
    v_mfma_f32_16x16x32_bf16 v[56:59], v[244:247], v[76:79], v[56:59]
    ds_read_b128 v[92:95], v4 offset:7168
    buffer_load_dwordx4 v[124:127], v9, s[16:19], s98 offen offset:2048 sc1
    s_waitcnt lgkmcnt(6)
    v_mfma_f32_16x16x32_bf16 v[40:43], v[240:243], v[80:83], v[40:43]
    ds_read_b128 v[76:79], v4 offset:3072
    s_add_u32 m0, s85, 45056
    v_mfma_f32_16x16x32_bf16 v[40:43], v[248:251], v[100:103], v[40:43]
    s_add_u32 s68, s84, 4096
    s_mov_b64 exec, s[4:5]
    buffer_load_dwordx4 v9, s[16:19], s68 offen sc1 lds
    s_mov_b64 exec, -1
    s_add_u32 s84, s84, 10240
    v_mfma_f32_16x16x32_bf16 v[60:63], v[244:247], v[80:83], v[60:63]
    ds_read_b128 v[96:99], v4 offset:8192
    buffer_load_dwordx4 v[128:131], v9, s[16:19], s86 offen offset:3072 sc1
    ds_read_b128 v[80:83], v4 offset:4096
    ds_read_b128 v[100:103], v4 offset:9216
    s_mov_b32 s87, 40000
    v_pk_mul_f32 v[44:45], v[44:45], v[18:19]
    v_pk_mul_f32 v[46:47], v[46:47], v[20:21]
    v_pk_mul_f32 v[48:49], v[48:49], v[18:19]
    v_pk_mul_f32 v[50:51], v[50:51], v[20:21]
    v_pk_mul_f32 v[52:53], v[52:53], v[18:19]
    v_pk_mul_f32 v[54:55], v[54:55], v[20:21]
    v_pk_mul_f32 v[56:57], v[56:57], v[18:19]
    v_pk_mul_f32 v[58:59], v[58:59], v[20:21]
    v_pk_mul_f32 v[60:61], v[60:61], v[18:19]
    v_pk_mul_f32 v[62:63], v[62:63], v[20:21]
    v_pk_mul_f32 v[24:25], v[24:25], v[14:15]
    v_pk_mul_f32 v[26:27], v[26:27], v[16:17]
    v_pk_mul_f32 v[28:29], v[28:29], v[14:15]
    v_pk_mul_f32 v[30:31], v[30:31], v[16:17]
    v_pk_mul_f32 v[32:33], v[32:33], v[14:15]
    v_pk_mul_f32 v[34:35], v[34:35], v[16:17]
    v_pk_mul_f32 v[36:37], v[36:37], v[14:15]
    v_pk_mul_f32 v[38:39], v[38:39], v[16:17]
    v_pk_mul_f32 v[40:41], v[40:41], v[14:15]
    v_pk_mul_f32 v[42:43], v[42:43], v[16:17]
    s_waitcnt vmcnt(10)
L_ov0:
    v_max3_u32 v1, v104, v105, v106
    v_max3_u32 v2, v107, v108, v109
    v_max3_u32 v1, v1, v110, v111
    v_max_u32 v1, v1, v2
    v_cmp_eq_u32 vcc, -1, v1
    s_nop 1
    s_cbranch_vccnz L_ore0
L_ook0:
    s_waitcnt lgkmcnt(9)
    v_mfma_f32_16x16x32_bf16 v[24:27], v[104:107], v[64:67], v[24:27]
    s_barrier
    buffer_load_dwordx4 v[132:135], v9, s[16:19], s98 offen offset:3072 sc1
    v_mfma_f32_16x16x32_bf16 v[44:47], v[108:111], v[64:67], v[44:47]
    v_subrev_u32 v4, 122880, v4
    ds_read_b128 v[64:67], v4 offset:0
    s_waitcnt lgkmcnt(8)
    v_mfma_f32_16x16x32_bf16 v[28:31], v[104:107], v[68:71], v[28:31]
    buffer_load_dwordx2 v[136:137], v8, s[16:19], s82 offen offset:0 sc1
    v_mfma_f32_16x16x32_bf16 v[48:51], v[108:111], v[68:71], v[48:51]
    ds_read_b128 v[68:71], v4 offset:1024
    s_waitcnt lgkmcnt(7)
    v_mfma_f32_16x16x32_bf16 v[32:35], v[104:107], v[72:75], v[32:35]
    buffer_load_dwordx2 v[138:139], v8, s[16:19], s82 offen offset:512 sc1
    v_mfma_f32_16x16x32_bf16 v[52:55], v[108:111], v[72:75], v[52:55]
    ds_read_b128 v[72:75], v4 offset:2048
    s_waitcnt lgkmcnt(6)
    v_mfma_f32_16x16x32_bf16 v[36:39], v[104:107], v[76:79], v[36:39]
    buffer_load_dwordx2 v[140:141], v8, s[16:19], s83 offen offset:0 sc1
    v_mfma_f32_16x16x32_bf16 v[56:59], v[108:111], v[76:79], v[56:59]
    ds_read_b128 v[76:79], v4 offset:3072
    s_waitcnt lgkmcnt(5)
    v_mfma_f32_16x16x32_bf16 v[40:43], v[104:107], v[80:83], v[40:43]
    buffer_load_dwordx2 v[142:143], v8, s[16:19], s83 offen offset:512 sc1
    v_mfma_f32_16x16x32_bf16 v[60:63], v[108:111], v[80:83], v[60:63]
    ds_read_b128 v[80:83], v4 offset:4096
    s_waitcnt vmcnt(12)
L_ov1:
    v_max3_u32 v1, v112, v113, v114
    v_max3_u32 v2, v115, v116, v117
    v_max3_u32 v1, v1, v118, v119
    v_max_u32 v1, v1, v2
    v_cmp_eq_u32 vcc, -1, v1
    s_nop 1
    s_cbranch_vccnz L_ore1
L_ook1:
    v_mfma_f32_16x16x32_bf16 v[24:27], v[112:115], v[84:87], v[24:27]
    v_mfma_f32_16x16x32_bf16 v[44:47], v[116:119], v[84:87], v[44:47]
    ds_read_b128 v[84:87], v4 offset:5120
    v_mfma_f32_16x16x32_bf16 v[28:31], v[112:115], v[88:91], v[28:31]
    v_mfma_f32_16x16x32_bf16 v[48:51], v[116:119], v[88:91], v[48:51]
    ds_read_b128 v[88:91], v4 offset:6144
    v_mfma_f32_16x16x32_bf16 v[32:35], v[112:115], v[92:95], v[32:35]
    v_mfma_f32_16x16x32_bf16 v[52:55], v[116:119], v[92:95], v[52:55]
    ds_read_b128 v[92:95], v4 offset:7168
    v_mfma_f32_16x16x32_bf16 v[36:39], v[112:115], v[96:99], v[36:39]
    v_mfma_f32_16x16x32_bf16 v[56:59], v[116:119], v[96:99], v[56:59]
    ds_read_b128 v[96:99], v4 offset:8192
    s_waitcnt lgkmcnt(9)
    v_mfma_f32_16x16x32_bf16 v[40:43], v[112:115], v[100:103], v[40:43]
    v_mfma_f32_16x16x32_bf16 v[60:63], v[116:119], v[100:103], v[60:63]
    ds_read_b128 v[100:103], v4 offset:9216
    s_waitcnt vmcnt(7)
L_ov2:
    v_max3_u32 v1, v120, v121, v122
    v_max3_u32 v2, v123, v124, v125
    v_max3_u32 v1, v1, v126, v127
    v_max_u32 v1, v1, v2
    v_cmp_eq_u32 vcc, -1, v1
    s_nop 1
    s_cbranch_vccnz L_ore2
L_ook2:
    s_waitcnt lgkmcnt(9)
    v_mfma_f32_16x16x32_bf16 v[24:27], v[120:123], v[64:67], v[24:27]
    s_waitcnt vmcnt(6)
    s_barrier
    v_mfma_f32_16x16x32_bf16 v[44:47], v[124:127], v[64:67], v[44:47]
    v_add_u32 v4, 40960, v4
    ds_read_b128 v[64:67], v4 offset:0
    s_waitcnt lgkmcnt(9)
    v_mfma_f32_16x16x32_bf16 v[28:31], v[120:123], v[68:71], v[28:31]
    v_mfma_f32_16x16x32_bf16 v[48:51], v[124:127], v[68:71], v[48:51]
    ds_read_b128 v[68:71], v4 offset:1024
    s_waitcnt lgkmcnt(9)
    v_mfma_f32_16x16x32_bf16 v[32:35], v[120:123], v[72:75], v[32:35]
    v_mfma_f32_16x16x32_bf16 v[52:55], v[124:127], v[72:75], v[52:55]
    ds_read_b128 v[72:75], v4 offset:2048
    s_waitcnt lgkmcnt(9)
    v_mfma_f32_16x16x32_bf16 v[36:39], v[120:123], v[76:79], v[36:39]
    v_mfma_f32_16x16x32_bf16 v[56:59], v[124:127], v[76:79], v[56:59]
    ds_read_b128 v[76:79], v4 offset:3072
    s_waitcnt lgkmcnt(9)
    v_mfma_f32_16x16x32_bf16 v[40:43], v[120:123], v[80:83], v[40:43]
    v_mfma_f32_16x16x32_bf16 v[60:63], v[124:127], v[80:83], v[60:63]
    ds_read_b128 v[80:83], v4 offset:4096
    s_waitcnt vmcnt(4)
L_ov3:
    v_max3_u32 v1, v128, v129, v130
    v_max3_u32 v2, v131, v132, v133
    v_max3_u32 v1, v1, v134, v135
    v_max_u32 v1, v1, v2
    v_cmp_eq_u32 vcc, -1, v1
    s_nop 1
    s_cbranch_vccnz L_ore3
L_ook3:
    s_waitcnt lgkmcnt(9)
    v_mfma_f32_16x16x32_bf16 v[24:27], v[128:131], v[84:87], v[24:27]
    v_mfma_f32_16x16x32_bf16 v[44:47], v[132:135], v[84:87], v[44:47]
    s_waitcnt lgkmcnt(8)
    v_mfma_f32_16x16x32_bf16 v[28:31], v[128:131], v[88:91], v[28:31]
    v_mfma_f32_16x16x32_bf16 v[48:51], v[132:135], v[88:91], v[48:51]
    s_waitcnt lgkmcnt(7)
    v_mfma_f32_16x16x32_bf16 v[32:35], v[128:131], v[92:95], v[32:35]
    v_mfma_f32_16x16x32_bf16 v[52:55], v[132:135], v[92:95], v[52:55]
    s_waitcnt lgkmcnt(6)
    v_mfma_f32_16x16x32_bf16 v[36:39], v[128:131], v[96:99], v[36:39]
    v_mfma_f32_16x16x32_bf16 v[56:59], v[132:135], v[96:99], v[56:59]
    s_waitcnt lgkmcnt(5)
    v_mfma_f32_16x16x32_bf16 v[40:43], v[128:131], v[100:103], v[40:43]
    v_mfma_f32_16x16x32_bf16 v[60:63], v[132:135], v[100:103], v[60:63]
    s_waitcnt vmcnt(0)
L_ov4:
    v_max3_u32 v1, v136, v137, v138
    v_max3_u32 v2, v139, v140, v141
    v_max3_u32 v1, v1, v142, v143
    v_max_u32 v1, v1, v2
    v_cmp_eq_u32 vcc, -1, v1
    s_nop 1
    s_cbranch_vccnz L_ore4
L_ook4:
    s_mov_b32 m0, s91
    s_waitcnt lgkmcnt(4)
    v_mfma_f32_16x16x32_bf16 v[24:27], v[136:139], v[64:67], v[24:27]
    v_mfma_f32_16x16x32_bf16 v[44:47], v[140:143], v[64:67], v[44:47]
    s_waitcnt lgkmcnt(3)
    v_mfma_f32_16x16x32_bf16 v[28:31], v[136:139], v[68:71], v[28:31]
    v_mfma_f32_16x16x32_bf16 v[48:51], v[140:143], v[68:71], v[48:51]
    s_nop 3
    ds_write_addtid_b32 v24 offset:0
    ds_write_addtid_b32 v25 offset:528
    ds_write_addtid_b32 v26 offset:256
    ds_write_addtid_b32 v27 offset:784
    ds_write_addtid_b32 v44 offset:5408
    ds_write_addtid_b32 v45 offset:5936
    ds_write_addtid_b32 v46 offset:5664
    ds_write_addtid_b32 v47 offset:6192
    s_waitcnt lgkmcnt(10)
    v_mfma_f32_16x16x32_bf16 v[32:35], v[136:139], v[72:75], v[32:35]
    v_mfma_f32_16x16x32_bf16 v[52:55], v[140:143], v[72:75], v[52:55]
    ds_write_addtid_b32 v28 offset:1088
    ds_write_addtid_b32 v29 offset:1616
    ds_write_addtid_b32 v30 offset:1344
    ds_write_addtid_b32 v31 offset:1872
    ds_write_addtid_b32 v48 offset:6496
    ds_write_addtid_b32 v49 offset:7024
    ds_write_addtid_b32 v50 offset:6752
    ds_write_addtid_b32 v51 offset:7280
    s_waitcnt lgkmcnt(15)
    v_mfma_f32_16x16x32_bf16 v[36:39], v[136:139], v[76:79], v[36:39]
    v_mfma_f32_16x16x32_bf16 v[56:59], v[140:143], v[76:79], v[56:59]
    ds_write_addtid_b32 v32 offset:2176
    ds_write_addtid_b32 v33 offset:2704
    ds_write_addtid_b32 v34 offset:2432
    ds_write_addtid_b32 v35 offset:2960
    ds_write_addtid_b32 v52 offset:7584
    ds_write_addtid_b32 v53 offset:8112
    ds_write_addtid_b32 v54 offset:7840
    ds_write_addtid_b32 v55 offset:8368
    v_mfma_f32_16x16x32_bf16 v[40:43], v[136:139], v[80:83], v[40:43]
    v_mfma_f32_16x16x32_bf16 v[60:63], v[140:143], v[80:83], v[60:63]
    ds_write_addtid_b32 v36 offset:3264
    ds_write_addtid_b32 v37 offset:3792
    ds_write_addtid_b32 v38 offset:3520
    ds_write_addtid_b32 v39 offset:4048
    ds_write_addtid_b32 v56 offset:8672
    ds_write_addtid_b32 v57 offset:9200
    ds_write_addtid_b32 v58 offset:8928
    ds_write_addtid_b32 v59 offset:9456
    ds_write_addtid_b32 v40 offset:4352
    ds_write_addtid_b32 v41 offset:4880
    ds_write_addtid_b32 v42 offset:4608
    ds_write_addtid_b32 v43 offset:5136
    ds_write_addtid_b32 v60 offset:9760
    ds_write_addtid_b32 v61 offset:10288
    ds_write_addtid_b32 v62 offset:10016
    ds_write_addtid_b32 v63 offset:10544
    s_waitcnt lgkmcnt(0)
    s_barrier
    ds_read_b128 v[64:67], v10 offset:0
    ds_read_b128 v[68:71], v10 offset:16
    ds_read_b128 v[72:75], v7 offset:10816
    ds_read_b128 v[76:79], v7 offset:10832
    ds_read_b128 v[80:83], v10 offset:21632
    ds_read_b128 v[84:87], v10 offset:21648
    ds_read_b128 v[88:91], v7 offset:32448
    ds_read_b128 v[92:95], v7 offset:32464
    s_mov_b64 exec, 0xffff
    ds_read_b128 v[96:99], v12 offset:0
    ds_read_b128 v[100:103], v12 offset:16
    ds_read_b128 v[104:107], v253 offset:10816
    ds_read_b128 v[108:111], v253 offset:10832
    ds_read_b128 v[112:115], v12 offset:21632
    ds_read_b128 v[116:119], v12 offset:21648
    ds_read_b128 v[120:123], v253 offset:32448
    ds_read_b128 v[124:127], v253 offset:32464
    s_mov_b64 exec, -1
    s_waitcnt lgkmcnt(12)
    v_pk_add_f32 v[64:65], v[64:65], v[72:73]
    v_pk_add_f32 v[66:67], v[66:67], v[74:75]
    v_pk_add_f32 v[68:69], v[68:69], v[76:77]
    v_pk_add_f32 v[70:71], v[70:71], v[78:79]
    s_waitcnt lgkmcnt(8)
    v_pk_add_f32 v[80:81], v[80:81], v[88:89]
    v_pk_add_f32 v[82:83], v[82:83], v[90:91]
    v_pk_add_f32 v[84:85], v[84:85], v[92:93]
    v_pk_add_f32 v[86:87], v[86:87], v[94:95]
    v_pk_add_f32 v[64:65], v[64:65], v[80:81]
    v_pk_add_f32 v[66:67], v[66:67], v[82:83]
    v_pk_add_f32 v[68:69], v[68:69], v[84:85]
    v_pk_add_f32 v[70:71], v[70:71], v[86:87]
    v_cvt_pk_bf16_f32 v72, v64, v65
    v_cvt_pk_bf16_f32 v73, v66, v67
    v_cvt_pk_bf16_f32 v74, v68, v69
    v_cvt_pk_bf16_f32 v75, v70, v71
    buffer_store_dwordx4 v[72:75], v11, s[24:27], s90 offen
    s_mov_b64 exec, 0xffff
    s_waitcnt lgkmcnt(4)
    v_pk_add_f32 v[96:97], v[96:97], v[104:105]
    v_pk_add_f32 v[98:99], v[98:99], v[106:107]
    v_pk_add_f32 v[100:101], v[100:101], v[108:109]
    v_pk_add_f32 v[102:103], v[102:103], v[110:111]
    s_waitcnt lgkmcnt(0)
    v_pk_add_f32 v[112:113], v[112:113], v[120:121]
    v_pk_add_f32 v[114:115], v[114:115], v[122:123]
    v_pk_add_f32 v[116:117], v[116:117], v[124:125]
    v_pk_add_f32 v[118:119], v[118:119], v[126:127]
    v_pk_add_f32 v[96:97], v[96:97], v[112:113]
    v_pk_add_f32 v[98:99], v[98:99], v[114:115]
    v_pk_add_f32 v[100:101], v[100:101], v[116:117]
    v_pk_add_f32 v[102:103], v[102:103], v[118:119]
    v_cvt_pk_bf16_f32 v104, v96, v97
    v_cvt_pk_bf16_f32 v105, v98, v99
    v_cvt_pk_bf16_f32 v106, v100, v101
    v_cvt_pk_bf16_f32 v107, v102, v103
    buffer_store_dwordx4 v[104:107], v13, s[24:27], s90 offen
L_fin:
    s_endpgm
L_fallback:
    s_mul_i32 s68, s80, 81920
    s_add_u32 s69, s68, 5570560
    s_add_u32 s68, s68, 2949120
    v_and_b32 v1, 31, v0
    v_cmp_gt_u32 vcc, 32, v0
    v_subrev_u32 v90, 123904, v5
    s_nop 0
    v_cndmask_b32 v100, 0, v100, vcc
    v_cndmask_b32 v90, 0, v90, vcc
    v_subrev_u32 v91, 128000, v6
    v_mov_b32 v2, 1073741824
    v_cmp_gt_u32 vcc, 20, v1
    s_nop 1
    v_cndmask_b32 v91, v2, v91, vcc
    v_mov_b32 v2, 0x3f803f80
    v_cndmask_b32 v92, v2, 0, vcc
    v_mov_b32 v88, 0xff800000
    s_mov_b32 s87, 64
    v_mov_b32 v56, 0
    v_mov_b32 v57, 0
    v_mov_b32 v58, 0
    v_mov_b32 v59, 0
    v_mov_b32 v60, 0
    v_mov_b32 v61, 0
    v_mov_b32 v62, 0
    v_mov_b32 v63, 0
    v_mov_b32 v64, 0
    v_mov_b32 v65, 0
    v_mov_b32 v66, 0
    v_mov_b32 v67, 0
    v_mov_b32 v68, 0
    v_mov_b32 v69, 0
    v_mov_b32 v70, 0
    v_mov_b32 v71, 0
L_fb_loop:
    buffer_load_dwordx4 v[102:105], v9, s[16:19], s68 offen sc1
    buffer_load_dwordx2 v[106:107], v90, s[16:19], s68 offen offset:1024 sc1
    buffer_load_dwordx4 v[114:117], v91, s[16:19], s69 offen sc1
    buffer_load_dwordx4 v[118:121], v91, s[16:19], s69 offen offset:640 sc1
    s_add_u32 s68, s68, 1280
    s_add_u32 s69, s69, 1280
    s_waitcnt vmcnt(0)
    v_mfma_f32_32x32x16_bf16 v[24:39], v[102:105], v[96:99], 0
    v_mfma_f32_32x32x8bf16_1k v[24:39], v[106:107], v[100:101], v[24:39]
    v_or_b32 v114, v114, v92
    v_or_b32 v115, v115, v92
    v_or_b32 v116, v116, v92
    v_or_b32 v117, v117, v92
    v_or_b32 v118, v118, v92
    v_or_b32 v119, v119, v92
    v_or_b32 v120, v120, v92
    v_or_b32 v121, v121, v92
    s_nop 3
    v_max3_f32 v1, v24, v25, v88
    v_max3_f32 v1, v1, v26, v27
    v_max3_f32 v1, v1, v28, v29
    v_max3_f32 v1, v1, v30, v31
    v_max3_f32 v1, v1, v32, v33
    v_max3_f32 v1, v1, v34, v35
    v_max3_f32 v1, v1, v36, v37
    v_max3_f32 v1, v1, v38, v39
    v_mov_b32 v2, v1
    s_nop 1
    v_permlane32_swap_b32 v1, v2
    v_max_f32 v1, v1, v2
    v_sub_f32 v89, v88, v1
    v_exp_f32 v89, v89
    v_mov_b32 v88, v1
    v_sub_f32 v24, v24, v1
    v_exp_f32 v24, v24
    v_mul_f32 v56, v56, v89
    v_sub_f32 v25, v25, v1
    v_exp_f32 v25, v25
    v_mul_f32 v57, v57, v89
    v_sub_f32 v26, v26, v1
    v_exp_f32 v26, v26
    v_mul_f32 v58, v58, v89
    v_sub_f32 v27, v27, v1
    v_exp_f32 v27, v27
    v_mul_f32 v59, v59, v89
    v_sub_f32 v28, v28, v1
    v_exp_f32 v28, v28
    v_mul_f32 v60, v60, v89
    v_sub_f32 v29, v29, v1
    v_exp_f32 v29, v29
    v_mul_f32 v61, v61, v89
    v_sub_f32 v30, v30, v1
    v_exp_f32 v30, v30
    v_mul_f32 v62, v62, v89
    v_sub_f32 v31, v31, v1
    v_exp_f32 v31, v31
    v_mul_f32 v63, v63, v89
    v_sub_f32 v32, v32, v1
    v_exp_f32 v32, v32
    v_mul_f32 v64, v64, v89
    v_sub_f32 v33, v33, v1
    v_exp_f32 v33, v33
    v_mul_f32 v65, v65, v89
    v_sub_f32 v34, v34, v1
    v_exp_f32 v34, v34
    v_mul_f32 v66, v66, v89
    v_sub_f32 v35, v35, v1
    v_exp_f32 v35, v35
    v_mul_f32 v67, v67, v89
    v_sub_f32 v36, v36, v1
    v_exp_f32 v36, v36
    v_mul_f32 v68, v68, v89
    v_sub_f32 v37, v37, v1
    v_exp_f32 v37, v37
    v_mul_f32 v69, v69, v89
    v_sub_f32 v38, v38, v1
    v_exp_f32 v38, v38
    v_mul_f32 v70, v70, v89
    v_sub_f32 v39, v39, v1
    v_exp_f32 v39, v39
    v_mul_f32 v71, v71, v89
    v_cvt_pk_bf16_f32 v130, v24, v25
    v_cvt_pk_bf16_f32 v131, v26, v27
    v_cvt_pk_bf16_f32 v132, v28, v29
    v_cvt_pk_bf16_f32 v133, v30, v31
    v_cvt_pk_bf16_f32 v134, v32, v33
    v_cvt_pk_bf16_f32 v135, v34, v35
    v_cvt_pk_bf16_f32 v136, v36, v37
    v_cvt_pk_bf16_f32 v137, v38, v39
    v_mfma_f32_32x32x16_bf16 v[56:71], v[114:117], v[130:133], v[56:71]
    s_nop 0
    v_mfma_f32_32x32x16_bf16 v[56:71], v[118:121], v[134:137], v[56:71]
    s_nop 15
    s_sub_u32 s87, s87, 1
    s_cmp_lg_u32 s87, 0
    s_cbranch_scc1 L_fb_loop
    v_mov_b32 v2, v64
    v_mov_b32 v3, v64
    s_nop 1
    v_permlane32_swap_b32 v2, v3
    s_nop 1
    s_branch L_norm
L_at_N0_1:
    buffer_atomic_add v21, v22, s[28:31], 0 offen sc1
    s_branch L_at_N0_1b
L_at_N0_2:
    buffer_atomic_add v21, v22, s[28:31], 0 offen sc1
    s_branch L_at_N0_2b
L_at_N0_3:
    buffer_atomic_add v21, v22, s[28:31], 0 offen sc1
    s_branch L_at_N0_3b
L_at_N0_4:
    buffer_atomic_add v21, v22, s[28:31], 0 offen sc1
    s_branch L_at_N0_4b
L_at_N0_5:
    buffer_atomic_add v21, v22, s[28:31], 0 offen sc1
    s_branch L_at_N0_5b
L_at_N0_6:
    buffer_atomic_add v21, v22, s[28:31], 0 offen sc1
    s_branch L_at_N0_6b
L_at_N0_7:
    buffer_atomic_add v21, v22, s[28:31], 0 offen sc1
    s_branch L_at_N0_7b
L_at_N0_8:
    buffer_atomic_add v21, v22, s[28:31], 0 offen sc1
    s_branch L_at_N0_8b
L_at_N1_1:
    buffer_atomic_add v21, v22, s[28:31], 0 offen sc1
    s_branch L_at_N1_1b
L_at_N1_2:
    buffer_atomic_add v21, v22, s[28:31], 0 offen sc1
    s_branch L_at_N1_2b
L_at_N1_3:
    buffer_atomic_add v21, v22, s[28:31], 0 offen sc1
    s_branch L_at_N1_3b
L_at_N1_4:
    buffer_atomic_add v21, v22, s[28:31], 0 offen sc1
    s_branch L_at_N1_4b
L_at_N1_5:
    buffer_atomic_add v21, v22, s[28:31], 0 offen sc1
    s_branch L_at_N1_5b
L_at_N1_6:
    buffer_atomic_add v21, v22, s[28:31], 0 offen sc1
    s_branch L_at_N1_6b
L_at_N1_7:
    buffer_atomic_add v21, v22, s[28:31], 0 offen sc1
    s_branch L_at_N1_7b
L_at_N1_8:
    buffer_atomic_add v21, v22, s[28:31], 0 offen sc1
    s_branch L_at_N1_8b
L_at_S0_1:
    buffer_atomic_add v21, v22, s[28:31], 0 offen sc1
    s_branch L_at_S0_1b
L_at_S0_2:
    buffer_atomic_add v21, v22, s[28:31], 0 offen sc1
    s_branch L_at_S0_2b
L_at_S0_3:
    buffer_atomic_add v21, v22, s[28:31], 0 offen sc1
    s_branch L_at_S0_3b
L_at_S0_4:
    buffer_atomic_add v21, v22, s[28:31], 0 offen sc1
    s_branch L_at_S0_4b
L_at_S0_5:
    buffer_atomic_add v21, v22, s[28:31], 0 offen sc1
    s_branch L_at_S0_5b
L_at_S0_6:
    buffer_atomic_add v21, v22, s[28:31], 0 offen sc1
    s_branch L_at_S0_6b
L_at_S0_7:
    buffer_atomic_add v21, v22, s[28:31], 0 offen sc1
    s_branch L_at_S0_7b
L_at_S0_8:
    buffer_atomic_add v21, v22, s[28:31], 0 offen sc1
    s_branch L_at_S0_8b
L_at_S1_1:
    buffer_atomic_add v21, v22, s[28:31], 0 offen sc1
    s_branch L_at_S1_1b
L_at_S1_2:
    buffer_atomic_add v21, v22, s[28:31], 0 offen sc1
    s_branch L_at_S1_2b
L_at_S1_3:
    buffer_atomic_add v21, v22, s[28:31], 0 offen sc1
    s_branch L_at_S1_3b
L_at_S1_4:
    buffer_atomic_add v21, v22, s[28:31], 0 offen sc1
    s_branch L_at_S1_4b
L_at_S1_5:
    buffer_atomic_add v21, v22, s[28:31], 0 offen sc1
    s_branch L_at_S1_5b
L_at_S1_6:
    buffer_atomic_add v21, v22, s[28:31], 0 offen sc1
    s_branch L_at_S1_6b
L_at_S1_7:
    buffer_atomic_add v21, v22, s[28:31], 0 offen sc1
    s_branch L_at_S1_7b
L_at_S1_8:
    buffer_atomic_add v21, v22, s[28:31], 0 offen sc1
    s_branch L_at_S1_8b
L_at_E0_1:
    buffer_atomic_add v21, v22, s[28:31], 0 offen sc1
    s_branch L_at_E0_1b
L_at_E0_2:
    buffer_atomic_add v21, v22, s[28:31], 0 offen sc1
    s_branch L_at_E0_2b
L_at_E0_3:
    buffer_atomic_add v21, v22, s[28:31], 0 offen sc1
    s_branch L_at_E0_3b
L_at_E0_4:
    buffer_atomic_add v21, v22, s[28:31], 0 offen sc1
    s_branch L_at_E0_4b
L_at_E0_5:
    buffer_atomic_add v21, v22, s[28:31], 0 offen sc1
    s_branch L_at_E0_5b
L_at_E0_6:
    buffer_atomic_add v21, v22, s[28:31], 0 offen sc1
    s_branch L_at_E0_6b
L_at_E0_7:
    buffer_atomic_add v21, v22, s[28:31], 0 offen sc1
    s_branch L_at_E0_7b
L_at_E0_8:
    buffer_atomic_add v21, v22, s[28:31], 0 offen sc1
    s_branch L_at_E0_8b
L_at_E1_1:
    buffer_atomic_add v21, v22, s[28:31], 0 offen sc1
    s_branch L_at_E1_1b
L_at_E1_2:
    buffer_atomic_add v21, v22, s[28:31], 0 offen sc1
    s_branch L_at_E1_2b
L_at_E1_3:
    buffer_atomic_add v21, v22, s[28:31], 0 offen sc1
    s_branch L_at_E1_3b
L_at_E1_4:
    buffer_atomic_add v21, v22, s[28:31], 0 offen sc1
    s_branch L_at_E1_4b
L_at_E1_5:
    buffer_atomic_add v21, v22, s[28:31], 0 offen sc1
    s_branch L_at_E1_5b
L_at_E1_6:
    buffer_atomic_add v21, v22, s[28:31], 0 offen sc1
    s_branch L_at_E1_6b
L_at_E1_7:
    buffer_atomic_add v21, v22, s[28:31], 0 offen sc1
    s_branch L_at_E1_7b
L_at_E1_8:
    buffer_atomic_add v21, v22, s[28:31], 0 offen sc1
    s_branch L_at_E1_8b
L_ore0:
    s_sub_u32 s87, s87, 1
    s_cbranch_scc1 L_ook0
    buffer_load_dwordx4 v[104:107], v9, s[16:19], s86 offen offset:0 sc1
    buffer_load_dwordx4 v[108:111], v9, s[16:19], s98 offen offset:0 sc1
    s_waitcnt vmcnt(0)
    s_branch L_ov0
L_ore1:
    s_sub_u32 s87, s87, 1
    s_cbranch_scc1 L_ook1
    buffer_load_dwordx4 v[112:115], v9, s[16:19], s86 offen offset:1024 sc1
    buffer_load_dwordx4 v[116:119], v9, s[16:19], s98 offen offset:1024 sc1
    s_waitcnt vmcnt(0)
    s_branch L_ov1
L_ore2:
    s_sub_u32 s87, s87, 1
    s_cbranch_scc1 L_ook2
    buffer_load_dwordx4 v[120:123], v9, s[16:19], s86 offen offset:2048 sc1
    buffer_load_dwordx4 v[124:127], v9, s[16:19], s98 offen offset:2048 sc1
    s_waitcnt vmcnt(0)
    s_branch L_ov2
L_ore3:
    s_sub_u32 s87, s87, 1
    s_cbranch_scc1 L_ook3
    buffer_load_dwordx4 v[128:131], v9, s[16:19], s86 offen offset:3072 sc1
    buffer_load_dwordx4 v[132:135], v9, s[16:19], s98 offen offset:3072 sc1
    s_waitcnt vmcnt(0)
    s_branch L_ov3
L_ore4:
    s_sub_u32 s87, s87, 1
    s_cbranch_scc1 L_ook4
    buffer_load_dwordx2 v[136:137], v8, s[16:19], s82 offen offset:0 sc1
    buffer_load_dwordx2 v[138:139], v8, s[16:19], s82 offen offset:512 sc1
    buffer_load_dwordx2 v[140:141], v8, s[16:19], s83 offen offset:0 sc1
    buffer_load_dwordx2 v[142:143], v8, s[16:19], s83 offen offset:512 sc1
    s_waitcnt vmcnt(0)
    s_branch L_ov4
L_end:
    s_endpgm
.section .rodata,"a"
.p2align 6
.amdhsa_kernel gated_mix__mha_block__glu_gated_bilinear__prompt_kernel
  .amdhsa_next_free_vgpr 256
  .amdhsa_next_free_sgpr 102
  .amdhsa_accum_offset 256
  .amdhsa_group_segment_fixed_size 0
  .amdhsa_kernarg_size 88
  .amdhsa_user_sgpr_count 2
  .amdhsa_user_sgpr_kernarg_segment_ptr 1
  .amdhsa_system_sgpr_workgroup_id_x 1
.end_amdhsa_kernel
```
